```python
import torch

def _softmax(x, axis=-1):
    return torch.softmax(x, dim=axis)

def _gelu(x):
    return torch.nn.functional.gelu(x, approximate='tanh')

def _silu(x):
    return torch.nn.functional.silu(x)

def _sigmoid(x):
    return torch.sigmoid(x)

def _layernorm(x, axis=-1, eps=1e-05):
    m = x.mean(dim=axis, keepdim=True)
    v = x.var(dim=axis, keepdim=True, unbiased=False)
    return (x - m) / torch.sqrt(v + eps)

def _scatter_add(tgt, idx, src, axis=0):
    return tgt.clone().index_add_(axis, idx, src)

def _segment_sum(src, seg, n):
    out = torch.zeros((n,) + src.shape[1:], dtype=src.dtype)
    return out.index_add_(0, seg, src)

def _pad(x, pw):
    flat = tuple((v for pair in reversed(pw) for v in pair))
    return torch.nn.functional.pad(x, flat)
kernel_name = 'sequential_preLN__memory_aug_recurrent_mem_tr__swiglu_ffn__prompt'

def setup_inputs():

    _w = lambda a: (lambda t: t.to(torch.bfloat16) if t.is_floating_point() else t)(torch.as_tensor(a))

    def _A_setup():
        B, S, Dm = (1, 2048, 576)
        H, Dh = (32, 128)
        M, seg = (8, 32)
        seg = min(seg, S)
        S = S // seg * seg
        return {'x': _w((lambda *s: torch.randn(*s, dtype=torch.bfloat16) * 0.05)(B, S, Dm)), 'mem0': _w((lambda *s: torch.randn(*s, dtype=torch.bfloat16) * 0.2)(B, M, Dm)), 'Wq': _w((lambda *s: torch.randn(*s, dtype=torch.bfloat16) * 1.6)(Dm, H, Dh) * Dm ** (-0.5)), 'Wk': _w((lambda *s: torch.randn(*s, dtype=torch.bfloat16) * 1.6)(Dm, H, Dh) * Dm ** (-0.5)), 'Wv': _w((lambda *s: torch.randn(*s, dtype=torch.bfloat16) * 0.2)(Dm, H, Dh) * Dm ** (-0.5)), 'Wo': _w((lambda *s: torch.randn(*s, dtype=torch.bfloat16) * 0.2)(H, Dh, Dm) * (H * Dh) ** (-0.5)), 'seg_len': seg}
    _A_in = _A_setup()

    def _B_setup():
        B, S, D, F = (1, 2048, 576, 4608)
        return {'x': _w((lambda *s: torch.randn(*s, dtype=torch.bfloat16) * 0.05)(B, S, D)), 'w_gate': _w((lambda *s: torch.randn(*s, dtype=torch.bfloat16) * 0.05)(D, F)), 'w_up': _w((lambda *s: torch.randn(*s, dtype=torch.bfloat16) * 0.05)(D, F)), 'w_down': _w((lambda *s: torch.randn(*s, dtype=torch.bfloat16) * 0.05)(F, D))}
    _B_in = _B_setup()
    return {'A_x': _A_in['x'], 'A_mem0': _A_in['mem0'], 'A_Wq': _A_in['Wq'], 'A_Wk': _A_in['Wk'], 'A_Wv': _A_in['Wv'], 'A_Wo': _A_in['Wo'], 'A_seg_len': _A_in['seg_len'], 'B_x': _B_in['x'], 'B_w_gate': _B_in['w_gate'], 'B_w_up': _B_in['w_up'], 'B_w_down': _B_in['w_down']}

def reference(A_x, A_mem0, A_Wq, A_Wk, A_Wv, A_Wo, A_seg_len, B_x, B_w_gate, B_w_up, B_w_down):

    def _A_ref(x, mem0, Wq, Wk, Wv, Wo, seg_len):
        B, S, Dm = x.shape
        H, Dh = (Wq.shape[1], Wq.shape[2])
        M = mem0.shape[1]
        scale = Dh ** (-0.5)
        n_seg = S // seg_len
        L = M + seg_len
        idx = torch.arange(L)
        mask = (idx[:, None] < M) | (idx[:, None] >= idx[None, :])
        mem = mem0
        outs = []
        for s in range(n_seg):
            xs = x[:, s * seg_len:(s + 1) * seg_len, :].clone()
            h = torch.concatenate([mem, xs], axis=1)
            q = torch.einsum('btd,dhe->bhte', h, Wq)
            k = torch.einsum('btd,dhe->bhte', h, Wk)
            v = torch.einsum('btd,dhe->bhte', h, Wv)
            scores = torch.einsum('bhqe,bhke->bhqk', q, k) * scale
            scores = torch.where(mask[None, None], scores, -1000000000.0)
            p = _softmax(scores, axis=-1)
            o = torch.einsum('bhqk,bhke->bhqe', p, v)
            o = torch.einsum('bhte,hed->btd', o, Wo)
            mem = o[:, :M, :].clone()
            outs.append(o[:, M:, :])
        return torch.concatenate(outs, axis=1)

    def _B_ref(x, w_gate, w_up, w_down):
        g = _silu(x @ w_gate)
        u = x @ w_up
        return g * u @ w_down
    x = A_x
    h = x + _A_ref(_layernorm(x, axis=-1), A_mem0, A_Wq, A_Wk, A_Wv, A_Wo, A_seg_len)
    h2 = h + _B_ref(_layernorm(h, axis=-1), B_w_gate, B_w_up, B_w_down)
    return h2
```

```asm
; @launch grid=(256,1,1) block=(256,1,1) lds=163840
.amdgcn_target "amdgcn-amd-amdhsa--gfx950"
.text
.globl sequential_preLN__memory_aug_recurrent_mem_tr__swiglu_ffn__prompt_kernel
.p2align 8
.type sequential_preLN__memory_aug_recurrent_mem_tr__swiglu_ffn__prompt_kernel,@function
sequential_preLN__memory_aug_recurrent_mem_tr__swiglu_ffn__prompt_kernel:
  s_cmp_ge_u32 s2, 256
  s_cbranch_scc1 K_exit
  s_load_dwordx8 s[16:23], s[0:1], 0
  s_load_dwordx4 s[24:27], s[0:1], 32
  s_load_dwordx8 s[32:39], s[0:1], 64
  s_load_dwordx4 s[40:43], s[0:1], 96
  v_lshrrev_b32 v1, 6, v0
  s_nop 0
  v_readfirstlane_b32 s44, v1
  s_getreg_b32 s3, hwreg(HW_REG_XCC_ID, 0, 3)
  s_lshl_b32 s3, s3, 2
  s_lshr_b32 s3, 0x76540213, s3
  s_and_b32 s3, s3, 7
  s_lshr_b32 s45, s2, 3
  s_mov_b32 s75, 0
  s_waitcnt lgkmcnt(0)
  s_mov_b32 s4, s42
  s_mov_b32 s5, s43
  s_mov_b32 s6, 268435456
  s_mov_b32 s7, 0x20000
K_go:
  s_cmp_eq_u32 s3, 0
  s_cbranch_scc0 W_start
  v_and_b32 v12, 63, v0
  v_and_b32 v13, 15, v12
  v_lshrrev_b32 v14, 4, v12
  v_lshlrev_b32 v0, 4, v12
  v_mov_b32 v10, 0
  s_mul_i32 s55, s44, 34816
  s_add_u32 s55, s55, 24576
  v_add_u32 v1, s55, v0
  v_and_b32 v15, 1, v14
  v_lshrrev_b32 v16, 1, v14
  v_and_b32 v17, 3, v13
  v_lshrrev_b32 v18, 2, v13
  v_mul_u32_u24 v3, 144, v18
  v_lshl_add_u32 v3, v14, 5, v3
  v_lshl_add_u32 v3, v17, 2, v3
  s_mul_i32 s55, s44, 1152
  s_add_u32 s55, s55, 18432
  v_add_u32 v3, s55, v3
  v_and_b32 v4, 0xf0, v0
  v_mul_u32_u24 v2, 144, v14
  v_lshl_add_u32 v2, v18, 5, v2
  v_and_b32 v19, 1, v13
  v_lshl_add_u32 v2, v19, 4, v2
  v_lshrrev_b32 v19, 3, v12
  v_mul_u32_u24 v5, 2176, v19
  v_and_b32 v19, 7, v12
  v_lshl_add_u32 v5, v19, 3, v5
  v_mul_u32_u24 v7, 2176, v14
  v_lshl_add_u32 v7, v13, 2, v7
  v_mov_b32 v21, 0x88884444
  v_mov_b32 v22, 0xDDDDEEEE
  v_and_b32 v19, 2, v13
  v_cmp_eq_u32 vcc, 0, v19
  s_nop 1
  v_cndmask_b32 v8, v22, v21, vcc
  v_lshlrev_b32 v19, 4, v14
  v_lshl_add_u32 v19, v13, 2, v19
  v_mul_u32_u24 v20, 1152, v15
  v_lshl_add_u32 v20, v13, 3, v20
  v_lshl_add_u32 v20, v16, 2, v20
  v_mov_b32 v21, 1073741824
  v_cmp_gt_u32 vcc, 4, v13
  s_nop 1
  v_cndmask_b32 v28, v21, v19, vcc
  v_cndmask_b32 v20, v21, v20, vcc
  v_add_u32 v19, 32752, v19
  v_cmp_eq_u32 vcc, 9, v18
  s_nop 1
  v_cndmask_b32 v6, v28, v19, vcc
  s_lshr_b32 s55, s45, 3
  s_lshl_b32 s55, s55, 1
  s_and_b32 s56, s45, 1
  s_add_u32 s55, s55, s56
  s_lshl_b32 s56, s44, 3
  s_add_u32 s55, s55, s56
  s_bfe_u32 s56, s45, 0x20001
  s_lshl_b32 s48, s55, 8
  s_lshl_b32 s57, s56, 6
  s_add_u32 s48, s48, s57
  s_mul_i32 s56, s56, 2304
  s_lshl_b32 s55, s55, 5
  s_add_u32 s64, s55, s56
  s_lshl_b32 s49, s45, 6
  s_add_u32 s49, s49, 8192
  s_and_b32 s56, s45, 3
  s_mul_i32 s56, s56, 2304
  s_lshr_b32 s55, s45, 2
  s_lshl_b32 s55, s55, 5
  s_add_u32 s55, s55, s56
  s_add_u32 s65, s55, 1024
  s_add_u32 s55, s45, 128
  s_mul_i32 s51, s55, 2176
  s_add_u32 s51, s51, 15728640
  s_cmp_eq_u32 s44, 3
  s_cselect_b32 s55, 16, 0
  s_cmp_lt_u32 s45, s55
  s_cselect_b32 s49, s49, 1073741824
  s_cselect_b32 s51, s51, 1073741824
  s_lshl_b32 s55, s44, 5
  s_add_u32 s55, s55, s45
  s_mul_i32 s50, s55, 2176
  s_add_u32 s50, s50, 15728640
  s_lshl_b32 s56, s45, 6
  s_add_u32 s56, s56, 15728640
  s_mul_i32 s55, s44, 17408
  s_add_u32 s68, s55, s56
  s_add_u32 s69, s68, 69632
  s_add_u32 s70, s68, 139264
  s_add_u32 s71, s68, 208896
  s_mul_i32 s55, s44, 8704
  s_add_u32 s55, s55, s56
  s_add_u32 s72, s55, 278528
  s_add_u32 s55, s50, 69632
  s_add_u32 s56, s48, 2048
  s_cmp_eq_u32 s44, 3
  s_cselect_b32 s51, s51, s55
  s_cselect_b32 s49, s49, s56
  s_cmp_eq_u32 s44, 0
  s_cbranch_scc0 arr_1
  s_getreg_b32 s28, hwreg(HW_REG_XCC_ID, 0, 3)
  s_cmp_eq_u32 s75, 0
  s_cselect_b32 s28, s28, s2
  s_lshl_b32 s28, s28, 2
  s_lshl_b32 s28, 1, s28
  s_lshr_b32 s29, s2, 3
  s_lshl_b32 s29, s29, 2
  v_mov_b32 v24, s28
  s_lshl_b32 s28, s75, 7
  s_add_u32 s29, s29, s28
  v_mov_b32 v25, s29
  s_mov_b64 exec, 1
  global_atomic_add v25, v24, s[40:41] sc1
  s_mov_b64 exec, -1
arr_1:
  v_lshlrev_b32 v21, 2, v14
  v_xor_b32 v21, v21, v13
  v_lshlrev_b32 v21, 4, v21
  v_lshl_add_u32 v21, v14, 13, v21
  v_lshl_add_u32 v22, v15, 3, v18
  v_lshlrev_b32 v22, 8, v22
  v_xor_b32 v23, s44, v18
  v_lshl_add_u32 v22, v23, 6, v22
  v_lshrrev_b32 v23, 1, v17
  v_lshl_add_u32 v22, v23, 5, v22
  v_and_b32 v23, 1, v17
  v_lshl_add_u32 v22, v23, 3, v22
  v_mul_u32_u24 v23, 34816, v16
  v_add_u32 v22, v22, v23
  v_add_u32 v22, 24576, v22
  v_add_u32 v23, 69632, v22
  s_lshl_b32 s58, s45, 8
  s_lshl_b32 s55, s44, 17
  s_add_u32 s58, s58, s55
  s_mul_i32 s57, s44, 34816
  s_add_u32 s57, s57, 24576
  s_mov_b32 s8, s26
  s_mov_b32 s9, s27
  s_mov_b32 s10, 4718592
  s_mov_b32 s11, 0x20000
  v_lshl_add_u32 v19, v15, 1, v16
  v_mul_u32_u24 v19, 4608, v19
  v_lshl_add_u32 v19, v13, 2, v19
  v_add_u32 v20, 18432, v19
  s_mul_i32 s55, s45, 147456
  s_lshl_b32 s56, s44, 6
  s_add_u32 s55, s55, s56
  s_xor_b32 s56, s44, 0
  s_mul_i32 s56, s56, 36864
  s_add_u32 s64, s55, s56
  s_xor_b32 s56, s44, 1
  s_mul_i32 s56, s56, 36864
  s_add_u32 s65, s55, s56
  s_xor_b32 s56, s44, 2
  s_mul_i32 s56, s56, 36864
  s_add_u32 s66, s55, s56
  s_xor_b32 s56, s44, 3
  s_mul_i32 s56, s56, 36864
  s_add_u32 s67, s55, s56
  v_lshrrev_b32 v65, 1, v12
  v_mul_u32_u24 v65, 1152, v65
  v_and_b32 v66, 1, v12
  v_lshl_add_u32 v65, v66, 4, v65
  s_lshl_b32 s56, s44, 5
  s_sub_u32 s56, 1024, s56
  v_add_u32 v65, s56, v65
  v_lshlrev_b32 v66, 4, v16
  v_lshl_add_u32 v66, v15, 2, v66
  v_add_u32 v66, v66, v18
  v_lshlrev_b32 v66, 5, v66
  v_lshl_add_u32 v66, v17, 3, v66
  s_lshl_b32 s56, s44, 12
  v_add_u32 v66, s56, v66
  s_mov_b32 s12, s20
  s_mov_b32 s13, s21
  s_mov_b32 s14, 4718592
  s_mov_b32 s15, 0x20000
  s_add_u32 m0, s57, 0
  s_add_u32 s55, s58, 0
  buffer_load_dwordx4 v21, s[12:15], s55 offen lds
  s_add_u32 m0, s57, 1024
  s_add_u32 s55, s58, 32768
  buffer_load_dwordx4 v21, s[12:15], s55 offen lds
  s_add_u32 m0, s57, 2048
  s_add_u32 s55, s58, 65536
  buffer_load_dwordx4 v21, s[12:15], s55 offen lds
  s_add_u32 m0, s57, 3072
  s_add_u32 s55, s58, 98304
  buffer_load_dwordx4 v21, s[12:15], s55 offen lds
  buffer_load_dword v152, v19, s[8:11], s64 offen offset:0
  buffer_load_dword v153, v19, s[8:11], s64 offen offset:1152
  buffer_load_dword v154, v19, s[8:11], s64 offen offset:2304
  buffer_load_dword v155, v19, s[8:11], s64 offen offset:3456
  buffer_load_dword v156, v20, s[8:11], s64 offen offset:0
  s_add_u32 m0, s57, 4096
  s_add_u32 s55, s58, 524288
  buffer_load_dwordx4 v21, s[12:15], s55 offen lds
  s_add_u32 m0, s57, 5120
  s_add_u32 s55, s58, 557056
  buffer_load_dwordx4 v21, s[12:15], s55 offen lds
  s_add_u32 m0, s57, 6144
  s_add_u32 s55, s58, 589824
  buffer_load_dwordx4 v21, s[12:15], s55 offen lds
  s_add_u32 m0, s57, 7168
  s_add_u32 s55, s58, 622592
  buffer_load_dwordx4 v21, s[12:15], s55 offen lds
  buffer_load_dword v157, v20, s[8:11], s64 offen offset:1152
  buffer_load_dword v158, v20, s[8:11], s64 offen offset:2304
  buffer_load_dword v159, v20, s[8:11], s64 offen offset:3456
  buffer_load_dword v160, v19, s[8:11], s65 offen offset:0
  buffer_load_dword v161, v19, s[8:11], s65 offen offset:1152
  s_add_u32 m0, s57, 8192
  s_add_u32 s55, s58, 1048576
  buffer_load_dwordx4 v21, s[12:15], s55 offen lds
  s_add_u32 m0, s57, 9216
  s_add_u32 s55, s58, 1081344
  buffer_load_dwordx4 v21, s[12:15], s55 offen lds
  s_add_u32 m0, s57, 10240
  s_add_u32 s55, s58, 1114112
  buffer_load_dwordx4 v21, s[12:15], s55 offen lds
  s_add_u32 m0, s57, 11264
  s_add_u32 s55, s58, 1146880
  buffer_load_dwordx4 v21, s[12:15], s55 offen lds
  buffer_load_dword v162, v19, s[8:11], s65 offen offset:2304
  buffer_load_dword v163, v19, s[8:11], s65 offen offset:3456
  buffer_load_dword v164, v20, s[8:11], s65 offen offset:0
  buffer_load_dword v165, v20, s[8:11], s65 offen offset:1152
  buffer_load_dword v166, v20, s[8:11], s65 offen offset:2304
  s_add_u32 m0, s57, 12288
  s_add_u32 s55, s58, 1572864
  buffer_load_dwordx4 v21, s[12:15], s55 offen lds
  s_add_u32 m0, s57, 13312
  s_add_u32 s55, s58, 1605632
  buffer_load_dwordx4 v21, s[12:15], s55 offen lds
  s_add_u32 m0, s57, 14336
  s_add_u32 s55, s58, 1638400
  buffer_load_dwordx4 v21, s[12:15], s55 offen lds
  s_add_u32 m0, s57, 15360
  s_add_u32 s55, s58, 1671168
  buffer_load_dwordx4 v21, s[12:15], s55 offen lds
  buffer_load_dword v167, v20, s[8:11], s65 offen offset:3456
  buffer_load_dword v168, v19, s[8:11], s66 offen offset:0
  buffer_load_dword v169, v19, s[8:11], s66 offen offset:1152
  buffer_load_dword v170, v19, s[8:11], s66 offen offset:2304
  buffer_load_dword v171, v19, s[8:11], s66 offen offset:3456
  s_add_u32 m0, s57, 16384
  s_add_u32 s55, s58, 2097152
  buffer_load_dwordx4 v21, s[12:15], s55 offen lds
  s_add_u32 m0, s57, 17408
  s_add_u32 s55, s58, 2129920
  buffer_load_dwordx4 v21, s[12:15], s55 offen lds
  s_add_u32 m0, s57, 18432
  s_add_u32 s55, s58, 2162688
  buffer_load_dwordx4 v21, s[12:15], s55 offen lds
  s_add_u32 m0, s57, 19456
  s_add_u32 s55, s58, 2195456
  buffer_load_dwordx4 v21, s[12:15], s55 offen lds
  buffer_load_dword v172, v20, s[8:11], s66 offen offset:0
  buffer_load_dword v173, v20, s[8:11], s66 offen offset:1152
  buffer_load_dword v174, v20, s[8:11], s66 offen offset:2304
  buffer_load_dword v175, v20, s[8:11], s66 offen offset:3456
  buffer_load_dword v176, v19, s[8:11], s67 offen offset:0
  s_add_u32 m0, s57, 20480
  s_add_u32 s55, s58, 2621440
  buffer_load_dwordx4 v21, s[12:15], s55 offen lds
  s_add_u32 m0, s57, 21504
  s_add_u32 s55, s58, 2654208
  buffer_load_dwordx4 v21, s[12:15], s55 offen lds
  s_add_u32 m0, s57, 22528
  s_add_u32 s55, s58, 2686976
  buffer_load_dwordx4 v21, s[12:15], s55 offen lds
  s_add_u32 m0, s57, 23552
  s_add_u32 s55, s58, 2719744
  buffer_load_dwordx4 v21, s[12:15], s55 offen lds
  buffer_load_dword v177, v19, s[8:11], s67 offen offset:1152
  buffer_load_dword v178, v19, s[8:11], s67 offen offset:2304
  buffer_load_dword v179, v19, s[8:11], s67 offen offset:3456
  buffer_load_dword v180, v20, s[8:11], s67 offen offset:0
  buffer_load_dword v181, v20, s[8:11], s67 offen offset:1152
  s_add_u32 m0, s57, 24576
  s_add_u32 s55, s58, 3145728
  buffer_load_dwordx4 v21, s[12:15], s55 offen lds
  s_add_u32 m0, s57, 25600
  s_add_u32 s55, s58, 3178496
  buffer_load_dwordx4 v21, s[12:15], s55 offen lds
  s_add_u32 m0, s57, 26624
  s_add_u32 s55, s58, 3211264
  buffer_load_dwordx4 v21, s[12:15], s55 offen lds
  s_add_u32 m0, s57, 27648
  s_add_u32 s55, s58, 3244032
  buffer_load_dwordx4 v21, s[12:15], s55 offen lds
  buffer_load_dword v182, v20, s[8:11], s67 offen offset:2304
  buffer_load_dword v183, v20, s[8:11], s67 offen offset:3456
  buffer_load_dword v184, v19, s[8:11], s64 offen offset:256
  buffer_load_dword v185, v19, s[8:11], s64 offen offset:1408
  buffer_load_dword v186, v19, s[8:11], s64 offen offset:2560
  s_waitcnt vmcnt(59)
  s_waitcnt lgkmcnt(0)
  s_barrier
  s_add_u32 m0, s57, 28672
  s_add_u32 s55, s58, 4194304
  buffer_load_dwordx4 v21, s[12:15], s55 offen lds
  s_add_u32 m0, s57, 29696
  s_add_u32 s55, s58, 4227072
  buffer_load_dwordx4 v21, s[12:15], s55 offen lds
  s_add_u32 m0, s57, 30720
  s_add_u32 s55, s58, 4259840
  buffer_load_dwordx4 v21, s[12:15], s55 offen lds
  s_add_u32 m0, s57, 31744
  s_add_u32 s55, s58, 4292608
  buffer_load_dwordx4 v21, s[12:15], s55 offen lds
  buffer_load_dword v187, v19, s[8:11], s64 offen offset:3712
  buffer_load_dword v188, v20, s[8:11], s64 offen offset:256
  buffer_load_dword v189, v20, s[8:11], s64 offen offset:1408
  buffer_load_dword v190, v20, s[8:11], s64 offen offset:2560
  buffer_load_dword v191, v20, s[8:11], s64 offen offset:3712
  ds_read_b64_tr_b16 a[0:1], v22 offset:0
  ds_read_b64_tr_b16 a[2:3], v22 offset:1024
  ds_read_b64_tr_b16 a[4:5], v23 offset:0
  ds_read_b64_tr_b16 a[6:7], v23 offset:1024
  ds_read_b64_tr_b16 a[8:9], v22 offset:16
  ds_read_b64_tr_b16 a[10:11], v22 offset:1040
  ds_read_b64_tr_b16 a[12:13], v23 offset:16
  ds_read_b64_tr_b16 a[14:15], v23 offset:1040
  s_waitcnt vmcnt(59)
  s_waitcnt lgkmcnt(0)
  s_barrier
  s_mov_b32 s12, s24
  s_mov_b32 s13, s25
  s_mov_b32 s14, 4718592
  s_mov_b32 s15, 0x20000
  s_add_u32 m0, s57, 0
  s_add_u32 s55, s58, 0
  buffer_load_dwordx4 v21, s[12:15], s55 offen lds
  s_add_u32 m0, s57, 1024
  s_add_u32 s55, s58, 32768
  buffer_load_dwordx4 v21, s[12:15], s55 offen lds
  s_add_u32 m0, s57, 2048
  s_add_u32 s55, s58, 65536
  buffer_load_dwordx4 v21, s[12:15], s55 offen lds
  s_add_u32 m0, s57, 3072
  s_add_u32 s55, s58, 98304
  buffer_load_dwordx4 v21, s[12:15], s55 offen lds
  buffer_load_dword v192, v19, s[8:11], s65 offen offset:256
  buffer_load_dword v193, v19, s[8:11], s65 offen offset:1408
  buffer_load_dword v194, v19, s[8:11], s65 offen offset:2560
  buffer_load_dword v195, v19, s[8:11], s65 offen offset:3712
  buffer_load_dword v196, v20, s[8:11], s65 offen offset:256
  ds_read_b64_tr_b16 a[16:17], v22 offset:4096
  ds_read_b64_tr_b16 a[18:19], v22 offset:5120
  ds_read_b64_tr_b16 a[20:21], v23 offset:4096
  ds_read_b64_tr_b16 a[22:23], v23 offset:5120
  ds_read_b64_tr_b16 a[24:25], v22 offset:4112
  ds_read_b64_tr_b16 a[26:27], v22 offset:5136
  ds_read_b64_tr_b16 a[28:29], v23 offset:4112
  ds_read_b64_tr_b16 a[30:31], v23 offset:5136
  s_waitcnt vmcnt(59)
  s_waitcnt lgkmcnt(0)
  s_barrier
  s_add_u32 m0, s57, 4096
  s_add_u32 s55, s58, 524288
  buffer_load_dwordx4 v21, s[12:15], s55 offen lds
  s_add_u32 m0, s57, 5120
  s_add_u32 s55, s58, 557056
  buffer_load_dwordx4 v21, s[12:15], s55 offen lds
  s_add_u32 m0, s57, 6144
  s_add_u32 s55, s58, 589824
  buffer_load_dwordx4 v21, s[12:15], s55 offen lds
  s_add_u32 m0, s57, 7168
  s_add_u32 s55, s58, 622592
  buffer_load_dwordx4 v21, s[12:15], s55 offen lds
  buffer_load_dword v197, v20, s[8:11], s65 offen offset:1408
  buffer_load_dword v198, v20, s[8:11], s65 offen offset:2560
  buffer_load_dword v199, v20, s[8:11], s65 offen offset:3712
  buffer_load_dword v200, v19, s[8:11], s66 offen offset:256
  buffer_load_dword v201, v19, s[8:11], s66 offen offset:1408
  ds_read_b64_tr_b16 a[32:33], v22 offset:8192
  ds_read_b64_tr_b16 a[34:35], v22 offset:9216
  ds_read_b64_tr_b16 a[36:37], v23 offset:8192
  ds_read_b64_tr_b16 a[38:39], v23 offset:9216
  ds_read_b64_tr_b16 a[40:41], v22 offset:8208
  ds_read_b64_tr_b16 a[42:43], v22 offset:9232
  ds_read_b64_tr_b16 a[44:45], v23 offset:8208
  ds_read_b64_tr_b16 a[46:47], v23 offset:9232
  s_waitcnt vmcnt(59)
  s_waitcnt lgkmcnt(0)
  s_barrier
  s_add_u32 m0, s57, 8192
  s_add_u32 s55, s58, 1048576
  buffer_load_dwordx4 v21, s[12:15], s55 offen lds
  s_add_u32 m0, s57, 9216
  s_add_u32 s55, s58, 1081344
  buffer_load_dwordx4 v21, s[12:15], s55 offen lds
  s_add_u32 m0, s57, 10240
  s_add_u32 s55, s58, 1114112
  buffer_load_dwordx4 v21, s[12:15], s55 offen lds
  s_add_u32 m0, s57, 11264
  s_add_u32 s55, s58, 1146880
  buffer_load_dwordx4 v21, s[12:15], s55 offen lds
  buffer_load_dword v202, v19, s[8:11], s66 offen offset:2560
  buffer_load_dword v203, v19, s[8:11], s66 offen offset:3712
  buffer_load_dword v204, v20, s[8:11], s66 offen offset:256
  buffer_load_dword v205, v20, s[8:11], s66 offen offset:1408
  buffer_load_dword v206, v20, s[8:11], s66 offen offset:2560
  ds_read_b64_tr_b16 a[48:49], v22 offset:12288
  ds_read_b64_tr_b16 a[50:51], v22 offset:13312
  ds_read_b64_tr_b16 a[52:53], v23 offset:12288
  ds_read_b64_tr_b16 a[54:55], v23 offset:13312
  ds_read_b64_tr_b16 a[56:57], v22 offset:12304
  ds_read_b64_tr_b16 a[58:59], v22 offset:13328
  ds_read_b64_tr_b16 a[60:61], v23 offset:12304
  ds_read_b64_tr_b16 a[62:63], v23 offset:13328
  s_waitcnt vmcnt(59)
  s_waitcnt lgkmcnt(0)
  s_barrier
  s_add_u32 m0, s57, 12288
  s_add_u32 s55, s58, 1572864
  buffer_load_dwordx4 v21, s[12:15], s55 offen lds
  s_add_u32 m0, s57, 13312
  s_add_u32 s55, s58, 1605632
  buffer_load_dwordx4 v21, s[12:15], s55 offen lds
  s_add_u32 m0, s57, 14336
  s_add_u32 s55, s58, 1638400
  buffer_load_dwordx4 v21, s[12:15], s55 offen lds
  s_add_u32 m0, s57, 15360
  s_add_u32 s55, s58, 1671168
  buffer_load_dwordx4 v21, s[12:15], s55 offen lds
  buffer_load_dword v207, v20, s[8:11], s66 offen offset:3712
  buffer_load_dword v208, v19, s[8:11], s67 offen offset:256
  buffer_load_dword v209, v19, s[8:11], s67 offen offset:1408
  buffer_load_dword v210, v19, s[8:11], s67 offen offset:2560
  buffer_load_dword v211, v19, s[8:11], s67 offen offset:3712
  ds_read_b64_tr_b16 a[64:65], v22 offset:16384
  ds_read_b64_tr_b16 a[66:67], v22 offset:17408
  ds_read_b64_tr_b16 a[68:69], v23 offset:16384
  ds_read_b64_tr_b16 a[70:71], v23 offset:17408
  ds_read_b64_tr_b16 a[72:73], v22 offset:16400
  ds_read_b64_tr_b16 a[74:75], v22 offset:17424
  ds_read_b64_tr_b16 a[76:77], v23 offset:16400
  ds_read_b64_tr_b16 a[78:79], v23 offset:17424
  s_waitcnt vmcnt(59)
  s_waitcnt lgkmcnt(0)
  s_barrier
  s_add_u32 m0, s57, 16384
  s_add_u32 s55, s58, 2097152
  buffer_load_dwordx4 v21, s[12:15], s55 offen lds
  s_add_u32 m0, s57, 17408
  s_add_u32 s55, s58, 2129920
  buffer_load_dwordx4 v21, s[12:15], s55 offen lds
  s_add_u32 m0, s57, 18432
  s_add_u32 s55, s58, 2162688
  buffer_load_dwordx4 v21, s[12:15], s55 offen lds
  s_add_u32 m0, s57, 19456
  s_add_u32 s55, s58, 2195456
  buffer_load_dwordx4 v21, s[12:15], s55 offen lds
  buffer_load_dword v212, v20, s[8:11], s67 offen offset:256
  buffer_load_dword v213, v20, s[8:11], s67 offen offset:1408
  buffer_load_dword v214, v20, s[8:11], s67 offen offset:2560
  buffer_load_dword v215, v20, s[8:11], s67 offen offset:3712
  buffer_load_dword v24, v19, s[8:11], s64 offen offset:512
  ds_read_b64_tr_b16 a[80:81], v22 offset:20480
  ds_read_b64_tr_b16 a[82:83], v22 offset:21504
  ds_read_b64_tr_b16 a[84:85], v23 offset:20480
  ds_read_b64_tr_b16 a[86:87], v23 offset:21504
  ds_read_b64_tr_b16 a[88:89], v22 offset:20496
  ds_read_b64_tr_b16 a[90:91], v22 offset:21520
  ds_read_b64_tr_b16 a[92:93], v23 offset:20496
  ds_read_b64_tr_b16 a[94:95], v23 offset:21520
  s_waitcnt vmcnt(59)
  s_waitcnt lgkmcnt(0)
  s_barrier
  s_add_u32 m0, s57, 20480
  s_add_u32 s55, s58, 2621440
  buffer_load_dwordx4 v21, s[12:15], s55 offen lds
  s_add_u32 m0, s57, 21504
  s_add_u32 s55, s58, 2654208
  buffer_load_dwordx4 v21, s[12:15], s55 offen lds
  s_add_u32 m0, s57, 22528
  s_add_u32 s55, s58, 2686976
  buffer_load_dwordx4 v21, s[12:15], s55 offen lds
  s_add_u32 m0, s57, 23552
  s_add_u32 s55, s58, 2719744
  buffer_load_dwordx4 v21, s[12:15], s55 offen lds
  buffer_load_dword v25, v19, s[8:11], s64 offen offset:1664
  buffer_load_dword v26, v19, s[8:11], s64 offen offset:2816
  buffer_load_dword v27, v19, s[8:11], s64 offen offset:3968
  buffer_load_dword v28, v20, s[8:11], s64 offen offset:512
  buffer_load_dword v29, v20, s[8:11], s64 offen offset:1664
  ds_read_b64_tr_b16 a[96:97], v22 offset:24576
  ds_read_b64_tr_b16 a[98:99], v22 offset:25600
  ds_read_b64_tr_b16 a[100:101], v23 offset:24576
  ds_read_b64_tr_b16 a[102:103], v23 offset:25600
  ds_read_b64_tr_b16 a[104:105], v22 offset:24592
  ds_read_b64_tr_b16 a[106:107], v22 offset:25616
  ds_read_b64_tr_b16 a[108:109], v23 offset:24592
  ds_read_b64_tr_b16 a[110:111], v23 offset:25616
  s_waitcnt vmcnt(59)
  s_waitcnt lgkmcnt(0)
  s_barrier
  s_add_u32 m0, s57, 24576
  s_add_u32 s55, s58, 3145728
  buffer_load_dwordx4 v21, s[12:15], s55 offen lds
  s_add_u32 m0, s57, 25600
  s_add_u32 s55, s58, 3178496
  buffer_load_dwordx4 v21, s[12:15], s55 offen lds
  s_add_u32 m0, s57, 26624
  s_add_u32 s55, s58, 3211264
  buffer_load_dwordx4 v21, s[12:15], s55 offen lds
  s_add_u32 m0, s57, 27648
  s_add_u32 s55, s58, 3244032
  buffer_load_dwordx4 v21, s[12:15], s55 offen lds
  buffer_load_dword v30, v20, s[8:11], s64 offen offset:2816
  buffer_load_dword v31, v20, s[8:11], s64 offen offset:3968
  buffer_load_dword v40, v19, s[8:11], s65 offen offset:512
  buffer_load_dword v41, v19, s[8:11], s65 offen offset:1664
  buffer_load_dword v42, v19, s[8:11], s65 offen offset:2816
  ds_read_b64_tr_b16 a[112:113], v22 offset:28672
  ds_read_b64_tr_b16 a[114:115], v22 offset:29696
  ds_read_b64_tr_b16 a[116:117], v23 offset:28672
  ds_read_b64_tr_b16 a[118:119], v23 offset:29696
  ds_read_b64_tr_b16 a[120:121], v22 offset:28688
  ds_read_b64_tr_b16 a[122:123], v22 offset:29712
  ds_read_b64_tr_b16 a[124:125], v23 offset:28688
  ds_read_b64_tr_b16 a[126:127], v23 offset:29712
  s_waitcnt vmcnt(59)
  s_waitcnt lgkmcnt(0)
  s_barrier
  s_add_u32 m0, s57, 28672
  s_add_u32 s55, s58, 3670016
  buffer_load_dwordx4 v21, s[12:15], s55 offen lds
  s_add_u32 m0, s57, 29696
  s_add_u32 s55, s58, 3702784
  buffer_load_dwordx4 v21, s[12:15], s55 offen lds
  s_add_u32 m0, s57, 30720
  s_add_u32 s55, s58, 3735552
  buffer_load_dwordx4 v21, s[12:15], s55 offen lds
  s_add_u32 m0, s57, 31744
  s_add_u32 s55, s58, 3768320
  buffer_load_dwordx4 v21, s[12:15], s55 offen lds
  buffer_load_dword v43, v19, s[8:11], s65 offen offset:3968
  buffer_load_dword v44, v20, s[8:11], s65 offen offset:512
  buffer_load_dword v45, v20, s[8:11], s65 offen offset:1664
  buffer_load_dword v46, v20, s[8:11], s65 offen offset:2816
  buffer_load_dword v47, v20, s[8:11], s65 offen offset:3968
  ds_read_b64_tr_b16 a[192:193], v22 offset:0
  ds_read_b64_tr_b16 a[194:195], v22 offset:1024
  ds_read_b64_tr_b16 a[196:197], v23 offset:0
  ds_read_b64_tr_b16 a[198:199], v23 offset:1024
  ds_read_b64_tr_b16 a[200:201], v22 offset:16
  ds_read_b64_tr_b16 a[202:203], v22 offset:1040
  ds_read_b64_tr_b16 a[204:205], v23 offset:16
  ds_read_b64_tr_b16 a[206:207], v23 offset:1040
  s_waitcnt vmcnt(59)
  s_waitcnt lgkmcnt(0)
  s_barrier
  s_add_u32 m0, s57, 0
  s_add_u32 s55, s58, 4194304
  buffer_load_dwordx4 v21, s[12:15], s55 offen lds
  s_add_u32 m0, s57, 1024
  s_add_u32 s55, s58, 4227072
  buffer_load_dwordx4 v21, s[12:15], s55 offen lds
  s_add_u32 m0, s57, 2048
  s_add_u32 s55, s58, 4259840
  buffer_load_dwordx4 v21, s[12:15], s55 offen lds
  s_add_u32 m0, s57, 3072
  s_add_u32 s55, s58, 4292608
  buffer_load_dwordx4 v21, s[12:15], s55 offen lds
  buffer_load_dword v216, v19, s[8:11], s66 offen offset:512
  buffer_load_dword v217, v19, s[8:11], s66 offen offset:1664
  buffer_load_dword v218, v19, s[8:11], s66 offen offset:2816
  buffer_load_dword v219, v19, s[8:11], s66 offen offset:3968
  buffer_load_dword v220, v20, s[8:11], s66 offen offset:512
  ds_read_b64_tr_b16 a[208:209], v22 offset:4096
  ds_read_b64_tr_b16 a[210:211], v22 offset:5120
  ds_read_b64_tr_b16 a[212:213], v23 offset:4096
  ds_read_b64_tr_b16 a[214:215], v23 offset:5120
  ds_read_b64_tr_b16 a[216:217], v22 offset:4112
  ds_read_b64_tr_b16 a[218:219], v22 offset:5136
  ds_read_b64_tr_b16 a[220:221], v23 offset:4112
  ds_read_b64_tr_b16 a[222:223], v23 offset:5136
  s_waitcnt vmcnt(59)
  s_waitcnt lgkmcnt(0)
  s_barrier
  s_mov_b32 s12, s22
  s_mov_b32 s13, s23
  s_mov_b32 s14, 4718592
  s_mov_b32 s15, 0x20000
  s_add_u32 m0, s57, 4096
  s_add_u32 s55, s58, 0
  buffer_load_dwordx4 v21, s[12:15], s55 offen lds
  s_add_u32 m0, s57, 5120
  s_add_u32 s55, s58, 32768
  buffer_load_dwordx4 v21, s[12:15], s55 offen lds
  s_add_u32 m0, s57, 6144
  s_add_u32 s55, s58, 65536
  buffer_load_dwordx4 v21, s[12:15], s55 offen lds
  s_add_u32 m0, s57, 7168
  s_add_u32 s55, s58, 98304
  buffer_load_dwordx4 v21, s[12:15], s55 offen lds
  buffer_load_dword v221, v20, s[8:11], s66 offen offset:1664
  buffer_load_dword v222, v20, s[8:11], s66 offen offset:2816
  buffer_load_dword v223, v20, s[8:11], s66 offen offset:3968
  buffer_load_dword v48, v19, s[8:11], s67 offen offset:512
  buffer_load_dword v49, v19, s[8:11], s67 offen offset:1664
  ds_read_b64_tr_b16 a[224:225], v22 offset:8192
  ds_read_b64_tr_b16 a[226:227], v22 offset:9216
  ds_read_b64_tr_b16 a[228:229], v23 offset:8192
  ds_read_b64_tr_b16 a[230:231], v23 offset:9216
  ds_read_b64_tr_b16 a[232:233], v22 offset:8208
  ds_read_b64_tr_b16 a[234:235], v22 offset:9232
  ds_read_b64_tr_b16 a[236:237], v23 offset:8208
  ds_read_b64_tr_b16 a[238:239], v23 offset:9232
  s_waitcnt vmcnt(59)
  s_waitcnt lgkmcnt(0)
  s_barrier
  s_add_u32 m0, s57, 8192
  s_add_u32 s55, s58, 3145728
  buffer_load_dwordx4 v21, s[12:15], s55 offen lds
  s_add_u32 m0, s57, 9216
  s_add_u32 s55, s58, 3178496
  buffer_load_dwordx4 v21, s[12:15], s55 offen lds
  s_add_u32 m0, s57, 10240
  s_add_u32 s55, s58, 3211264
  buffer_load_dwordx4 v21, s[12:15], s55 offen lds
  s_add_u32 m0, s57, 11264
  s_add_u32 s55, s58, 3244032
  buffer_load_dwordx4 v21, s[12:15], s55 offen lds
  s_add_u32 m0, s56, 0
  s_nop 0
  buffer_load_dwordx4 v65, s[8:11], s64 offen lds
  s_add_u32 m0, s56, 1024
  s_nop 0
  buffer_load_dwordx4 v65, s[8:11], s65 offen lds
  s_add_u32 m0, s56, 2048
  s_nop 0
  buffer_load_dwordx4 v65, s[8:11], s66 offen lds
  s_add_u32 m0, s56, 3072
  s_nop 0
  buffer_load_dwordx4 v65, s[8:11], s67 offen lds
  buffer_load_dword v50, v19, s[8:11], s67 offen offset:2816
  buffer_load_dword v51, v19, s[8:11], s67 offen offset:3968
  buffer_load_dword v52, v20, s[8:11], s67 offen offset:512
  buffer_load_dword v53, v20, s[8:11], s67 offen offset:1664
  buffer_load_dword v54, v20, s[8:11], s67 offen offset:2816
  ds_read_b64_tr_b16 a[240:241], v22 offset:12288
  ds_read_b64_tr_b16 a[242:243], v22 offset:13312
  ds_read_b64_tr_b16 a[244:245], v23 offset:12288
  ds_read_b64_tr_b16 a[246:247], v23 offset:13312
  ds_read_b64_tr_b16 a[248:249], v22 offset:12304
  ds_read_b64_tr_b16 a[250:251], v22 offset:13328
  ds_read_b64_tr_b16 a[252:253], v23 offset:12304
  ds_read_b64_tr_b16 a[254:255], v23 offset:13328
  s_waitcnt vmcnt(63)
  s_waitcnt lgkmcnt(0)
  s_barrier
  s_add_u32 m0, s57, 12288
  s_add_u32 s55, s58, 3670016
  buffer_load_dwordx4 v21, s[12:15], s55 offen lds
  s_add_u32 m0, s57, 13312
  s_add_u32 s55, s58, 3702784
  buffer_load_dwordx4 v21, s[12:15], s55 offen lds
  s_add_u32 m0, s57, 14336
  s_add_u32 s55, s58, 3735552
  buffer_load_dwordx4 v21, s[12:15], s55 offen lds
  s_add_u32 m0, s57, 15360
  s_add_u32 s55, s58, 3768320
  buffer_load_dwordx4 v21, s[12:15], s55 offen lds
  buffer_load_dword v55, v20, s[8:11], s67 offen offset:3968
  v_add_u32 v19, 768, v19
  v_add_u32 v20, 768, v20
  buffer_load_dword v32, v19, s[8:11], s64 offen offset:0
  buffer_load_dword v33, v19, s[8:11], s64 offen offset:1152
  buffer_load_dword v34, v19, s[8:11], s64 offen offset:2304
  buffer_load_dword v35, v19, s[8:11], s64 offen offset:3456
  ds_read_b64_tr_b16 v[72:73], v22 offset:16384
  ds_read_b64_tr_b16 v[74:75], v22 offset:17408
  ds_read_b64_tr_b16 v[76:77], v23 offset:16384
  ds_read_b64_tr_b16 v[78:79], v23 offset:17408
  ds_read_b64_tr_b16 v[80:81], v22 offset:16400
  ds_read_b64_tr_b16 v[82:83], v22 offset:17424
  ds_read_b64_tr_b16 v[84:85], v23 offset:16400
  ds_read_b64_tr_b16 v[86:87], v23 offset:17424
  s_waitcnt vmcnt(63)
  s_waitcnt lgkmcnt(0)
  s_barrier
  s_add_u32 m0, s57, 16384
  s_add_u32 s55, s58, 4194304
  buffer_load_dwordx4 v21, s[12:15], s55 offen lds
  s_add_u32 m0, s57, 17408
  s_add_u32 s55, s58, 4227072
  buffer_load_dwordx4 v21, s[12:15], s55 offen lds
  s_add_u32 m0, s57, 18432
  s_add_u32 s55, s58, 4259840
  buffer_load_dwordx4 v21, s[12:15], s55 offen lds
  s_add_u32 m0, s57, 19456
  s_add_u32 s55, s58, 4292608
  buffer_load_dwordx4 v21, s[12:15], s55 offen lds
  buffer_load_dword v36, v20, s[8:11], s64 offen offset:0
  buffer_load_dword v37, v20, s[8:11], s64 offen offset:1152
  buffer_load_dword v38, v20, s[8:11], s64 offen offset:2304
  buffer_load_dword v39, v20, s[8:11], s64 offen offset:3456
  buffer_load_dword v224, v19, s[8:11], s65 offen offset:0
  ds_read_b64_tr_b16 v[88:89], v22 offset:20480
  ds_read_b64_tr_b16 v[90:91], v22 offset:21504
  ds_read_b64_tr_b16 v[92:93], v23 offset:20480
  ds_read_b64_tr_b16 v[94:95], v23 offset:21504
  ds_read_b64_tr_b16 v[96:97], v22 offset:20496
  ds_read_b64_tr_b16 v[98:99], v22 offset:21520
  ds_read_b64_tr_b16 v[100:101], v23 offset:20496
  ds_read_b64_tr_b16 v[102:103], v23 offset:21520
  s_waitcnt vmcnt(63)
  s_waitcnt lgkmcnt(0)
  s_barrier
  s_add_u32 m0, s57, 20480
  s_add_u32 s55, s58, 524288
  buffer_load_dwordx4 v21, s[12:15], s55 offen lds
  s_add_u32 m0, s57, 21504
  s_add_u32 s55, s58, 557056
  buffer_load_dwordx4 v21, s[12:15], s55 offen lds
  s_add_u32 m0, s57, 22528
  s_add_u32 s55, s58, 589824
  buffer_load_dwordx4 v21, s[12:15], s55 offen lds
  s_add_u32 m0, s57, 23552
  s_add_u32 s55, s58, 622592
  buffer_load_dwordx4 v21, s[12:15], s55 offen lds
  buffer_load_dword v225, v19, s[8:11], s65 offen offset:1152
  buffer_load_dword v226, v19, s[8:11], s65 offen offset:2304
  buffer_load_dword v227, v19, s[8:11], s65 offen offset:3456
  buffer_load_dword v228, v20, s[8:11], s65 offen offset:0
  buffer_load_dword v229, v20, s[8:11], s65 offen offset:1152
  ds_read_b64_tr_b16 v[104:105], v22 offset:24576
  ds_read_b64_tr_b16 v[106:107], v22 offset:25600
  ds_read_b64_tr_b16 v[108:109], v23 offset:24576
  ds_read_b64_tr_b16 v[110:111], v23 offset:25600
  ds_read_b64_tr_b16 v[112:113], v22 offset:24592
  ds_read_b64_tr_b16 v[114:115], v22 offset:25616
  ds_read_b64_tr_b16 v[116:117], v23 offset:24592
  ds_read_b64_tr_b16 v[118:119], v23 offset:25616
  s_waitcnt vmcnt(63)
  s_waitcnt lgkmcnt(0)
  s_barrier
  s_add_u32 m0, s57, 24576
  s_add_u32 s55, s58, 1048576
  buffer_load_dwordx4 v21, s[12:15], s55 offen lds
  s_add_u32 m0, s57, 25600
  s_add_u32 s55, s58, 1081344
  buffer_load_dwordx4 v21, s[12:15], s55 offen lds
  s_add_u32 m0, s57, 26624
  s_add_u32 s55, s58, 1114112
  buffer_load_dwordx4 v21, s[12:15], s55 offen lds
  s_add_u32 m0, s57, 27648
  s_add_u32 s55, s58, 1146880
  buffer_load_dwordx4 v21, s[12:15], s55 offen lds
  buffer_load_dword v230, v20, s[8:11], s65 offen offset:2304
  buffer_load_dword v231, v20, s[8:11], s65 offen offset:3456
  buffer_load_dword v232, v19, s[8:11], s66 offen offset:0
  buffer_load_dword v233, v19, s[8:11], s66 offen offset:1152
  buffer_load_dword v234, v19, s[8:11], s66 offen offset:2304
  ds_read_b64_tr_b16 v[120:121], v22 offset:28672
  ds_read_b64_tr_b16 v[122:123], v22 offset:29696
  ds_read_b64_tr_b16 v[124:125], v23 offset:28672
  ds_read_b64_tr_b16 v[126:127], v23 offset:29696
  ds_read_b64_tr_b16 v[128:129], v22 offset:28688
  ds_read_b64_tr_b16 v[130:131], v22 offset:29712
  ds_read_b64_tr_b16 v[132:133], v23 offset:28688
  ds_read_b64_tr_b16 v[134:135], v23 offset:29712
  v_bfe_u32 v18, v0, 4, 1
  v_xor_b32 v18, s45, v18
  v_lshlrev_b32 v18, 2, v18
  global_load_dword v9, v18, s[40:41] sc1
  s_waitcnt vmcnt(63)
  s_waitcnt lgkmcnt(0)
  s_barrier
  s_add_u32 m0, s57, 28672
  s_add_u32 s55, s58, 1572864
  buffer_load_dwordx4 v21, s[12:15], s55 offen lds
  s_add_u32 m0, s57, 29696
  s_add_u32 s55, s58, 1605632
  buffer_load_dwordx4 v21, s[12:15], s55 offen lds
  s_add_u32 m0, s57, 30720
  s_add_u32 s55, s58, 1638400
  buffer_load_dwordx4 v21, s[12:15], s55 offen lds
  s_add_u32 m0, s57, 31744
  s_add_u32 s55, s58, 1671168
  buffer_load_dwordx4 v21, s[12:15], s55 offen lds
  buffer_load_dword v235, v19, s[8:11], s66 offen offset:3456
  buffer_load_dword v236, v20, s[8:11], s66 offen offset:0
  buffer_load_dword v237, v20, s[8:11], s66 offen offset:1152
  buffer_load_dword v238, v20, s[8:11], s66 offen offset:2304
  buffer_load_dword v239, v20, s[8:11], s66 offen offset:3456
  ds_read_b64_tr_b16 v[136:137], v22 offset:0
  ds_read_b64_tr_b16 v[138:139], v22 offset:1024
  ds_read_b64_tr_b16 v[140:141], v23 offset:0
  ds_read_b64_tr_b16 v[142:143], v23 offset:1024
  ds_read_b64_tr_b16 v[144:145], v22 offset:16
  ds_read_b64_tr_b16 v[146:147], v22 offset:1040
  ds_read_b64_tr_b16 v[148:149], v23 offset:16
  ds_read_b64_tr_b16 v[150:151], v23 offset:1040
  s_waitcnt vmcnt(63)
  s_waitcnt lgkmcnt(0)
  s_barrier
  s_add_u32 m0, s57, 0
  s_add_u32 s55, s58, 2097152
  buffer_load_dwordx4 v21, s[12:15], s55 offen lds
  s_add_u32 m0, s57, 1024
  s_add_u32 s55, s58, 2129920
  buffer_load_dwordx4 v21, s[12:15], s55 offen lds
  s_add_u32 m0, s57, 2048
  s_add_u32 s55, s58, 2162688
  buffer_load_dwordx4 v21, s[12:15], s55 offen lds
  s_add_u32 m0, s57, 3072
  s_add_u32 s55, s58, 2195456
  buffer_load_dwordx4 v21, s[12:15], s55 offen lds
  buffer_load_dword v56, v19, s[8:11], s67 offen offset:0
  buffer_load_dword v57, v19, s[8:11], s67 offen offset:1152
  buffer_load_dword v58, v19, s[8:11], s67 offen offset:2304
  buffer_load_dword v59, v19, s[8:11], s67 offen offset:3456
  buffer_load_dword v60, v20, s[8:11], s67 offen offset:0
  ds_read_b64_tr_b16 a[128:129], v22 offset:4096
  ds_read_b64_tr_b16 a[130:131], v22 offset:5120
  ds_read_b64_tr_b16 a[132:133], v23 offset:4096
  ds_read_b64_tr_b16 a[134:135], v23 offset:5120
  ds_read_b64_tr_b16 a[136:137], v22 offset:4112
  ds_read_b64_tr_b16 a[138:139], v22 offset:5136
  ds_read_b64_tr_b16 a[140:141], v23 offset:4112
  ds_read_b64_tr_b16 a[142:143], v23 offset:5136
  s_waitcnt vmcnt(63)
  s_waitcnt lgkmcnt(0)
  s_barrier
  s_add_u32 m0, s57, 4096
  s_add_u32 s55, s58, 2621440
  buffer_load_dwordx4 v21, s[12:15], s55 offen lds
  s_add_u32 m0, s57, 5120
  s_add_u32 s55, s58, 2654208
  buffer_load_dwordx4 v21, s[12:15], s55 offen lds
  s_add_u32 m0, s57, 6144
  s_add_u32 s55, s58, 2686976
  buffer_load_dwordx4 v21, s[12:15], s55 offen lds
  s_add_u32 m0, s57, 7168
  s_add_u32 s55, s58, 2719744
  buffer_load_dwordx4 v21, s[12:15], s55 offen lds
  buffer_load_dword v61, v20, s[8:11], s67 offen offset:1152
  buffer_load_dword v62, v20, s[8:11], s67 offen offset:2304
  buffer_load_dword v63, v20, s[8:11], s67 offen offset:3456
  ds_read_b64_tr_b16 a[144:145], v22 offset:8192
  ds_read_b64_tr_b16 a[146:147], v22 offset:9216
  ds_read_b64_tr_b16 a[148:149], v23 offset:8192
  ds_read_b64_tr_b16 a[150:151], v23 offset:9216
  ds_read_b64_tr_b16 a[152:153], v22 offset:8208
  ds_read_b64_tr_b16 a[154:155], v22 offset:9232
  ds_read_b64_tr_b16 a[156:157], v23 offset:8208
  ds_read_b64_tr_b16 a[158:159], v23 offset:9232
  s_waitcnt vmcnt(58)
  s_waitcnt lgkmcnt(0)
  s_barrier
  s_mov_b32 s12, s20
  s_mov_b32 s13, s21
  s_mov_b32 s14, 4718592
  s_mov_b32 s15, 0x20000
  s_add_u32 m0, s57, 8192
  s_add_u32 s55, s58, 3670016
  buffer_load_dwordx4 v21, s[12:15], s55 offen lds
  s_add_u32 m0, s57, 9216
  s_add_u32 s55, s58, 3702784
  buffer_load_dwordx4 v21, s[12:15], s55 offen lds
  s_add_u32 m0, s57, 10240
  s_add_u32 s55, s58, 3735552
  buffer_load_dwordx4 v21, s[12:15], s55 offen lds
  s_add_u32 m0, s57, 11264
  s_add_u32 s55, s58, 3768320
  buffer_load_dwordx4 v21, s[12:15], s55 offen lds
  ds_read_b64_tr_b16 a[160:161], v22 offset:12288
  ds_read_b64_tr_b16 a[162:163], v22 offset:13312
  ds_read_b64_tr_b16 a[164:165], v23 offset:12288
  ds_read_b64_tr_b16 a[166:167], v23 offset:13312
  ds_read_b64_tr_b16 a[168:169], v22 offset:12304
  ds_read_b64_tr_b16 a[170:171], v22 offset:13328
  ds_read_b64_tr_b16 a[172:173], v23 offset:12304
  ds_read_b64_tr_b16 a[174:175], v23 offset:13328
  s_waitcnt vmcnt(53)
  s_waitcnt lgkmcnt(0)
  s_barrier
  ds_read_b64_tr_b16 a[176:177], v22 offset:16384
  ds_read_b64_tr_b16 a[178:179], v22 offset:17408
  ds_read_b64_tr_b16 a[180:181], v23 offset:16384
  ds_read_b64_tr_b16 a[182:183], v23 offset:17408
  ds_read_b64_tr_b16 a[184:185], v22 offset:16400
  ds_read_b64_tr_b16 a[186:187], v22 offset:17424
  ds_read_b64_tr_b16 a[188:189], v23 offset:16400
  ds_read_b64_tr_b16 a[190:191], v23 offset:17424
  ds_read_b64_tr_b16 v[240:241], v66 offset:0
  ds_read_b64_tr_b16 v[242:243], v66 offset:256
  ds_read_b64_tr_b16 v[244:245], v66 offset:1024
  ds_read_b64_tr_b16 v[246:247], v66 offset:1280
  ds_read_b64_tr_b16 v[248:249], v66 offset:2048
  ds_read_b64_tr_b16 v[250:251], v66 offset:2304
  ds_read_b64_tr_b16 v[252:253], v66 offset:3072
  ds_read_b64_tr_b16 v[254:255], v66 offset:3328
  s_waitcnt vmcnt(44)
  s_waitcnt lgkmcnt(0)
  s_barrier
  ds_read_b64_tr_b16 v[12:13], v22 offset:20480
  ds_read_b64_tr_b16 v[14:15], v22 offset:21504
  ds_read_b64_tr_b16 v[68:69], v23 offset:20480
  ds_read_b64_tr_b16 v[70:71], v23 offset:21504
  s_waitcnt lgkmcnt(2)
  ds_write_b128 v1, v[12:15] offset:16384
  s_waitcnt lgkmcnt(1)
  ds_write_b128 v1, v[68:71] offset:17408
  s_waitcnt lgkmcnt(0)
  ds_read_b64_tr_b16 v[12:13], v22 offset:20496
  ds_read_b64_tr_b16 v[14:15], v22 offset:21520
  ds_read_b64_tr_b16 v[68:69], v23 offset:20496
  ds_read_b64_tr_b16 v[70:71], v23 offset:21520
  s_waitcnt lgkmcnt(2)
  ds_write_b128 v1, v[12:15] offset:18432
  s_waitcnt lgkmcnt(1)
  ds_write_b128 v1, v[68:71] offset:19456
  s_waitcnt lgkmcnt(0)
  s_waitcnt vmcnt(35)
  s_waitcnt lgkmcnt(0)
  s_barrier
  ds_read_b64_tr_b16 v[12:13], v22 offset:24576
  ds_read_b64_tr_b16 v[14:15], v22 offset:25600
  ds_read_b64_tr_b16 v[68:69], v23 offset:24576
  ds_read_b64_tr_b16 v[70:71], v23 offset:25600
  s_waitcnt lgkmcnt(2)
  ds_write_b128 v1, v[12:15] offset:20480
  s_waitcnt lgkmcnt(1)
  ds_write_b128 v1, v[68:71] offset:21504
  s_waitcnt lgkmcnt(0)
  ds_read_b64_tr_b16 v[12:13], v22 offset:24592
  ds_read_b64_tr_b16 v[14:15], v22 offset:25616
  ds_read_b64_tr_b16 v[68:69], v23 offset:24592
  ds_read_b64_tr_b16 v[70:71], v23 offset:25616
  s_waitcnt lgkmcnt(2)
  ds_write_b128 v1, v[12:15] offset:22528
  s_waitcnt lgkmcnt(1)
  ds_write_b128 v1, v[68:71] offset:23552
  s_waitcnt lgkmcnt(0)
  s_waitcnt vmcnt(25)
  s_waitcnt lgkmcnt(0)
  s_barrier
  ds_read_b64_tr_b16 v[12:13], v22 offset:28672
  ds_read_b64_tr_b16 v[14:15], v22 offset:29696
  ds_read_b64_tr_b16 v[68:69], v23 offset:28672
  ds_read_b64_tr_b16 v[70:71], v23 offset:29696
  s_waitcnt lgkmcnt(2)
  ds_write_b128 v1, v[12:15] offset:24576
  s_waitcnt lgkmcnt(1)
  ds_write_b128 v1, v[68:71] offset:25600
  s_waitcnt lgkmcnt(0)
  ds_read_b64_tr_b16 v[12:13], v22 offset:28688
  ds_read_b64_tr_b16 v[14:15], v22 offset:29712
  ds_read_b64_tr_b16 v[68:69], v23 offset:28688
  ds_read_b64_tr_b16 v[70:71], v23 offset:29712
  s_waitcnt lgkmcnt(2)
  ds_write_b128 v1, v[12:15] offset:26624
  s_waitcnt lgkmcnt(1)
  ds_write_b128 v1, v[68:71] offset:27648
  s_waitcnt lgkmcnt(0)
  s_waitcnt vmcnt(16)
  s_waitcnt lgkmcnt(0)
  s_barrier
  ds_read_b64_tr_b16 v[12:13], v22 offset:0
  ds_read_b64_tr_b16 v[14:15], v22 offset:1024
  ds_read_b64_tr_b16 v[68:69], v23 offset:0
  ds_read_b64_tr_b16 v[70:71], v23 offset:1024
  s_waitcnt lgkmcnt(2)
  ds_write_b128 v1, v[12:15] offset:28672
  s_waitcnt lgkmcnt(1)
  ds_write_b128 v1, v[68:71] offset:29696
  s_waitcnt lgkmcnt(0)
  ds_read_b64_tr_b16 v[12:13], v22 offset:16
  ds_read_b64_tr_b16 v[14:15], v22 offset:1040
  ds_read_b64_tr_b16 v[68:69], v23 offset:16
  ds_read_b64_tr_b16 v[70:71], v23 offset:1040
  s_waitcnt lgkmcnt(2)
  ds_write_b128 v1, v[12:15] offset:30720
  s_waitcnt lgkmcnt(1)
  ds_write_b128 v1, v[68:71] offset:31744
  s_waitcnt lgkmcnt(0)
  v_mbcnt_lo_u32_b32 v16, -1, 0
  v_and_b32 v16, 31, v16
  v_lshlrev_b32 v16, 2, v16
  v_lshl_add_u32 v16, s75, 7, v16
  global_load_dword v17, v16, s[40:41] sc1
  v_lshlrev_b32 v18, 4, v18
  v_add_u32 v9, s75, v9
  buffer_load_dword v11, v18, s[4:7], 0 offen sc1
  s_waitcnt vmcnt(9)
  s_waitcnt lgkmcnt(0)
  s_barrier
  ds_read_b64_tr_b16 v[12:13], v22 offset:4096
  ds_read_b64_tr_b16 v[14:15], v22 offset:5120
  ds_read_b64_tr_b16 v[68:69], v23 offset:4096
  ds_read_b64_tr_b16 v[70:71], v23 offset:5120
  s_waitcnt lgkmcnt(2)
  ds_write_b128 v1, v[12:15] offset:0
  s_waitcnt lgkmcnt(1)
  ds_write_b128 v1, v[68:71] offset:1024
  s_waitcnt lgkmcnt(0)
  ds_read_b64_tr_b16 v[12:13], v22 offset:4112
  ds_read_b64_tr_b16 v[14:15], v22 offset:5136
  ds_read_b64_tr_b16 v[68:69], v23 offset:4112
  ds_read_b64_tr_b16 v[70:71], v23 offset:5136
  s_waitcnt lgkmcnt(2)
  ds_write_b128 v1, v[12:15] offset:2048
  s_waitcnt lgkmcnt(1)
  ds_write_b128 v1, v[68:71] offset:3072
  s_waitcnt lgkmcnt(0)
  s_waitcnt vmcnt(2)
  s_waitcnt lgkmcnt(0)
  s_barrier
  ds_read_b64_tr_b16 v[12:13], v22 offset:8192
  ds_read_b64_tr_b16 v[14:15], v22 offset:9216
  ds_read_b64_tr_b16 v[68:69], v23 offset:8192
  ds_read_b64_tr_b16 v[70:71], v23 offset:9216
  s_waitcnt lgkmcnt(2)
  ds_write_b128 v1, v[12:15] offset:4096
  s_waitcnt lgkmcnt(1)
  ds_write_b128 v1, v[68:71] offset:5120
  s_waitcnt lgkmcnt(0)
  ds_read_b64_tr_b16 v[12:13], v22 offset:8208
  ds_read_b64_tr_b16 v[14:15], v22 offset:9232
  ds_read_b64_tr_b16 v[68:69], v23 offset:8208
  ds_read_b64_tr_b16 v[70:71], v23 offset:9232
  s_waitcnt lgkmcnt(2)
  ds_write_b128 v1, v[12:15] offset:6144
  s_waitcnt lgkmcnt(1)
  ds_write_b128 v1, v[68:71] offset:7168
  s_waitcnt lgkmcnt(0)
  s_waitcnt vmcnt(0)
  s_barrier
  v_cmp_eq_u32 vcc, 0x11111111, v9
  s_nop 1
  v_cndmask_b32 v11, 0, v11, vcc
  s_nop 0
  v_readlane_b32 s60, v11, 0
  v_readlane_b32 s64, v11, 1
  ds_write_b128 v1, v[24:27] offset:8192
  ds_write_b128 v1, v[28:31] offset:9216
  ds_write_b128 v1, v[32:35] offset:10240
  ds_write_b128 v1, v[36:39] offset:11264
  ds_write_b128 v1, v[40:43] offset:12288
  ds_write_b128 v1, v[44:47] offset:13312
  ds_write_b128 v1, v[48:51] offset:14336
  ds_write_b128 v1, v[52:55] offset:15360
  ds_write_b128 v1, v[56:59] offset:32768
  ds_write_b128 v1, v[60:63] offset:33792
  s_waitcnt lgkmcnt(0)
  s_cmp_gt_u32 s60, 1
  s_cbranch_scc1 R_ok
  s_mov_b32 s54, 0x40000
  s_mov_b32 s55, 0x11111111
  s_branch gb_29_c
gb_29:
  s_sleep 8
gb_29_l:
  v_mbcnt_lo_u32_b32 v16, -1, 0
  v_and_b32 v16, 31, v16
  v_lshlrev_b32 v16, 2, v16
  v_lshl_add_u32 v16, s75, 7, v16
  global_load_dword v17, v16, s[40:41] sc1
  s_sub_u32 s54, s54, 1
  s_cbranch_scc1 K_end
  s_waitcnt vmcnt(0)
gb_29_c:
  v_mul_lo_u32 v18, v17, s55
  v_cmp_le_i32 vcc, 0, v18
  s_cbranch_vccnz gb_29
  v_cmp_ne_u32 vcc, s55, v17
  s_cmp_lg_u64 vcc, 0
  s_cselect_b32 s55, 1, 0
  s_cmp_gt_u32 s55, s75
  s_cbranch_scc1 K_again
R_ok:
  s_mov_b32 s46, 0
  s_mov_b32 s47, 100663296
  s_lshl_b32 s55, s45, 14
  s_lshl_b32 s56, s44, 12
  s_add_u32 s52, s55, s56
  s_add_u32 s52, s52, 58720000
  s_mov_b32 s21, 524544
  s_mov_b32 s20, -1
  s_mov_b32 s24, -1
  s_cmp_lg_u32 s51, 1073741824
  s_cselect_b32 s18, 1, 0
  s_lshl_b32 s23, s45, 12
  s_add_u32 s23, s23, 100171520
  s_cmp_lt_u32 s45, 2
  s_cselect_b32 s23, s23, 1073741824
  s_mul_i32 s55, s44, 4352
  s_mov_b32 m0, s55
  s_lshl_b32 s53, s45, 12
  s_lshl_b32 s59, s45, 6
  s_mov_b32 s61, 2048
  s_cmp_eq_u32 s45, 31
  s_cselect_b32 s61, s61, 1073741824
  s_add_u32 s53, s53, 4194304
  s_mov_b32 s58, 0x3e0293ee
  s_mov_b32 s62, 0x3f803f80
  s_mov_b32 s63, 0x3f803f80
  s_mov_b32 s54, 0x40000
  v_mov_b32 v9, 0x3f80
  s_mov_b32 vcc_lo, 0xaaaaaaaa
  s_mov_b32 vcc_hi, 0xaaaaaaaa
  v_cndmask_b32 v9, v9, 1.0, vcc
  s_mov_b32 vcc_lo, 0xf000f
  s_mov_b32 vcc_hi, 0xf000f
  v_cndmask_b32 v64, 0, v9, vcc
  s_mov_b32 vcc_lo, 0xf000f0
  s_mov_b32 vcc_hi, 0xf000f0
  v_cndmask_b32 v65, 0, v9, vcc
  s_mov_b32 vcc_lo, 0xf000f00
  s_mov_b32 vcc_hi, 0xf000f00
  v_cndmask_b32 v66, 0, v9, vcc
  s_mov_b32 vcc_lo, 0xf000f000
  s_mov_b32 vcc_hi, 0xf000f000
  v_cndmask_b32 v67, 0, v9, vcc
  v_mov_b32 v9, 0x3f80
  s_mov_b32 vcc_lo, 0xf0f0f0f0
  s_mov_b32 vcc_hi, 0xf0f0f0f0
  v_cndmask_b32 v9, v9, 1.0, vcc
  s_mov_b32 vcc_lo, 0x550055
  s_mov_b32 vcc_hi, 0x550055
  v_cndmask_b32 v68, 0, v9, vcc
  s_mov_b32 vcc_lo, 0xaa00aa
  s_mov_b32 vcc_hi, 0xaa00aa
  v_cndmask_b32 v69, 0, v9, vcc
  s_mov_b32 vcc_lo, 0x55005500
  s_mov_b32 vcc_hi, 0x55005500
  v_cndmask_b32 v70, 0, v9, vcc
  s_mov_b32 vcc_lo, 0xaa00aa00
  s_mov_b32 vcc_hi, 0xaa00aa00
  v_cndmask_b32 v71, 0, v9, vcc
  ds_write_b128 v4, v[64:67] offset:23040
  ds_write_b128 v4, v[68:71] offset:23296
  ds_write_b128 v0, v[4:7] offset:23552
  s_waitcnt lgkmcnt(0)
  s_cmp_eq_u32 s75, 0
  s_cbranch_scc0 RF_disp
  s_cmp_eq_u32 s44, 0
  s_cbranch_scc1 R0_in
  s_cmp_eq_u32 s44, 1
  s_cbranch_scc1 R1_in
  s_cmp_eq_u32 s44, 2
  s_cbranch_scc1 R2_in
  s_branch R3_in
R0_go:
  s_waitcnt vmcnt(3)
R0_go2:
  v_cmp_eq_u32 vcc, -1, v15
  v_smfmac_f32_16x16x64_bf16 v[24:27], v[12:15], a[0:7], v8
  ds_read_b128 v[40:43], v1 offset:16384
  v_smfmac_f32_16x16x64_bf16 v[28:31], v[12:15], a[8:15], v8
  s_cbranch_vccnz R0_f0
  v_smfmac_f32_16x16x64_bf16 v[32:35], v[12:15], a[128:135], v8
  ds_read_b128 v[44:47], v1 offset:17408
  v_smfmac_f32_16x16x64_bf16 v[36:39], v[12:15], a[136:143], v8
  ds_read_b128 v[48:51], v1 offset:18432
  s_waitcnt vmcnt(2)
  v_cmp_eq_u32 vcc, -1, v19
  v_smfmac_f32_16x16x64_bf16 v[64:67], v[12:15], a[192:199], v8
  ds_read_b128 v[52:55], v1 offset:19456
  v_smfmac_f32_16x16x64_bf16 v[68:71], v[12:15], a[200:207], v8
  s_cbranch_vccnz R0_c1
R0_g1:
  v_smfmac_f32_16x16x64_bf16 v[24:27], v[16:19], a[16:23], v8
  buffer_load_dwordx4 v[60:63], v0, s[4:7], s16 offen offset:0
  s_waitcnt lgkmcnt(2)
  v_smfmac_f32_16x16x64_bf16 v[32:35], v[16:19], v[40:47], v8
  ds_read_b128 v[40:43], v1 offset:20480
  buffer_load_dwordx4 v[12:15], v0, s[4:7], s16 offen offset:1024
  v_smfmac_f32_16x16x64_bf16 v[28:31], v[16:19], a[24:31], v8
  ds_read_b128 v[44:47], v1 offset:21504
  s_waitcnt lgkmcnt(2)
  v_smfmac_f32_16x16x64_bf16 v[36:39], v[16:19], v[48:55], v8
  ds_read_b128 v[48:51], v1 offset:22528
  s_waitcnt vmcnt(3)
  v_cmp_eq_u32 vcc, -1, v23
  v_smfmac_f32_16x16x64_bf16 v[64:67], v[16:19], a[208:215], v8
  ds_read_b128 v[52:55], v1 offset:23552
  v_smfmac_f32_16x16x64_bf16 v[68:71], v[16:19], a[216:223], v8
  s_cbranch_vccnz R0_c2
R0_g2:
  v_smfmac_f32_16x16x64_bf16 v[24:27], v[20:23], a[32:39], v8
  buffer_load_dwordx4 v0, s[4:7], s52 offen offset:256 sc1 lds
  s_waitcnt lgkmcnt(2)
  v_smfmac_f32_16x16x64_bf16 v[32:35], v[20:23], v[40:47], v8
  ds_read_b128 v[40:43], v1 offset:24576
  v_smfmac_f32_16x16x64_bf16 v[28:31], v[20:23], a[40:47], v8
  ds_read_b128 v[44:47], v1 offset:25600
  buffer_load_dwordx4 v[16:19], v0, s[4:7], s16 offen offset:2048
  s_waitcnt lgkmcnt(2)
  v_smfmac_f32_16x16x64_bf16 v[36:39], v[20:23], v[48:55], v8
  ds_read_b128 v[48:51], v1 offset:26624
  s_waitcnt vmcnt(4)
  v_cmp_eq_u32 vcc, -1, v59
  v_smfmac_f32_16x16x64_bf16 v[64:67], v[20:23], a[224:231], v8
  ds_read_b128 v[52:55], v1 offset:27648
  buffer_load_dwordx4 v[4:7], v0, s[4:7], s17 offen offset:0
  v_smfmac_f32_16x16x64_bf16 v[68:71], v[20:23], a[232:239], v8
  s_cbranch_vccnz R0_c3
R0_g3:
  v_smfmac_f32_16x16x64_bf16 v[24:27], v[56:59], a[48:55], v8
  buffer_load_dwordx4 v[20:23], v0, s[4:7], s16 offen offset:3072
  s_waitcnt lgkmcnt(2)
  v_smfmac_f32_16x16x64_bf16 v[32:35], v[56:59], v[40:47], v8
  ds_read_b128 v[40:43], v1 offset:28672
  buffer_load_dwordx4 v0, s[4:7], s52 offen offset:1280 sc1 lds
  v_smfmac_f32_16x16x64_bf16 v[28:31], v[56:59], a[56:63], v8
  ds_read_b128 v[44:47], v1 offset:29696
  s_waitcnt lgkmcnt(2)
  v_smfmac_f32_16x16x64_bf16 v[36:39], v[56:59], v[48:55], v8
  ds_read_b128 v[48:51], v1 offset:30720
  s_waitcnt vmcnt(5)
  v_cmp_u_f32 vcc, v63, v15
  v_smfmac_f32_16x16x64_bf16 v[64:67], v[56:59], a[240:247], v8
  ds_read_b128 v[52:55], v1 offset:31744
  v_smfmac_f32_16x16x64_bf16 v[68:71], v[56:59], a[248:255], v8
  s_cbranch_vccnz R0_c45
R0_g45:
  v_smfmac_f32_16x16x64_bf16 v[24:27], v[60:63], a[64:71], v8
  s_waitcnt lgkmcnt(2)
  v_smfmac_f32_16x16x64_bf16 v[32:35], v[60:63], v[40:47], v8
  ds_read_b128 v[40:43], v1 offset:0
  v_smfmac_f32_16x16x64_bf16 v[28:31], v[60:63], a[72:79], v8
  ds_read_b128 v[44:47], v1 offset:1024
  buffer_load_dwordx4 v0, s[4:7], s52 offen offset:2304 sc1 lds
  s_waitcnt lgkmcnt(2)
  v_smfmac_f32_16x16x64_bf16 v[36:39], v[60:63], v[48:55], v8
  ds_read_b128 v[48:51], v1 offset:2048
  v_smfmac_f32_16x16x64_bf16 v[64:67], v[60:63], v[72:79], v8
  ds_read_b128 v[52:55], v1 offset:3072
  v_smfmac_f32_16x16x64_bf16 v[68:71], v[60:63], v[80:87], v8
  v_lshl_add_u32 v11, v0, 3, s21
  v_smfmac_f32_16x16x64_bf16 v[24:27], v[12:15], a[80:87], v8
  s_waitcnt lgkmcnt(2)
  v_smfmac_f32_16x16x64_bf16 v[32:35], v[12:15], v[40:47], v8
  ds_read_b128 v[40:43], v1 offset:4096
  v_smfmac_f32_16x16x64_bf16 v[28:31], v[12:15], a[88:95], v8
  ds_read_b128 v[44:47], v1 offset:5120
  s_waitcnt vmcnt(3) lgkmcnt(2)
  v_max_u32 v9, v19, v7
  v_smfmac_f32_16x16x64_bf16 v[36:39], v[12:15], v[48:55], v8
  ds_read_b128 v[48:51], v1 offset:6144
  s_waitcnt vmcnt(2)
  v_cmp_u_f32 vcc, v9, v23
  v_smfmac_f32_16x16x64_bf16 v[64:67], v[12:15], v[88:95], v8
  ds_read_b128 v[52:55], v1 offset:7168
  buffer_load_dwordx4 v0, s[4:7], s52 offen offset:3328 sc1 lds
  v_smfmac_f32_16x16x64_bf16 v[68:71], v[12:15], v[96:103], v8
  s_cbranch_vccnz R0_c678
R0_g678:
  v_smfmac_f32_16x16x64_bf16 v[24:27], v[16:19], a[96:103], v8
  s_waitcnt vmcnt(2)
  s_waitcnt lgkmcnt(2)
  s_barrier
  ds_read_b128 v[12:15], v0 offset:5632
  v_smfmac_f32_16x16x64_bf16 v[24:27], v[20:23], v[40:47], v8
  buffer_load_dword v11, s[4:7], s52 offen sc1 lds
  v_smfmac_f32_16x16x64_bf16 v[28:31], v[16:19], a[104:111], v8
  s_waitcnt lgkmcnt(1)
  v_smfmac_f32_16x16x64_bf16 v[28:31], v[20:23], v[48:55], v8
  ds_read_b128 v[60:63], v0 offset:4608
  v_smfmac_f32_16x16x64_bf16 v[24:27], v[4:7], a[112:119], v8
  ds_read_b128 v[44:47], v0 offset:256
  v_smfmac_f32_16x16x64_bf16 v[28:31], v[4:7], a[120:127], v8
  ds_read_b128 v[56:59], v0 offset:1280
  v_smfmac_f32_16x16x64_bf16 v[32:35], v[16:19], a[144:151], v8
  v_add_f32 v24, v24, v26
  v_add_f32 v25, v25, v27
  v_smfmac_f32_16x16x64_bf16 v[32:35], v[20:23], a[160:167], v8
  v_add_f32 v28, v28, v30
  v_add_f32 v29, v29, v31
  v_smfmac_f32_16x16x64_bf16 v[32:35], v[4:7], a[176:183], v8
  v_cvt_pk_bf16_f32 v41, v24, v28
  v_cvt_pk_bf16_f32 v43, v25, v29
  v_smfmac_f32_16x16x64_bf16 v[36:39], v[16:19], a[152:159], v8
  ds_write2_b32 v3, v41, v43 offset0:0 offset1:4
  v_smfmac_f32_16x16x64_bf16 v[36:39], v[20:23], a[168:175], v8
  ds_read_b128 v[24:27], v2 offset:18432
  v_add_f32 v32, v32, v34
  v_smfmac_f32_16x16x64_bf16 v[36:39], v[4:7], a[184:191], v8
  v_add_f32 v33, v33, v35
  v_smfmac_f32_16x16x64_bf16 v[64:67], v[16:19], v[104:111], v8
  v_smfmac_f32_16x16x64_bf16 v[68:71], v[16:19], v[112:119], v8
  s_waitcnt lgkmcnt(1)
  s_barrier
  v_add_f32 v36, v36, v38
  v_smfmac_f32_16x16x64_bf16 v[64:67], v[20:23], v[120:127], v8
  ds_read_b128 v[28:31], v2 offset:19584
  v_add_f32 v37, v37, v39
  v_smfmac_f32_16x16x64_bf16 v[68:71], v[20:23], v[128:135], v8
  ds_read_b128 v[16:19], v0 offset:8960
  v_cvt_pk_bf16_f32 v40, v32, v36
  v_smfmac_f32_16x16x64_bf16 v[64:67], v[4:7], v[136:143], v8
  ds_read_b128 v[20:23], v0 offset:9984
  v_cvt_pk_bf16_f32 v42, v33, v37
  v_smfmac_f32_16x16x64_bf16 v[68:71], v[4:7], v[144:151], v8
  ds_read_b128 v[48:51], v2 offset:20736
  ds_read_b128 v[4:7], v0 offset:13312
  ds_write2_b32 v3, v40, v42 offset0:144 offset1:148
  s_waitcnt lgkmcnt(6)
  v_mfma_f32_16x16x32_bf16 v[32:35], v[44:47], v[24:27], 0
  ds_read_b128 v[44:47], v0 offset:14336
  v_add_f32 v64, v64, v66
  v_mfma_f32_16x16x32_bf16 v[36:39], v[56:59], v[24:27], 0
  ds_read_b128 v[52:55], v2 offset:21888
  s_waitcnt lgkmcnt(7)
  v_add_f32 v65, v65, v67
  v_mfma_f32_16x16x32_bf16 v[32:35], v[60:63], v[28:31], v[32:35]
  v_cvt_pk_bf16_f32 v41, v64, v65
  v_mfma_f32_16x16x32_bf16 v[36:39], v[12:15], v[28:31], v[36:39]
  ds_read_b128 v[64:67], v2 offset:19008
  s_waitcnt lgkmcnt(5)
  v_add_f32 v68, v68, v70
  v_mfma_f32_16x16x32_bf16 v[32:35], v[16:19], v[48:51], v[32:35]
  s_waitcnt lgkmcnt(2)
  s_barrier
  ds_read_b128 v[12:15], v2 offset:20160
  v_add_f32 v69, v69, v71
  v_mfma_f32_16x16x32_bf16 v[36:39], v[20:23], v[48:51], v[36:39]
  ds_read_b128 v[16:19], v2 offset:21312
  s_waitcnt lgkmcnt(3)
  v_cvt_pk_bf16_f32 v43, v68, v69
  v_mfma_f32_16x16x32_bf16 v[32:35], v[4:7], v[52:55], v[32:35]
  s_waitcnt vmcnt(2)
  ds_read_b128 v[56:59], v0 offset:2304
  ds_read_b128 v[68:71], v2 offset:22464
  v_mfma_f32_16x16x32_bf16 v[36:39], v[44:47], v[52:55], v[36:39]
  s_waitcnt vmcnt(1)
  ds_read_b128 v[60:63], v0 offset:3328
  s_waitcnt lgkmcnt(5)
  v_mfma_f32_16x16x32_bf16 v[44:47], v[64:67], v[24:27], 0
  s_waitcnt lgkmcnt(4)
  v_cmp_u_f32 vcc, v32, v32
  v_max3_f32 v9, v32, v33, v34
  v_mfma_f32_16x16x32_bf16 v[44:47], v[12:15], v[28:31], v[44:47]
  s_waitcnt lgkmcnt(3)
  v_max3_f32 v9, v9, v35, v36
  v_max3_f32 v9, v9, v37, v38
  v_mfma_f32_16x16x32_bf16 v[44:47], v[16:19], v[48:51], v[44:47]
  s_cbranch_vccnz R0_fn
R0_gn:
  s_waitcnt lgkmcnt(1)
  v_mfma_f32_16x16x32_bf16 v[44:47], v[68:71], v[52:55], v[44:47]
  buffer_store_dwordx4 v[40:43], v0, s[4:7], s53 offen offset:0 sc1
  ds_read_b128 v[4:7], v0 offset:23552
  ds_read_b128 v[24:27], v1 offset:8192
  v_mov_b64 v[12:13], s[62:63]
  v_mov_b64 v[14:15], s[62:63]
  v_max_f32 v9, v9, v39
  s_nop 1
  v_max3_f32 v46, v9, v44, v45
  v_max3_f32 v9, v9, v44, v45
  s_add_u32 s53, s53, 131072
  s_add_u32 s47, s47, 16384
  v_permlane32_swap_b32 v9, v46
  v_max_f32 v47, v9, v46
  v_max_f32 v9, v9, v46
  s_add_u32 s22, s47, s48
  s_nop 0
  v_permlane16_swap_b32 v9, v47
  v_max_f32 v9, v9, v47
  v_mul_f32 v46, s58, v9
  v_pk_fma_f32 v[44:45], v[44:45], s[58:59], v[46:47] op_sel_hi:[1,0,0] neg_lo:[0,0,1] neg_hi:[0,0,1]
  v_pk_fma_f32 v[32:33], v[32:33], s[58:59], v[46:47] op_sel_hi:[1,0,0] neg_lo:[0,0,1] neg_hi:[0,0,1]
  v_pk_fma_f32 v[34:35], v[34:35], s[58:59], v[46:47] op_sel_hi:[1,0,0] neg_lo:[0,0,1] neg_hi:[0,0,1]
  v_pk_fma_f32 v[36:37], v[36:37], s[58:59], v[46:47] op_sel_hi:[1,0,0] neg_lo:[0,0,1] neg_hi:[0,0,1]
  v_pk_fma_f32 v[38:39], v[38:39], s[58:59], v[46:47] op_sel_hi:[1,0,0] neg_lo:[0,0,1] neg_hi:[0,0,1]
  v_exp_f32 v44, v44
  v_exp_f32 v45, v45
  v_exp_f32 v32, v32
  v_cvt_pk_bf16_f32 v11, v44, v45
  v_exp_f32 v33, v33
  v_exp_f32 v34, v34
  v_mfma_f32_16x16x16_bf16 v[16:19], v[40:41], v[10:11], 0
  v_cvt_pk_bf16_f32 v64, v32, v33
  v_exp_f32 v35, v35
  v_mfma_f32_16x16x16_bf16 v[68:71], v[42:43], v[10:11], 0
  v_exp_f32 v36, v36
  v_cvt_pk_bf16_f32 v65, v34, v35
  v_exp_f32 v37, v37
  v_mfma_f32_16x16x16_bf16 v[20:23], v[10:11], v[12:13], 0
  ds_read_b128 v[28:31], v1 offset:9216
  v_exp_f32 v38, v38
  v_exp_f32 v39, v39
  v_cvt_pk_bf16_f32 v66, v36, v37
  v_cvt_pk_bf16_f32 v67, v38, v39
  v_mov_b64 v[32:33], 0
  v_mov_b64 v[34:35], 0
  v_mfma_f32_16x16x32_bf16 v[16:19], v[56:59], v[64:67], v[16:19]
  v_mov_b64 v[36:37], 0
  v_mov_b64 v[38:39], 0
  s_waitcnt lgkmcnt(3)
  v_mfma_f32_16x16x32_bf16 v[68:71], v[60:63], v[64:67], v[68:71]
  v_mov_b64 v[56:57], 0
  v_mov_b64 v[58:59], 0
  v_mfma_f32_16x16x32_bf16 v[20:23], v[64:67], v[12:15], v[20:23]
  v_cvt_pk_bf16_f32 v64, v16, v17
  v_cvt_pk_bf16_f32 v65, v18, v19
  v_mov_b64 v[60:61], 0
  v_mov_b64 v[62:63], 0
  v_cvt_pk_bf16_f32 v66, v68, v69
  v_cvt_pk_bf16_f32 v67, v70, v71
  ds_write_b128 v2, v[64:67] offset:18432
  s_add_u32 s52, s52, 524288
  v_mfma_f32_16x16x32_bf16 v[44:47], v[64:67], v[240:243], 0
  ds_read_b128 v[48:51], v1 offset:10240
  s_waitcnt lgkmcnt(2)
  v_smfmac_f32_16x16x64_bf16 v[32:35], v[64:67], v[24:31], v8 abid:1
  ds_read_b128 v[52:55], v1 offset:11264
  s_cmp_eq_u32 s46, 63
  v_smfmac_f32_16x16x64_bf16 v[56:59], v[64:67], v[152:159], v8 abid:1
  s_cbranch_scc1 K_end
  s_waitcnt lgkmcnt(2)
  s_barrier
  v_smfmac_f32_16x16x64_bf16 v[60:63], v[64:67], v[184:191], v8 abid:1
  ds_read_b128 v[12:15], v2 offset:19584
  ds_read_b128 v[16:19], v2 offset:20736
  ds_read_b128 v[68:71], v2 offset:21888
  s_waitcnt lgkmcnt(3)
  v_smfmac_f32_16x16x64_bf16 v[36:39], v[64:67], v[48:55], v8 abid:1
  ds_read_b128 v[24:27], v1 offset:12288
  ds_read_b128 v[28:31], v1 offset:13312
  v_rcp_f32 v20, v20
  v_rcp_f32 v21, v21
  s_waitcnt lgkmcnt(4)
  v_smfmac_f32_16x16x64_bf16 v[56:59], v[12:15], v[160:167], v8 abid:1
  ds_read_b128 v[48:51], v1 offset:14336
  s_waitcnt lgkmcnt(4)
  v_smfmac_f32_16x16x64_bf16 v[56:59], v[16:19], v[168:175], v8 abid:1
  ds_read_b128 v[52:55], v1 offset:15360
  s_waitcnt lgkmcnt(4)
  v_smfmac_f32_16x16x64_bf16 v[56:59], v[68:71], v[176:183], v8 abid:1
  ds_read_b128 v[64:67], v4 offset:23040
  v_smfmac_f32_16x16x64_bf16 v[60:63], v[12:15], v[192:199], v8 abid:1
  s_add_u32 s46, s46, 1
  s_add_u32 s56, s47, s49
  v_smfmac_f32_16x16x64_bf16 v[60:63], v[16:19], v[200:207], v8 abid:1
  v_mul_f32 v56, v56, v20
  v_mul_f32 v58, v58, v20
  v_mul_f32 v57, v57, v21
  v_mul_f32 v59, v59, v21
  v_cvt_pk_bf16_f32 v56, v56, v58
  v_cvt_pk_bf16_f32 v57, v57, v59
  v_bfi_b32 v56, 1, s46, v56
  v_bfi_b32 v57, 1, s46, v57
  buffer_store_dwordx2 v[56:57], v5, s[4:7], s68 offen
  v_smfmac_f32_16x16x64_bf16 v[60:63], v[68:71], v[208:215], v8 abid:1
  s_waitcnt lgkmcnt(3)
  v_smfmac_f32_16x16x64_bf16 v[32:35], v[12:15], v[24:31], v8 abid:1
  ds_read_b128 v[24:27], v1 offset:32768
  v_smfmac_f32_16x16x64_bf16 v[32:35], v[16:19], v[216:223], v8 abid:1
  ds_read_b128 v[28:31], v1 offset:33792
  v_mul_f32 v60, v60, v20
  v_mul_f32 v62, v62, v20
  v_mul_f32 v61, v61, v21
  v_mul_f32 v63, v63, v21
  v_cvt_pk_bf16_f32 v60, v60, v62
  v_cvt_pk_bf16_f32 v61, v61, v63
  v_bfi_b32 v60, 1, s46, v60
  v_bfi_b32 v61, 1, s46, v61
  s_waitcnt lgkmcnt(3)
  v_smfmac_f32_16x16x64_bf16 v[32:35], v[68:71], v[48:55], v8 abid:1
  buffer_store_dwordx2 v[60:61], v5, s[4:7], s69 offen
  v_smfmac_f32_16x16x64_bf16 v[36:39], v[12:15], v[224:231], v8 abid:1
  v_smfmac_f32_16x16x64_bf16 v[36:39], v[16:19], v[232:239], v8 abid:1
  v_mul_f32 v32, v32, v20
  v_mul_f32 v34, v34, v20
  v_mul_f32 v33, v33, v21
  v_mul_f32 v35, v35, v21
  v_cvt_pk_bf16_f32 v32, v32, v34
  v_cvt_pk_bf16_f32 v33, v33, v35
  v_bfi_b32 v32, 1, s46, v32
  v_bfi_b32 v33, 1, s46, v33
  s_waitcnt lgkmcnt(0)
  v_smfmac_f32_16x16x64_bf16 v[36:39], v[68:71], v[24:31], v8 abid:1
  buffer_load_dwordx4 v[48:51], v0, s[4:7], s50 offen offset:0 sc1
  buffer_load_dwordx4 v[52:55], v0, s[4:7], s50 offen offset:1024 sc1
  buffer_store_dwordx2 v[32:33], v5, s[4:7], s70 offen
  v_mfma_f32_16x16x32_bf16 v[44:47], v[12:15], v[244:247], v[44:47]
  v_mfma_f32_16x16x32_bf16 v[44:47], v[16:19], v[248:251], v[44:47]
  v_mul_f32 v36, v36, v20
  v_mul_f32 v38, v38, v20
  v_mfma_f32_16x16x32_bf16 v[44:47], v[68:71], v[252:255], v[44:47]
  v_mul_f32 v37, v37, v21
  v_mul_f32 v39, v39, v21
  v_cvt_pk_bf16_f32 v36, v36, v38
  v_cvt_pk_bf16_f32 v37, v37, v39
  v_bfi_b32 v36, 1, s46, v36
  v_bfi_b32 v37, 1, s46, v37
  buffer_load_dwordx4 v[48:51], v0, s[4:7], s50 offen offset:0 sc1
  buffer_load_dwordx4 v[52:55], v0, s[4:7], s50 offen offset:1024 sc1
  buffer_store_dwordx2 v[36:37], v5, s[4:7], s71 offen
  v_mul_f32 v44, v44, v20
  v_mul_f32 v45, v45, v21
  v_cvt_pk_bf16_f32 v44, v44, v45
  v_bfi_b32 v44, 1, s46, v44
  buffer_store_dword v44, v7, s[4:7], s72 offen
  buffer_load_dwordx4 v[48:51], v0, s[4:7], s50 offen offset:0 sc1
  buffer_load_dwordx4 v[52:55], v0, s[4:7], s50 offen offset:1024 sc1
  buffer_load_dwordx4 v[56:59], v0, s[4:7], s51 offen offset:0 sc1
  buffer_load_dwordx4 v[60:63], v0, s[4:7], s51 offen offset:1024 sc1
  s_waitcnt vmcnt(12)
  buffer_load_dwordx4 v[48:51], v0, s[4:7], s50 offen offset:0 sc1
  buffer_load_dwordx4 v[52:55], v0, s[4:7], s50 offen offset:1024 sc1
  s_waitcnt vmcnt(12)
  v_bitop3_b32 v9, v48, v49, s46 bitop3:0x7e
  v_bitop3_b32 v11, v50, v51, s46 bitop3:0x7e
  v_mfma_f32_16x16x32_bf16 v[40:43], v[64:67], v[48:51], 0
  s_waitcnt vmcnt(11)
  v_bitop3_b32 v44, v52, v53, s46 bitop3:0x7e
  v_bitop3_b32 v45, v54, v55, s46 bitop3:0x7e
  v_mfma_f32_16x16x32_bf16 v[40:43], v[64:67], v[52:55], v[40:43]
  v_or3_b32 v9, v9, v11, v44
  v_bitop3_b32 v9, v9, v45, 1 bitop3:0xa8
  v_cmp_ne_u32 vcc, 0, v9
  s_nop 4
  v_add_f32_dpp v40, v40, v40 row_ror:8 row_mask:0xf bank_mask:0xf
  v_add_f32_dpp v41, v41, v41 row_ror:8 row_mask:0xf bank_mask:0xf
  s_cbranch_vccnz R0_frp
R0_rp:
  s_barrier
  v_add_f32_dpp v46, v40, v40 row_ror:4 row_mask:0xf bank_mask:0x1
  v_add_f32_dpp v47, v41, v41 row_ror:4 row_mask:0xf bank_mask:0x1
  v_cvt_pk_bf16_f32 v9, v46, v47
  buffer_store_dword v9, v6, s[4:7], s22 offen
R0_yrp:
  buffer_load_dwordx4 v[56:59], v0, s[4:7], s51 offen offset:0 sc1
  buffer_load_dwordx4 v[60:63], v0, s[4:7], s51 offen offset:1024 sc1
  s_add_u32 s16, s47, 4096
  s_add_u32 s17, s47, 8192
  s_waitcnt vmcnt(6)
  v_bitop3_b32 v9, v56, v57, s46 bitop3:0x7e
  v_bitop3_b32 v11, v58, v59, s46 bitop3:0x7e
  v_mfma_f32_16x16x32_bf16 v[40:43], v[64:67], v[56:59], 0
  s_waitcnt vmcnt(5)
  v_bitop3_b32 v44, v60, v61, s46 bitop3:0x7e
  v_bitop3_b32 v45, v62, v63, s46 bitop3:0x7e
  v_mfma_f32_16x16x32_bf16 v[40:43], v[64:67], v[60:63], v[40:43]
  v_or3_b32 v9, v9, v11, v44
  v_bitop3_b32 v9, v9, v45, 1 bitop3:0xa8
  v_cmp_ne_u32 vcc, 0, v9
  s_barrier
  s_nop 3
  v_add_f32_dpp v40, v40, v40 row_ror:8 row_mask:0xf bank_mask:0xf
  v_add_f32_dpp v41, v41, v41 row_ror:8 row_mask:0xf bank_mask:0xf
  s_cbranch_vccnz R0_frq
R0_rq:
  v_add_f32_dpp v46, v40, v40 row_ror:4 row_mask:0xf bank_mask:0x1
  v_add_f32_dpp v47, v41, v41 row_ror:4 row_mask:0xf bank_mask:0x1
  v_cvt_pk_bf16_f32 v9, v46, v47
  buffer_store_dword v9, v6, s[4:7], s56 offen
  buffer_load_dwordx4 v[12:15], v0, s[4:7], s47 offen offset:0
  buffer_load_dwordx4 v[16:19], v0, s[4:7], s47 offen offset:1024
  v_mov_b64 v[24:25], 0
  v_mov_b64 v[26:27], 0
  v_mov_b64 v[28:29], 0
  v_mov_b64 v[30:31], 0
  v_mov_b64 v[32:33], 0
  v_mov_b64 v[34:35], 0
  v_mov_b64 v[36:37], 0
  v_mov_b64 v[38:39], 0
  v_mov_b64 v[64:65], 0
  v_mov_b64 v[66:67], 0
  v_mov_b64 v[68:69], 0
  v_mov_b64 v[70:71], 0
  s_waitcnt vmcnt(2)
  buffer_load_dwordx4 v[20:23], v0, s[4:7], s47 offen offset:2048
  buffer_load_dwordx4 v[56:59], v0, s[4:7], s47 offen offset:3072
  s_branch R0_go
R0_in:
  s_cmp_gt_u32 s60, 1
  s_cselect_b32 s55, s64, 0
  s_cmp_gt_u32 s55, 0
  s_cbranch_scc1 R0_in1
  s_xor_b32 s55, s59, 64
R0_in0:
  s_load_dword s60, s[42:43], s59 glc
  s_load_dword s64, s[42:43], s55 glc
  s_sub_u32 s54, s54, 1
  s_cbranch_scc1 K_end
  s_waitcnt lgkmcnt(0)
  s_cmp_gt_u32 s60, 1
  s_cbranch_scc0 R0_in0
R0_in1:
  s_add_u32 s16, s47, 4096
  s_add_u32 s17, s47, 8192
  buffer_load_dwordx4 v[12:15], v0, s[4:7], s47 offen offset:0
  buffer_load_dwordx4 v[16:19], v0, s[4:7], s47 offen offset:1024
  buffer_load_dwordx4 v[20:23], v0, s[4:7], s47 offen offset:2048
  buffer_load_dwordx4 v[56:59], v0, s[4:7], s47 offen offset:3072
  v_lshlrev_b32 v11, 3, v0
  s_bitcmp1_b32 s45, 0
  s_cselect_b32 s56, -1, 1
  s_mul_i32 s56, s56, 2176
  s_add_u32 s55, s52, 256
  buffer_load_dword v11, s[4:7], s55 offen sc1 lds
  s_add_u32 s55, s50, s56
  s_add_u32 s56, s51, s56
  s_mov_b64 exec, 0x3ffff
  buffer_load_dword v11, s[4:7], s55 offen sc1 lds
  buffer_load_dword v11, s[4:7], s56 offen sc1 lds
  s_mov_b64 exec, -1
  v_mov_b64 v[24:25], 0
  v_mov_b64 v[26:27], 0
  v_mov_b64 v[28:29], 0
  v_mov_b64 v[30:31], 0
  v_mov_b64 v[32:33], 0
  v_mov_b64 v[34:35], 0
  v_mov_b64 v[36:37], 0
  v_mov_b64 v[38:39], 0
  v_mov_b64 v[64:65], 0
  v_mov_b64 v[66:67], 0
  v_mov_b64 v[68:69], 0
  v_mov_b64 v[70:71], 0
  s_waitcnt vmcnt(3)
  s_barrier
  s_branch R0_go2
R0_in2:
  buffer_load_dwordx4 v[12:15], v0, s[4:7], s47 offen offset:0
  buffer_load_dwordx4 v[16:19], v0, s[4:7], s47 offen offset:1024
  buffer_load_dwordx4 v[20:23], v0, s[4:7], s47 offen offset:2048
  buffer_load_dwordx4 v[56:59], v0, s[4:7], s47 offen offset:3072
  v_mov_b64 v[24:25], 0
  v_mov_b64 v[26:27], 0
  v_mov_b64 v[28:29], 0
  v_mov_b64 v[30:31], 0
  v_mov_b64 v[32:33], 0
  v_mov_b64 v[34:35], 0
  v_mov_b64 v[36:37], 0
  v_mov_b64 v[38:39], 0
  v_mov_b64 v[64:65], 0
  v_mov_b64 v[66:67], 0
  v_mov_b64 v[68:69], 0
  v_mov_b64 v[70:71], 0
  s_waitcnt vmcnt(0)
  s_barrier
  s_branch R0_go2
R0_f0:
  buffer_load_dwordx4 v[12:15], v0, s[4:7], s47 offen offset:0 sc1
  s_sub_u32 s54, s54, 1
  s_cbranch_scc1 K_end
  s_nop 3
  v_mov_b64 v[24:25], 0
  v_mov_b64 v[26:27], 0
  v_mov_b64 v[28:29], 0
  v_mov_b64 v[30:31], 0
  buffer_load_dwordx4 v[16:19], v0, s[4:7], s47 offen offset:1024 sc1
  buffer_load_dwordx4 v[20:23], v0, s[4:7], s47 offen offset:2048 sc1
  buffer_load_dwordx4 v[56:59], v0, s[4:7], s47 offen offset:3072 sc1
  s_waitcnt vmcnt(3) lgkmcnt(0)
  s_branch R0_go2
R0_c1:
  buffer_load_dwordx4 v[16:19], v0, s[4:7], s47 offen offset:1024 sc1
  s_sub_u32 s54, s54, 1
  s_cbranch_scc1 K_end
  buffer_load_dwordx4 v[20:23], v0, s[4:7], s47 offen offset:2048 sc1
  buffer_load_dwordx4 v[56:59], v0, s[4:7], s47 offen offset:3072 sc1
  s_waitcnt vmcnt(2)
  v_max3_u32 v9, v19, v19, v19
  v_cmp_eq_u32 vcc, -1, v9
  s_cbranch_vccnz R0_c1
  s_branch R0_g1
R0_c2:
  buffer_load_dwordx4 v[20:23], v0, s[4:7], s47 offen offset:2048 sc1
  s_sub_u32 s54, s54, 1
  s_cbranch_scc1 K_end
  buffer_load_dwordx4 v[56:59], v0, s[4:7], s47 offen offset:3072 sc1
  buffer_load_dwordx4 v[60:63], v0, s[4:7], s16 offen offset:0 sc1
  buffer_load_dwordx4 v[12:15], v0, s[4:7], s16 offen offset:1024 sc1
  s_waitcnt vmcnt(3)
  v_max3_u32 v9, v23, v23, v23
  v_cmp_eq_u32 vcc, -1, v9
  s_cbranch_vccnz R0_c2
  s_branch R0_g2
R0_c3:
  buffer_load_dwordx4 v[56:59], v0, s[4:7], s47 offen offset:3072 sc1
  s_sub_u32 s54, s54, 1
  s_cbranch_scc1 K_end
  buffer_load_dwordx4 v[60:63], v0, s[4:7], s16 offen offset:0 sc1
  buffer_load_dwordx4 v[12:15], v0, s[4:7], s16 offen offset:1024 sc1
  buffer_load_dword v10, s[4:7], s47 offen lds
  buffer_load_dwordx4 v[16:19], v0, s[4:7], s16 offen offset:2048 sc1
  buffer_load_dwordx4 v[4:7], v0, s[4:7], s17 offen offset:0 sc1
  s_waitcnt vmcnt(5)
  v_max3_u32 v9, v59, v59, v59
  v_cmp_eq_u32 vcc, -1, v9
  s_cbranch_vccnz R0_c3
  s_branch R0_g3
R0_c45:
  buffer_load_dwordx4 v[60:63], v0, s[4:7], s16 offen offset:0 sc1
  buffer_load_dwordx4 v[12:15], v0, s[4:7], s16 offen offset:1024 sc1
  s_sub_u32 s54, s54, 1
  s_cbranch_scc1 K_end
  buffer_load_dword v10, s[4:7], s47 offen lds
  buffer_load_dwordx4 v[16:19], v0, s[4:7], s16 offen offset:2048 sc1
  buffer_load_dwordx4 v[4:7], v0, s[4:7], s17 offen offset:0 sc1
  buffer_load_dwordx4 v[20:23], v0, s[4:7], s16 offen offset:3072 sc1
  buffer_load_dword v10, s[4:7], s47 offen lds
  s_waitcnt vmcnt(5)
  v_max3_u32 v9, v63, v15, v63
  v_cmp_eq_u32 vcc, -1, v9
  s_cbranch_vccnz R0_c45
  s_branch R0_g45
R0_c678:
  buffer_load_dwordx4 v[16:19], v0, s[4:7], s16 offen offset:2048 sc1
  buffer_load_dwordx4 v[4:7], v0, s[4:7], s17 offen offset:0 sc1
  buffer_load_dwordx4 v[20:23], v0, s[4:7], s16 offen offset:3072 sc1
  s_sub_u32 s54, s54, 1
  s_cbranch_scc1 K_end
  buffer_load_dword v10, s[4:7], s47 offen lds
  buffer_load_dword v10, s[4:7], s47 offen lds
  buffer_load_dword v10, s[4:7], s47 offen lds
  s_waitcnt vmcnt(3)
  v_max3_u32 v9, v19, v23, v7
  v_cmp_eq_u32 vcc, -1, v9
  s_cbranch_vccnz R0_c678
  s_branch R0_g678
R0_fn:
  s_cmp_eq_u32 s20, s46
  s_cbranch_scc1 R0_gn
  s_mov_b32 s20, s46
  s_waitcnt vmcnt(0) lgkmcnt(0)
  s_nop 7
R0_fl:
  buffer_load_dwordx4 v[12:15], v0, s[4:7], s47 offen offset:0 sc1
  buffer_load_dwordx4 v[16:19], v0, s[4:7], s47 offen offset:1024 sc1
  buffer_load_dwordx4 v[20:23], v0, s[4:7], s47 offen offset:2048 sc1
  buffer_load_dwordx4 v[24:27], v0, s[4:7], s47 offen offset:3072 sc1
  buffer_load_dwordx4 v[28:31], v0, s[4:7], s16 offen offset:0 sc1
  buffer_load_dwordx4 v[32:35], v0, s[4:7], s16 offen offset:1024 sc1
  buffer_load_dwordx4 v[36:39], v0, s[4:7], s16 offen offset:2048 sc1
  buffer_load_dwordx4 v[40:43], v0, s[4:7], s16 offen offset:3072 sc1
  buffer_load_dwordx4 v[44:47], v0, s[4:7], s17 offen offset:0 sc1
  s_sub_u32 s54, s54, 1
  s_cbranch_scc1 K_end
  s_waitcnt vmcnt(8)
  v_max_u32 v9, v12, v13
  v_max3_u32 v9, v9, v14, v15
  s_waitcnt vmcnt(7)
  v_max3_u32 v9, v9, v16, v17
  v_max3_u32 v9, v9, v18, v19
  s_waitcnt vmcnt(6)
  v_max3_u32 v9, v9, v20, v21
  v_max3_u32 v9, v9, v22, v23
  s_waitcnt vmcnt(5)
  v_max3_u32 v9, v9, v24, v25
  v_max3_u32 v9, v9, v26, v27
  s_waitcnt vmcnt(4)
  v_max3_u32 v9, v9, v28, v29
  v_max3_u32 v9, v9, v30, v31
  s_waitcnt vmcnt(3)
  v_max3_u32 v9, v9, v32, v33
  v_max3_u32 v9, v9, v34, v35
  s_waitcnt vmcnt(2)
  v_max3_u32 v9, v9, v36, v37
  v_max3_u32 v9, v9, v38, v39
  s_waitcnt vmcnt(1)
  v_max3_u32 v9, v9, v40, v41
  v_max3_u32 v9, v9, v42, v43
  s_waitcnt vmcnt(0)
  v_max3_u32 v9, v9, v44, v45
  v_max3_u32 v9, v9, v46, v47
  v_cmp_eq_u32 vcc, -1, v9
  s_cbranch_vccnz R0_fl
  s_barrier
  buffer_inv sc1
  s_waitcnt vmcnt(0)
  s_barrier
  s_branch R0_in2
R0_xrp:
  v_add_f32_dpp v46, v40, v40 row_ror:4 row_mask:0xf bank_mask:0x1
  v_add_f32_dpp v47, v41, v41 row_ror:4 row_mask:0xf bank_mask:0x1
  v_cvt_pk_bf16_f32 v9, v46, v47
  buffer_store_dword v9, v6, s[4:7], s22 offen
  s_waitcnt vmcnt(5)
  s_barrier
  s_branch R0_yrp
R0_frp:
  buffer_load_dwordx4 v[48:51], v0, s[4:7], s50 offen offset:0 sc1
  buffer_load_dwordx4 v[52:55], v0, s[4:7], s50 offen offset:1024 sc1
  buffer_load_dwordx4 v[56:59], v0, s[4:7], s51 offen offset:0 sc1
  buffer_load_dwordx4 v[60:63], v0, s[4:7], s51 offen offset:1024 sc1
  s_waitcnt vmcnt(12)
  v_bitop3_b32 v9, v48, v49, s46 bitop3:0x7e
  v_bitop3_b32 v11, v50, v51, s46 bitop3:0x7e
  v_mfma_f32_16x16x32_bf16 v[40:43], v[64:67], v[48:51], 0
  v_bitop3_b32 v44, v52, v53, s46 bitop3:0x7e
  v_bitop3_b32 v45, v54, v55, s46 bitop3:0x7e
  v_mfma_f32_16x16x32_bf16 v[40:43], v[64:67], v[52:55], v[40:43]
  v_or3_b32 v9, v9, v11, v44
  v_bitop3_b32 v9, v9, v45, 1 bitop3:0xa8
  v_cmp_ne_u32 vcc, 0, v9
  s_nop 4
  v_add_f32_dpp v40, v40, v40 row_ror:8 row_mask:0xf bank_mask:0xf
  v_add_f32_dpp v41, v41, v41 row_ror:8 row_mask:0xf bank_mask:0xf
  s_cbranch_vccz R0_xrp
  buffer_load_dwordx4 v[48:51], v0, s[4:7], s50 offen offset:0 sc1
  buffer_load_dwordx4 v[52:55], v0, s[4:7], s50 offen offset:1024 sc1
  buffer_load_dwordx4 v[56:59], v0, s[4:7], s51 offen offset:0 sc1
  buffer_load_dwordx4 v[60:63], v0, s[4:7], s51 offen offset:1024 sc1
  s_waitcnt vmcnt(12)
  v_bitop3_b32 v9, v48, v49, s46 bitop3:0x7e
  v_bitop3_b32 v11, v50, v51, s46 bitop3:0x7e
  v_mfma_f32_16x16x32_bf16 v[40:43], v[64:67], v[48:51], 0
  v_bitop3_b32 v44, v52, v53, s46 bitop3:0x7e
  v_bitop3_b32 v45, v54, v55, s46 bitop3:0x7e
  v_mfma_f32_16x16x32_bf16 v[40:43], v[64:67], v[52:55], v[40:43]
  v_or3_b32 v9, v9, v11, v44
  v_bitop3_b32 v9, v9, v45, 1 bitop3:0xa8
  v_cmp_ne_u32 vcc, 0, v9
  s_nop 4
  v_add_f32_dpp v40, v40, v40 row_ror:8 row_mask:0xf bank_mask:0xf
  v_add_f32_dpp v41, v41, v41 row_ror:8 row_mask:0xf bank_mask:0xf
  s_cbranch_vccz R0_xrp
  buffer_load_dwordx4 v[48:51], v0, s[4:7], s50 offen offset:0 sc1
  buffer_load_dwordx4 v[52:55], v0, s[4:7], s50 offen offset:1024 sc1
  buffer_load_dwordx4 v[56:59], v0, s[4:7], s51 offen offset:0 sc1
  buffer_load_dwordx4 v[60:63], v0, s[4:7], s51 offen offset:1024 sc1
  s_waitcnt vmcnt(12)
  v_bitop3_b32 v9, v48, v49, s46 bitop3:0x7e
  v_bitop3_b32 v11, v50, v51, s46 bitop3:0x7e
  v_mfma_f32_16x16x32_bf16 v[40:43], v[64:67], v[48:51], 0
  v_bitop3_b32 v44, v52, v53, s46 bitop3:0x7e
  v_bitop3_b32 v45, v54, v55, s46 bitop3:0x7e
  v_mfma_f32_16x16x32_bf16 v[40:43], v[64:67], v[52:55], v[40:43]
  v_or3_b32 v9, v9, v11, v44
  v_bitop3_b32 v9, v9, v45, 1 bitop3:0xa8
  v_cmp_ne_u32 vcc, 0, v9
  s_nop 4
  v_add_f32_dpp v40, v40, v40 row_ror:8 row_mask:0xf bank_mask:0xf
  v_add_f32_dpp v41, v41, v41 row_ror:8 row_mask:0xf bank_mask:0xf
  s_cbranch_vccz R0_xrp
R0_lrp:
  buffer_load_dwordx4 v[48:51], v0, s[4:7], s50 offen offset:0 sc1
  buffer_load_dwordx4 v[52:55], v0, s[4:7], s50 offen offset:1024 sc1
  buffer_load_dwordx4 v[56:59], v0, s[4:7], s51 offen offset:0 sc1
  buffer_load_dwordx4 v[60:63], v0, s[4:7], s51 offen offset:1024 sc1
  s_sub_u32 s54, s54, 1
  s_cbranch_scc1 K_end
  s_waitcnt vmcnt(14)
  v_bitop3_b32 v9, v48, v49, s46 bitop3:0x7e
  v_bitop3_b32 v11, v50, v51, s46 bitop3:0x7e
  v_mfma_f32_16x16x32_bf16 v[40:43], v[64:67], v[48:51], 0
  v_bitop3_b32 v44, v52, v53, s46 bitop3:0x7e
  v_bitop3_b32 v45, v54, v55, s46 bitop3:0x7e
  v_mfma_f32_16x16x32_bf16 v[40:43], v[64:67], v[52:55], v[40:43]
  v_or3_b32 v9, v9, v11, v44
  v_bitop3_b32 v9, v9, v45, 1 bitop3:0xa8
  v_cmp_ne_u32 vcc, 0, v9
  s_nop 4
  v_add_f32_dpp v40, v40, v40 row_ror:8 row_mask:0xf bank_mask:0xf
  v_add_f32_dpp v41, v41, v41 row_ror:8 row_mask:0xf bank_mask:0xf
  s_cbranch_vccz R0_xrp
  s_branch R0_lrp
R0_frq:
  buffer_load_dwordx4 v[56:59], v0, s[4:7], s51 offen offset:0 sc1
  buffer_load_dwordx4 v[60:63], v0, s[4:7], s51 offen offset:1024 sc1
  s_waitcnt vmcnt(2)
  v_bitop3_b32 v9, v56, v57, s46 bitop3:0x7e
  v_bitop3_b32 v11, v58, v59, s46 bitop3:0x7e
  v_mfma_f32_16x16x32_bf16 v[40:43], v[64:67], v[56:59], 0
  v_bitop3_b32 v44, v60, v61, s46 bitop3:0x7e
  v_bitop3_b32 v45, v62, v63, s46 bitop3:0x7e
  v_mfma_f32_16x16x32_bf16 v[40:43], v[64:67], v[60:63], v[40:43]
  v_or3_b32 v9, v9, v11, v44
  v_bitop3_b32 v9, v9, v45, 1 bitop3:0xa8
  v_cmp_ne_u32 vcc, 0, v9
  s_nop 4
  v_add_f32_dpp v40, v40, v40 row_ror:8 row_mask:0xf bank_mask:0xf
  v_add_f32_dpp v41, v41, v41 row_ror:8 row_mask:0xf bank_mask:0xf
  s_cbranch_vccz R0_rq
R0_lrq:
  buffer_load_dwordx4 v[56:59], v0, s[4:7], s51 offen offset:0 sc1
  buffer_load_dwordx4 v[60:63], v0, s[4:7], s51 offen offset:1024 sc1
  s_sub_u32 s54, s54, 1
  s_cbranch_scc1 K_end
  s_waitcnt vmcnt(2)
  v_bitop3_b32 v9, v56, v57, s46 bitop3:0x7e
  v_bitop3_b32 v11, v58, v59, s46 bitop3:0x7e
  v_mfma_f32_16x16x32_bf16 v[40:43], v[64:67], v[56:59], 0
  v_bitop3_b32 v44, v60, v61, s46 bitop3:0x7e
  v_bitop3_b32 v45, v62, v63, s46 bitop3:0x7e
  v_mfma_f32_16x16x32_bf16 v[40:43], v[64:67], v[60:63], v[40:43]
  v_or3_b32 v9, v9, v11, v44
  v_bitop3_b32 v9, v9, v45, 1 bitop3:0xa8
  v_cmp_ne_u32 vcc, 0, v9
  s_nop 4
  v_add_f32_dpp v40, v40, v40 row_ror:8 row_mask:0xf bank_mask:0xf
  v_add_f32_dpp v41, v41, v41 row_ror:8 row_mask:0xf bank_mask:0xf
  s_cbranch_vccz R0_rq
  s_branch R0_lrq
R1_go:
  s_waitcnt vmcnt(4)
R1_go2:
  v_cmp_eq_u32 vcc, -1, v15
  v_smfmac_f32_16x16x64_bf16 v[24:27], v[12:15], a[0:7], v8
  ds_read_b128 v[40:43], v1 offset:16384
  v_smfmac_f32_16x16x64_bf16 v[28:31], v[12:15], a[8:15], v8
  s_cbranch_vccnz R1_f0
  v_smfmac_f32_16x16x64_bf16 v[32:35], v[12:15], a[128:135], v8
  ds_read_b128 v[44:47], v1 offset:17408
  v_smfmac_f32_16x16x64_bf16 v[36:39], v[12:15], a[136:143], v8
  ds_read_b128 v[48:51], v1 offset:18432
  s_waitcnt vmcnt(3)
  v_cmp_eq_u32 vcc, -1, v19
  v_smfmac_f32_16x16x64_bf16 v[64:67], v[12:15], a[192:199], v8
  ds_read_b128 v[52:55], v1 offset:19456
  v_smfmac_f32_16x16x64_bf16 v[68:71], v[12:15], a[200:207], v8
  s_cbranch_vccnz R1_c1
R1_g1:
  v_smfmac_f32_16x16x64_bf16 v[24:27], v[16:19], a[16:23], v8
  buffer_load_dwordx4 v[60:63], v0, s[4:7], s16 offen offset:0
  s_waitcnt lgkmcnt(2)
  v_smfmac_f32_16x16x64_bf16 v[32:35], v[16:19], v[40:47], v8
  ds_read_b128 v[40:43], v1 offset:20480
  buffer_load_dwordx4 v[12:15], v0, s[4:7], s16 offen offset:1024
  v_smfmac_f32_16x16x64_bf16 v[28:31], v[16:19], a[24:31], v8
  ds_read_b128 v[44:47], v1 offset:21504
  s_waitcnt lgkmcnt(2)
  v_smfmac_f32_16x16x64_bf16 v[36:39], v[16:19], v[48:55], v8
  ds_read_b128 v[48:51], v1 offset:22528
  s_waitcnt vmcnt(4)
  v_cmp_eq_u32 vcc, -1, v23
  v_smfmac_f32_16x16x64_bf16 v[64:67], v[16:19], a[208:215], v8
  ds_read_b128 v[52:55], v1 offset:23552
  v_smfmac_f32_16x16x64_bf16 v[68:71], v[16:19], a[216:223], v8
  s_cbranch_vccnz R1_c2
R1_g2:
  v_smfmac_f32_16x16x64_bf16 v[24:27], v[20:23], a[32:39], v8
  buffer_load_dwordx4 v0, s[4:7], s52 offen offset:256 sc1 lds
  s_waitcnt lgkmcnt(2)
  v_smfmac_f32_16x16x64_bf16 v[32:35], v[20:23], v[40:47], v8
  ds_read_b128 v[40:43], v1 offset:24576
  v_smfmac_f32_16x16x64_bf16 v[28:31], v[20:23], a[40:47], v8
  ds_read_b128 v[44:47], v1 offset:25600
  buffer_load_dwordx4 v[16:19], v0, s[4:7], s16 offen offset:2048
  s_waitcnt lgkmcnt(2)
  v_smfmac_f32_16x16x64_bf16 v[36:39], v[20:23], v[48:55], v8
  ds_read_b128 v[48:51], v1 offset:26624
  s_waitcnt vmcnt(5)
  v_cmp_eq_u32 vcc, -1, v59
  v_smfmac_f32_16x16x64_bf16 v[64:67], v[20:23], a[224:231], v8
  ds_read_b128 v[52:55], v1 offset:27648
  buffer_load_dwordx4 v[4:7], v0, s[4:7], s17 offen offset:0
  v_smfmac_f32_16x16x64_bf16 v[68:71], v[20:23], a[232:239], v8
  s_cbranch_vccnz R1_c3
R1_g3:
  v_smfmac_f32_16x16x64_bf16 v[24:27], v[56:59], a[48:55], v8
  buffer_load_dwordx4 v[20:23], v0, s[4:7], s16 offen offset:3072
  s_waitcnt lgkmcnt(2)
  v_smfmac_f32_16x16x64_bf16 v[32:35], v[56:59], v[40:47], v8
  ds_read_b128 v[40:43], v1 offset:28672
  buffer_load_dwordx4 v0, s[4:7], s52 offen offset:1280 sc1 lds
  v_smfmac_f32_16x16x64_bf16 v[28:31], v[56:59], a[56:63], v8
  ds_read_b128 v[44:47], v1 offset:29696
  s_waitcnt lgkmcnt(2)
  v_smfmac_f32_16x16x64_bf16 v[36:39], v[56:59], v[48:55], v8
  ds_read_b128 v[48:51], v1 offset:30720
  s_waitcnt vmcnt(5)
  v_cmp_u_f32 vcc, v63, v15
  v_smfmac_f32_16x16x64_bf16 v[64:67], v[56:59], a[240:247], v8
  ds_read_b128 v[52:55], v1 offset:31744
  v_smfmac_f32_16x16x64_bf16 v[68:71], v[56:59], a[248:255], v8
  s_cbranch_vccnz R1_c45
R1_g45:
  v_smfmac_f32_16x16x64_bf16 v[24:27], v[60:63], a[64:71], v8
  s_waitcnt lgkmcnt(2)
  v_smfmac_f32_16x16x64_bf16 v[32:35], v[60:63], v[40:47], v8
  ds_read_b128 v[40:43], v1 offset:0
  v_smfmac_f32_16x16x64_bf16 v[28:31], v[60:63], a[72:79], v8
  ds_read_b128 v[44:47], v1 offset:1024
  buffer_load_dwordx4 v0, s[4:7], s52 offen offset:2304 sc1 lds
  s_waitcnt lgkmcnt(2)
  v_smfmac_f32_16x16x64_bf16 v[36:39], v[60:63], v[48:55], v8
  ds_read_b128 v[48:51], v1 offset:2048
  v_smfmac_f32_16x16x64_bf16 v[64:67], v[60:63], v[72:79], v8
  ds_read_b128 v[52:55], v1 offset:3072
  v_smfmac_f32_16x16x64_bf16 v[68:71], v[60:63], v[80:87], v8
  v_lshl_add_u32 v11, v0, 3, s21
  v_smfmac_f32_16x16x64_bf16 v[24:27], v[12:15], a[80:87], v8
  s_waitcnt lgkmcnt(2)
  v_smfmac_f32_16x16x64_bf16 v[32:35], v[12:15], v[40:47], v8
  ds_read_b128 v[40:43], v1 offset:4096
  v_smfmac_f32_16x16x64_bf16 v[28:31], v[12:15], a[88:95], v8
  ds_read_b128 v[44:47], v1 offset:5120
  s_waitcnt vmcnt(3) lgkmcnt(2)
  v_max_u32 v9, v19, v7
  v_smfmac_f32_16x16x64_bf16 v[36:39], v[12:15], v[48:55], v8
  ds_read_b128 v[48:51], v1 offset:6144
  s_waitcnt vmcnt(2)
  v_cmp_u_f32 vcc, v9, v23
  v_smfmac_f32_16x16x64_bf16 v[64:67], v[12:15], v[88:95], v8
  ds_read_b128 v[52:55], v1 offset:7168
  buffer_load_dwordx4 v0, s[4:7], s52 offen offset:3328 sc1 lds
  v_smfmac_f32_16x16x64_bf16 v[68:71], v[12:15], v[96:103], v8
  s_cbranch_vccnz R1_c678
R1_g678:
  v_smfmac_f32_16x16x64_bf16 v[24:27], v[16:19], a[96:103], v8
  s_waitcnt vmcnt(2)
  s_waitcnt lgkmcnt(2)
  s_barrier
  ds_read_b128 v[12:15], v0 offset:1280
  v_smfmac_f32_16x16x64_bf16 v[24:27], v[20:23], v[40:47], v8
  buffer_load_dword v11, s[4:7], s23 offen sc1 lds
  v_smfmac_f32_16x16x64_bf16 v[28:31], v[16:19], a[104:111], v8
  s_waitcnt lgkmcnt(1)
  v_smfmac_f32_16x16x64_bf16 v[28:31], v[20:23], v[48:55], v8
  ds_read_b128 v[60:63], v0 offset:256
  v_smfmac_f32_16x16x64_bf16 v[24:27], v[4:7], a[112:119], v8
  ds_read_b128 v[44:47], v0 offset:4608
  v_smfmac_f32_16x16x64_bf16 v[28:31], v[4:7], a[120:127], v8
  ds_read_b128 v[56:59], v0 offset:5632
  v_smfmac_f32_16x16x64_bf16 v[32:35], v[16:19], a[144:151], v8
  v_add_f32 v24, v24, v26
  v_add_f32 v25, v25, v27
  v_smfmac_f32_16x16x64_bf16 v[32:35], v[20:23], a[160:167], v8
  v_add_f32 v28, v28, v30
  v_add_f32 v29, v29, v31
  v_smfmac_f32_16x16x64_bf16 v[32:35], v[4:7], a[176:183], v8
  v_cvt_pk_bf16_f32 v41, v24, v28
  v_cvt_pk_bf16_f32 v43, v25, v29
  v_smfmac_f32_16x16x64_bf16 v[36:39], v[16:19], a[152:159], v8
  ds_write2_b32 v3, v41, v43 offset0:0 offset1:4
  v_smfmac_f32_16x16x64_bf16 v[36:39], v[20:23], a[168:175], v8
  ds_read_b128 v[24:27], v2 offset:19584
  v_add_f32 v32, v32, v34
  v_smfmac_f32_16x16x64_bf16 v[36:39], v[4:7], a[184:191], v8
  v_add_f32 v33, v33, v35
  v_smfmac_f32_16x16x64_bf16 v[64:67], v[16:19], v[104:111], v8
  v_smfmac_f32_16x16x64_bf16 v[68:71], v[16:19], v[112:119], v8
  s_waitcnt lgkmcnt(1)
  s_barrier
  v_add_f32 v36, v36, v38
  v_smfmac_f32_16x16x64_bf16 v[64:67], v[20:23], v[120:127], v8
  ds_read_b128 v[28:31], v2 offset:18432
  v_add_f32 v37, v37, v39
  v_smfmac_f32_16x16x64_bf16 v[68:71], v[20:23], v[128:135], v8
  ds_read_b128 v[16:19], v0 offset:13312
  v_cvt_pk_bf16_f32 v40, v32, v36
  v_smfmac_f32_16x16x64_bf16 v[64:67], v[4:7], v[136:143], v8
  ds_read_b128 v[20:23], v0 offset:14336
  v_cvt_pk_bf16_f32 v42, v33, v37
  v_smfmac_f32_16x16x64_bf16 v[68:71], v[4:7], v[144:151], v8
  ds_read_b128 v[48:51], v2 offset:21888
  ds_read_b128 v[4:7], v0 offset:8960
  ds_write2_b32 v3, v40, v42 offset0:144 offset1:148
  s_waitcnt lgkmcnt(6)
  v_mfma_f32_16x16x32_bf16 v[32:35], v[44:47], v[24:27], 0
  ds_read_b128 v[44:47], v0 offset:9984
  v_add_f32 v64, v64, v66
  v_mfma_f32_16x16x32_bf16 v[36:39], v[56:59], v[24:27], 0
  ds_read_b128 v[52:55], v2 offset:20736
  s_waitcnt lgkmcnt(7)
  v_add_f32 v65, v65, v67
  v_mfma_f32_16x16x32_bf16 v[32:35], v[60:63], v[28:31], v[32:35]
  v_cvt_pk_bf16_f32 v41, v64, v65
  v_mfma_f32_16x16x32_bf16 v[36:39], v[12:15], v[28:31], v[36:39]
  ds_read_b128 v[64:67], v2 offset:20160
  s_waitcnt lgkmcnt(5)
  v_add_f32 v68, v68, v70
  v_mfma_f32_16x16x32_bf16 v[32:35], v[16:19], v[48:51], v[32:35]
  s_waitcnt lgkmcnt(2)
  s_barrier
  ds_read_b128 v[12:15], v2 offset:19008
  v_add_f32 v69, v69, v71
  v_mfma_f32_16x16x32_bf16 v[36:39], v[20:23], v[48:51], v[36:39]
  ds_read_b128 v[16:19], v2 offset:22464
  s_waitcnt lgkmcnt(3)
  v_cvt_pk_bf16_f32 v43, v68, v69
  v_mfma_f32_16x16x32_bf16 v[32:35], v[4:7], v[52:55], v[32:35]
  s_waitcnt vmcnt(2)
  ds_read_b128 v[56:59], v0 offset:6656
  ds_read_b128 v[68:71], v2 offset:21312
  v_mfma_f32_16x16x32_bf16 v[36:39], v[44:47], v[52:55], v[36:39]
  s_waitcnt vmcnt(1)
  ds_read_b128 v[60:63], v0 offset:7680
  s_waitcnt lgkmcnt(5)
  v_mfma_f32_16x16x32_bf16 v[44:47], v[64:67], v[24:27], 0
  s_waitcnt lgkmcnt(4)
  v_cmp_u_f32 vcc, v32, v32
  v_max3_f32 v9, v32, v33, v34
  v_mfma_f32_16x16x32_bf16 v[44:47], v[12:15], v[28:31], v[44:47]
  s_waitcnt lgkmcnt(3)
  v_max3_f32 v9, v9, v35, v36
  v_max3_f32 v9, v9, v37, v38
  v_mfma_f32_16x16x32_bf16 v[44:47], v[16:19], v[48:51], v[44:47]
  s_cbranch_vccnz R1_fn
R1_gn:
  s_waitcnt lgkmcnt(1)
  v_mfma_f32_16x16x32_bf16 v[44:47], v[68:71], v[52:55], v[44:47]
  buffer_store_dwordx4 v[40:43], v0, s[4:7], s53 offen offset:1024 sc1
  ds_read_b128 v[4:7], v0 offset:23552
  ds_read_b128 v[24:27], v1 offset:8192
  v_mov_b64 v[12:13], s[62:63]
  v_mov_b64 v[14:15], s[62:63]
  v_max_f32 v9, v9, v39
  s_nop 1
  v_max3_f32 v46, v9, v44, v45
  v_max3_f32 v9, v9, v44, v45
  s_add_u32 s53, s53, 131072
  s_add_u32 s47, s47, 16384
  v_permlane32_swap_b32 v9, v46
  v_max_f32 v47, v9, v46
  v_max_f32 v9, v9, v46
  s_add_u32 s22, s47, s48
  s_nop 0
  v_permlane16_swap_b32 v9, v47
  v_max_f32 v9, v9, v47
  v_mul_f32 v46, s58, v9
  v_pk_fma_f32 v[44:45], v[44:45], s[58:59], v[46:47] op_sel_hi:[1,0,0] neg_lo:[0,0,1] neg_hi:[0,0,1]
  v_pk_fma_f32 v[32:33], v[32:33], s[58:59], v[46:47] op_sel_hi:[1,0,0] neg_lo:[0,0,1] neg_hi:[0,0,1]
  v_pk_fma_f32 v[34:35], v[34:35], s[58:59], v[46:47] op_sel_hi:[1,0,0] neg_lo:[0,0,1] neg_hi:[0,0,1]
  v_pk_fma_f32 v[36:37], v[36:37], s[58:59], v[46:47] op_sel_hi:[1,0,0] neg_lo:[0,0,1] neg_hi:[0,0,1]
  v_pk_fma_f32 v[38:39], v[38:39], s[58:59], v[46:47] op_sel_hi:[1,0,0] neg_lo:[0,0,1] neg_hi:[0,0,1]
  v_exp_f32 v44, v44
  v_exp_f32 v45, v45
  v_exp_f32 v32, v32
  v_cvt_pk_bf16_f32 v11, v44, v45
  v_exp_f32 v33, v33
  v_exp_f32 v34, v34
  v_mfma_f32_16x16x16_bf16 v[16:19], v[40:41], v[10:11], 0
  v_cvt_pk_bf16_f32 v64, v32, v33
  v_exp_f32 v35, v35
  v_mfma_f32_16x16x16_bf16 v[68:71], v[42:43], v[10:11], 0
  v_exp_f32 v36, v36
  v_cvt_pk_bf16_f32 v65, v34, v35
  v_exp_f32 v37, v37
  v_mfma_f32_16x16x16_bf16 v[20:23], v[10:11], v[12:13], 0
  ds_read_b128 v[28:31], v1 offset:9216
  v_exp_f32 v38, v38
  v_exp_f32 v39, v39
  v_cvt_pk_bf16_f32 v66, v36, v37
  v_cvt_pk_bf16_f32 v67, v38, v39
  v_mov_b64 v[32:33], 0
  v_mov_b64 v[34:35], 0
  v_mfma_f32_16x16x32_bf16 v[16:19], v[56:59], v[64:67], v[16:19]
  v_mov_b64 v[36:37], 0
  v_mov_b64 v[38:39], 0
  s_waitcnt lgkmcnt(3)
  v_mfma_f32_16x16x32_bf16 v[68:71], v[60:63], v[64:67], v[68:71]
  v_mov_b64 v[56:57], 0
  v_mov_b64 v[58:59], 0
  v_mfma_f32_16x16x32_bf16 v[20:23], v[64:67], v[12:15], v[20:23]
  v_cvt_pk_bf16_f32 v64, v16, v17
  v_cvt_pk_bf16_f32 v65, v18, v19
  v_mov_b64 v[60:61], 0
  v_mov_b64 v[62:63], 0
  v_cvt_pk_bf16_f32 v66, v68, v69
  v_cvt_pk_bf16_f32 v67, v70, v71
  ds_write_b128 v2, v[64:67] offset:19584
  s_add_u32 s52, s52, 524288
  v_mfma_f32_16x16x32_bf16 v[44:47], v[64:67], v[240:243], 0
  ds_read_b128 v[48:51], v1 offset:10240
  s_waitcnt lgkmcnt(2)
  v_smfmac_f32_16x16x64_bf16 v[32:35], v[64:67], v[24:31], v8 abid:1
  ds_read_b128 v[52:55], v1 offset:11264
  s_cmp_eq_u32 s46, 63
  v_smfmac_f32_16x16x64_bf16 v[56:59], v[64:67], v[152:159], v8 abid:1
  s_cbranch_scc1 K_end
  s_waitcnt lgkmcnt(2)
  s_barrier
  v_smfmac_f32_16x16x64_bf16 v[60:63], v[64:67], v[184:191], v8 abid:1
  ds_read_b128 v[12:15], v2 offset:18432
  ds_read_b128 v[16:19], v2 offset:21888
  ds_read_b128 v[68:71], v2 offset:20736
  s_waitcnt lgkmcnt(3)
  v_smfmac_f32_16x16x64_bf16 v[36:39], v[64:67], v[48:55], v8 abid:1
  ds_read_b128 v[24:27], v1 offset:12288
  ds_read_b128 v[28:31], v1 offset:13312
  v_rcp_f32 v20, v20
  v_rcp_f32 v21, v21
  s_waitcnt lgkmcnt(4)
  v_smfmac_f32_16x16x64_bf16 v[56:59], v[12:15], v[160:167], v8 abid:1
  ds_read_b128 v[48:51], v1 offset:14336
  s_waitcnt lgkmcnt(4)
  v_smfmac_f32_16x16x64_bf16 v[56:59], v[16:19], v[168:175], v8 abid:1
  ds_read_b128 v[52:55], v1 offset:15360
  s_waitcnt lgkmcnt(4)
  v_smfmac_f32_16x16x64_bf16 v[56:59], v[68:71], v[176:183], v8 abid:1
  ds_read_b128 v[64:67], v4 offset:23040
  v_smfmac_f32_16x16x64_bf16 v[60:63], v[12:15], v[192:199], v8 abid:1
  s_add_u32 s46, s46, 1
  s_add_u32 s56, s47, s49
  v_smfmac_f32_16x16x64_bf16 v[60:63], v[16:19], v[200:207], v8 abid:1
  v_mul_f32 v56, v56, v20
  v_mul_f32 v58, v58, v20
  v_mul_f32 v57, v57, v21
  v_mul_f32 v59, v59, v21
  v_cvt_pk_bf16_f32 v56, v56, v58
  v_cvt_pk_bf16_f32 v57, v57, v59
  v_bfi_b32 v56, 1, s46, v56
  v_bfi_b32 v57, 1, s46, v57
  buffer_store_dwordx2 v[56:57], v5, s[4:7], s68 offen
  v_smfmac_f32_16x16x64_bf16 v[60:63], v[68:71], v[208:215], v8 abid:1
  s_waitcnt lgkmcnt(3)
  v_smfmac_f32_16x16x64_bf16 v[32:35], v[12:15], v[24:31], v8 abid:1
  ds_read_b128 v[24:27], v1 offset:32768
  v_smfmac_f32_16x16x64_bf16 v[32:35], v[16:19], v[216:223], v8 abid:1
  ds_read_b128 v[28:31], v1 offset:33792
  v_mul_f32 v60, v60, v20
  v_mul_f32 v62, v62, v20
  v_mul_f32 v61, v61, v21
  v_mul_f32 v63, v63, v21
  v_cvt_pk_bf16_f32 v60, v60, v62
  v_cvt_pk_bf16_f32 v61, v61, v63
  v_bfi_b32 v60, 1, s46, v60
  v_bfi_b32 v61, 1, s46, v61
  s_waitcnt lgkmcnt(3)
  v_smfmac_f32_16x16x64_bf16 v[32:35], v[68:71], v[48:55], v8 abid:1
  buffer_store_dwordx2 v[60:61], v5, s[4:7], s69 offen
  v_smfmac_f32_16x16x64_bf16 v[36:39], v[12:15], v[224:231], v8 abid:1
  v_smfmac_f32_16x16x64_bf16 v[36:39], v[16:19], v[232:239], v8 abid:1
  v_mul_f32 v32, v32, v20
  v_mul_f32 v34, v34, v20
  v_mul_f32 v33, v33, v21
  v_mul_f32 v35, v35, v21
  v_cvt_pk_bf16_f32 v32, v32, v34
  v_cvt_pk_bf16_f32 v33, v33, v35
  v_bfi_b32 v32, 1, s46, v32
  v_bfi_b32 v33, 1, s46, v33
  s_waitcnt lgkmcnt(0)
  v_smfmac_f32_16x16x64_bf16 v[36:39], v[68:71], v[24:31], v8 abid:1
  buffer_store_dwordx2 v[32:33], v5, s[4:7], s70 offen
  v_mfma_f32_16x16x32_bf16 v[44:47], v[12:15], v[244:247], v[44:47]
  v_mfma_f32_16x16x32_bf16 v[44:47], v[16:19], v[248:251], v[44:47]
  v_mul_f32 v36, v36, v20
  v_mul_f32 v38, v38, v20
  v_mfma_f32_16x16x32_bf16 v[44:47], v[68:71], v[252:255], v[44:47]
  v_mul_f32 v37, v37, v21
  v_mul_f32 v39, v39, v21
  v_cvt_pk_bf16_f32 v36, v36, v38
  v_cvt_pk_bf16_f32 v37, v37, v39
  v_bfi_b32 v36, 1, s46, v36
  v_bfi_b32 v37, 1, s46, v37
  buffer_store_dwordx2 v[36:37], v5, s[4:7], s71 offen
  s_nop 0
  v_mul_f32 v44, v44, v20
  v_mul_f32 v45, v45, v21
  v_cvt_pk_bf16_f32 v44, v44, v45
  v_bfi_b32 v44, 1, s46, v44
  buffer_store_dword v44, v7, s[4:7], s72 offen
  s_barrier
  buffer_load_dwordx4 v[56:59], v0, s[4:7], s51 offen offset:0 sc1
  buffer_load_dwordx4 v[60:63], v0, s[4:7], s51 offen offset:1024 sc1
  v_mov_b64 v[24:25], 0
  v_mov_b64 v[26:27], 0
  v_mov_b64 v[28:29], 0
  v_mov_b64 v[30:31], 0
  v_mov_b64 v[32:33], 0
  v_mov_b64 v[34:35], 0
  v_mov_b64 v[36:37], 0
  v_mov_b64 v[38:39], 0
  s_add_u32 s16, s47, 4096
  s_add_u32 s17, s47, 8192
  s_add_u32 s23, s23, 16384
  s_barrier
  buffer_load_dwordx4 v[12:15], v0, s[4:7], s47 offen offset:0
  s_waitcnt vmcnt(2)
  buffer_load_dwordx4 v[16:19], v0, s[4:7], s47 offen offset:1024
  v_bitop3_b32 v9, v56, v57, s46 bitop3:0x7e
  v_bitop3_b32 v11, v58, v59, s46 bitop3:0x7e
  v_mfma_f32_16x16x32_bf16 v[40:43], v[64:67], v[56:59], 0
  s_waitcnt vmcnt(2)
  v_bitop3_b32 v44, v60, v61, s46 bitop3:0x7e
  v_bitop3_b32 v45, v62, v63, s46 bitop3:0x7e
  v_mfma_f32_16x16x32_bf16 v[40:43], v[64:67], v[60:63], v[40:43]
  v_or3_b32 v9, v9, v11, v44
  v_bitop3_b32 v9, v9, v45, 1 bitop3:0xa8
  v_cmp_ne_u32 vcc, 0, v9
  s_nop 4
  v_add_f32_dpp v40, v40, v40 row_ror:8 row_mask:0xf bank_mask:0xf
  v_add_f32_dpp v41, v41, v41 row_ror:8 row_mask:0xf bank_mask:0xf
  s_cbranch_vccnz R1_frq
R1_rq:
  v_add_f32_dpp v46, v40, v40 row_ror:4 row_mask:0xf bank_mask:0x1
  v_add_f32_dpp v47, v41, v41 row_ror:4 row_mask:0xf bank_mask:0x1
  v_cvt_pk_bf16_f32 v9, v46, v47
  buffer_load_dwordx4 v[20:23], v0, s[4:7], s47 offen offset:2048
  buffer_load_dwordx4 v[56:59], v0, s[4:7], s47 offen offset:3072
  buffer_store_dword v9, v6, s[4:7], s56 offen
  v_mov_b64 v[64:65], 0
  v_mov_b64 v[66:67], 0
  v_mov_b64 v[68:69], 0
  v_mov_b64 v[70:71], 0
  s_branch R1_go
R1_in:
  s_cmp_gt_u32 s60, 1
  s_cselect_b32 s55, s64, 0
  s_cmp_gt_u32 s55, 0
  s_cbranch_scc1 R1_in1
  s_xor_b32 s55, s59, 64
R1_in0:
  s_load_dword s60, s[42:43], s59 glc
  s_load_dword s64, s[42:43], s55 glc
  s_sub_u32 s54, s54, 1
  s_cbranch_scc1 K_end
  s_waitcnt lgkmcnt(0)
  s_cmp_gt_u32 s60, 1
  s_cbranch_scc0 R1_in0
R1_in1:
  s_add_u32 s16, s47, 4096
  s_add_u32 s17, s47, 8192
  buffer_load_dwordx4 v[12:15], v0, s[4:7], s47 offen offset:0
  buffer_load_dwordx4 v[16:19], v0, s[4:7], s47 offen offset:1024
  buffer_load_dwordx4 v[20:23], v0, s[4:7], s47 offen offset:2048
  buffer_load_dwordx4 v[56:59], v0, s[4:7], s47 offen offset:3072
  v_lshlrev_b32 v11, 3, v0
  s_bitcmp1_b32 s45, 0
  s_cselect_b32 s56, -1, 1
  s_mul_i32 s56, s56, 2176
  s_add_u32 s55, s52, -3840
  s_xor_b32 s55, s55, 16384
  s_cmp_gt_u32 s64, 0
  s_cselect_b32 s55, s55, 1073741824
  buffer_load_dword v11, s[4:7], s55 offen sc1 lds
  s_add_u32 s56, s51, s56
  s_mov_b64 exec, 0x3ffff
  buffer_load_dword v11, s[4:7], s56 offen sc1 lds
  s_mov_b64 exec, -1
  v_mov_b64 v[24:25], 0
  v_mov_b64 v[26:27], 0
  v_mov_b64 v[28:29], 0
  v_mov_b64 v[30:31], 0
  v_mov_b64 v[32:33], 0
  v_mov_b64 v[34:35], 0
  v_mov_b64 v[36:37], 0
  v_mov_b64 v[38:39], 0
  v_mov_b64 v[64:65], 0
  v_mov_b64 v[66:67], 0
  v_mov_b64 v[68:69], 0
  v_mov_b64 v[70:71], 0
  s_waitcnt vmcnt(2)
  s_barrier
  s_branch R1_go2
R1_in2:
  buffer_load_dwordx4 v[12:15], v0, s[4:7], s47 offen offset:0
  buffer_load_dwordx4 v[16:19], v0, s[4:7], s47 offen offset:1024
  buffer_load_dwordx4 v[20:23], v0, s[4:7], s47 offen offset:2048
  buffer_load_dwordx4 v[56:59], v0, s[4:7], s47 offen offset:3072
  v_mov_b64 v[24:25], 0
  v_mov_b64 v[26:27], 0
  v_mov_b64 v[28:29], 0
  v_mov_b64 v[30:31], 0
  v_mov_b64 v[32:33], 0
  v_mov_b64 v[34:35], 0
  v_mov_b64 v[36:37], 0
  v_mov_b64 v[38:39], 0
  v_mov_b64 v[64:65], 0
  v_mov_b64 v[66:67], 0
  v_mov_b64 v[68:69], 0
  v_mov_b64 v[70:71], 0
  s_waitcnt vmcnt(0)
  s_barrier
  s_branch R1_go2
R1_f0:
  buffer_load_dwordx4 v[12:15], v0, s[4:7], s47 offen offset:0 sc1
  s_sub_u32 s54, s54, 1
  s_cbranch_scc1 K_end
  s_nop 3
  v_mov_b64 v[24:25], 0
  v_mov_b64 v[26:27], 0
  v_mov_b64 v[28:29], 0
  v_mov_b64 v[30:31], 0
  buffer_load_dwordx4 v[16:19], v0, s[4:7], s47 offen offset:1024 sc1
  buffer_load_dwordx4 v[20:23], v0, s[4:7], s47 offen offset:2048 sc1
  buffer_load_dwordx4 v[56:59], v0, s[4:7], s47 offen offset:3072 sc1
  buffer_load_dword v10, s[4:7], s47 offen lds
  s_waitcnt vmcnt(4) lgkmcnt(0)
  s_branch R1_go2
R1_c1:
  buffer_load_dwordx4 v[16:19], v0, s[4:7], s47 offen offset:1024 sc1
  s_sub_u32 s54, s54, 1
  s_cbranch_scc1 K_end
  buffer_load_dwordx4 v[20:23], v0, s[4:7], s47 offen offset:2048 sc1
  buffer_load_dwordx4 v[56:59], v0, s[4:7], s47 offen offset:3072 sc1
  buffer_load_dword v10, s[4:7], s47 offen lds
  s_waitcnt vmcnt(3)
  v_max3_u32 v9, v19, v19, v19
  v_cmp_eq_u32 vcc, -1, v9
  s_cbranch_vccnz R1_c1
  s_branch R1_g1
R1_c2:
  buffer_load_dwordx4 v[20:23], v0, s[4:7], s47 offen offset:2048 sc1
  s_sub_u32 s54, s54, 1
  s_cbranch_scc1 K_end
  buffer_load_dwordx4 v[56:59], v0, s[4:7], s47 offen offset:3072 sc1
  buffer_load_dword v10, s[4:7], s47 offen lds
  buffer_load_dwordx4 v[60:63], v0, s[4:7], s16 offen offset:0 sc1
  buffer_load_dwordx4 v[12:15], v0, s[4:7], s16 offen offset:1024 sc1
  s_waitcnt vmcnt(4)
  v_max3_u32 v9, v23, v23, v23
  v_cmp_eq_u32 vcc, -1, v9
  s_cbranch_vccnz R1_c2
  s_branch R1_g2
R1_c3:
  buffer_load_dwordx4 v[56:59], v0, s[4:7], s47 offen offset:3072 sc1
  s_sub_u32 s54, s54, 1
  s_cbranch_scc1 K_end
  buffer_load_dword v10, s[4:7], s47 offen lds
  buffer_load_dwordx4 v[60:63], v0, s[4:7], s16 offen offset:0 sc1
  buffer_load_dwordx4 v[12:15], v0, s[4:7], s16 offen offset:1024 sc1
  buffer_load_dword v10, s[4:7], s47 offen lds
  buffer_load_dwordx4 v[16:19], v0, s[4:7], s16 offen offset:2048 sc1
  buffer_load_dwordx4 v[4:7], v0, s[4:7], s17 offen offset:0 sc1
  s_waitcnt vmcnt(6)
  v_max3_u32 v9, v59, v59, v59
  v_cmp_eq_u32 vcc, -1, v9
  s_cbranch_vccnz R1_c3
  s_branch R1_g3
R1_c45:
  buffer_load_dwordx4 v[60:63], v0, s[4:7], s16 offen offset:0 sc1
  buffer_load_dwordx4 v[12:15], v0, s[4:7], s16 offen offset:1024 sc1
  s_sub_u32 s54, s54, 1
  s_cbranch_scc1 K_end
  buffer_load_dword v10, s[4:7], s47 offen lds
  buffer_load_dwordx4 v[16:19], v0, s[4:7], s16 offen offset:2048 sc1
  buffer_load_dwordx4 v[4:7], v0, s[4:7], s17 offen offset:0 sc1
  buffer_load_dwordx4 v[20:23], v0, s[4:7], s16 offen offset:3072 sc1
  buffer_load_dword v10, s[4:7], s47 offen lds
  s_waitcnt vmcnt(5)
  v_max3_u32 v9, v63, v15, v63
  v_cmp_eq_u32 vcc, -1, v9
  s_cbranch_vccnz R1_c45
  s_branch R1_g45
R1_c678:
  buffer_load_dwordx4 v[16:19], v0, s[4:7], s16 offen offset:2048 sc1
  buffer_load_dwordx4 v[4:7], v0, s[4:7], s17 offen offset:0 sc1
  buffer_load_dwordx4 v[20:23], v0, s[4:7], s16 offen offset:3072 sc1
  s_sub_u32 s54, s54, 1
  s_cbranch_scc1 K_end
  buffer_load_dword v10, s[4:7], s47 offen lds
  buffer_load_dword v10, s[4:7], s47 offen lds
  buffer_load_dword v10, s[4:7], s47 offen lds
  s_waitcnt vmcnt(3)
  v_max3_u32 v9, v19, v23, v7
  v_cmp_eq_u32 vcc, -1, v9
  s_cbranch_vccnz R1_c678
  s_branch R1_g678
R1_fn:
  s_cmp_eq_u32 s20, s46
  s_cbranch_scc1 R1_gn
  s_mov_b32 s20, s46
  s_waitcnt vmcnt(0) lgkmcnt(0)
  s_nop 7
R1_fl:
  buffer_load_dwordx4 v[12:15], v0, s[4:7], s47 offen offset:0 sc1
  buffer_load_dwordx4 v[16:19], v0, s[4:7], s47 offen offset:1024 sc1
  buffer_load_dwordx4 v[20:23], v0, s[4:7], s47 offen offset:2048 sc1
  buffer_load_dwordx4 v[24:27], v0, s[4:7], s47 offen offset:3072 sc1
  buffer_load_dwordx4 v[28:31], v0, s[4:7], s16 offen offset:0 sc1
  buffer_load_dwordx4 v[32:35], v0, s[4:7], s16 offen offset:1024 sc1
  buffer_load_dwordx4 v[36:39], v0, s[4:7], s16 offen offset:2048 sc1
  buffer_load_dwordx4 v[40:43], v0, s[4:7], s16 offen offset:3072 sc1
  buffer_load_dwordx4 v[44:47], v0, s[4:7], s17 offen offset:0 sc1
  s_sub_u32 s54, s54, 1
  s_cbranch_scc1 K_end
  s_waitcnt vmcnt(8)
  v_max_u32 v9, v12, v13
  v_max3_u32 v9, v9, v14, v15
  s_waitcnt vmcnt(7)
  v_max3_u32 v9, v9, v16, v17
  v_max3_u32 v9, v9, v18, v19
  s_waitcnt vmcnt(6)
  v_max3_u32 v9, v9, v20, v21
  v_max3_u32 v9, v9, v22, v23
  s_waitcnt vmcnt(5)
  v_max3_u32 v9, v9, v24, v25
  v_max3_u32 v9, v9, v26, v27
  s_waitcnt vmcnt(4)
  v_max3_u32 v9, v9, v28, v29
  v_max3_u32 v9, v9, v30, v31
  s_waitcnt vmcnt(3)
  v_max3_u32 v9, v9, v32, v33
  v_max3_u32 v9, v9, v34, v35
  s_waitcnt vmcnt(2)
  v_max3_u32 v9, v9, v36, v37
  v_max3_u32 v9, v9, v38, v39
  s_waitcnt vmcnt(1)
  v_max3_u32 v9, v9, v40, v41
  v_max3_u32 v9, v9, v42, v43
  s_waitcnt vmcnt(0)
  v_max3_u32 v9, v9, v44, v45
  v_max3_u32 v9, v9, v46, v47
  v_cmp_eq_u32 vcc, -1, v9
  s_cbranch_vccnz R1_fl
  s_barrier
  buffer_inv sc1
  s_waitcnt vmcnt(0)
  s_barrier
  s_branch R1_in2
R1_frq:
R1_lrq:
  buffer_load_dwordx4 v[56:59], v0, s[4:7], s51 offen offset:0 sc1
  buffer_load_dwordx4 v[60:63], v0, s[4:7], s51 offen offset:1024 sc1
  s_sub_u32 s54, s54, 1
  s_cbranch_scc1 K_end
  s_waitcnt vmcnt(0)
  v_bitop3_b32 v9, v56, v57, s46 bitop3:0x7e
  v_bitop3_b32 v11, v58, v59, s46 bitop3:0x7e
  v_mfma_f32_16x16x32_bf16 v[40:43], v[64:67], v[56:59], 0
  v_bitop3_b32 v44, v60, v61, s46 bitop3:0x7e
  v_bitop3_b32 v45, v62, v63, s46 bitop3:0x7e
  v_mfma_f32_16x16x32_bf16 v[40:43], v[64:67], v[60:63], v[40:43]
  v_or3_b32 v9, v9, v11, v44
  v_bitop3_b32 v9, v9, v45, 1 bitop3:0xa8
  v_cmp_ne_u32 vcc, 0, v9
  s_nop 4
  v_add_f32_dpp v40, v40, v40 row_ror:8 row_mask:0xf bank_mask:0xf
  v_add_f32_dpp v41, v41, v41 row_ror:8 row_mask:0xf bank_mask:0xf
  s_cbranch_vccz R1_rq
  s_branch R1_lrq
R2_go:
  s_waitcnt vmcnt(4)
R2_go2:
  v_cmp_eq_u32 vcc, -1, v15
  v_smfmac_f32_16x16x64_bf16 v[24:27], v[12:15], a[0:7], v8
  ds_read_b128 v[40:43], v1 offset:16384
  v_smfmac_f32_16x16x64_bf16 v[28:31], v[12:15], a[8:15], v8
  s_cbranch_vccnz R2_f0
  v_smfmac_f32_16x16x64_bf16 v[32:35], v[12:15], a[128:135], v8
  ds_read_b128 v[44:47], v1 offset:17408
  v_smfmac_f32_16x16x64_bf16 v[36:39], v[12:15], a[136:143], v8
  ds_read_b128 v[48:51], v1 offset:18432
  s_waitcnt vmcnt(3)
  v_cmp_eq_u32 vcc, -1, v19
  v_smfmac_f32_16x16x64_bf16 v[64:67], v[12:15], a[192:199], v8
  ds_read_b128 v[52:55], v1 offset:19456
  v_smfmac_f32_16x16x64_bf16 v[68:71], v[12:15], a[200:207], v8
  s_cbranch_vccnz R2_c1
R2_g1:
  v_smfmac_f32_16x16x64_bf16 v[24:27], v[16:19], a[16:23], v8
  buffer_load_dwordx4 v[60:63], v0, s[4:7], s16 offen offset:0
  s_waitcnt lgkmcnt(2)
  v_smfmac_f32_16x16x64_bf16 v[32:35], v[16:19], v[40:47], v8
  ds_read_b128 v[40:43], v1 offset:20480
  buffer_load_dwordx4 v[12:15], v0, s[4:7], s16 offen offset:1024
  v_smfmac_f32_16x16x64_bf16 v[28:31], v[16:19], a[24:31], v8
  ds_read_b128 v[44:47], v1 offset:21504
  s_waitcnt lgkmcnt(2)
  v_smfmac_f32_16x16x64_bf16 v[36:39], v[16:19], v[48:55], v8
  ds_read_b128 v[48:51], v1 offset:22528
  s_waitcnt vmcnt(4)
  v_cmp_eq_u32 vcc, -1, v23
  v_smfmac_f32_16x16x64_bf16 v[64:67], v[16:19], a[208:215], v8
  ds_read_b128 v[52:55], v1 offset:23552
  v_smfmac_f32_16x16x64_bf16 v[68:71], v[16:19], a[216:223], v8
  s_cbranch_vccnz R2_c2
R2_g2:
  v_smfmac_f32_16x16x64_bf16 v[24:27], v[20:23], a[32:39], v8
  buffer_load_dwordx4 v0, s[4:7], s52 offen offset:256 sc1 lds
  s_waitcnt lgkmcnt(2)
  v_smfmac_f32_16x16x64_bf16 v[32:35], v[20:23], v[40:47], v8
  ds_read_b128 v[40:43], v1 offset:24576
  v_smfmac_f32_16x16x64_bf16 v[28:31], v[20:23], a[40:47], v8
  ds_read_b128 v[44:47], v1 offset:25600
  buffer_load_dwordx4 v[16:19], v0, s[4:7], s16 offen offset:2048
  s_waitcnt lgkmcnt(2)
  v_smfmac_f32_16x16x64_bf16 v[36:39], v[20:23], v[48:55], v8
  ds_read_b128 v[48:51], v1 offset:26624
  s_waitcnt vmcnt(5)
  v_cmp_eq_u32 vcc, -1, v59
  v_smfmac_f32_16x16x64_bf16 v[64:67], v[20:23], a[224:231], v8
  ds_read_b128 v[52:55], v1 offset:27648
  buffer_load_dwordx4 v[4:7], v0, s[4:7], s17 offen offset:0
  v_smfmac_f32_16x16x64_bf16 v[68:71], v[20:23], a[232:239], v8
  s_cbranch_vccnz R2_c3
R2_g3:
  v_smfmac_f32_16x16x64_bf16 v[24:27], v[56:59], a[48:55], v8
  buffer_load_dwordx4 v[20:23], v0, s[4:7], s16 offen offset:3072
  s_waitcnt lgkmcnt(2)
  v_smfmac_f32_16x16x64_bf16 v[32:35], v[56:59], v[40:47], v8
  ds_read_b128 v[40:43], v1 offset:28672
  buffer_load_dwordx4 v0, s[4:7], s52 offen offset:1280 sc1 lds
  v_smfmac_f32_16x16x64_bf16 v[28:31], v[56:59], a[56:63], v8
  ds_read_b128 v[44:47], v1 offset:29696
  s_waitcnt lgkmcnt(2)
  v_smfmac_f32_16x16x64_bf16 v[36:39], v[56:59], v[48:55], v8
  ds_read_b128 v[48:51], v1 offset:30720
  s_waitcnt vmcnt(5)
  v_cmp_u_f32 vcc, v63, v15
  v_smfmac_f32_16x16x64_bf16 v[64:67], v[56:59], a[240:247], v8
  ds_read_b128 v[52:55], v1 offset:31744
  v_smfmac_f32_16x16x64_bf16 v[68:71], v[56:59], a[248:255], v8
  s_cbranch_vccnz R2_c45
R2_g45:
  v_smfmac_f32_16x16x64_bf16 v[24:27], v[60:63], a[64:71], v8
  s_waitcnt lgkmcnt(2)
  v_smfmac_f32_16x16x64_bf16 v[32:35], v[60:63], v[40:47], v8
  ds_read_b128 v[40:43], v1 offset:0
  v_smfmac_f32_16x16x64_bf16 v[28:31], v[60:63], a[72:79], v8
  ds_read_b128 v[44:47], v1 offset:1024
  buffer_load_dwordx4 v0, s[4:7], s52 offen offset:2304 sc1 lds
  s_waitcnt lgkmcnt(2)
  v_smfmac_f32_16x16x64_bf16 v[36:39], v[60:63], v[48:55], v8
  ds_read_b128 v[48:51], v1 offset:2048
  v_smfmac_f32_16x16x64_bf16 v[64:67], v[60:63], v[72:79], v8
  ds_read_b128 v[52:55], v1 offset:3072
  v_smfmac_f32_16x16x64_bf16 v[68:71], v[60:63], v[80:87], v8
  v_lshl_add_u32 v11, v0, 3, s21
  v_smfmac_f32_16x16x64_bf16 v[24:27], v[12:15], a[80:87], v8
  s_waitcnt lgkmcnt(2)
  v_smfmac_f32_16x16x64_bf16 v[32:35], v[12:15], v[40:47], v8
  ds_read_b128 v[40:43], v1 offset:4096
  v_smfmac_f32_16x16x64_bf16 v[28:31], v[12:15], a[88:95], v8
  ds_read_b128 v[44:47], v1 offset:5120
  s_waitcnt vmcnt(3) lgkmcnt(2)
  v_max_u32 v9, v19, v7
  v_smfmac_f32_16x16x64_bf16 v[36:39], v[12:15], v[48:55], v8
  ds_read_b128 v[48:51], v1 offset:6144
  s_waitcnt vmcnt(2)
  v_cmp_u_f32 vcc, v9, v23
  v_smfmac_f32_16x16x64_bf16 v[64:67], v[12:15], v[88:95], v8
  ds_read_b128 v[52:55], v1 offset:7168
  buffer_load_dwordx4 v0, s[4:7], s52 offen offset:3328 sc1 lds
  v_smfmac_f32_16x16x64_bf16 v[68:71], v[12:15], v[96:103], v8
  s_cbranch_vccnz R2_c678
R2_g678:
  v_smfmac_f32_16x16x64_bf16 v[24:27], v[16:19], a[96:103], v8
  s_waitcnt vmcnt(2)
  s_waitcnt lgkmcnt(2)
  s_barrier
  ds_read_b128 v[12:15], v0 offset:14336
  v_smfmac_f32_16x16x64_bf16 v[24:27], v[20:23], v[40:47], v8
  buffer_load_dword v11, s[4:7], s52 offen sc1 lds
  v_smfmac_f32_16x16x64_bf16 v[28:31], v[16:19], a[104:111], v8
  s_waitcnt lgkmcnt(1)
  v_smfmac_f32_16x16x64_bf16 v[28:31], v[20:23], v[48:55], v8
  ds_read_b128 v[60:63], v0 offset:13312
  v_smfmac_f32_16x16x64_bf16 v[24:27], v[4:7], a[112:119], v8
  ds_read_b128 v[44:47], v0 offset:8960
  v_smfmac_f32_16x16x64_bf16 v[28:31], v[4:7], a[120:127], v8
  ds_read_b128 v[56:59], v0 offset:9984
  v_smfmac_f32_16x16x64_bf16 v[32:35], v[16:19], a[144:151], v8
  v_add_f32 v24, v24, v26
  v_add_f32 v25, v25, v27
  v_smfmac_f32_16x16x64_bf16 v[32:35], v[20:23], a[160:167], v8
  v_add_f32 v28, v28, v30
  v_add_f32 v29, v29, v31
  v_smfmac_f32_16x16x64_bf16 v[32:35], v[4:7], a[176:183], v8
  v_cvt_pk_bf16_f32 v41, v24, v28
  v_cvt_pk_bf16_f32 v43, v25, v29
  v_smfmac_f32_16x16x64_bf16 v[36:39], v[16:19], a[152:159], v8
  ds_write2_b32 v3, v41, v43 offset0:0 offset1:4
  v_smfmac_f32_16x16x64_bf16 v[36:39], v[20:23], a[168:175], v8
  ds_read_b128 v[24:27], v2 offset:20736
  v_add_f32 v32, v32, v34
  v_smfmac_f32_16x16x64_bf16 v[36:39], v[4:7], a[184:191], v8
  v_add_f32 v33, v33, v35
  v_smfmac_f32_16x16x64_bf16 v[64:67], v[16:19], v[104:111], v8
  v_smfmac_f32_16x16x64_bf16 v[68:71], v[16:19], v[112:119], v8
  s_waitcnt lgkmcnt(1)
  s_barrier
  v_add_f32 v36, v36, v38
  v_smfmac_f32_16x16x64_bf16 v[64:67], v[20:23], v[120:127], v8
  ds_read_b128 v[28:31], v2 offset:21888
  v_add_f32 v37, v37, v39
  v_smfmac_f32_16x16x64_bf16 v[68:71], v[20:23], v[128:135], v8
  ds_read_b128 v[16:19], v0 offset:256
  v_cvt_pk_bf16_f32 v40, v32, v36
  v_smfmac_f32_16x16x64_bf16 v[64:67], v[4:7], v[136:143], v8
  ds_read_b128 v[20:23], v0 offset:1280
  v_cvt_pk_bf16_f32 v42, v33, v37
  v_smfmac_f32_16x16x64_bf16 v[68:71], v[4:7], v[144:151], v8
  ds_read_b128 v[48:51], v2 offset:18432
  ds_read_b128 v[4:7], v0 offset:4608
  ds_write2_b32 v3, v40, v42 offset0:144 offset1:148
  s_waitcnt lgkmcnt(6)
  v_mfma_f32_16x16x32_bf16 v[32:35], v[44:47], v[24:27], 0
  ds_read_b128 v[44:47], v0 offset:5632
  v_add_f32 v64, v64, v66
  v_mfma_f32_16x16x32_bf16 v[36:39], v[56:59], v[24:27], 0
  ds_read_b128 v[52:55], v2 offset:19584
  s_waitcnt lgkmcnt(7)
  v_add_f32 v65, v65, v67
  v_mfma_f32_16x16x32_bf16 v[32:35], v[60:63], v[28:31], v[32:35]
  v_cvt_pk_bf16_f32 v41, v64, v65
  v_mfma_f32_16x16x32_bf16 v[36:39], v[12:15], v[28:31], v[36:39]
  ds_read_b128 v[64:67], v2 offset:21312
  s_waitcnt lgkmcnt(5)
  v_add_f32 v68, v68, v70
  v_mfma_f32_16x16x32_bf16 v[32:35], v[16:19], v[48:51], v[32:35]
  s_waitcnt lgkmcnt(2)
  s_barrier
  ds_read_b128 v[12:15], v2 offset:22464
  v_add_f32 v69, v69, v71
  v_mfma_f32_16x16x32_bf16 v[36:39], v[20:23], v[48:51], v[36:39]
  ds_read_b128 v[16:19], v2 offset:19008
  s_waitcnt lgkmcnt(3)
  v_cvt_pk_bf16_f32 v43, v68, v69
  v_mfma_f32_16x16x32_bf16 v[32:35], v[4:7], v[52:55], v[32:35]
  s_waitcnt vmcnt(2)
  ds_read_b128 v[56:59], v0 offset:11008
  ds_read_b128 v[68:71], v2 offset:20160
  v_mfma_f32_16x16x32_bf16 v[36:39], v[44:47], v[52:55], v[36:39]
  s_waitcnt vmcnt(1)
  ds_read_b128 v[60:63], v0 offset:12032
  s_waitcnt lgkmcnt(5)
  v_mfma_f32_16x16x32_bf16 v[44:47], v[64:67], v[24:27], 0
  s_waitcnt lgkmcnt(4)
  v_cmp_u_f32 vcc, v32, v32
  v_max3_f32 v9, v32, v33, v34
  v_mfma_f32_16x16x32_bf16 v[44:47], v[12:15], v[28:31], v[44:47]
  s_waitcnt lgkmcnt(3)
  v_max3_f32 v9, v9, v35, v36
  v_max3_f32 v9, v9, v37, v38
  v_mfma_f32_16x16x32_bf16 v[44:47], v[16:19], v[48:51], v[44:47]
  s_cbranch_vccnz R2_fn
R2_gn:
  s_waitcnt lgkmcnt(1)
  v_mfma_f32_16x16x32_bf16 v[44:47], v[68:71], v[52:55], v[44:47]
  buffer_store_dwordx4 v[40:43], v0, s[4:7], s53 offen offset:2048 sc1
  ds_read_b128 v[4:7], v0 offset:23552
  ds_read_b128 v[24:27], v1 offset:8192
  v_mov_b64 v[12:13], s[62:63]
  v_mov_b64 v[14:15], s[62:63]
  v_max_f32 v9, v9, v39
  s_nop 1
  v_max3_f32 v46, v9, v44, v45
  v_max3_f32 v9, v9, v44, v45
  s_add_u32 s53, s53, 131072
  s_add_u32 s47, s47, 16384
  v_permlane32_swap_b32 v9, v46
  v_max_f32 v47, v9, v46
  v_max_f32 v9, v9, v46
  s_add_u32 s22, s47, s48
  s_nop 0
  v_permlane16_swap_b32 v9, v47
  v_max_f32 v9, v9, v47
  v_mul_f32 v46, s58, v9
  v_pk_fma_f32 v[44:45], v[44:45], s[58:59], v[46:47] op_sel_hi:[1,0,0] neg_lo:[0,0,1] neg_hi:[0,0,1]
  v_pk_fma_f32 v[32:33], v[32:33], s[58:59], v[46:47] op_sel_hi:[1,0,0] neg_lo:[0,0,1] neg_hi:[0,0,1]
  v_pk_fma_f32 v[34:35], v[34:35], s[58:59], v[46:47] op_sel_hi:[1,0,0] neg_lo:[0,0,1] neg_hi:[0,0,1]
  v_pk_fma_f32 v[36:37], v[36:37], s[58:59], v[46:47] op_sel_hi:[1,0,0] neg_lo:[0,0,1] neg_hi:[0,0,1]
  v_pk_fma_f32 v[38:39], v[38:39], s[58:59], v[46:47] op_sel_hi:[1,0,0] neg_lo:[0,0,1] neg_hi:[0,0,1]
  v_exp_f32 v44, v44
  v_exp_f32 v45, v45
  v_exp_f32 v32, v32
  v_cvt_pk_bf16_f32 v11, v44, v45
  v_exp_f32 v33, v33
  v_exp_f32 v34, v34
  v_mfma_f32_16x16x16_bf16 v[16:19], v[40:41], v[10:11], 0
  v_cvt_pk_bf16_f32 v64, v32, v33
  v_exp_f32 v35, v35
  v_mfma_f32_16x16x16_bf16 v[68:71], v[42:43], v[10:11], 0
  v_exp_f32 v36, v36
  v_cvt_pk_bf16_f32 v65, v34, v35
  v_exp_f32 v37, v37
  v_mfma_f32_16x16x16_bf16 v[20:23], v[10:11], v[12:13], 0
  ds_read_b128 v[28:31], v1 offset:9216
  v_exp_f32 v38, v38
  v_exp_f32 v39, v39
  v_cvt_pk_bf16_f32 v66, v36, v37
  v_cvt_pk_bf16_f32 v67, v38, v39
  v_mov_b64 v[32:33], 0
  v_mov_b64 v[34:35], 0
  v_mfma_f32_16x16x32_bf16 v[16:19], v[56:59], v[64:67], v[16:19]
  v_mov_b64 v[36:37], 0
  v_mov_b64 v[38:39], 0
  s_waitcnt lgkmcnt(3)
  v_mfma_f32_16x16x32_bf16 v[68:71], v[60:63], v[64:67], v[68:71]
  v_mov_b64 v[56:57], 0
  v_mov_b64 v[58:59], 0
  v_mfma_f32_16x16x32_bf16 v[20:23], v[64:67], v[12:15], v[20:23]
  v_cvt_pk_bf16_f32 v64, v16, v17
  v_cvt_pk_bf16_f32 v65, v18, v19
  v_mov_b64 v[60:61], 0
  v_mov_b64 v[62:63], 0
  v_cvt_pk_bf16_f32 v66, v68, v69
  v_cvt_pk_bf16_f32 v67, v70, v71
  ds_write_b128 v2, v[64:67] offset:20736
  s_add_u32 s52, s52, 524288
  v_mfma_f32_16x16x32_bf16 v[44:47], v[64:67], v[240:243], 0
  ds_read_b128 v[48:51], v1 offset:10240
  s_waitcnt lgkmcnt(2)
  v_smfmac_f32_16x16x64_bf16 v[32:35], v[64:67], v[24:31], v8 abid:1
  ds_read_b128 v[52:55], v1 offset:11264
  s_cmp_eq_u32 s46, 63
  v_smfmac_f32_16x16x64_bf16 v[56:59], v[64:67], v[152:159], v8 abid:1
  s_cbranch_scc1 K_end
  s_waitcnt lgkmcnt(2)
  s_barrier
  v_smfmac_f32_16x16x64_bf16 v[60:63], v[64:67], v[184:191], v8 abid:1
  ds_read_b128 v[12:15], v2 offset:21888
  ds_read_b128 v[16:19], v2 offset:18432
  ds_read_b128 v[68:71], v2 offset:19584
  s_waitcnt lgkmcnt(3)
  v_smfmac_f32_16x16x64_bf16 v[36:39], v[64:67], v[48:55], v8 abid:1
  ds_read_b128 v[24:27], v1 offset:12288
  ds_read_b128 v[28:31], v1 offset:13312
  v_rcp_f32 v20, v20
  v_rcp_f32 v21, v21
  s_waitcnt lgkmcnt(4)
  v_smfmac_f32_16x16x64_bf16 v[56:59], v[12:15], v[160:167], v8 abid:1
  ds_read_b128 v[48:51], v1 offset:14336
  s_waitcnt lgkmcnt(4)
  v_smfmac_f32_16x16x64_bf16 v[56:59], v[16:19], v[168:175], v8 abid:1
  ds_read_b128 v[52:55], v1 offset:15360
  s_waitcnt lgkmcnt(4)
  v_smfmac_f32_16x16x64_bf16 v[56:59], v[68:71], v[176:183], v8 abid:1
  ds_read_b128 v[64:67], v4 offset:23040
  v_smfmac_f32_16x16x64_bf16 v[60:63], v[12:15], v[192:199], v8 abid:1
  s_add_u32 s46, s46, 1
  s_add_u32 s56, s47, s49
  v_smfmac_f32_16x16x64_bf16 v[60:63], v[16:19], v[200:207], v8 abid:1
  v_mul_f32 v56, v56, v20
  v_mul_f32 v58, v58, v20
  v_mul_f32 v57, v57, v21
  v_mul_f32 v59, v59, v21
  v_cvt_pk_bf16_f32 v56, v56, v58
  v_cvt_pk_bf16_f32 v57, v57, v59
  v_bfi_b32 v56, 1, s46, v56
  v_bfi_b32 v57, 1, s46, v57
  buffer_store_dwordx2 v[56:57], v5, s[4:7], s68 offen
  v_smfmac_f32_16x16x64_bf16 v[60:63], v[68:71], v[208:215], v8 abid:1
  s_waitcnt lgkmcnt(3)
  v_smfmac_f32_16x16x64_bf16 v[32:35], v[12:15], v[24:31], v8 abid:1
  ds_read_b128 v[24:27], v1 offset:32768
  v_smfmac_f32_16x16x64_bf16 v[32:35], v[16:19], v[216:223], v8 abid:1
  ds_read_b128 v[28:31], v1 offset:33792
  v_mul_f32 v60, v60, v20
  v_mul_f32 v62, v62, v20
  v_mul_f32 v61, v61, v21
  v_mul_f32 v63, v63, v21
  v_cvt_pk_bf16_f32 v60, v60, v62
  v_cvt_pk_bf16_f32 v61, v61, v63
  v_bfi_b32 v60, 1, s46, v60
  v_bfi_b32 v61, 1, s46, v61
  s_waitcnt lgkmcnt(3)
  v_smfmac_f32_16x16x64_bf16 v[32:35], v[68:71], v[48:55], v8 abid:1
  buffer_store_dwordx2 v[60:61], v5, s[4:7], s69 offen
  v_smfmac_f32_16x16x64_bf16 v[36:39], v[12:15], v[224:231], v8 abid:1
  v_smfmac_f32_16x16x64_bf16 v[36:39], v[16:19], v[232:239], v8 abid:1
  v_mul_f32 v32, v32, v20
  v_mul_f32 v34, v34, v20
  v_mul_f32 v33, v33, v21
  v_mul_f32 v35, v35, v21
  v_cvt_pk_bf16_f32 v32, v32, v34
  v_cvt_pk_bf16_f32 v33, v33, v35
  v_bfi_b32 v32, 1, s46, v32
  v_bfi_b32 v33, 1, s46, v33
  s_waitcnt lgkmcnt(0)
  v_smfmac_f32_16x16x64_bf16 v[36:39], v[68:71], v[24:31], v8 abid:1
  buffer_store_dwordx2 v[32:33], v5, s[4:7], s70 offen
  v_mfma_f32_16x16x32_bf16 v[44:47], v[12:15], v[244:247], v[44:47]
  v_mfma_f32_16x16x32_bf16 v[44:47], v[16:19], v[248:251], v[44:47]
  v_mul_f32 v36, v36, v20
  v_mul_f32 v38, v38, v20
  v_mfma_f32_16x16x32_bf16 v[44:47], v[68:71], v[252:255], v[44:47]
  v_mul_f32 v37, v37, v21
  v_mul_f32 v39, v39, v21
  v_cvt_pk_bf16_f32 v36, v36, v38
  v_cvt_pk_bf16_f32 v37, v37, v39
  v_bfi_b32 v36, 1, s46, v36
  v_bfi_b32 v37, 1, s46, v37
  buffer_store_dwordx2 v[36:37], v5, s[4:7], s71 offen
  s_nop 0
  v_mul_f32 v44, v44, v20
  v_mul_f32 v45, v45, v21
  v_cvt_pk_bf16_f32 v44, v44, v45
  v_bfi_b32 v44, 1, s46, v44
  buffer_store_dword v44, v7, s[4:7], s72 offen
  s_barrier
  v_mov_b64 v[24:25], 0
  v_mov_b64 v[26:27], 0
  v_mov_b64 v[28:29], 0
  v_mov_b64 v[30:31], 0
  v_mov_b64 v[32:33], 0
  v_mov_b64 v[34:35], 0
  v_mov_b64 v[36:37], 0
  v_mov_b64 v[38:39], 0
  buffer_load_dwordx4 v[56:59], v0, s[4:7], s51 offen offset:0 sc1
  buffer_load_dwordx4 v[60:63], v0, s[4:7], s51 offen offset:1024 sc1
  s_add_u32 s16, s47, 4096
  s_add_u32 s17, s47, 8192
  s_barrier
  buffer_load_dwordx4 v[12:15], v0, s[4:7], s47 offen offset:0
  s_waitcnt vmcnt(2)
  buffer_load_dwordx4 v[16:19], v0, s[4:7], s47 offen offset:1024
  v_bitop3_b32 v9, v56, v57, s46 bitop3:0x7e
  v_bitop3_b32 v11, v58, v59, s46 bitop3:0x7e
  v_mfma_f32_16x16x32_bf16 v[40:43], v[64:67], v[56:59], 0
  s_waitcnt vmcnt(2)
  v_bitop3_b32 v44, v60, v61, s46 bitop3:0x7e
  v_bitop3_b32 v45, v62, v63, s46 bitop3:0x7e
  v_mfma_f32_16x16x32_bf16 v[40:43], v[64:67], v[60:63], v[40:43]
  v_or3_b32 v9, v9, v11, v44
  v_bitop3_b32 v9, v9, v45, 1 bitop3:0xa8
  v_cmp_ne_u32 vcc, 0, v9
  s_nop 4
  v_add_f32_dpp v40, v40, v40 row_ror:8 row_mask:0xf bank_mask:0xf
  v_add_f32_dpp v41, v41, v41 row_ror:8 row_mask:0xf bank_mask:0xf
  s_cbranch_vccnz R2_frq
R2_rq:
  v_add_f32_dpp v46, v40, v40 row_ror:4 row_mask:0xf bank_mask:0x1
  v_add_f32_dpp v47, v41, v41 row_ror:4 row_mask:0xf bank_mask:0x1
  v_cvt_pk_bf16_f32 v9, v46, v47
  buffer_load_dwordx4 v[20:23], v0, s[4:7], s47 offen offset:2048
  buffer_load_dwordx4 v[56:59], v0, s[4:7], s47 offen offset:3072
  buffer_store_dword v9, v6, s[4:7], s56 offen
  v_mov_b64 v[64:65], 0
  v_mov_b64 v[66:67], 0
  v_mov_b64 v[68:69], 0
  v_mov_b64 v[70:71], 0
  s_branch R2_go
R2_in:
  s_cmp_gt_u32 s60, 1
  s_cselect_b32 s55, s64, 0
  s_cmp_gt_u32 s55, 0
  s_cbranch_scc1 R2_in1
  s_xor_b32 s55, s59, 64
R2_in0:
  s_load_dword s60, s[42:43], s59 glc
  s_load_dword s64, s[42:43], s55 glc
  s_sub_u32 s54, s54, 1
  s_cbranch_scc1 K_end
  s_waitcnt lgkmcnt(0)
  s_cmp_gt_u32 s60, 1
  s_cbranch_scc0 R2_in0
R2_in1:
  s_add_u32 s16, s47, 4096
  s_add_u32 s17, s47, 8192
  buffer_load_dwordx4 v[12:15], v0, s[4:7], s47 offen offset:0
  buffer_load_dwordx4 v[16:19], v0, s[4:7], s47 offen offset:1024
  buffer_load_dwordx4 v[20:23], v0, s[4:7], s47 offen offset:2048
  buffer_load_dwordx4 v[56:59], v0, s[4:7], s47 offen offset:3072
  v_lshlrev_b32 v11, 3, v0
  s_bitcmp1_b32 s45, 0
  s_cselect_b32 s56, -1, 1
  s_mul_i32 s56, s56, 2176
  s_add_u32 s55, s52, 256
  buffer_load_dword v11, s[4:7], s55 offen sc1 lds
  s_bfe_u32 s55, s45, 0x20002
  s_mul_i32 s55, s55, 2304
  s_and_b32 s57, s45, 16
  s_lshl_b32 s57, s57, 10
  s_add_u32 s55, s55, s57
  s_add_u32 s55, s55, s47
  s_add_u32 s56, s51, s56
  s_mov_b64 exec, 0x3ffff
  buffer_load_dword v11, s[4:7], s55 offen sc1 lds
  buffer_load_dword v11, s[4:7], s56 offen sc1 lds
  s_mov_b64 exec, -1
  v_mov_b64 v[24:25], 0
  v_mov_b64 v[26:27], 0
  v_mov_b64 v[28:29], 0
  v_mov_b64 v[30:31], 0
  v_mov_b64 v[32:33], 0
  v_mov_b64 v[34:35], 0
  v_mov_b64 v[36:37], 0
  v_mov_b64 v[38:39], 0
  v_mov_b64 v[64:65], 0
  v_mov_b64 v[66:67], 0
  v_mov_b64 v[68:69], 0
  v_mov_b64 v[70:71], 0
  s_waitcnt vmcnt(3)
  s_barrier
  s_branch R2_go2
R2_in2:
  buffer_load_dwordx4 v[12:15], v0, s[4:7], s47 offen offset:0
  buffer_load_dwordx4 v[16:19], v0, s[4:7], s47 offen offset:1024
  buffer_load_dwordx4 v[20:23], v0, s[4:7], s47 offen offset:2048
  buffer_load_dwordx4 v[56:59], v0, s[4:7], s47 offen offset:3072
  v_mov_b64 v[24:25], 0
  v_mov_b64 v[26:27], 0
  v_mov_b64 v[28:29], 0
  v_mov_b64 v[30:31], 0
  v_mov_b64 v[32:33], 0
  v_mov_b64 v[34:35], 0
  v_mov_b64 v[36:37], 0
  v_mov_b64 v[38:39], 0
  v_mov_b64 v[64:65], 0
  v_mov_b64 v[66:67], 0
  v_mov_b64 v[68:69], 0
  v_mov_b64 v[70:71], 0
  s_waitcnt vmcnt(0)
  s_barrier
  s_branch R2_go2
R2_f0:
  buffer_load_dwordx4 v[12:15], v0, s[4:7], s47 offen offset:0 sc1
  s_sub_u32 s54, s54, 1
  s_cbranch_scc1 K_end
  s_nop 3
  v_mov_b64 v[24:25], 0
  v_mov_b64 v[26:27], 0
  v_mov_b64 v[28:29], 0
  v_mov_b64 v[30:31], 0
  buffer_load_dwordx4 v[16:19], v0, s[4:7], s47 offen offset:1024 sc1
  buffer_load_dwordx4 v[20:23], v0, s[4:7], s47 offen offset:2048 sc1
  buffer_load_dwordx4 v[56:59], v0, s[4:7], s47 offen offset:3072 sc1
  buffer_load_dword v10, s[4:7], s47 offen lds
  s_waitcnt vmcnt(4) lgkmcnt(0)
  s_branch R2_go2
R2_c1:
  buffer_load_dwordx4 v[16:19], v0, s[4:7], s47 offen offset:1024 sc1
  s_sub_u32 s54, s54, 1
  s_cbranch_scc1 K_end
  buffer_load_dwordx4 v[20:23], v0, s[4:7], s47 offen offset:2048 sc1
  buffer_load_dwordx4 v[56:59], v0, s[4:7], s47 offen offset:3072 sc1
  buffer_load_dword v10, s[4:7], s47 offen lds
  s_waitcnt vmcnt(3)
  v_max3_u32 v9, v19, v19, v19
  v_cmp_eq_u32 vcc, -1, v9
  s_cbranch_vccnz R2_c1
  s_branch R2_g1
R2_c2:
  buffer_load_dwordx4 v[20:23], v0, s[4:7], s47 offen offset:2048 sc1
  s_sub_u32 s54, s54, 1
  s_cbranch_scc1 K_end
  buffer_load_dwordx4 v[56:59], v0, s[4:7], s47 offen offset:3072 sc1
  buffer_load_dword v10, s[4:7], s47 offen lds
  buffer_load_dwordx4 v[60:63], v0, s[4:7], s16 offen offset:0 sc1
  buffer_load_dwordx4 v[12:15], v0, s[4:7], s16 offen offset:1024 sc1
  s_waitcnt vmcnt(4)
  v_max3_u32 v9, v23, v23, v23
  v_cmp_eq_u32 vcc, -1, v9
  s_cbranch_vccnz R2_c2
  s_branch R2_g2
R2_c3:
  buffer_load_dwordx4 v[56:59], v0, s[4:7], s47 offen offset:3072 sc1
  s_sub_u32 s54, s54, 1
  s_cbranch_scc1 K_end
  buffer_load_dword v10, s[4:7], s47 offen lds
  buffer_load_dwordx4 v[60:63], v0, s[4:7], s16 offen offset:0 sc1
  buffer_load_dwordx4 v[12:15], v0, s[4:7], s16 offen offset:1024 sc1
  buffer_load_dword v10, s[4:7], s47 offen lds
  buffer_load_dwordx4 v[16:19], v0, s[4:7], s16 offen offset:2048 sc1
  buffer_load_dwordx4 v[4:7], v0, s[4:7], s17 offen offset:0 sc1
  s_waitcnt vmcnt(6)
  v_max3_u32 v9, v59, v59, v59
  v_cmp_eq_u32 vcc, -1, v9
  s_cbranch_vccnz R2_c3
  s_branch R2_g3
R2_c45:
  buffer_load_dwordx4 v[60:63], v0, s[4:7], s16 offen offset:0 sc1
  buffer_load_dwordx4 v[12:15], v0, s[4:7], s16 offen offset:1024 sc1
  s_sub_u32 s54, s54, 1
  s_cbranch_scc1 K_end
  buffer_load_dword v10, s[4:7], s47 offen lds
  buffer_load_dwordx4 v[16:19], v0, s[4:7], s16 offen offset:2048 sc1
  buffer_load_dwordx4 v[4:7], v0, s[4:7], s17 offen offset:0 sc1
  buffer_load_dwordx4 v[20:23], v0, s[4:7], s16 offen offset:3072 sc1
  buffer_load_dword v10, s[4:7], s47 offen lds
  s_waitcnt vmcnt(5)
  v_max3_u32 v9, v63, v15, v63
  v_cmp_eq_u32 vcc, -1, v9
  s_cbranch_vccnz R2_c45
  s_branch R2_g45
R2_c678:
  buffer_load_dwordx4 v[16:19], v0, s[4:7], s16 offen offset:2048 sc1
  buffer_load_dwordx4 v[4:7], v0, s[4:7], s17 offen offset:0 sc1
  buffer_load_dwordx4 v[20:23], v0, s[4:7], s16 offen offset:3072 sc1
  s_sub_u32 s54, s54, 1
  s_cbranch_scc1 K_end
  buffer_load_dword v10, s[4:7], s47 offen lds
  buffer_load_dword v10, s[4:7], s47 offen lds
  buffer_load_dword v10, s[4:7], s47 offen lds
  s_waitcnt vmcnt(3)
  v_max3_u32 v9, v19, v23, v7
  v_cmp_eq_u32 vcc, -1, v9
  s_cbranch_vccnz R2_c678
  s_branch R2_g678
R2_fn:
  s_cmp_eq_u32 s20, s46
  s_cbranch_scc1 R2_gn
  s_mov_b32 s20, s46
  s_waitcnt vmcnt(0) lgkmcnt(0)
  s_nop 7
R2_fl:
  buffer_load_dwordx4 v[12:15], v0, s[4:7], s47 offen offset:0 sc1
  buffer_load_dwordx4 v[16:19], v0, s[4:7], s47 offen offset:1024 sc1
  buffer_load_dwordx4 v[20:23], v0, s[4:7], s47 offen offset:2048 sc1
  buffer_load_dwordx4 v[24:27], v0, s[4:7], s47 offen offset:3072 sc1
  buffer_load_dwordx4 v[28:31], v0, s[4:7], s16 offen offset:0 sc1
  buffer_load_dwordx4 v[32:35], v0, s[4:7], s16 offen offset:1024 sc1
  buffer_load_dwordx4 v[36:39], v0, s[4:7], s16 offen offset:2048 sc1
  buffer_load_dwordx4 v[40:43], v0, s[4:7], s16 offen offset:3072 sc1
  buffer_load_dwordx4 v[44:47], v0, s[4:7], s17 offen offset:0 sc1
  s_sub_u32 s54, s54, 1
  s_cbranch_scc1 K_end
  s_waitcnt vmcnt(8)
  v_max_u32 v9, v12, v13
  v_max3_u32 v9, v9, v14, v15
  s_waitcnt vmcnt(7)
  v_max3_u32 v9, v9, v16, v17
  v_max3_u32 v9, v9, v18, v19
  s_waitcnt vmcnt(6)
  v_max3_u32 v9, v9, v20, v21
  v_max3_u32 v9, v9, v22, v23
  s_waitcnt vmcnt(5)
  v_max3_u32 v9, v9, v24, v25
  v_max3_u32 v9, v9, v26, v27
  s_waitcnt vmcnt(4)
  v_max3_u32 v9, v9, v28, v29
  v_max3_u32 v9, v9, v30, v31
  s_waitcnt vmcnt(3)
  v_max3_u32 v9, v9, v32, v33
  v_max3_u32 v9, v9, v34, v35
  s_waitcnt vmcnt(2)
  v_max3_u32 v9, v9, v36, v37
  v_max3_u32 v9, v9, v38, v39
  s_waitcnt vmcnt(1)
  v_max3_u32 v9, v9, v40, v41
  v_max3_u32 v9, v9, v42, v43
  s_waitcnt vmcnt(0)
  v_max3_u32 v9, v9, v44, v45
  v_max3_u32 v9, v9, v46, v47
  v_cmp_eq_u32 vcc, -1, v9
  s_cbranch_vccnz R2_fl
  s_barrier
  buffer_inv sc1
  s_waitcnt vmcnt(0)
  s_barrier
  s_branch R2_in2
R2_frq:
R2_lrq:
  buffer_load_dwordx4 v[56:59], v0, s[4:7], s51 offen offset:0 sc1
  buffer_load_dwordx4 v[60:63], v0, s[4:7], s51 offen offset:1024 sc1
  s_sub_u32 s54, s54, 1
  s_cbranch_scc1 K_end
  s_waitcnt vmcnt(0)
  v_bitop3_b32 v9, v56, v57, s46 bitop3:0x7e
  v_bitop3_b32 v11, v58, v59, s46 bitop3:0x7e
  v_mfma_f32_16x16x32_bf16 v[40:43], v[64:67], v[56:59], 0
  v_bitop3_b32 v44, v60, v61, s46 bitop3:0x7e
  v_bitop3_b32 v45, v62, v63, s46 bitop3:0x7e
  v_mfma_f32_16x16x32_bf16 v[40:43], v[64:67], v[60:63], v[40:43]
  v_or3_b32 v9, v9, v11, v44
  v_bitop3_b32 v9, v9, v45, 1 bitop3:0xa8
  v_cmp_ne_u32 vcc, 0, v9
  s_nop 4
  v_add_f32_dpp v40, v40, v40 row_ror:8 row_mask:0xf bank_mask:0xf
  v_add_f32_dpp v41, v41, v41 row_ror:8 row_mask:0xf bank_mask:0xf
  s_cbranch_vccz R2_rq
  s_branch R2_lrq
R3_go:
  s_waitcnt vmcnt(4)
R3_go2:
  v_cmp_eq_u32 vcc, -1, v15
  v_smfmac_f32_16x16x64_bf16 v[24:27], v[12:15], a[0:7], v8
  ds_read_b128 v[40:43], v1 offset:16384
  v_smfmac_f32_16x16x64_bf16 v[28:31], v[12:15], a[8:15], v8
  s_cbranch_vccnz R3_f0
  v_smfmac_f32_16x16x64_bf16 v[32:35], v[12:15], a[128:135], v8
  ds_read_b128 v[44:47], v1 offset:17408
  v_smfmac_f32_16x16x64_bf16 v[36:39], v[12:15], a[136:143], v8
  ds_read_b128 v[48:51], v1 offset:18432
  s_waitcnt vmcnt(3)
  v_cmp_eq_u32 vcc, -1, v19
  v_smfmac_f32_16x16x64_bf16 v[64:67], v[12:15], a[192:199], v8
  ds_read_b128 v[52:55], v1 offset:19456
  v_smfmac_f32_16x16x64_bf16 v[68:71], v[12:15], a[200:207], v8
  s_cbranch_vccnz R3_c1
R3_g1:
  v_smfmac_f32_16x16x64_bf16 v[24:27], v[16:19], a[16:23], v8
  buffer_load_dwordx4 v[60:63], v0, s[4:7], s16 offen offset:0
  s_waitcnt lgkmcnt(2)
  v_smfmac_f32_16x16x64_bf16 v[32:35], v[16:19], v[40:47], v8
  ds_read_b128 v[40:43], v1 offset:20480
  buffer_load_dwordx4 v[12:15], v0, s[4:7], s16 offen offset:1024
  v_smfmac_f32_16x16x64_bf16 v[28:31], v[16:19], a[24:31], v8
  ds_read_b128 v[44:47], v1 offset:21504
  s_waitcnt lgkmcnt(2)
  v_smfmac_f32_16x16x64_bf16 v[36:39], v[16:19], v[48:55], v8
  ds_read_b128 v[48:51], v1 offset:22528
  s_waitcnt vmcnt(4)
  v_cmp_eq_u32 vcc, -1, v23
  v_smfmac_f32_16x16x64_bf16 v[64:67], v[16:19], a[208:215], v8
  ds_read_b128 v[52:55], v1 offset:23552
  v_smfmac_f32_16x16x64_bf16 v[68:71], v[16:19], a[216:223], v8
  s_cbranch_vccnz R3_c2
R3_g2:
  v_smfmac_f32_16x16x64_bf16 v[24:27], v[20:23], a[32:39], v8
  buffer_load_dwordx4 v0, s[4:7], s52 offen offset:256 sc1 lds
  s_waitcnt lgkmcnt(2)
  v_smfmac_f32_16x16x64_bf16 v[32:35], v[20:23], v[40:47], v8
  ds_read_b128 v[40:43], v1 offset:24576
  v_smfmac_f32_16x16x64_bf16 v[28:31], v[20:23], a[40:47], v8
  ds_read_b128 v[44:47], v1 offset:25600
  buffer_load_dwordx4 v[16:19], v0, s[4:7], s16 offen offset:2048
  s_waitcnt lgkmcnt(2)
  v_smfmac_f32_16x16x64_bf16 v[36:39], v[20:23], v[48:55], v8
  ds_read_b128 v[48:51], v1 offset:26624
  s_waitcnt vmcnt(5)
  v_cmp_eq_u32 vcc, -1, v59
  v_smfmac_f32_16x16x64_bf16 v[64:67], v[20:23], a[224:231], v8
  ds_read_b128 v[52:55], v1 offset:27648
  buffer_load_dwordx4 v[4:7], v0, s[4:7], s17 offen offset:0
  v_smfmac_f32_16x16x64_bf16 v[68:71], v[20:23], a[232:239], v8
  s_cbranch_vccnz R3_c3
R3_g3:
  v_smfmac_f32_16x16x64_bf16 v[24:27], v[56:59], a[48:55], v8
  buffer_load_dwordx4 v[20:23], v0, s[4:7], s16 offen offset:3072
  s_waitcnt lgkmcnt(2)
  v_smfmac_f32_16x16x64_bf16 v[32:35], v[56:59], v[40:47], v8
  ds_read_b128 v[40:43], v1 offset:28672
  buffer_load_dwordx4 v0, s[4:7], s52 offen offset:1280 sc1 lds
  v_smfmac_f32_16x16x64_bf16 v[28:31], v[56:59], a[56:63], v8
  ds_read_b128 v[44:47], v1 offset:29696
  s_waitcnt lgkmcnt(2)
  v_smfmac_f32_16x16x64_bf16 v[36:39], v[56:59], v[48:55], v8
  ds_read_b128 v[48:51], v1 offset:30720
  s_waitcnt vmcnt(5)
  v_cmp_u_f32 vcc, v63, v15
  v_smfmac_f32_16x16x64_bf16 v[64:67], v[56:59], a[240:247], v8
  ds_read_b128 v[52:55], v1 offset:31744
  v_smfmac_f32_16x16x64_bf16 v[68:71], v[56:59], a[248:255], v8
  s_cbranch_vccnz R3_c45
R3_g45:
  v_smfmac_f32_16x16x64_bf16 v[24:27], v[60:63], a[64:71], v8
  s_waitcnt lgkmcnt(2)
  v_smfmac_f32_16x16x64_bf16 v[32:35], v[60:63], v[40:47], v8
  ds_read_b128 v[40:43], v1 offset:0
  v_smfmac_f32_16x16x64_bf16 v[28:31], v[60:63], a[72:79], v8
  ds_read_b128 v[44:47], v1 offset:1024
  buffer_load_dwordx4 v0, s[4:7], s52 offen offset:2304 sc1 lds
  s_waitcnt lgkmcnt(2)
  v_smfmac_f32_16x16x64_bf16 v[36:39], v[60:63], v[48:55], v8
  ds_read_b128 v[48:51], v1 offset:2048
  v_smfmac_f32_16x16x64_bf16 v[64:67], v[60:63], v[72:79], v8
  ds_read_b128 v[52:55], v1 offset:3072
  v_smfmac_f32_16x16x64_bf16 v[68:71], v[60:63], v[80:87], v8
  v_smfmac_f32_16x16x64_bf16 v[24:27], v[12:15], a[80:87], v8
  s_waitcnt lgkmcnt(2)
  v_smfmac_f32_16x16x64_bf16 v[32:35], v[12:15], v[40:47], v8
  ds_read_b128 v[40:43], v1 offset:4096
  v_smfmac_f32_16x16x64_bf16 v[28:31], v[12:15], a[88:95], v8
  ds_read_b128 v[44:47], v1 offset:5120
  s_waitcnt vmcnt(3) lgkmcnt(2)
  v_max_u32 v9, v19, v7
  v_smfmac_f32_16x16x64_bf16 v[36:39], v[12:15], v[48:55], v8
  ds_read_b128 v[48:51], v1 offset:6144
  s_waitcnt vmcnt(2)
  v_cmp_u_f32 vcc, v9, v23
  v_smfmac_f32_16x16x64_bf16 v[64:67], v[12:15], v[88:95], v8
  ds_read_b128 v[52:55], v1 offset:7168
  buffer_load_dwordx4 v0, s[4:7], s52 offen offset:3328 sc1 lds
  v_smfmac_f32_16x16x64_bf16 v[68:71], v[12:15], v[96:103], v8
  s_cbranch_vccnz R3_c678
R3_g678:
  v_smfmac_f32_16x16x64_bf16 v[24:27], v[16:19], a[96:103], v8
  s_waitcnt vmcnt(2)
  s_waitcnt lgkmcnt(2)
  s_barrier
  ds_read_b128 v[12:15], v0 offset:9984
  v_smfmac_f32_16x16x64_bf16 v[24:27], v[20:23], v[40:47], v8
  v_smfmac_f32_16x16x64_bf16 v[28:31], v[16:19], a[104:111], v8
  s_waitcnt lgkmcnt(1)
  v_mov_b32 v9, s46
  buffer_store_dword v9, v10, s[4:7], s61 offen sc1
  v_smfmac_f32_16x16x64_bf16 v[28:31], v[20:23], v[48:55], v8
  ds_read_b128 v[60:63], v0 offset:8960
  v_smfmac_f32_16x16x64_bf16 v[24:27], v[4:7], a[112:119], v8
  ds_read_b128 v[44:47], v0 offset:13312
  v_smfmac_f32_16x16x64_bf16 v[28:31], v[4:7], a[120:127], v8
  ds_read_b128 v[56:59], v0 offset:14336
  v_smfmac_f32_16x16x64_bf16 v[32:35], v[16:19], a[144:151], v8
  v_add_f32 v24, v24, v26
  v_add_f32 v25, v25, v27
  v_smfmac_f32_16x16x64_bf16 v[32:35], v[20:23], a[160:167], v8
  v_add_f32 v28, v28, v30
  v_add_f32 v29, v29, v31
  v_smfmac_f32_16x16x64_bf16 v[32:35], v[4:7], a[176:183], v8
  v_cvt_pk_bf16_f32 v41, v24, v28
  v_cvt_pk_bf16_f32 v43, v25, v29
  v_smfmac_f32_16x16x64_bf16 v[36:39], v[16:19], a[152:159], v8
  ds_write2_b32 v3, v41, v43 offset0:0 offset1:4
  v_smfmac_f32_16x16x64_bf16 v[36:39], v[20:23], a[168:175], v8
  ds_read_b128 v[24:27], v2 offset:21888
  v_add_f32 v32, v32, v34
  v_smfmac_f32_16x16x64_bf16 v[36:39], v[4:7], a[184:191], v8
  v_add_f32 v33, v33, v35
  v_smfmac_f32_16x16x64_bf16 v[64:67], v[16:19], v[104:111], v8
  v_smfmac_f32_16x16x64_bf16 v[68:71], v[16:19], v[112:119], v8
  s_waitcnt lgkmcnt(1)
  s_barrier
  v_add_f32 v36, v36, v38
  v_smfmac_f32_16x16x64_bf16 v[64:67], v[20:23], v[120:127], v8
  ds_read_b128 v[28:31], v2 offset:20736
  v_add_f32 v37, v37, v39
  v_smfmac_f32_16x16x64_bf16 v[68:71], v[20:23], v[128:135], v8
  ds_read_b128 v[16:19], v0 offset:4608
  v_cvt_pk_bf16_f32 v40, v32, v36
  v_smfmac_f32_16x16x64_bf16 v[64:67], v[4:7], v[136:143], v8
  ds_read_b128 v[20:23], v0 offset:5632
  v_cvt_pk_bf16_f32 v42, v33, v37
  v_smfmac_f32_16x16x64_bf16 v[68:71], v[4:7], v[144:151], v8
  ds_read_b128 v[48:51], v2 offset:19584
  ds_read_b128 v[4:7], v0 offset:256
  ds_write2_b32 v3, v40, v42 offset0:144 offset1:148
  s_waitcnt lgkmcnt(6)
  v_mfma_f32_16x16x32_bf16 v[32:35], v[44:47], v[24:27], 0
  ds_read_b128 v[44:47], v0 offset:1280
  v_add_f32 v64, v64, v66
  v_mfma_f32_16x16x32_bf16 v[36:39], v[56:59], v[24:27], 0
  ds_read_b128 v[52:55], v2 offset:18432
  s_waitcnt lgkmcnt(7)
  v_add_f32 v65, v65, v67
  v_mfma_f32_16x16x32_bf16 v[32:35], v[60:63], v[28:31], v[32:35]
  v_cvt_pk_bf16_f32 v41, v64, v65
  v_mfma_f32_16x16x32_bf16 v[36:39], v[12:15], v[28:31], v[36:39]
  ds_read_b128 v[64:67], v2 offset:22464
  s_waitcnt lgkmcnt(5)
  v_add_f32 v68, v68, v70
  v_mfma_f32_16x16x32_bf16 v[32:35], v[16:19], v[48:51], v[32:35]
  s_waitcnt lgkmcnt(2)
  s_barrier
  ds_read_b128 v[12:15], v2 offset:21312
  v_add_f32 v69, v69, v71
  v_mfma_f32_16x16x32_bf16 v[36:39], v[20:23], v[48:51], v[36:39]
  ds_read_b128 v[16:19], v2 offset:20160
  s_waitcnt lgkmcnt(3)
  v_cvt_pk_bf16_f32 v43, v68, v69
  v_mfma_f32_16x16x32_bf16 v[32:35], v[4:7], v[52:55], v[32:35]
  s_waitcnt vmcnt(2)
  ds_read_b128 v[56:59], v0 offset:15360
  ds_read_b128 v[68:71], v2 offset:19008
  v_mfma_f32_16x16x32_bf16 v[36:39], v[44:47], v[52:55], v[36:39]
  s_waitcnt vmcnt(1)
  ds_read_b128 v[60:63], v0 offset:16384
  s_waitcnt lgkmcnt(5)
  v_mfma_f32_16x16x32_bf16 v[44:47], v[64:67], v[24:27], 0
  s_waitcnt lgkmcnt(4)
  v_cmp_u_f32 vcc, v32, v32
  v_max3_f32 v9, v32, v33, v34
  v_mfma_f32_16x16x32_bf16 v[44:47], v[12:15], v[28:31], v[44:47]
  s_waitcnt lgkmcnt(3)
  v_max3_f32 v9, v9, v35, v36
  v_max3_f32 v9, v9, v37, v38
  v_mfma_f32_16x16x32_bf16 v[44:47], v[16:19], v[48:51], v[44:47]
  s_cbranch_vccnz R3_fn
R3_gn:
  s_waitcnt lgkmcnt(1)
  v_mfma_f32_16x16x32_bf16 v[44:47], v[68:71], v[52:55], v[44:47]
  buffer_store_dwordx4 v[40:43], v0, s[4:7], s53 offen offset:3072 sc1
  ds_read_b128 v[4:7], v0 offset:23552
  ds_read_b128 v[24:27], v1 offset:8192
  v_mov_b64 v[12:13], s[62:63]
  v_mov_b64 v[14:15], s[62:63]
  v_max_f32 v9, v9, v39
  s_nop 1
  v_max3_f32 v46, v9, v44, v45
  v_max3_f32 v9, v9, v44, v45
  s_add_u32 s53, s53, 131072
  s_add_u32 s47, s47, 16384
  v_permlane32_swap_b32 v9, v46
  v_max_f32 v47, v9, v46
  v_max_f32 v9, v9, v46
  s_add_u32 s22, s47, s48
  s_nop 0
  v_permlane16_swap_b32 v9, v47
  v_max_f32 v9, v9, v47
  v_mul_f32 v46, s58, v9
  v_pk_fma_f32 v[44:45], v[44:45], s[58:59], v[46:47] op_sel_hi:[1,0,0] neg_lo:[0,0,1] neg_hi:[0,0,1]
  v_pk_fma_f32 v[32:33], v[32:33], s[58:59], v[46:47] op_sel_hi:[1,0,0] neg_lo:[0,0,1] neg_hi:[0,0,1]
  v_pk_fma_f32 v[34:35], v[34:35], s[58:59], v[46:47] op_sel_hi:[1,0,0] neg_lo:[0,0,1] neg_hi:[0,0,1]
  v_pk_fma_f32 v[36:37], v[36:37], s[58:59], v[46:47] op_sel_hi:[1,0,0] neg_lo:[0,0,1] neg_hi:[0,0,1]
  v_pk_fma_f32 v[38:39], v[38:39], s[58:59], v[46:47] op_sel_hi:[1,0,0] neg_lo:[0,0,1] neg_hi:[0,0,1]
  v_exp_f32 v44, v44
  v_exp_f32 v45, v45
  v_exp_f32 v32, v32
  v_cvt_pk_bf16_f32 v11, v44, v45
  v_exp_f32 v33, v33
  v_exp_f32 v34, v34
  v_mfma_f32_16x16x16_bf16 v[16:19], v[40:41], v[10:11], 0
  v_cvt_pk_bf16_f32 v64, v32, v33
  v_exp_f32 v35, v35
  v_mfma_f32_16x16x16_bf16 v[68:71], v[42:43], v[10:11], 0
  s_cmp_ge_u32 s46, 51
  s_cselect_b32 s55, s61, 1073741824
  v_add_u32 v9, s46, 1
  s_waitcnt lgkmcnt(1)
  buffer_store_dword v9, v6, s[4:7], s55 offen sc1
  v_exp_f32 v36, v36
  v_cvt_pk_bf16_f32 v65, v34, v35
  v_exp_f32 v37, v37
  v_mfma_f32_16x16x16_bf16 v[20:23], v[10:11], v[12:13], 0
  ds_read_b128 v[28:31], v1 offset:9216
  v_exp_f32 v38, v38
  v_exp_f32 v39, v39
  v_cvt_pk_bf16_f32 v66, v36, v37
  v_cvt_pk_bf16_f32 v67, v38, v39
  v_mov_b64 v[32:33], 0
  v_mov_b64 v[34:35], 0
  v_mfma_f32_16x16x32_bf16 v[16:19], v[56:59], v[64:67], v[16:19]
  v_mov_b64 v[36:37], 0
  v_mov_b64 v[38:39], 0
  v_mfma_f32_16x16x32_bf16 v[68:71], v[60:63], v[64:67], v[68:71]
  v_mov_b64 v[56:57], 0
  v_mov_b64 v[58:59], 0
  v_mfma_f32_16x16x32_bf16 v[20:23], v[64:67], v[12:15], v[20:23]
  v_cvt_pk_bf16_f32 v64, v16, v17
  v_cvt_pk_bf16_f32 v65, v18, v19
  v_mov_b64 v[60:61], 0
  v_mov_b64 v[62:63], 0
  v_cvt_pk_bf16_f32 v66, v68, v69
  v_cvt_pk_bf16_f32 v67, v70, v71
  ds_write_b128 v2, v[64:67] offset:21888
  s_add_u32 s52, s52, 524288
  v_mfma_f32_16x16x32_bf16 v[44:47], v[64:67], v[240:243], 0
  ds_read_b128 v[48:51], v1 offset:10240
  s_waitcnt lgkmcnt(2)
  v_smfmac_f32_16x16x64_bf16 v[32:35], v[64:67], v[24:31], v8 abid:1
  ds_read_b128 v[52:55], v1 offset:11264
  s_cmp_eq_u32 s46, 63
  v_smfmac_f32_16x16x64_bf16 v[56:59], v[64:67], v[152:159], v8 abid:1
  s_cbranch_scc1 K_end
  s_waitcnt lgkmcnt(2)
  s_barrier
  v_smfmac_f32_16x16x64_bf16 v[60:63], v[64:67], v[184:191], v8 abid:1
  ds_read_b128 v[12:15], v2 offset:20736
  ds_read_b128 v[16:19], v2 offset:19584
  ds_read_b128 v[68:71], v2 offset:18432
  s_waitcnt lgkmcnt(3)
  v_smfmac_f32_16x16x64_bf16 v[36:39], v[64:67], v[48:55], v8 abid:1
  ds_read_b128 v[24:27], v1 offset:12288
  ds_read_b128 v[28:31], v1 offset:13312
  v_rcp_f32 v20, v20
  v_rcp_f32 v21, v21
  s_waitcnt lgkmcnt(4)
  v_smfmac_f32_16x16x64_bf16 v[56:59], v[12:15], v[160:167], v8 abid:1
  ds_read_b128 v[48:51], v1 offset:14336
  s_waitcnt lgkmcnt(4)
  v_smfmac_f32_16x16x64_bf16 v[56:59], v[16:19], v[168:175], v8 abid:1
  ds_read_b128 v[52:55], v1 offset:15360
  s_waitcnt lgkmcnt(4)
  v_smfmac_f32_16x16x64_bf16 v[56:59], v[68:71], v[176:183], v8 abid:1
  ds_read_b128 v[64:67], v4 offset:23296
  v_smfmac_f32_16x16x64_bf16 v[60:63], v[12:15], v[192:199], v8 abid:1
  s_add_u32 s46, s46, 1
  s_add_u32 s56, s47, s49
  s_and_b32 s19, s46, s18
  v_smfmac_f32_16x16x64_bf16 v[60:63], v[16:19], v[200:207], v8 abid:1
  v_mul_f32 v56, v56, v20
  v_mul_f32 v58, v58, v20
  v_mul_f32 v57, v57, v21
  v_mul_f32 v59, v59, v21
  v_cvt_pk_bf16_f32 v56, v56, v58
  v_cvt_pk_bf16_f32 v57, v57, v59
  v_bfi_b32 v56, 1, s46, v56
  v_bfi_b32 v57, 1, s46, v57
  buffer_store_dwordx2 v[56:57], v5, s[4:7], s68 offen
  v_smfmac_f32_16x16x64_bf16 v[60:63], v[68:71], v[208:215], v8 abid:1
  s_waitcnt lgkmcnt(3)
  v_smfmac_f32_16x16x64_bf16 v[32:35], v[12:15], v[24:31], v8 abid:1
  ds_read_b128 v[24:27], v1 offset:32768
  v_smfmac_f32_16x16x64_bf16 v[32:35], v[16:19], v[216:223], v8 abid:1
  ds_read_b128 v[28:31], v1 offset:33792
  v_mul_f32 v60, v60, v20
  v_mul_f32 v62, v62, v20
  v_mul_f32 v61, v61, v21
  v_mul_f32 v63, v63, v21
  v_cvt_pk_bf16_f32 v60, v60, v62
  v_cvt_pk_bf16_f32 v61, v61, v63
  v_bfi_b32 v60, 1, s46, v60
  v_bfi_b32 v61, 1, s46, v61
  s_waitcnt lgkmcnt(3)
  v_smfmac_f32_16x16x64_bf16 v[32:35], v[68:71], v[48:55], v8 abid:1
  buffer_store_dwordx2 v[60:61], v5, s[4:7], s69 offen
  v_smfmac_f32_16x16x64_bf16 v[36:39], v[12:15], v[224:231], v8 abid:1
  v_smfmac_f32_16x16x64_bf16 v[36:39], v[16:19], v[232:239], v8 abid:1
  v_mul_f32 v32, v32, v20
  v_mul_f32 v34, v34, v20
  v_mul_f32 v33, v33, v21
  v_mul_f32 v35, v35, v21
  v_cvt_pk_bf16_f32 v32, v32, v34
  v_cvt_pk_bf16_f32 v33, v33, v35
  v_bfi_b32 v32, 1, s46, v32
  v_bfi_b32 v33, 1, s46, v33
  s_waitcnt lgkmcnt(0)
  v_smfmac_f32_16x16x64_bf16 v[36:39], v[68:71], v[24:31], v8 abid:1
  buffer_store_dwordx2 v[32:33], v5, s[4:7], s70 offen
  v_mfma_f32_16x16x32_bf16 v[44:47], v[12:15], v[244:247], v[44:47]
  v_mfma_f32_16x16x32_bf16 v[44:47], v[16:19], v[248:251], v[44:47]
  v_mul_f32 v36, v36, v20
  v_mul_f32 v38, v38, v20
  v_mfma_f32_16x16x32_bf16 v[44:47], v[68:71], v[252:255], v[44:47]
  v_mul_f32 v37, v37, v21
  v_mul_f32 v39, v39, v21
  v_cvt_pk_bf16_f32 v36, v36, v38
  v_cvt_pk_bf16_f32 v37, v37, v39
  v_bfi_b32 v36, 1, s46, v36
  v_bfi_b32 v37, 1, s46, v37
  buffer_store_dwordx2 v[36:37], v5, s[4:7], s71 offen
  s_nop 0
  v_mul_f32 v44, v44, v20
  v_mul_f32 v45, v45, v21
  v_cvt_pk_bf16_f32 v44, v44, v45
  v_bfi_b32 v44, 1, s46, v44
  buffer_store_dword v44, v7, s[4:7], s72 offen
  s_add_u32 s55, s46, 1
R3_fc:
  s_cmp_gt_u32 s60, s55
  s_cbranch_scc0 R3_flg
  s_barrier
  s_load_dword s60, s[42:43], s59 glc
  v_mov_b64 v[24:25], 0
  v_mov_b64 v[26:27], 0
  v_mov_b64 v[28:29], 0
  v_mov_b64 v[30:31], 0
  v_mov_b64 v[32:33], 0
  v_mov_b64 v[34:35], 0
  v_mov_b64 v[36:37], 0
  v_mov_b64 v[38:39], 0
  s_add_u32 s16, s47, 4096
  s_add_u32 s17, s47, 8192
  buffer_load_dwordx4 v[56:59], v0, s[4:7], s51 offen offset:0 sc1
  buffer_load_dwordx4 v[60:63], v0, s[4:7], s51 offen offset:1024 sc1
  s_barrier
  buffer_load_dwordx4 v[12:15], v0, s[4:7], s47 offen offset:0
  s_waitcnt vmcnt(2)
  buffer_load_dwordx4 v[16:19], v0, s[4:7], s47 offen offset:1024
  v_bitop3_b32 v9, v56, v57, s19 bitop3:0x7e
  v_bitop3_b32 v11, v58, v59, s19 bitop3:0x7e
  v_mfma_f32_16x16x32_bf16 v[40:43], v[64:67], v[56:59], 0
  s_waitcnt vmcnt(2)
  v_bitop3_b32 v44, v60, v61, s19 bitop3:0x7e
  v_bitop3_b32 v45, v62, v63, s19 bitop3:0x7e
  v_mfma_f32_16x16x32_bf16 v[40:43], v[64:67], v[60:63], v[40:43]
  v_or3_b32 v9, v9, v11, v44
  v_bitop3_b32 v9, v9, v45, 1 bitop3:0xa8
  v_cmp_ne_u32 vcc, 0, v9
  s_nop 4
  v_add_f32_dpp v40, v40, v40 row_ror:8 row_mask:0xf bank_mask:0xf
  v_add_f32_dpp v41, v41, v41 row_ror:8 row_mask:0xf bank_mask:0xf
  s_cbranch_vccnz R3_frq
R3_rq:
  v_add_f32_dpp v46, v40, v40 row_ror:4 row_mask:0xf bank_mask:0x1
  v_add_f32_dpp v47, v41, v41 row_ror:4 row_mask:0xf bank_mask:0x1
  v_cvt_pk_bf16_f32 v9, v46, v47
  buffer_load_dwordx4 v[20:23], v0, s[4:7], s47 offen offset:2048
  buffer_load_dwordx4 v[56:59], v0, s[4:7], s47 offen offset:3072
  buffer_store_dword v9, v6, s[4:7], s56 offen
  v_mov_b64 v[64:65], 0
  v_mov_b64 v[66:67], 0
  v_mov_b64 v[68:69], 0
  v_mov_b64 v[70:71], 0
  s_branch R3_go
R3_in:
  s_cmp_gt_u32 s60, 1
  s_cselect_b32 s55, s64, 0
  s_cmp_gt_u32 s55, 0
  s_cbranch_scc1 R3_in1
  s_xor_b32 s55, s59, 64
R3_in0:
  s_load_dword s60, s[42:43], s59 glc
  s_load_dword s64, s[42:43], s55 glc
  s_sub_u32 s54, s54, 1
  s_cbranch_scc1 K_end
  s_waitcnt lgkmcnt(0)
  s_cmp_gt_u32 s60, 1
  s_cbranch_scc0 R3_in0
R3_in1:
  s_add_u32 s16, s47, 4096
  s_add_u32 s17, s47, 8192
  buffer_load_dwordx4 v[12:15], v0, s[4:7], s47 offen offset:0
  buffer_load_dwordx4 v[16:19], v0, s[4:7], s47 offen offset:1024
  buffer_load_dwordx4 v[20:23], v0, s[4:7], s47 offen offset:2048
  buffer_load_dwordx4 v[56:59], v0, s[4:7], s47 offen offset:3072
  v_lshlrev_b32 v11, 3, v0
  s_bitcmp1_b32 s45, 0
  s_cselect_b32 s56, -1, 1
  s_mul_i32 s56, s56, 2176
  s_add_u32 s55, s52, -3840
  s_xor_b32 s55, s55, 16384
  s_cmp_gt_u32 s64, 0
  s_cselect_b32 s55, s55, 1073741824
  buffer_load_dword v11, s[4:7], s55 offen sc1 lds
  s_add_u32 s56, s51, s56
  s_mov_b64 exec, 0x3ffff
  buffer_load_dword v11, s[4:7], s56 offen sc1 lds
  s_mov_b64 exec, -1
  v_mov_b64 v[24:25], 0
  v_mov_b64 v[26:27], 0
  v_mov_b64 v[28:29], 0
  v_mov_b64 v[30:31], 0
  v_mov_b64 v[32:33], 0
  v_mov_b64 v[34:35], 0
  v_mov_b64 v[36:37], 0
  v_mov_b64 v[38:39], 0
  v_mov_b64 v[64:65], 0
  v_mov_b64 v[66:67], 0
  v_mov_b64 v[68:69], 0
  v_mov_b64 v[70:71], 0
  s_waitcnt vmcnt(2)
  s_barrier
  s_branch R3_go2
R3_in2:
  buffer_load_dwordx4 v[12:15], v0, s[4:7], s47 offen offset:0
  buffer_load_dwordx4 v[16:19], v0, s[4:7], s47 offen offset:1024
  buffer_load_dwordx4 v[20:23], v0, s[4:7], s47 offen offset:2048
  buffer_load_dwordx4 v[56:59], v0, s[4:7], s47 offen offset:3072
  v_mov_b64 v[24:25], 0
  v_mov_b64 v[26:27], 0
  v_mov_b64 v[28:29], 0
  v_mov_b64 v[30:31], 0
  v_mov_b64 v[32:33], 0
  v_mov_b64 v[34:35], 0
  v_mov_b64 v[36:37], 0
  v_mov_b64 v[38:39], 0
  v_mov_b64 v[64:65], 0
  v_mov_b64 v[66:67], 0
  v_mov_b64 v[68:69], 0
  v_mov_b64 v[70:71], 0
  s_waitcnt vmcnt(0)
  s_barrier
  s_branch R3_go2
R3_f0:
  buffer_load_dwordx4 v[12:15], v0, s[4:7], s47 offen offset:0 sc1
  s_sub_u32 s54, s54, 1
  s_cbranch_scc1 K_end
  s_nop 3
  v_mov_b64 v[24:25], 0
  v_mov_b64 v[26:27], 0
  v_mov_b64 v[28:29], 0
  v_mov_b64 v[30:31], 0
  buffer_load_dwordx4 v[16:19], v0, s[4:7], s47 offen offset:1024 sc1
  buffer_load_dwordx4 v[20:23], v0, s[4:7], s47 offen offset:2048 sc1
  buffer_load_dwordx4 v[56:59], v0, s[4:7], s47 offen offset:3072 sc1
  buffer_load_dword v10, s[4:7], s47 offen lds
  s_waitcnt vmcnt(4) lgkmcnt(0)
  s_branch R3_go2
R3_c1:
  buffer_load_dwordx4 v[16:19], v0, s[4:7], s47 offen offset:1024 sc1
  s_sub_u32 s54, s54, 1
  s_cbranch_scc1 K_end
  buffer_load_dwordx4 v[20:23], v0, s[4:7], s47 offen offset:2048 sc1
  buffer_load_dwordx4 v[56:59], v0, s[4:7], s47 offen offset:3072 sc1
  buffer_load_dword v10, s[4:7], s47 offen lds
  s_waitcnt vmcnt(3)
  v_max3_u32 v9, v19, v19, v19
  v_cmp_eq_u32 vcc, -1, v9
  s_cbranch_vccnz R3_c1
  s_branch R3_g1
R3_c2:
  buffer_load_dwordx4 v[20:23], v0, s[4:7], s47 offen offset:2048 sc1
  s_sub_u32 s54, s54, 1
  s_cbranch_scc1 K_end
  buffer_load_dwordx4 v[56:59], v0, s[4:7], s47 offen offset:3072 sc1
  buffer_load_dword v10, s[4:7], s47 offen lds
  buffer_load_dwordx4 v[60:63], v0, s[4:7], s16 offen offset:0 sc1
  buffer_load_dwordx4 v[12:15], v0, s[4:7], s16 offen offset:1024 sc1
  s_waitcnt vmcnt(4)
  v_max3_u32 v9, v23, v23, v23
  v_cmp_eq_u32 vcc, -1, v9
  s_cbranch_vccnz R3_c2
  s_branch R3_g2
R3_c3:
  buffer_load_dwordx4 v[56:59], v0, s[4:7], s47 offen offset:3072 sc1
  s_sub_u32 s54, s54, 1
  s_cbranch_scc1 K_end
  buffer_load_dword v10, s[4:7], s47 offen lds
  buffer_load_dwordx4 v[60:63], v0, s[4:7], s16 offen offset:0 sc1
  buffer_load_dwordx4 v[12:15], v0, s[4:7], s16 offen offset:1024 sc1
  buffer_load_dword v10, s[4:7], s47 offen lds
  buffer_load_dwordx4 v[16:19], v0, s[4:7], s16 offen offset:2048 sc1
  buffer_load_dwordx4 v[4:7], v0, s[4:7], s17 offen offset:0 sc1
  s_waitcnt vmcnt(6)
  v_max3_u32 v9, v59, v59, v59
  v_cmp_eq_u32 vcc, -1, v9
  s_cbranch_vccnz R3_c3
  s_branch R3_g3
R3_c45:
  buffer_load_dwordx4 v[60:63], v0, s[4:7], s16 offen offset:0 sc1
  buffer_load_dwordx4 v[12:15], v0, s[4:7], s16 offen offset:1024 sc1
  s_sub_u32 s54, s54, 1
  s_cbranch_scc1 K_end
  buffer_load_dword v10, s[4:7], s47 offen lds
  buffer_load_dwordx4 v[16:19], v0, s[4:7], s16 offen offset:2048 sc1
  buffer_load_dwordx4 v[4:7], v0, s[4:7], s17 offen offset:0 sc1
  buffer_load_dwordx4 v[20:23], v0, s[4:7], s16 offen offset:3072 sc1
  buffer_load_dword v10, s[4:7], s47 offen lds
  s_waitcnt vmcnt(5)
  v_max3_u32 v9, v63, v15, v63
  v_cmp_eq_u32 vcc, -1, v9
  s_cbranch_vccnz R3_c45
  s_branch R3_g45
R3_c678:
  buffer_load_dwordx4 v[16:19], v0, s[4:7], s16 offen offset:2048 sc1
  buffer_load_dwordx4 v[4:7], v0, s[4:7], s17 offen offset:0 sc1
  buffer_load_dwordx4 v[20:23], v0, s[4:7], s16 offen offset:3072 sc1
  s_sub_u32 s54, s54, 1
  s_cbranch_scc1 K_end
  buffer_load_dword v10, s[4:7], s47 offen lds
  buffer_load_dword v10, s[4:7], s47 offen lds
  buffer_load_dword v10, s[4:7], s47 offen lds
  s_waitcnt vmcnt(3)
  v_max3_u32 v9, v19, v23, v7
  v_cmp_eq_u32 vcc, -1, v9
  s_cbranch_vccnz R3_c678
  s_branch R3_g678
R3_fn:
  s_cmp_eq_u32 s20, s46
  s_cbranch_scc1 R3_gn
  s_mov_b32 s20, s46
  s_waitcnt vmcnt(0) lgkmcnt(0)
  s_nop 7
R3_fl:
  buffer_load_dwordx4 v[12:15], v0, s[4:7], s47 offen offset:0 sc1
  buffer_load_dwordx4 v[16:19], v0, s[4:7], s47 offen offset:1024 sc1
  buffer_load_dwordx4 v[20:23], v0, s[4:7], s47 offen offset:2048 sc1
  buffer_load_dwordx4 v[24:27], v0, s[4:7], s47 offen offset:3072 sc1
  buffer_load_dwordx4 v[28:31], v0, s[4:7], s16 offen offset:0 sc1
  buffer_load_dwordx4 v[32:35], v0, s[4:7], s16 offen offset:1024 sc1
  buffer_load_dwordx4 v[36:39], v0, s[4:7], s16 offen offset:2048 sc1
  buffer_load_dwordx4 v[40:43], v0, s[4:7], s16 offen offset:3072 sc1
  buffer_load_dwordx4 v[44:47], v0, s[4:7], s17 offen offset:0 sc1
  s_sub_u32 s54, s54, 1
  s_cbranch_scc1 K_end
  s_waitcnt vmcnt(8)
  v_max_u32 v9, v12, v13
  v_max3_u32 v9, v9, v14, v15
  s_waitcnt vmcnt(7)
  v_max3_u32 v9, v9, v16, v17
  v_max3_u32 v9, v9, v18, v19
  s_waitcnt vmcnt(6)
  v_max3_u32 v9, v9, v20, v21
  v_max3_u32 v9, v9, v22, v23
  s_waitcnt vmcnt(5)
  v_max3_u32 v9, v9, v24, v25
  v_max3_u32 v9, v9, v26, v27
  s_waitcnt vmcnt(4)
  v_max3_u32 v9, v9, v28, v29
  v_max3_u32 v9, v9, v30, v31
  s_waitcnt vmcnt(3)
  v_max3_u32 v9, v9, v32, v33
  v_max3_u32 v9, v9, v34, v35
  s_waitcnt vmcnt(2)
  v_max3_u32 v9, v9, v36, v37
  v_max3_u32 v9, v9, v38, v39
  s_waitcnt vmcnt(1)
  v_max3_u32 v9, v9, v40, v41
  v_max3_u32 v9, v9, v42, v43
  s_waitcnt vmcnt(0)
  v_max3_u32 v9, v9, v44, v45
  v_max3_u32 v9, v9, v46, v47
  v_cmp_eq_u32 vcc, -1, v9
  s_cbranch_vccnz R3_fl
  s_barrier
  buffer_inv sc1
  s_waitcnt vmcnt(0)
  s_barrier
  s_branch R3_in2
R3_frq:
R3_lrq:
  buffer_load_dwordx4 v[56:59], v0, s[4:7], s51 offen offset:0 sc1
  buffer_load_dwordx4 v[60:63], v0, s[4:7], s51 offen offset:1024 sc1
  s_sub_u32 s54, s54, 1
  s_cbranch_scc1 K_end
  s_waitcnt vmcnt(0)
  v_bitop3_b32 v9, v56, v57, s19 bitop3:0x7e
  v_bitop3_b32 v11, v58, v59, s19 bitop3:0x7e
  v_mfma_f32_16x16x32_bf16 v[40:43], v[64:67], v[56:59], 0
  v_bitop3_b32 v44, v60, v61, s19 bitop3:0x7e
  v_bitop3_b32 v45, v62, v63, s19 bitop3:0x7e
  v_mfma_f32_16x16x32_bf16 v[40:43], v[64:67], v[60:63], v[40:43]
  v_or3_b32 v9, v9, v11, v44
  v_bitop3_b32 v9, v9, v45, 1 bitop3:0xa8
  v_cmp_ne_u32 vcc, 0, v9
  s_nop 4
  v_add_f32_dpp v40, v40, v40 row_ror:8 row_mask:0xf bank_mask:0xf
  v_add_f32_dpp v41, v41, v41 row_ror:8 row_mask:0xf bank_mask:0xf
  s_cbranch_vccz R3_rq
  s_branch R3_lrq
R3_flg:
  s_load_dword s60, s[42:43], s59 glc
  s_sub_u32 s54, s54, 1
  s_cbranch_scc1 K_end
  s_waitcnt lgkmcnt(0)
  s_branch R3_fc
RF_disp:
  s_cmp_eq_u32 s44, 0
  s_cbranch_scc1 RF0_in
  s_cmp_eq_u32 s44, 1
  s_cbranch_scc1 RF1_in
  s_cmp_eq_u32 s44, 2
  s_cbranch_scc1 RF2_in
  s_branch RF3_in
RF0_go:
  s_waitcnt vmcnt(3)
RF0_go2:
  v_cmp_eq_u32 vcc, -1, v15
  v_smfmac_f32_16x16x64_bf16 v[24:27], v[12:15], a[0:7], v8
  ds_read_b128 v[40:43], v1 offset:16384
  v_smfmac_f32_16x16x64_bf16 v[28:31], v[12:15], a[8:15], v8
  s_cbranch_vccnz RF0_f0
  v_smfmac_f32_16x16x64_bf16 v[32:35], v[12:15], a[128:135], v8
  ds_read_b128 v[44:47], v1 offset:17408
  v_smfmac_f32_16x16x64_bf16 v[36:39], v[12:15], a[136:143], v8
  ds_read_b128 v[48:51], v1 offset:18432
  s_waitcnt vmcnt(2)
  v_cmp_eq_u32 vcc, -1, v19
  v_smfmac_f32_16x16x64_bf16 v[64:67], v[12:15], a[192:199], v8
  ds_read_b128 v[52:55], v1 offset:19456
  v_smfmac_f32_16x16x64_bf16 v[68:71], v[12:15], a[200:207], v8
  s_cbranch_vccnz RF0_c1
RF0_g1:
  v_smfmac_f32_16x16x64_bf16 v[24:27], v[16:19], a[16:23], v8
  buffer_load_dwordx4 v[60:63], v0, s[4:7], s16 offen offset:0 sc1
  s_waitcnt lgkmcnt(2)
  v_smfmac_f32_16x16x64_bf16 v[32:35], v[16:19], v[40:47], v8
  ds_read_b128 v[40:43], v1 offset:20480
  buffer_load_dwordx4 v[12:15], v0, s[4:7], s16 offen offset:1024 sc1
  v_smfmac_f32_16x16x64_bf16 v[28:31], v[16:19], a[24:31], v8
  ds_read_b128 v[44:47], v1 offset:21504
  s_waitcnt lgkmcnt(2)
  v_smfmac_f32_16x16x64_bf16 v[36:39], v[16:19], v[48:55], v8
  ds_read_b128 v[48:51], v1 offset:22528
  s_waitcnt vmcnt(3)
  v_cmp_eq_u32 vcc, -1, v23
  v_smfmac_f32_16x16x64_bf16 v[64:67], v[16:19], a[208:215], v8
  ds_read_b128 v[52:55], v1 offset:23552
  v_smfmac_f32_16x16x64_bf16 v[68:71], v[16:19], a[216:223], v8
  s_cbranch_vccnz RF0_c2
RF0_g2:
  v_smfmac_f32_16x16x64_bf16 v[24:27], v[20:23], a[32:39], v8
  buffer_load_dwordx4 v0, s[4:7], s52 offen offset:256 sc1 lds
  s_waitcnt lgkmcnt(2)
  v_smfmac_f32_16x16x64_bf16 v[32:35], v[20:23], v[40:47], v8
  ds_read_b128 v[40:43], v1 offset:24576
  v_smfmac_f32_16x16x64_bf16 v[28:31], v[20:23], a[40:47], v8
  ds_read_b128 v[44:47], v1 offset:25600
  buffer_load_dwordx4 v[16:19], v0, s[4:7], s16 offen offset:2048 sc1
  s_waitcnt lgkmcnt(2)
  v_smfmac_f32_16x16x64_bf16 v[36:39], v[20:23], v[48:55], v8
  ds_read_b128 v[48:51], v1 offset:26624
  s_waitcnt vmcnt(4)
  v_cmp_eq_u32 vcc, -1, v59
  v_smfmac_f32_16x16x64_bf16 v[64:67], v[20:23], a[224:231], v8
  ds_read_b128 v[52:55], v1 offset:27648
  buffer_load_dwordx4 v[4:7], v0, s[4:7], s17 offen offset:0 sc1
  v_smfmac_f32_16x16x64_bf16 v[68:71], v[20:23], a[232:239], v8
  s_cbranch_vccnz RF0_c3
RF0_g3:
  v_smfmac_f32_16x16x64_bf16 v[24:27], v[56:59], a[48:55], v8
  buffer_load_dwordx4 v[20:23], v0, s[4:7], s16 offen offset:3072 sc1
  s_waitcnt lgkmcnt(2)
  v_smfmac_f32_16x16x64_bf16 v[32:35], v[56:59], v[40:47], v8
  ds_read_b128 v[40:43], v1 offset:28672
  buffer_load_dwordx4 v0, s[4:7], s52 offen offset:1280 sc1 lds
  v_smfmac_f32_16x16x64_bf16 v[28:31], v[56:59], a[56:63], v8
  ds_read_b128 v[44:47], v1 offset:29696
  s_waitcnt lgkmcnt(2)
  v_smfmac_f32_16x16x64_bf16 v[36:39], v[56:59], v[48:55], v8
  ds_read_b128 v[48:51], v1 offset:30720
  s_waitcnt vmcnt(5)
  v_cmp_u_f32 vcc, v63, v15
  v_smfmac_f32_16x16x64_bf16 v[64:67], v[56:59], a[240:247], v8
  ds_read_b128 v[52:55], v1 offset:31744
  v_smfmac_f32_16x16x64_bf16 v[68:71], v[56:59], a[248:255], v8
  s_cbranch_vccnz RF0_c45
RF0_g45:
  v_smfmac_f32_16x16x64_bf16 v[24:27], v[60:63], a[64:71], v8
  s_waitcnt lgkmcnt(2)
  v_smfmac_f32_16x16x64_bf16 v[32:35], v[60:63], v[40:47], v8
  ds_read_b128 v[40:43], v1 offset:0
  v_smfmac_f32_16x16x64_bf16 v[28:31], v[60:63], a[72:79], v8
  ds_read_b128 v[44:47], v1 offset:1024
  buffer_load_dwordx4 v0, s[4:7], s52 offen offset:2304 sc1 lds
  s_waitcnt lgkmcnt(2)
  v_smfmac_f32_16x16x64_bf16 v[36:39], v[60:63], v[48:55], v8
  ds_read_b128 v[48:51], v1 offset:2048
  v_smfmac_f32_16x16x64_bf16 v[64:67], v[60:63], v[72:79], v8
  ds_read_b128 v[52:55], v1 offset:3072
  v_smfmac_f32_16x16x64_bf16 v[68:71], v[60:63], v[80:87], v8
  v_lshl_add_u32 v11, v0, 3, s21
  v_smfmac_f32_16x16x64_bf16 v[24:27], v[12:15], a[80:87], v8
  s_waitcnt lgkmcnt(2)
  v_smfmac_f32_16x16x64_bf16 v[32:35], v[12:15], v[40:47], v8
  ds_read_b128 v[40:43], v1 offset:4096
  v_smfmac_f32_16x16x64_bf16 v[28:31], v[12:15], a[88:95], v8
  ds_read_b128 v[44:47], v1 offset:5120
  s_waitcnt vmcnt(3) lgkmcnt(2)
  v_max_u32 v9, v19, v7
  v_smfmac_f32_16x16x64_bf16 v[36:39], v[12:15], v[48:55], v8
  ds_read_b128 v[48:51], v1 offset:6144
  s_waitcnt vmcnt(2)
  v_cmp_u_f32 vcc, v9, v23
  v_smfmac_f32_16x16x64_bf16 v[64:67], v[12:15], v[88:95], v8
  ds_read_b128 v[52:55], v1 offset:7168
  buffer_load_dwordx4 v0, s[4:7], s52 offen offset:3328 sc1 lds
  v_smfmac_f32_16x16x64_bf16 v[68:71], v[12:15], v[96:103], v8
  s_cbranch_vccnz RF0_c678
RF0_g678:
  v_smfmac_f32_16x16x64_bf16 v[24:27], v[16:19], a[96:103], v8
  s_waitcnt vmcnt(2)
  s_waitcnt lgkmcnt(2)
  s_barrier
  ds_read_b128 v[12:15], v0 offset:5632
  v_smfmac_f32_16x16x64_bf16 v[24:27], v[20:23], v[40:47], v8
  buffer_load_dword v11, s[4:7], s52 offen sc1 lds
  v_smfmac_f32_16x16x64_bf16 v[28:31], v[16:19], a[104:111], v8
  s_waitcnt lgkmcnt(1)
  v_smfmac_f32_16x16x64_bf16 v[28:31], v[20:23], v[48:55], v8
  ds_read_b128 v[60:63], v0 offset:4608
  v_smfmac_f32_16x16x64_bf16 v[24:27], v[4:7], a[112:119], v8
  ds_read_b128 v[44:47], v0 offset:256
  v_smfmac_f32_16x16x64_bf16 v[28:31], v[4:7], a[120:127], v8
  ds_read_b128 v[56:59], v0 offset:1280
  v_smfmac_f32_16x16x64_bf16 v[32:35], v[16:19], a[144:151], v8
  v_add_f32 v24, v24, v26
  v_add_f32 v25, v25, v27
  v_smfmac_f32_16x16x64_bf16 v[32:35], v[20:23], a[160:167], v8
  v_add_f32 v28, v28, v30
  v_add_f32 v29, v29, v31
  v_smfmac_f32_16x16x64_bf16 v[32:35], v[4:7], a[176:183], v8
  v_cvt_pk_bf16_f32 v41, v24, v28
  v_cvt_pk_bf16_f32 v43, v25, v29
  v_smfmac_f32_16x16x64_bf16 v[36:39], v[16:19], a[152:159], v8
  ds_write2_b32 v3, v41, v43 offset0:0 offset1:4
  v_smfmac_f32_16x16x64_bf16 v[36:39], v[20:23], a[168:175], v8
  ds_read_b128 v[24:27], v2 offset:18432
  v_add_f32 v32, v32, v34
  v_smfmac_f32_16x16x64_bf16 v[36:39], v[4:7], a[184:191], v8
  v_add_f32 v33, v33, v35
  v_smfmac_f32_16x16x64_bf16 v[64:67], v[16:19], v[104:111], v8
  v_smfmac_f32_16x16x64_bf16 v[68:71], v[16:19], v[112:119], v8
  s_waitcnt lgkmcnt(1)
  s_barrier
  v_add_f32 v36, v36, v38
  v_smfmac_f32_16x16x64_bf16 v[64:67], v[20:23], v[120:127], v8
  ds_read_b128 v[28:31], v2 offset:19584
  v_add_f32 v37, v37, v39
  v_smfmac_f32_16x16x64_bf16 v[68:71], v[20:23], v[128:135], v8
  ds_read_b128 v[16:19], v0 offset:8960
  v_cvt_pk_bf16_f32 v40, v32, v36
  v_smfmac_f32_16x16x64_bf16 v[64:67], v[4:7], v[136:143], v8
  ds_read_b128 v[20:23], v0 offset:9984
  v_cvt_pk_bf16_f32 v42, v33, v37
  v_smfmac_f32_16x16x64_bf16 v[68:71], v[4:7], v[144:151], v8
  ds_read_b128 v[48:51], v2 offset:20736
  ds_read_b128 v[4:7], v0 offset:13312
  ds_write2_b32 v3, v40, v42 offset0:144 offset1:148
  s_waitcnt lgkmcnt(6)
  v_mfma_f32_16x16x32_bf16 v[32:35], v[44:47], v[24:27], 0
  ds_read_b128 v[44:47], v0 offset:14336
  v_add_f32 v64, v64, v66
  v_mfma_f32_16x16x32_bf16 v[36:39], v[56:59], v[24:27], 0
  ds_read_b128 v[52:55], v2 offset:21888
  s_waitcnt lgkmcnt(7)
  v_add_f32 v65, v65, v67
  v_mfma_f32_16x16x32_bf16 v[32:35], v[60:63], v[28:31], v[32:35]
  v_cvt_pk_bf16_f32 v41, v64, v65
  v_mfma_f32_16x16x32_bf16 v[36:39], v[12:15], v[28:31], v[36:39]
  ds_read_b128 v[64:67], v2 offset:19008
  s_waitcnt lgkmcnt(5)
  v_add_f32 v68, v68, v70
  v_mfma_f32_16x16x32_bf16 v[32:35], v[16:19], v[48:51], v[32:35]
  s_waitcnt lgkmcnt(2)
  s_barrier
  ds_read_b128 v[12:15], v2 offset:20160
  v_add_f32 v69, v69, v71
  v_mfma_f32_16x16x32_bf16 v[36:39], v[20:23], v[48:51], v[36:39]
  ds_read_b128 v[16:19], v2 offset:21312
  s_waitcnt lgkmcnt(3)
  v_cvt_pk_bf16_f32 v43, v68, v69
  v_mfma_f32_16x16x32_bf16 v[32:35], v[4:7], v[52:55], v[32:35]
  s_waitcnt vmcnt(2)
  ds_read_b128 v[56:59], v0 offset:2304
  ds_read_b128 v[68:71], v2 offset:22464
  v_mfma_f32_16x16x32_bf16 v[36:39], v[44:47], v[52:55], v[36:39]
  s_waitcnt vmcnt(1)
  ds_read_b128 v[60:63], v0 offset:3328
  s_waitcnt lgkmcnt(5)
  v_mfma_f32_16x16x32_bf16 v[44:47], v[64:67], v[24:27], 0
  s_waitcnt lgkmcnt(4)
  v_cmp_u_f32 vcc, v32, v32
  v_max3_f32 v9, v32, v33, v34
  v_mfma_f32_16x16x32_bf16 v[44:47], v[12:15], v[28:31], v[44:47]
  s_waitcnt lgkmcnt(3)
  v_max3_f32 v9, v9, v35, v36
  v_max3_f32 v9, v9, v37, v38
  v_mfma_f32_16x16x32_bf16 v[44:47], v[16:19], v[48:51], v[44:47]
  s_cbranch_vccnz RF0_fn
RF0_gn:
  s_waitcnt lgkmcnt(1)
  v_mfma_f32_16x16x32_bf16 v[44:47], v[68:71], v[52:55], v[44:47]
  buffer_store_dwordx4 v[40:43], v0, s[4:7], s53 offen offset:0 sc1
  ds_read_b128 v[4:7], v0 offset:23552
  ds_read_b128 v[24:27], v1 offset:8192
  v_mov_b64 v[12:13], s[62:63]
  v_mov_b64 v[14:15], s[62:63]
  v_max_f32 v9, v9, v39
  s_nop 1
  v_max3_f32 v46, v9, v44, v45
  v_max3_f32 v9, v9, v44, v45
  s_add_u32 s53, s53, 131072
  s_add_u32 s47, s47, 16384
  v_permlane32_swap_b32 v9, v46
  v_max_f32 v47, v9, v46
  v_max_f32 v9, v9, v46
  s_add_u32 s22, s47, s48
  s_nop 0
  v_permlane16_swap_b32 v9, v47
  v_max_f32 v9, v9, v47
  v_mul_f32 v46, s58, v9
  v_pk_fma_f32 v[44:45], v[44:45], s[58:59], v[46:47] op_sel_hi:[1,0,0] neg_lo:[0,0,1] neg_hi:[0,0,1]
  v_pk_fma_f32 v[32:33], v[32:33], s[58:59], v[46:47] op_sel_hi:[1,0,0] neg_lo:[0,0,1] neg_hi:[0,0,1]
  v_pk_fma_f32 v[34:35], v[34:35], s[58:59], v[46:47] op_sel_hi:[1,0,0] neg_lo:[0,0,1] neg_hi:[0,0,1]
  v_pk_fma_f32 v[36:37], v[36:37], s[58:59], v[46:47] op_sel_hi:[1,0,0] neg_lo:[0,0,1] neg_hi:[0,0,1]
  v_pk_fma_f32 v[38:39], v[38:39], s[58:59], v[46:47] op_sel_hi:[1,0,0] neg_lo:[0,0,1] neg_hi:[0,0,1]
  v_exp_f32 v44, v44
  v_exp_f32 v45, v45
  v_exp_f32 v32, v32
  v_cvt_pk_bf16_f32 v11, v44, v45
  v_exp_f32 v33, v33
  v_exp_f32 v34, v34
  v_mfma_f32_16x16x16_bf16 v[16:19], v[40:41], v[10:11], 0
  v_cvt_pk_bf16_f32 v64, v32, v33
  v_exp_f32 v35, v35
  v_mfma_f32_16x16x16_bf16 v[68:71], v[42:43], v[10:11], 0
  v_exp_f32 v36, v36
  v_cvt_pk_bf16_f32 v65, v34, v35
  v_exp_f32 v37, v37
  v_mfma_f32_16x16x16_bf16 v[20:23], v[10:11], v[12:13], 0
  ds_read_b128 v[28:31], v1 offset:9216
  v_exp_f32 v38, v38
  v_exp_f32 v39, v39
  v_cvt_pk_bf16_f32 v66, v36, v37
  v_cvt_pk_bf16_f32 v67, v38, v39
  v_mov_b64 v[32:33], 0
  v_mov_b64 v[34:35], 0
  v_mfma_f32_16x16x32_bf16 v[16:19], v[56:59], v[64:67], v[16:19]
  v_mov_b64 v[36:37], 0
  v_mov_b64 v[38:39], 0
  s_waitcnt lgkmcnt(3)
  v_mfma_f32_16x16x32_bf16 v[68:71], v[60:63], v[64:67], v[68:71]
  v_mov_b64 v[56:57], 0
  v_mov_b64 v[58:59], 0
  v_mfma_f32_16x16x32_bf16 v[20:23], v[64:67], v[12:15], v[20:23]
  v_cvt_pk_bf16_f32 v64, v16, v17
  v_cvt_pk_bf16_f32 v65, v18, v19
  v_mov_b64 v[60:61], 0
  v_mov_b64 v[62:63], 0
  v_cvt_pk_bf16_f32 v66, v68, v69
  v_cvt_pk_bf16_f32 v67, v70, v71
  ds_write_b128 v2, v[64:67] offset:18432
  s_add_u32 s52, s52, 524288
  v_mfma_f32_16x16x32_bf16 v[44:47], v[64:67], v[240:243], 0
  ds_read_b128 v[48:51], v1 offset:10240
  s_waitcnt lgkmcnt(2)
  v_smfmac_f32_16x16x64_bf16 v[32:35], v[64:67], v[24:31], v8 abid:1
  ds_read_b128 v[52:55], v1 offset:11264
  s_cmp_eq_u32 s46, 63
  v_smfmac_f32_16x16x64_bf16 v[56:59], v[64:67], v[152:159], v8 abid:1
  s_cbranch_scc1 K_end
  s_waitcnt lgkmcnt(2)
  s_barrier
  v_smfmac_f32_16x16x64_bf16 v[60:63], v[64:67], v[184:191], v8 abid:1
  ds_read_b128 v[12:15], v2 offset:19584
  ds_read_b128 v[16:19], v2 offset:20736
  ds_read_b128 v[68:71], v2 offset:21888
  s_waitcnt lgkmcnt(3)
  v_smfmac_f32_16x16x64_bf16 v[36:39], v[64:67], v[48:55], v8 abid:1
  ds_read_b128 v[24:27], v1 offset:12288
  ds_read_b128 v[28:31], v1 offset:13312
  v_rcp_f32 v20, v20
  v_rcp_f32 v21, v21
  s_waitcnt lgkmcnt(4)
  v_smfmac_f32_16x16x64_bf16 v[56:59], v[12:15], v[160:167], v8 abid:1
  ds_read_b128 v[48:51], v1 offset:14336
  s_waitcnt lgkmcnt(4)
  v_smfmac_f32_16x16x64_bf16 v[56:59], v[16:19], v[168:175], v8 abid:1
  ds_read_b128 v[52:55], v1 offset:15360
  s_waitcnt lgkmcnt(4)
  v_smfmac_f32_16x16x64_bf16 v[56:59], v[68:71], v[176:183], v8 abid:1
  ds_read_b128 v[64:67], v4 offset:23040
  v_smfmac_f32_16x16x64_bf16 v[60:63], v[12:15], v[192:199], v8 abid:1
  s_add_u32 s46, s46, 1
  s_add_u32 s56, s47, s49
  v_smfmac_f32_16x16x64_bf16 v[60:63], v[16:19], v[200:207], v8 abid:1
  v_mul_f32 v56, v56, v20
  v_mul_f32 v58, v58, v20
  v_mul_f32 v57, v57, v21
  v_mul_f32 v59, v59, v21
  v_cvt_pk_bf16_f32 v56, v56, v58
  v_cvt_pk_bf16_f32 v57, v57, v59
  v_bfi_b32 v56, 1, s46, v56
  v_bfi_b32 v57, 1, s46, v57
  buffer_store_dwordx2 v[56:57], v5, s[4:7], s68 offen sc1
  v_smfmac_f32_16x16x64_bf16 v[60:63], v[68:71], v[208:215], v8 abid:1
  s_waitcnt lgkmcnt(3)
  v_smfmac_f32_16x16x64_bf16 v[32:35], v[12:15], v[24:31], v8 abid:1
  ds_read_b128 v[24:27], v1 offset:32768
  v_smfmac_f32_16x16x64_bf16 v[32:35], v[16:19], v[216:223], v8 abid:1
  ds_read_b128 v[28:31], v1 offset:33792
  v_mul_f32 v60, v60, v20
  v_mul_f32 v62, v62, v20
  v_mul_f32 v61, v61, v21
  v_mul_f32 v63, v63, v21
  v_cvt_pk_bf16_f32 v60, v60, v62
  v_cvt_pk_bf16_f32 v61, v61, v63
  v_bfi_b32 v60, 1, s46, v60
  v_bfi_b32 v61, 1, s46, v61
  s_waitcnt lgkmcnt(3)
  v_smfmac_f32_16x16x64_bf16 v[32:35], v[68:71], v[48:55], v8 abid:1
  buffer_store_dwordx2 v[60:61], v5, s[4:7], s69 offen sc1
  v_smfmac_f32_16x16x64_bf16 v[36:39], v[12:15], v[224:231], v8 abid:1
  v_smfmac_f32_16x16x64_bf16 v[36:39], v[16:19], v[232:239], v8 abid:1
  v_mul_f32 v32, v32, v20
  v_mul_f32 v34, v34, v20
  v_mul_f32 v33, v33, v21
  v_mul_f32 v35, v35, v21
  v_cvt_pk_bf16_f32 v32, v32, v34
  v_cvt_pk_bf16_f32 v33, v33, v35
  v_bfi_b32 v32, 1, s46, v32
  v_bfi_b32 v33, 1, s46, v33
  s_waitcnt lgkmcnt(0)
  v_smfmac_f32_16x16x64_bf16 v[36:39], v[68:71], v[24:31], v8 abid:1
  buffer_load_dwordx4 v[48:51], v0, s[4:7], s50 offen offset:0 sc1
  buffer_load_dwordx4 v[52:55], v0, s[4:7], s50 offen offset:1024 sc1
  buffer_store_dwordx2 v[32:33], v5, s[4:7], s70 offen sc1
  v_mfma_f32_16x16x32_bf16 v[44:47], v[12:15], v[244:247], v[44:47]
  v_mfma_f32_16x16x32_bf16 v[44:47], v[16:19], v[248:251], v[44:47]
  v_mul_f32 v36, v36, v20
  v_mul_f32 v38, v38, v20
  v_mfma_f32_16x16x32_bf16 v[44:47], v[68:71], v[252:255], v[44:47]
  v_mul_f32 v37, v37, v21
  v_mul_f32 v39, v39, v21
  v_cvt_pk_bf16_f32 v36, v36, v38
  v_cvt_pk_bf16_f32 v37, v37, v39
  v_bfi_b32 v36, 1, s46, v36
  v_bfi_b32 v37, 1, s46, v37
  buffer_load_dwordx4 v[48:51], v0, s[4:7], s50 offen offset:0 sc1
  buffer_load_dwordx4 v[52:55], v0, s[4:7], s50 offen offset:1024 sc1
  buffer_store_dwordx2 v[36:37], v5, s[4:7], s71 offen sc1
  v_mul_f32 v44, v44, v20
  v_mul_f32 v45, v45, v21
  v_cvt_pk_bf16_f32 v44, v44, v45
  v_bfi_b32 v44, 1, s46, v44
  buffer_store_dword v44, v7, s[4:7], s72 offen sc1
  buffer_load_dwordx4 v[48:51], v0, s[4:7], s50 offen offset:0 sc1
  buffer_load_dwordx4 v[52:55], v0, s[4:7], s50 offen offset:1024 sc1
  buffer_load_dwordx4 v[56:59], v0, s[4:7], s51 offen offset:0 sc1
  buffer_load_dwordx4 v[60:63], v0, s[4:7], s51 offen offset:1024 sc1
  s_waitcnt vmcnt(12)
  buffer_load_dwordx4 v[48:51], v0, s[4:7], s50 offen offset:0 sc1
  buffer_load_dwordx4 v[52:55], v0, s[4:7], s50 offen offset:1024 sc1
  s_waitcnt vmcnt(12)
  v_bitop3_b32 v9, v48, v49, s46 bitop3:0x7e
  v_bitop3_b32 v11, v50, v51, s46 bitop3:0x7e
  v_mfma_f32_16x16x32_bf16 v[40:43], v[64:67], v[48:51], 0
  s_waitcnt vmcnt(11)
  v_bitop3_b32 v44, v52, v53, s46 bitop3:0x7e
  v_bitop3_b32 v45, v54, v55, s46 bitop3:0x7e
  v_mfma_f32_16x16x32_bf16 v[40:43], v[64:67], v[52:55], v[40:43]
  v_or3_b32 v9, v9, v11, v44
  v_bitop3_b32 v9, v9, v45, 1 bitop3:0xa8
  v_cmp_ne_u32 vcc, 0, v9
  s_nop 4
  v_add_f32_dpp v40, v40, v40 row_ror:8 row_mask:0xf bank_mask:0xf
  v_add_f32_dpp v41, v41, v41 row_ror:8 row_mask:0xf bank_mask:0xf
  s_cbranch_vccnz RF0_frp
RF0_rp:
  s_barrier
  v_add_f32_dpp v46, v40, v40 row_ror:4 row_mask:0xf bank_mask:0x1
  v_add_f32_dpp v47, v41, v41 row_ror:4 row_mask:0xf bank_mask:0x1
  v_cvt_pk_bf16_f32 v9, v46, v47
  buffer_store_dword v9, v6, s[4:7], s22 offen sc1
RF0_yrp:
  buffer_load_dwordx4 v[56:59], v0, s[4:7], s51 offen offset:0 sc1
  buffer_load_dwordx4 v[60:63], v0, s[4:7], s51 offen offset:1024 sc1
  s_add_u32 s16, s47, 4096
  s_add_u32 s17, s47, 8192
  s_waitcnt vmcnt(6)
  v_bitop3_b32 v9, v56, v57, s46 bitop3:0x7e
  v_bitop3_b32 v11, v58, v59, s46 bitop3:0x7e
  v_mfma_f32_16x16x32_bf16 v[40:43], v[64:67], v[56:59], 0
  s_waitcnt vmcnt(5)
  v_bitop3_b32 v44, v60, v61, s46 bitop3:0x7e
  v_bitop3_b32 v45, v62, v63, s46 bitop3:0x7e
  v_mfma_f32_16x16x32_bf16 v[40:43], v[64:67], v[60:63], v[40:43]
  v_or3_b32 v9, v9, v11, v44
  v_bitop3_b32 v9, v9, v45, 1 bitop3:0xa8
  v_cmp_ne_u32 vcc, 0, v9
  s_barrier
  s_nop 3
  v_add_f32_dpp v40, v40, v40 row_ror:8 row_mask:0xf bank_mask:0xf
  v_add_f32_dpp v41, v41, v41 row_ror:8 row_mask:0xf bank_mask:0xf
  s_cbranch_vccnz RF0_frq
RF0_rq:
  v_add_f32_dpp v46, v40, v40 row_ror:4 row_mask:0xf bank_mask:0x1
  v_add_f32_dpp v47, v41, v41 row_ror:4 row_mask:0xf bank_mask:0x1
  v_cvt_pk_bf16_f32 v9, v46, v47
  buffer_store_dword v9, v6, s[4:7], s56 offen sc1
  buffer_load_dwordx4 v[12:15], v0, s[4:7], s47 offen offset:0 sc1
  buffer_load_dwordx4 v[16:19], v0, s[4:7], s47 offen offset:1024 sc1
  v_mov_b64 v[24:25], 0
  v_mov_b64 v[26:27], 0
  v_mov_b64 v[28:29], 0
  v_mov_b64 v[30:31], 0
  v_mov_b64 v[32:33], 0
  v_mov_b64 v[34:35], 0
  v_mov_b64 v[36:37], 0
  v_mov_b64 v[38:39], 0
  v_mov_b64 v[64:65], 0
  v_mov_b64 v[66:67], 0
  v_mov_b64 v[68:69], 0
  v_mov_b64 v[70:71], 0
  s_waitcnt vmcnt(2)
  buffer_load_dwordx4 v[20:23], v0, s[4:7], s47 offen offset:2048 sc1
  buffer_load_dwordx4 v[56:59], v0, s[4:7], s47 offen offset:3072 sc1
  s_branch RF0_go
RF0_in:
  s_cmp_gt_u32 s60, 1
  s_cselect_b32 s55, s64, 0
  s_cmp_gt_u32 s55, 0
  s_cbranch_scc1 RF0_in1
  s_xor_b32 s55, s59, 64
RF0_in0:
  s_load_dword s60, s[42:43], s59 glc
  s_load_dword s64, s[42:43], s55 glc
  s_sub_u32 s54, s54, 1
  s_cbranch_scc1 K_end
  s_waitcnt lgkmcnt(0)
  s_cmp_gt_u32 s60, 1
  s_cbranch_scc0 RF0_in0
RF0_in1:
  s_add_u32 s16, s47, 4096
  s_add_u32 s17, s47, 8192
  buffer_load_dwordx4 v[12:15], v0, s[4:7], s47 offen offset:0 sc1
  buffer_load_dwordx4 v[16:19], v0, s[4:7], s47 offen offset:1024 sc1
  buffer_load_dwordx4 v[20:23], v0, s[4:7], s47 offen offset:2048 sc1
  buffer_load_dwordx4 v[56:59], v0, s[4:7], s47 offen offset:3072 sc1
  v_lshlrev_b32 v11, 3, v0
  s_bitcmp1_b32 s45, 0
  s_cselect_b32 s56, -1, 1
  s_mul_i32 s56, s56, 2176
  s_add_u32 s55, s52, 256
  buffer_load_dword v11, s[4:7], s55 offen sc1 lds
  s_add_u32 s55, s50, s56
  s_add_u32 s56, s51, s56
  s_mov_b64 exec, 0x3ffff
  buffer_load_dword v11, s[4:7], s55 offen sc1 lds
  buffer_load_dword v11, s[4:7], s56 offen sc1 lds
  s_mov_b64 exec, -1
  v_mov_b64 v[24:25], 0
  v_mov_b64 v[26:27], 0
  v_mov_b64 v[28:29], 0
  v_mov_b64 v[30:31], 0
  v_mov_b64 v[32:33], 0
  v_mov_b64 v[34:35], 0
  v_mov_b64 v[36:37], 0
  v_mov_b64 v[38:39], 0
  v_mov_b64 v[64:65], 0
  v_mov_b64 v[66:67], 0
  v_mov_b64 v[68:69], 0
  v_mov_b64 v[70:71], 0
  s_waitcnt vmcnt(3)
  s_barrier
  s_branch RF0_go2
RF0_in2:
  buffer_load_dwordx4 v[12:15], v0, s[4:7], s47 offen offset:0 sc1
  buffer_load_dwordx4 v[16:19], v0, s[4:7], s47 offen offset:1024 sc1
  buffer_load_dwordx4 v[20:23], v0, s[4:7], s47 offen offset:2048 sc1
  buffer_load_dwordx4 v[56:59], v0, s[4:7], s47 offen offset:3072 sc1
  v_mov_b64 v[24:25], 0
  v_mov_b64 v[26:27], 0
  v_mov_b64 v[28:29], 0
  v_mov_b64 v[30:31], 0
  v_mov_b64 v[32:33], 0
  v_mov_b64 v[34:35], 0
  v_mov_b64 v[36:37], 0
  v_mov_b64 v[38:39], 0
  v_mov_b64 v[64:65], 0
  v_mov_b64 v[66:67], 0
  v_mov_b64 v[68:69], 0
  v_mov_b64 v[70:71], 0
  s_waitcnt vmcnt(0)
  s_barrier
  s_branch RF0_go2
RF0_f0:
  buffer_load_dwordx4 v[12:15], v0, s[4:7], s47 offen offset:0 sc1
  s_sub_u32 s54, s54, 1
  s_cbranch_scc1 K_end
  s_nop 3
  v_mov_b64 v[24:25], 0
  v_mov_b64 v[26:27], 0
  v_mov_b64 v[28:29], 0
  v_mov_b64 v[30:31], 0
  buffer_load_dwordx4 v[16:19], v0, s[4:7], s47 offen offset:1024 sc1
  buffer_load_dwordx4 v[20:23], v0, s[4:7], s47 offen offset:2048 sc1
  buffer_load_dwordx4 v[56:59], v0, s[4:7], s47 offen offset:3072 sc1
  s_waitcnt vmcnt(3) lgkmcnt(0)
  s_branch RF0_go2
RF0_c1:
  buffer_load_dwordx4 v[16:19], v0, s[4:7], s47 offen offset:1024 sc1
  s_sub_u32 s54, s54, 1
  s_cbranch_scc1 K_end
  buffer_load_dwordx4 v[20:23], v0, s[4:7], s47 offen offset:2048 sc1
  buffer_load_dwordx4 v[56:59], v0, s[4:7], s47 offen offset:3072 sc1
  s_waitcnt vmcnt(2)
  v_max3_u32 v9, v19, v19, v19
  v_cmp_eq_u32 vcc, -1, v9
  s_cbranch_vccnz RF0_c1
  s_branch RF0_g1
RF0_c2:
  buffer_load_dwordx4 v[20:23], v0, s[4:7], s47 offen offset:2048 sc1
  s_sub_u32 s54, s54, 1
  s_cbranch_scc1 K_end
  buffer_load_dwordx4 v[56:59], v0, s[4:7], s47 offen offset:3072 sc1
  buffer_load_dwordx4 v[60:63], v0, s[4:7], s16 offen offset:0 sc1
  buffer_load_dwordx4 v[12:15], v0, s[4:7], s16 offen offset:1024 sc1
  s_waitcnt vmcnt(3)
  v_max3_u32 v9, v23, v23, v23
  v_cmp_eq_u32 vcc, -1, v9
  s_cbranch_vccnz RF0_c2
  s_branch RF0_g2
RF0_c3:
  buffer_load_dwordx4 v[56:59], v0, s[4:7], s47 offen offset:3072 sc1
  s_sub_u32 s54, s54, 1
  s_cbranch_scc1 K_end
  buffer_load_dwordx4 v[60:63], v0, s[4:7], s16 offen offset:0 sc1
  buffer_load_dwordx4 v[12:15], v0, s[4:7], s16 offen offset:1024 sc1
  buffer_load_dword v10, s[4:7], s47 offen lds
  buffer_load_dwordx4 v[16:19], v0, s[4:7], s16 offen offset:2048 sc1
  buffer_load_dwordx4 v[4:7], v0, s[4:7], s17 offen offset:0 sc1
  s_waitcnt vmcnt(5)
  v_max3_u32 v9, v59, v59, v59
  v_cmp_eq_u32 vcc, -1, v9
  s_cbranch_vccnz RF0_c3
  s_branch RF0_g3
RF0_c45:
  buffer_load_dwordx4 v[60:63], v0, s[4:7], s16 offen offset:0 sc1
  buffer_load_dwordx4 v[12:15], v0, s[4:7], s16 offen offset:1024 sc1
  s_sub_u32 s54, s54, 1
  s_cbranch_scc1 K_end
  buffer_load_dword v10, s[4:7], s47 offen lds
  buffer_load_dwordx4 v[16:19], v0, s[4:7], s16 offen offset:2048 sc1
  buffer_load_dwordx4 v[4:7], v0, s[4:7], s17 offen offset:0 sc1
  buffer_load_dwordx4 v[20:23], v0, s[4:7], s16 offen offset:3072 sc1
  buffer_load_dword v10, s[4:7], s47 offen lds
  s_waitcnt vmcnt(5)
  v_max3_u32 v9, v63, v15, v63
  v_cmp_eq_u32 vcc, -1, v9
  s_cbranch_vccnz RF0_c45
  s_branch RF0_g45
RF0_c678:
  buffer_load_dwordx4 v[16:19], v0, s[4:7], s16 offen offset:2048 sc1
  buffer_load_dwordx4 v[4:7], v0, s[4:7], s17 offen offset:0 sc1
  buffer_load_dwordx4 v[20:23], v0, s[4:7], s16 offen offset:3072 sc1
  s_sub_u32 s54, s54, 1
  s_cbranch_scc1 K_end
  buffer_load_dword v10, s[4:7], s47 offen lds
  buffer_load_dword v10, s[4:7], s47 offen lds
  buffer_load_dword v10, s[4:7], s47 offen lds
  s_waitcnt vmcnt(3)
  v_max3_u32 v9, v19, v23, v7
  v_cmp_eq_u32 vcc, -1, v9
  s_cbranch_vccnz RF0_c678
  s_branch RF0_g678
RF0_fn:
  s_cmp_eq_u32 s20, s46
  s_cbranch_scc1 RF0_gn
  s_mov_b32 s20, s46
  s_waitcnt vmcnt(0) lgkmcnt(0)
  s_nop 7
RF0_fl:
  buffer_load_dwordx4 v[12:15], v0, s[4:7], s47 offen offset:0 sc1
  buffer_load_dwordx4 v[16:19], v0, s[4:7], s47 offen offset:1024 sc1
  buffer_load_dwordx4 v[20:23], v0, s[4:7], s47 offen offset:2048 sc1
  buffer_load_dwordx4 v[24:27], v0, s[4:7], s47 offen offset:3072 sc1
  buffer_load_dwordx4 v[28:31], v0, s[4:7], s16 offen offset:0 sc1
  buffer_load_dwordx4 v[32:35], v0, s[4:7], s16 offen offset:1024 sc1
  buffer_load_dwordx4 v[36:39], v0, s[4:7], s16 offen offset:2048 sc1
  buffer_load_dwordx4 v[40:43], v0, s[4:7], s16 offen offset:3072 sc1
  buffer_load_dwordx4 v[44:47], v0, s[4:7], s17 offen offset:0 sc1
  s_sub_u32 s54, s54, 1
  s_cbranch_scc1 K_end
  s_waitcnt vmcnt(8)
  v_max_u32 v9, v12, v13
  v_max3_u32 v9, v9, v14, v15
  s_waitcnt vmcnt(7)
  v_max3_u32 v9, v9, v16, v17
  v_max3_u32 v9, v9, v18, v19
  s_waitcnt vmcnt(6)
  v_max3_u32 v9, v9, v20, v21
  v_max3_u32 v9, v9, v22, v23
  s_waitcnt vmcnt(5)
  v_max3_u32 v9, v9, v24, v25
  v_max3_u32 v9, v9, v26, v27
  s_waitcnt vmcnt(4)
  v_max3_u32 v9, v9, v28, v29
  v_max3_u32 v9, v9, v30, v31
  s_waitcnt vmcnt(3)
  v_max3_u32 v9, v9, v32, v33
  v_max3_u32 v9, v9, v34, v35
  s_waitcnt vmcnt(2)
  v_max3_u32 v9, v9, v36, v37
  v_max3_u32 v9, v9, v38, v39
  s_waitcnt vmcnt(1)
  v_max3_u32 v9, v9, v40, v41
  v_max3_u32 v9, v9, v42, v43
  s_waitcnt vmcnt(0)
  v_max3_u32 v9, v9, v44, v45
  v_max3_u32 v9, v9, v46, v47
  v_cmp_eq_u32 vcc, -1, v9
  s_cbranch_vccnz RF0_fl
  s_barrier
  buffer_inv sc1
  s_waitcnt vmcnt(0)
  s_barrier
  s_branch RF0_in2
RF0_xrp:
  v_add_f32_dpp v46, v40, v40 row_ror:4 row_mask:0xf bank_mask:0x1
  v_add_f32_dpp v47, v41, v41 row_ror:4 row_mask:0xf bank_mask:0x1
  v_cvt_pk_bf16_f32 v9, v46, v47
  buffer_store_dword v9, v6, s[4:7], s22 offen sc1
  s_waitcnt vmcnt(5)
  s_barrier
  s_branch RF0_yrp
RF0_frp:
  buffer_load_dwordx4 v[48:51], v0, s[4:7], s50 offen offset:0 sc1
  buffer_load_dwordx4 v[52:55], v0, s[4:7], s50 offen offset:1024 sc1
  buffer_load_dwordx4 v[56:59], v0, s[4:7], s51 offen offset:0 sc1
  buffer_load_dwordx4 v[60:63], v0, s[4:7], s51 offen offset:1024 sc1
  s_waitcnt vmcnt(12)
  v_bitop3_b32 v9, v48, v49, s46 bitop3:0x7e
  v_bitop3_b32 v11, v50, v51, s46 bitop3:0x7e
  v_mfma_f32_16x16x32_bf16 v[40:43], v[64:67], v[48:51], 0
  v_bitop3_b32 v44, v52, v53, s46 bitop3:0x7e
  v_bitop3_b32 v45, v54, v55, s46 bitop3:0x7e
  v_mfma_f32_16x16x32_bf16 v[40:43], v[64:67], v[52:55], v[40:43]
  v_or3_b32 v9, v9, v11, v44
  v_bitop3_b32 v9, v9, v45, 1 bitop3:0xa8
  v_cmp_ne_u32 vcc, 0, v9
  s_nop 4
  v_add_f32_dpp v40, v40, v40 row_ror:8 row_mask:0xf bank_mask:0xf
  v_add_f32_dpp v41, v41, v41 row_ror:8 row_mask:0xf bank_mask:0xf
  s_cbranch_vccz RF0_xrp
  buffer_load_dwordx4 v[48:51], v0, s[4:7], s50 offen offset:0 sc1
  buffer_load_dwordx4 v[52:55], v0, s[4:7], s50 offen offset:1024 sc1
  buffer_load_dwordx4 v[56:59], v0, s[4:7], s51 offen offset:0 sc1
  buffer_load_dwordx4 v[60:63], v0, s[4:7], s51 offen offset:1024 sc1
  s_waitcnt vmcnt(12)
  v_bitop3_b32 v9, v48, v49, s46 bitop3:0x7e
  v_bitop3_b32 v11, v50, v51, s46 bitop3:0x7e
  v_mfma_f32_16x16x32_bf16 v[40:43], v[64:67], v[48:51], 0
  v_bitop3_b32 v44, v52, v53, s46 bitop3:0x7e
  v_bitop3_b32 v45, v54, v55, s46 bitop3:0x7e
  v_mfma_f32_16x16x32_bf16 v[40:43], v[64:67], v[52:55], v[40:43]
  v_or3_b32 v9, v9, v11, v44
  v_bitop3_b32 v9, v9, v45, 1 bitop3:0xa8
  v_cmp_ne_u32 vcc, 0, v9
  s_nop 4
  v_add_f32_dpp v40, v40, v40 row_ror:8 row_mask:0xf bank_mask:0xf
  v_add_f32_dpp v41, v41, v41 row_ror:8 row_mask:0xf bank_mask:0xf
  s_cbranch_vccz RF0_xrp
  buffer_load_dwordx4 v[48:51], v0, s[4:7], s50 offen offset:0 sc1
  buffer_load_dwordx4 v[52:55], v0, s[4:7], s50 offen offset:1024 sc1
  buffer_load_dwordx4 v[56:59], v0, s[4:7], s51 offen offset:0 sc1
  buffer_load_dwordx4 v[60:63], v0, s[4:7], s51 offen offset:1024 sc1
  s_waitcnt vmcnt(12)
  v_bitop3_b32 v9, v48, v49, s46 bitop3:0x7e
  v_bitop3_b32 v11, v50, v51, s46 bitop3:0x7e
  v_mfma_f32_16x16x32_bf16 v[40:43], v[64:67], v[48:51], 0
  v_bitop3_b32 v44, v52, v53, s46 bitop3:0x7e
  v_bitop3_b32 v45, v54, v55, s46 bitop3:0x7e
  v_mfma_f32_16x16x32_bf16 v[40:43], v[64:67], v[52:55], v[40:43]
  v_or3_b32 v9, v9, v11, v44
  v_bitop3_b32 v9, v9, v45, 1 bitop3:0xa8
  v_cmp_ne_u32 vcc, 0, v9
  s_nop 4
  v_add_f32_dpp v40, v40, v40 row_ror:8 row_mask:0xf bank_mask:0xf
  v_add_f32_dpp v41, v41, v41 row_ror:8 row_mask:0xf bank_mask:0xf
  s_cbranch_vccz RF0_xrp
RF0_lrp:
  buffer_load_dwordx4 v[48:51], v0, s[4:7], s50 offen offset:0 sc1
  buffer_load_dwordx4 v[52:55], v0, s[4:7], s50 offen offset:1024 sc1
  buffer_load_dwordx4 v[56:59], v0, s[4:7], s51 offen offset:0 sc1
  buffer_load_dwordx4 v[60:63], v0, s[4:7], s51 offen offset:1024 sc1
  s_sub_u32 s54, s54, 1
  s_cbranch_scc1 K_end
  s_waitcnt vmcnt(14)
  v_bitop3_b32 v9, v48, v49, s46 bitop3:0x7e
  v_bitop3_b32 v11, v50, v51, s46 bitop3:0x7e
  v_mfma_f32_16x16x32_bf16 v[40:43], v[64:67], v[48:51], 0
  v_bitop3_b32 v44, v52, v53, s46 bitop3:0x7e
  v_bitop3_b32 v45, v54, v55, s46 bitop3:0x7e
  v_mfma_f32_16x16x32_bf16 v[40:43], v[64:67], v[52:55], v[40:43]
  v_or3_b32 v9, v9, v11, v44
  v_bitop3_b32 v9, v9, v45, 1 bitop3:0xa8
  v_cmp_ne_u32 vcc, 0, v9
  s_nop 4
  v_add_f32_dpp v40, v40, v40 row_ror:8 row_mask:0xf bank_mask:0xf
  v_add_f32_dpp v41, v41, v41 row_ror:8 row_mask:0xf bank_mask:0xf
  s_cbranch_vccz RF0_xrp
  s_branch RF0_lrp
RF0_frq:
  buffer_load_dwordx4 v[56:59], v0, s[4:7], s51 offen offset:0 sc1
  buffer_load_dwordx4 v[60:63], v0, s[4:7], s51 offen offset:1024 sc1
  s_waitcnt vmcnt(2)
  v_bitop3_b32 v9, v56, v57, s46 bitop3:0x7e
  v_bitop3_b32 v11, v58, v59, s46 bitop3:0x7e
  v_mfma_f32_16x16x32_bf16 v[40:43], v[64:67], v[56:59], 0
  v_bitop3_b32 v44, v60, v61, s46 bitop3:0x7e
  v_bitop3_b32 v45, v62, v63, s46 bitop3:0x7e
  v_mfma_f32_16x16x32_bf16 v[40:43], v[64:67], v[60:63], v[40:43]
  v_or3_b32 v9, v9, v11, v44
  v_bitop3_b32 v9, v9, v45, 1 bitop3:0xa8
  v_cmp_ne_u32 vcc, 0, v9
  s_nop 4
  v_add_f32_dpp v40, v40, v40 row_ror:8 row_mask:0xf bank_mask:0xf
  v_add_f32_dpp v41, v41, v41 row_ror:8 row_mask:0xf bank_mask:0xf
  s_cbranch_vccz RF0_rq
RF0_lrq:
  buffer_load_dwordx4 v[56:59], v0, s[4:7], s51 offen offset:0 sc1
  buffer_load_dwordx4 v[60:63], v0, s[4:7], s51 offen offset:1024 sc1
  s_sub_u32 s54, s54, 1
  s_cbranch_scc1 K_end
  s_waitcnt vmcnt(2)
  v_bitop3_b32 v9, v56, v57, s46 bitop3:0x7e
  v_bitop3_b32 v11, v58, v59, s46 bitop3:0x7e
  v_mfma_f32_16x16x32_bf16 v[40:43], v[64:67], v[56:59], 0
  v_bitop3_b32 v44, v60, v61, s46 bitop3:0x7e
  v_bitop3_b32 v45, v62, v63, s46 bitop3:0x7e
  v_mfma_f32_16x16x32_bf16 v[40:43], v[64:67], v[60:63], v[40:43]
  v_or3_b32 v9, v9, v11, v44
  v_bitop3_b32 v9, v9, v45, 1 bitop3:0xa8
  v_cmp_ne_u32 vcc, 0, v9
  s_nop 4
  v_add_f32_dpp v40, v40, v40 row_ror:8 row_mask:0xf bank_mask:0xf
  v_add_f32_dpp v41, v41, v41 row_ror:8 row_mask:0xf bank_mask:0xf
  s_cbranch_vccz RF0_rq
  s_branch RF0_lrq
RF1_go:
  s_waitcnt vmcnt(4)
RF1_go2:
  v_cmp_eq_u32 vcc, -1, v15
  v_smfmac_f32_16x16x64_bf16 v[24:27], v[12:15], a[0:7], v8
  ds_read_b128 v[40:43], v1 offset:16384
  v_smfmac_f32_16x16x64_bf16 v[28:31], v[12:15], a[8:15], v8
  s_cbranch_vccnz RF1_f0
  v_smfmac_f32_16x16x64_bf16 v[32:35], v[12:15], a[128:135], v8
  ds_read_b128 v[44:47], v1 offset:17408
  v_smfmac_f32_16x16x64_bf16 v[36:39], v[12:15], a[136:143], v8
  ds_read_b128 v[48:51], v1 offset:18432
  s_waitcnt vmcnt(3)
  v_cmp_eq_u32 vcc, -1, v19
  v_smfmac_f32_16x16x64_bf16 v[64:67], v[12:15], a[192:199], v8
  ds_read_b128 v[52:55], v1 offset:19456
  v_smfmac_f32_16x16x64_bf16 v[68:71], v[12:15], a[200:207], v8
  s_cbranch_vccnz RF1_c1
RF1_g1:
  v_smfmac_f32_16x16x64_bf16 v[24:27], v[16:19], a[16:23], v8
  buffer_load_dwordx4 v[60:63], v0, s[4:7], s16 offen offset:0 sc1
  s_waitcnt lgkmcnt(2)
  v_smfmac_f32_16x16x64_bf16 v[32:35], v[16:19], v[40:47], v8
  ds_read_b128 v[40:43], v1 offset:20480
  buffer_load_dwordx4 v[12:15], v0, s[4:7], s16 offen offset:1024 sc1
  v_smfmac_f32_16x16x64_bf16 v[28:31], v[16:19], a[24:31], v8
  ds_read_b128 v[44:47], v1 offset:21504
  s_waitcnt lgkmcnt(2)
  v_smfmac_f32_16x16x64_bf16 v[36:39], v[16:19], v[48:55], v8
  ds_read_b128 v[48:51], v1 offset:22528
  s_waitcnt vmcnt(4)
  v_cmp_eq_u32 vcc, -1, v23
  v_smfmac_f32_16x16x64_bf16 v[64:67], v[16:19], a[208:215], v8
  ds_read_b128 v[52:55], v1 offset:23552
  v_smfmac_f32_16x16x64_bf16 v[68:71], v[16:19], a[216:223], v8
  s_cbranch_vccnz RF1_c2
RF1_g2:
  v_smfmac_f32_16x16x64_bf16 v[24:27], v[20:23], a[32:39], v8
  buffer_load_dwordx4 v0, s[4:7], s52 offen offset:256 sc1 lds
  s_waitcnt lgkmcnt(2)
  v_smfmac_f32_16x16x64_bf16 v[32:35], v[20:23], v[40:47], v8
  ds_read_b128 v[40:43], v1 offset:24576
  v_smfmac_f32_16x16x64_bf16 v[28:31], v[20:23], a[40:47], v8
  ds_read_b128 v[44:47], v1 offset:25600
  buffer_load_dwordx4 v[16:19], v0, s[4:7], s16 offen offset:2048 sc1
  s_waitcnt lgkmcnt(2)
  v_smfmac_f32_16x16x64_bf16 v[36:39], v[20:23], v[48:55], v8
  ds_read_b128 v[48:51], v1 offset:26624
  s_waitcnt vmcnt(5)
  v_cmp_eq_u32 vcc, -1, v59
  v_smfmac_f32_16x16x64_bf16 v[64:67], v[20:23], a[224:231], v8
  ds_read_b128 v[52:55], v1 offset:27648
  buffer_load_dwordx4 v[4:7], v0, s[4:7], s17 offen offset:0 sc1
  v_smfmac_f32_16x16x64_bf16 v[68:71], v[20:23], a[232:239], v8
  s_cbranch_vccnz RF1_c3
RF1_g3:
  v_smfmac_f32_16x16x64_bf16 v[24:27], v[56:59], a[48:55], v8
  buffer_load_dwordx4 v[20:23], v0, s[4:7], s16 offen offset:3072 sc1
  s_waitcnt lgkmcnt(2)
  v_smfmac_f32_16x16x64_bf16 v[32:35], v[56:59], v[40:47], v8
  ds_read_b128 v[40:43], v1 offset:28672
  buffer_load_dwordx4 v0, s[4:7], s52 offen offset:1280 sc1 lds
  v_smfmac_f32_16x16x64_bf16 v[28:31], v[56:59], a[56:63], v8
  ds_read_b128 v[44:47], v1 offset:29696
  s_waitcnt lgkmcnt(2)
  v_smfmac_f32_16x16x64_bf16 v[36:39], v[56:59], v[48:55], v8
  ds_read_b128 v[48:51], v1 offset:30720
  s_waitcnt vmcnt(5)
  v_cmp_u_f32 vcc, v63, v15
  v_smfmac_f32_16x16x64_bf16 v[64:67], v[56:59], a[240:247], v8
  ds_read_b128 v[52:55], v1 offset:31744
  v_smfmac_f32_16x16x64_bf16 v[68:71], v[56:59], a[248:255], v8
  s_cbranch_vccnz RF1_c45
RF1_g45:
  v_smfmac_f32_16x16x64_bf16 v[24:27], v[60:63], a[64:71], v8
  s_waitcnt lgkmcnt(2)
  v_smfmac_f32_16x16x64_bf16 v[32:35], v[60:63], v[40:47], v8
  ds_read_b128 v[40:43], v1 offset:0
  v_smfmac_f32_16x16x64_bf16 v[28:31], v[60:63], a[72:79], v8
  ds_read_b128 v[44:47], v1 offset:1024
  buffer_load_dwordx4 v0, s[4:7], s52 offen offset:2304 sc1 lds
  s_waitcnt lgkmcnt(2)
  v_smfmac_f32_16x16x64_bf16 v[36:39], v[60:63], v[48:55], v8
  ds_read_b128 v[48:51], v1 offset:2048
  v_smfmac_f32_16x16x64_bf16 v[64:67], v[60:63], v[72:79], v8
  ds_read_b128 v[52:55], v1 offset:3072
  v_smfmac_f32_16x16x64_bf16 v[68:71], v[60:63], v[80:87], v8
  v_lshl_add_u32 v11, v0, 3, s21
  v_smfmac_f32_16x16x64_bf16 v[24:27], v[12:15], a[80:87], v8
  s_waitcnt lgkmcnt(2)
  v_smfmac_f32_16x16x64_bf16 v[32:35], v[12:15], v[40:47], v8
  ds_read_b128 v[40:43], v1 offset:4096
  v_smfmac_f32_16x16x64_bf16 v[28:31], v[12:15], a[88:95], v8
  ds_read_b128 v[44:47], v1 offset:5120
  s_waitcnt vmcnt(3) lgkmcnt(2)
  v_max_u32 v9, v19, v7
  v_smfmac_f32_16x16x64_bf16 v[36:39], v[12:15], v[48:55], v8
  ds_read_b128 v[48:51], v1 offset:6144
  s_waitcnt vmcnt(2)
  v_cmp_u_f32 vcc, v9, v23
  v_smfmac_f32_16x16x64_bf16 v[64:67], v[12:15], v[88:95], v8
  ds_read_b128 v[52:55], v1 offset:7168
  buffer_load_dwordx4 v0, s[4:7], s52 offen offset:3328 sc1 lds
  v_smfmac_f32_16x16x64_bf16 v[68:71], v[12:15], v[96:103], v8
  s_cbranch_vccnz RF1_c678
RF1_g678:
  v_smfmac_f32_16x16x64_bf16 v[24:27], v[16:19], a[96:103], v8
  s_waitcnt vmcnt(2)
  s_waitcnt lgkmcnt(2)
  s_barrier
  ds_read_b128 v[12:15], v0 offset:1280
  v_smfmac_f32_16x16x64_bf16 v[24:27], v[20:23], v[40:47], v8
  buffer_load_dword v11, s[4:7], s23 offen sc1 lds
  v_smfmac_f32_16x16x64_bf16 v[28:31], v[16:19], a[104:111], v8
  s_waitcnt lgkmcnt(1)
  v_smfmac_f32_16x16x64_bf16 v[28:31], v[20:23], v[48:55], v8
  ds_read_b128 v[60:63], v0 offset:256
  v_smfmac_f32_16x16x64_bf16 v[24:27], v[4:7], a[112:119], v8
  ds_read_b128 v[44:47], v0 offset:4608
  v_smfmac_f32_16x16x64_bf16 v[28:31], v[4:7], a[120:127], v8
  ds_read_b128 v[56:59], v0 offset:5632
  v_smfmac_f32_16x16x64_bf16 v[32:35], v[16:19], a[144:151], v8
  v_add_f32 v24, v24, v26
  v_add_f32 v25, v25, v27
  v_smfmac_f32_16x16x64_bf16 v[32:35], v[20:23], a[160:167], v8
  v_add_f32 v28, v28, v30
  v_add_f32 v29, v29, v31
  v_smfmac_f32_16x16x64_bf16 v[32:35], v[4:7], a[176:183], v8
  v_cvt_pk_bf16_f32 v41, v24, v28
  v_cvt_pk_bf16_f32 v43, v25, v29
  v_smfmac_f32_16x16x64_bf16 v[36:39], v[16:19], a[152:159], v8
  ds_write2_b32 v3, v41, v43 offset0:0 offset1:4
  v_smfmac_f32_16x16x64_bf16 v[36:39], v[20:23], a[168:175], v8
  ds_read_b128 v[24:27], v2 offset:19584
  v_add_f32 v32, v32, v34
  v_smfmac_f32_16x16x64_bf16 v[36:39], v[4:7], a[184:191], v8
  v_add_f32 v33, v33, v35
  v_smfmac_f32_16x16x64_bf16 v[64:67], v[16:19], v[104:111], v8
  v_smfmac_f32_16x16x64_bf16 v[68:71], v[16:19], v[112:119], v8
  s_waitcnt lgkmcnt(1)
  s_barrier
  v_add_f32 v36, v36, v38
  v_smfmac_f32_16x16x64_bf16 v[64:67], v[20:23], v[120:127], v8
  ds_read_b128 v[28:31], v2 offset:18432
  v_add_f32 v37, v37, v39
  v_smfmac_f32_16x16x64_bf16 v[68:71], v[20:23], v[128:135], v8
  ds_read_b128 v[16:19], v0 offset:13312
  v_cvt_pk_bf16_f32 v40, v32, v36
  v_smfmac_f32_16x16x64_bf16 v[64:67], v[4:7], v[136:143], v8
  ds_read_b128 v[20:23], v0 offset:14336
  v_cvt_pk_bf16_f32 v42, v33, v37
  v_smfmac_f32_16x16x64_bf16 v[68:71], v[4:7], v[144:151], v8
  ds_read_b128 v[48:51], v2 offset:21888
  ds_read_b128 v[4:7], v0 offset:8960
  ds_write2_b32 v3, v40, v42 offset0:144 offset1:148
  s_waitcnt lgkmcnt(6)
  v_mfma_f32_16x16x32_bf16 v[32:35], v[44:47], v[24:27], 0
  ds_read_b128 v[44:47], v0 offset:9984
  v_add_f32 v64, v64, v66
  v_mfma_f32_16x16x32_bf16 v[36:39], v[56:59], v[24:27], 0
  ds_read_b128 v[52:55], v2 offset:20736
  s_waitcnt lgkmcnt(7)
  v_add_f32 v65, v65, v67
  v_mfma_f32_16x16x32_bf16 v[32:35], v[60:63], v[28:31], v[32:35]
  v_cvt_pk_bf16_f32 v41, v64, v65
  v_mfma_f32_16x16x32_bf16 v[36:39], v[12:15], v[28:31], v[36:39]
  ds_read_b128 v[64:67], v2 offset:20160
  s_waitcnt lgkmcnt(5)
  v_add_f32 v68, v68, v70
  v_mfma_f32_16x16x32_bf16 v[32:35], v[16:19], v[48:51], v[32:35]
  s_waitcnt lgkmcnt(2)
  s_barrier
  ds_read_b128 v[12:15], v2 offset:19008
  v_add_f32 v69, v69, v71
  v_mfma_f32_16x16x32_bf16 v[36:39], v[20:23], v[48:51], v[36:39]
  ds_read_b128 v[16:19], v2 offset:22464
  s_waitcnt lgkmcnt(3)
  v_cvt_pk_bf16_f32 v43, v68, v69
  v_mfma_f32_16x16x32_bf16 v[32:35], v[4:7], v[52:55], v[32:35]
  s_waitcnt vmcnt(2)
  ds_read_b128 v[56:59], v0 offset:6656
  ds_read_b128 v[68:71], v2 offset:21312
  v_mfma_f32_16x16x32_bf16 v[36:39], v[44:47], v[52:55], v[36:39]
  s_waitcnt vmcnt(1)
  ds_read_b128 v[60:63], v0 offset:7680
  s_waitcnt lgkmcnt(5)
  v_mfma_f32_16x16x32_bf16 v[44:47], v[64:67], v[24:27], 0
  s_waitcnt lgkmcnt(4)
  v_cmp_u_f32 vcc, v32, v32
  v_max3_f32 v9, v32, v33, v34
  v_mfma_f32_16x16x32_bf16 v[44:47], v[12:15], v[28:31], v[44:47]
  s_waitcnt lgkmcnt(3)
  v_max3_f32 v9, v9, v35, v36
  v_max3_f32 v9, v9, v37, v38
  v_mfma_f32_16x16x32_bf16 v[44:47], v[16:19], v[48:51], v[44:47]
  s_cbranch_vccnz RF1_fn
RF1_gn:
  s_waitcnt lgkmcnt(1)
  v_mfma_f32_16x16x32_bf16 v[44:47], v[68:71], v[52:55], v[44:47]
  buffer_store_dwordx4 v[40:43], v0, s[4:7], s53 offen offset:1024 sc1
  ds_read_b128 v[4:7], v0 offset:23552
  ds_read_b128 v[24:27], v1 offset:8192
  v_mov_b64 v[12:13], s[62:63]
  v_mov_b64 v[14:15], s[62:63]
  v_max_f32 v9, v9, v39
  s_nop 1
  v_max3_f32 v46, v9, v44, v45
  v_max3_f32 v9, v9, v44, v45
  s_add_u32 s53, s53, 131072
  s_add_u32 s47, s47, 16384
  v_permlane32_swap_b32 v9, v46
  v_max_f32 v47, v9, v46
  v_max_f32 v9, v9, v46
  s_add_u32 s22, s47, s48
  s_nop 0
  v_permlane16_swap_b32 v9, v47
  v_max_f32 v9, v9, v47
  v_mul_f32 v46, s58, v9
  v_pk_fma_f32 v[44:45], v[44:45], s[58:59], v[46:47] op_sel_hi:[1,0,0] neg_lo:[0,0,1] neg_hi:[0,0,1]
  v_pk_fma_f32 v[32:33], v[32:33], s[58:59], v[46:47] op_sel_hi:[1,0,0] neg_lo:[0,0,1] neg_hi:[0,0,1]
  v_pk_fma_f32 v[34:35], v[34:35], s[58:59], v[46:47] op_sel_hi:[1,0,0] neg_lo:[0,0,1] neg_hi:[0,0,1]
  v_pk_fma_f32 v[36:37], v[36:37], s[58:59], v[46:47] op_sel_hi:[1,0,0] neg_lo:[0,0,1] neg_hi:[0,0,1]
  v_pk_fma_f32 v[38:39], v[38:39], s[58:59], v[46:47] op_sel_hi:[1,0,0] neg_lo:[0,0,1] neg_hi:[0,0,1]
  v_exp_f32 v44, v44
  v_exp_f32 v45, v45
  v_exp_f32 v32, v32
  v_cvt_pk_bf16_f32 v11, v44, v45
  v_exp_f32 v33, v33
  v_exp_f32 v34, v34
  v_mfma_f32_16x16x16_bf16 v[16:19], v[40:41], v[10:11], 0
  v_cvt_pk_bf16_f32 v64, v32, v33
  v_exp_f32 v35, v35
  v_mfma_f32_16x16x16_bf16 v[68:71], v[42:43], v[10:11], 0
  v_exp_f32 v36, v36
  v_cvt_pk_bf16_f32 v65, v34, v35
  v_exp_f32 v37, v37
  v_mfma_f32_16x16x16_bf16 v[20:23], v[10:11], v[12:13], 0
  ds_read_b128 v[28:31], v1 offset:9216
  v_exp_f32 v38, v38
  v_exp_f32 v39, v39
  v_cvt_pk_bf16_f32 v66, v36, v37
  v_cvt_pk_bf16_f32 v67, v38, v39
  v_mov_b64 v[32:33], 0
  v_mov_b64 v[34:35], 0
  v_mfma_f32_16x16x32_bf16 v[16:19], v[56:59], v[64:67], v[16:19]
  v_mov_b64 v[36:37], 0
  v_mov_b64 v[38:39], 0
  s_waitcnt lgkmcnt(3)
  v_mfma_f32_16x16x32_bf16 v[68:71], v[60:63], v[64:67], v[68:71]
  v_mov_b64 v[56:57], 0
  v_mov_b64 v[58:59], 0
  v_mfma_f32_16x16x32_bf16 v[20:23], v[64:67], v[12:15], v[20:23]
  v_cvt_pk_bf16_f32 v64, v16, v17
  v_cvt_pk_bf16_f32 v65, v18, v19
  v_mov_b64 v[60:61], 0
  v_mov_b64 v[62:63], 0
  v_cvt_pk_bf16_f32 v66, v68, v69
  v_cvt_pk_bf16_f32 v67, v70, v71
  ds_write_b128 v2, v[64:67] offset:19584
  s_add_u32 s52, s52, 524288
  v_mfma_f32_16x16x32_bf16 v[44:47], v[64:67], v[240:243], 0
  ds_read_b128 v[48:51], v1 offset:10240
  s_waitcnt lgkmcnt(2)
  v_smfmac_f32_16x16x64_bf16 v[32:35], v[64:67], v[24:31], v8 abid:1
  ds_read_b128 v[52:55], v1 offset:11264
  s_cmp_eq_u32 s46, 63
  v_smfmac_f32_16x16x64_bf16 v[56:59], v[64:67], v[152:159], v8 abid:1
  s_cbranch_scc1 K_end
  s_waitcnt lgkmcnt(2)
  s_barrier
  v_smfmac_f32_16x16x64_bf16 v[60:63], v[64:67], v[184:191], v8 abid:1
  ds_read_b128 v[12:15], v2 offset:18432
  ds_read_b128 v[16:19], v2 offset:21888
  ds_read_b128 v[68:71], v2 offset:20736
  s_waitcnt lgkmcnt(3)
  v_smfmac_f32_16x16x64_bf16 v[36:39], v[64:67], v[48:55], v8 abid:1
  ds_read_b128 v[24:27], v1 offset:12288
  ds_read_b128 v[28:31], v1 offset:13312
  v_rcp_f32 v20, v20
  v_rcp_f32 v21, v21
  s_waitcnt lgkmcnt(4)
  v_smfmac_f32_16x16x64_bf16 v[56:59], v[12:15], v[160:167], v8 abid:1
  ds_read_b128 v[48:51], v1 offset:14336
  s_waitcnt lgkmcnt(4)
  v_smfmac_f32_16x16x64_bf16 v[56:59], v[16:19], v[168:175], v8 abid:1
  ds_read_b128 v[52:55], v1 offset:15360
  s_waitcnt lgkmcnt(4)
  v_smfmac_f32_16x16x64_bf16 v[56:59], v[68:71], v[176:183], v8 abid:1
  ds_read_b128 v[64:67], v4 offset:23040
  v_smfmac_f32_16x16x64_bf16 v[60:63], v[12:15], v[192:199], v8 abid:1
  s_add_u32 s46, s46, 1
  s_add_u32 s56, s47, s49
  v_smfmac_f32_16x16x64_bf16 v[60:63], v[16:19], v[200:207], v8 abid:1
  v_mul_f32 v56, v56, v20
  v_mul_f32 v58, v58, v20
  v_mul_f32 v57, v57, v21
  v_mul_f32 v59, v59, v21
  v_cvt_pk_bf16_f32 v56, v56, v58
  v_cvt_pk_bf16_f32 v57, v57, v59
  v_bfi_b32 v56, 1, s46, v56
  v_bfi_b32 v57, 1, s46, v57
  buffer_store_dwordx2 v[56:57], v5, s[4:7], s68 offen sc1
  v_smfmac_f32_16x16x64_bf16 v[60:63], v[68:71], v[208:215], v8 abid:1
  s_waitcnt lgkmcnt(3)
  v_smfmac_f32_16x16x64_bf16 v[32:35], v[12:15], v[24:31], v8 abid:1
  ds_read_b128 v[24:27], v1 offset:32768
  v_smfmac_f32_16x16x64_bf16 v[32:35], v[16:19], v[216:223], v8 abid:1
  ds_read_b128 v[28:31], v1 offset:33792
  v_mul_f32 v60, v60, v20
  v_mul_f32 v62, v62, v20
  v_mul_f32 v61, v61, v21
  v_mul_f32 v63, v63, v21
  v_cvt_pk_bf16_f32 v60, v60, v62
  v_cvt_pk_bf16_f32 v61, v61, v63
  v_bfi_b32 v60, 1, s46, v60
  v_bfi_b32 v61, 1, s46, v61
  s_waitcnt lgkmcnt(3)
  v_smfmac_f32_16x16x64_bf16 v[32:35], v[68:71], v[48:55], v8 abid:1
  buffer_store_dwordx2 v[60:61], v5, s[4:7], s69 offen sc1
  v_smfmac_f32_16x16x64_bf16 v[36:39], v[12:15], v[224:231], v8 abid:1
  v_smfmac_f32_16x16x64_bf16 v[36:39], v[16:19], v[232:239], v8 abid:1
  v_mul_f32 v32, v32, v20
  v_mul_f32 v34, v34, v20
  v_mul_f32 v33, v33, v21
  v_mul_f32 v35, v35, v21
  v_cvt_pk_bf16_f32 v32, v32, v34
  v_cvt_pk_bf16_f32 v33, v33, v35
  v_bfi_b32 v32, 1, s46, v32
  v_bfi_b32 v33, 1, s46, v33
  s_waitcnt lgkmcnt(0)
  v_smfmac_f32_16x16x64_bf16 v[36:39], v[68:71], v[24:31], v8 abid:1
  buffer_store_dwordx2 v[32:33], v5, s[4:7], s70 offen sc1
  v_mfma_f32_16x16x32_bf16 v[44:47], v[12:15], v[244:247], v[44:47]
  v_mfma_f32_16x16x32_bf16 v[44:47], v[16:19], v[248:251], v[44:47]
  v_mul_f32 v36, v36, v20
  v_mul_f32 v38, v38, v20
  v_mfma_f32_16x16x32_bf16 v[44:47], v[68:71], v[252:255], v[44:47]
  v_mul_f32 v37, v37, v21
  v_mul_f32 v39, v39, v21
  v_cvt_pk_bf16_f32 v36, v36, v38
  v_cvt_pk_bf16_f32 v37, v37, v39
  v_bfi_b32 v36, 1, s46, v36
  v_bfi_b32 v37, 1, s46, v37
  buffer_store_dwordx2 v[36:37], v5, s[4:7], s71 offen sc1
  s_nop 0
  v_mul_f32 v44, v44, v20
  v_mul_f32 v45, v45, v21
  v_cvt_pk_bf16_f32 v44, v44, v45
  v_bfi_b32 v44, 1, s46, v44
  buffer_store_dword v44, v7, s[4:7], s72 offen sc1
  s_barrier
  buffer_load_dwordx4 v[56:59], v0, s[4:7], s51 offen offset:0 sc1
  buffer_load_dwordx4 v[60:63], v0, s[4:7], s51 offen offset:1024 sc1
  v_mov_b64 v[24:25], 0
  v_mov_b64 v[26:27], 0
  v_mov_b64 v[28:29], 0
  v_mov_b64 v[30:31], 0
  v_mov_b64 v[32:33], 0
  v_mov_b64 v[34:35], 0
  v_mov_b64 v[36:37], 0
  v_mov_b64 v[38:39], 0
  s_add_u32 s16, s47, 4096
  s_add_u32 s17, s47, 8192
  s_add_u32 s23, s23, 16384
  s_barrier
  buffer_load_dwordx4 v[12:15], v0, s[4:7], s47 offen offset:0 sc1
  s_waitcnt vmcnt(2)
  buffer_load_dwordx4 v[16:19], v0, s[4:7], s47 offen offset:1024 sc1
  v_bitop3_b32 v9, v56, v57, s46 bitop3:0x7e
  v_bitop3_b32 v11, v58, v59, s46 bitop3:0x7e
  v_mfma_f32_16x16x32_bf16 v[40:43], v[64:67], v[56:59], 0
  s_waitcnt vmcnt(2)
  v_bitop3_b32 v44, v60, v61, s46 bitop3:0x7e
  v_bitop3_b32 v45, v62, v63, s46 bitop3:0x7e
  v_mfma_f32_16x16x32_bf16 v[40:43], v[64:67], v[60:63], v[40:43]
  v_or3_b32 v9, v9, v11, v44
  v_bitop3_b32 v9, v9, v45, 1 bitop3:0xa8
  v_cmp_ne_u32 vcc, 0, v9
  s_nop 4
  v_add_f32_dpp v40, v40, v40 row_ror:8 row_mask:0xf bank_mask:0xf
  v_add_f32_dpp v41, v41, v41 row_ror:8 row_mask:0xf bank_mask:0xf
  s_cbranch_vccnz RF1_frq
RF1_rq:
  v_add_f32_dpp v46, v40, v40 row_ror:4 row_mask:0xf bank_mask:0x1
  v_add_f32_dpp v47, v41, v41 row_ror:4 row_mask:0xf bank_mask:0x1
  v_cvt_pk_bf16_f32 v9, v46, v47
  buffer_load_dwordx4 v[20:23], v0, s[4:7], s47 offen offset:2048 sc1
  buffer_load_dwordx4 v[56:59], v0, s[4:7], s47 offen offset:3072 sc1
  buffer_store_dword v9, v6, s[4:7], s56 offen sc1
  v_mov_b64 v[64:65], 0
  v_mov_b64 v[66:67], 0
  v_mov_b64 v[68:69], 0
  v_mov_b64 v[70:71], 0
  s_branch RF1_go
RF1_in:
  s_cmp_gt_u32 s60, 1
  s_cselect_b32 s55, s64, 0
  s_cmp_gt_u32 s55, 0
  s_cbranch_scc1 RF1_in1
  s_xor_b32 s55, s59, 64
RF1_in0:
  s_load_dword s60, s[42:43], s59 glc
  s_load_dword s64, s[42:43], s55 glc
  s_sub_u32 s54, s54, 1
  s_cbranch_scc1 K_end
  s_waitcnt lgkmcnt(0)
  s_cmp_gt_u32 s60, 1
  s_cbranch_scc0 RF1_in0
RF1_in1:
  s_add_u32 s16, s47, 4096
  s_add_u32 s17, s47, 8192
  buffer_load_dwordx4 v[12:15], v0, s[4:7], s47 offen offset:0 sc1
  buffer_load_dwordx4 v[16:19], v0, s[4:7], s47 offen offset:1024 sc1
  buffer_load_dwordx4 v[20:23], v0, s[4:7], s47 offen offset:2048 sc1
  buffer_load_dwordx4 v[56:59], v0, s[4:7], s47 offen offset:3072 sc1
  v_lshlrev_b32 v11, 3, v0
  s_bitcmp1_b32 s45, 0
  s_cselect_b32 s56, -1, 1
  s_mul_i32 s56, s56, 2176
  s_add_u32 s55, s52, -3840
  s_xor_b32 s55, s55, 16384
  s_cmp_gt_u32 s64, 0
  s_cselect_b32 s55, s55, 1073741824
  buffer_load_dword v11, s[4:7], s55 offen sc1 lds
  s_add_u32 s56, s51, s56
  s_mov_b64 exec, 0x3ffff
  buffer_load_dword v11, s[4:7], s56 offen sc1 lds
  s_mov_b64 exec, -1
  v_mov_b64 v[24:25], 0
  v_mov_b64 v[26:27], 0
  v_mov_b64 v[28:29], 0
  v_mov_b64 v[30:31], 0
  v_mov_b64 v[32:33], 0
  v_mov_b64 v[34:35], 0
  v_mov_b64 v[36:37], 0
  v_mov_b64 v[38:39], 0
  v_mov_b64 v[64:65], 0
  v_mov_b64 v[66:67], 0
  v_mov_b64 v[68:69], 0
  v_mov_b64 v[70:71], 0
  s_waitcnt vmcnt(2)
  s_barrier
  s_branch RF1_go2
RF1_in2:
  buffer_load_dwordx4 v[12:15], v0, s[4:7], s47 offen offset:0 sc1
  buffer_load_dwordx4 v[16:19], v0, s[4:7], s47 offen offset:1024 sc1
  buffer_load_dwordx4 v[20:23], v0, s[4:7], s47 offen offset:2048 sc1
  buffer_load_dwordx4 v[56:59], v0, s[4:7], s47 offen offset:3072 sc1
  v_mov_b64 v[24:25], 0
  v_mov_b64 v[26:27], 0
  v_mov_b64 v[28:29], 0
  v_mov_b64 v[30:31], 0
  v_mov_b64 v[32:33], 0
  v_mov_b64 v[34:35], 0
  v_mov_b64 v[36:37], 0
  v_mov_b64 v[38:39], 0
  v_mov_b64 v[64:65], 0
  v_mov_b64 v[66:67], 0
  v_mov_b64 v[68:69], 0
  v_mov_b64 v[70:71], 0
  s_waitcnt vmcnt(0)
  s_barrier
  s_branch RF1_go2
RF1_f0:
  buffer_load_dwordx4 v[12:15], v0, s[4:7], s47 offen offset:0 sc1
  s_sub_u32 s54, s54, 1
  s_cbranch_scc1 K_end
  s_nop 3
  v_mov_b64 v[24:25], 0
  v_mov_b64 v[26:27], 0
  v_mov_b64 v[28:29], 0
  v_mov_b64 v[30:31], 0
  buffer_load_dwordx4 v[16:19], v0, s[4:7], s47 offen offset:1024 sc1
  buffer_load_dwordx4 v[20:23], v0, s[4:7], s47 offen offset:2048 sc1
  buffer_load_dwordx4 v[56:59], v0, s[4:7], s47 offen offset:3072 sc1
  buffer_load_dword v10, s[4:7], s47 offen lds
  s_waitcnt vmcnt(4) lgkmcnt(0)
  s_branch RF1_go2
RF1_c1:
  buffer_load_dwordx4 v[16:19], v0, s[4:7], s47 offen offset:1024 sc1
  s_sub_u32 s54, s54, 1
  s_cbranch_scc1 K_end
  buffer_load_dwordx4 v[20:23], v0, s[4:7], s47 offen offset:2048 sc1
  buffer_load_dwordx4 v[56:59], v0, s[4:7], s47 offen offset:3072 sc1
  buffer_load_dword v10, s[4:7], s47 offen lds
  s_waitcnt vmcnt(3)
  v_max3_u32 v9, v19, v19, v19
  v_cmp_eq_u32 vcc, -1, v9
  s_cbranch_vccnz RF1_c1
  s_branch RF1_g1
RF1_c2:
  buffer_load_dwordx4 v[20:23], v0, s[4:7], s47 offen offset:2048 sc1
  s_sub_u32 s54, s54, 1
  s_cbranch_scc1 K_end
  buffer_load_dwordx4 v[56:59], v0, s[4:7], s47 offen offset:3072 sc1
  buffer_load_dword v10, s[4:7], s47 offen lds
  buffer_load_dwordx4 v[60:63], v0, s[4:7], s16 offen offset:0 sc1
  buffer_load_dwordx4 v[12:15], v0, s[4:7], s16 offen offset:1024 sc1
  s_waitcnt vmcnt(4)
  v_max3_u32 v9, v23, v23, v23
  v_cmp_eq_u32 vcc, -1, v9
  s_cbranch_vccnz RF1_c2
  s_branch RF1_g2
RF1_c3:
  buffer_load_dwordx4 v[56:59], v0, s[4:7], s47 offen offset:3072 sc1
  s_sub_u32 s54, s54, 1
  s_cbranch_scc1 K_end
  buffer_load_dword v10, s[4:7], s47 offen lds
  buffer_load_dwordx4 v[60:63], v0, s[4:7], s16 offen offset:0 sc1
  buffer_load_dwordx4 v[12:15], v0, s[4:7], s16 offen offset:1024 sc1
  buffer_load_dword v10, s[4:7], s47 offen lds
  buffer_load_dwordx4 v[16:19], v0, s[4:7], s16 offen offset:2048 sc1
  buffer_load_dwordx4 v[4:7], v0, s[4:7], s17 offen offset:0 sc1
  s_waitcnt vmcnt(6)
  v_max3_u32 v9, v59, v59, v59
  v_cmp_eq_u32 vcc, -1, v9
  s_cbranch_vccnz RF1_c3
  s_branch RF1_g3
RF1_c45:
  buffer_load_dwordx4 v[60:63], v0, s[4:7], s16 offen offset:0 sc1
  buffer_load_dwordx4 v[12:15], v0, s[4:7], s16 offen offset:1024 sc1
  s_sub_u32 s54, s54, 1
  s_cbranch_scc1 K_end
  buffer_load_dword v10, s[4:7], s47 offen lds
  buffer_load_dwordx4 v[16:19], v0, s[4:7], s16 offen offset:2048 sc1
  buffer_load_dwordx4 v[4:7], v0, s[4:7], s17 offen offset:0 sc1
  buffer_load_dwordx4 v[20:23], v0, s[4:7], s16 offen offset:3072 sc1
  buffer_load_dword v10, s[4:7], s47 offen lds
  s_waitcnt vmcnt(5)
  v_max3_u32 v9, v63, v15, v63
  v_cmp_eq_u32 vcc, -1, v9
  s_cbranch_vccnz RF1_c45
  s_branch RF1_g45
RF1_c678:
  buffer_load_dwordx4 v[16:19], v0, s[4:7], s16 offen offset:2048 sc1
  buffer_load_dwordx4 v[4:7], v0, s[4:7], s17 offen offset:0 sc1
  buffer_load_dwordx4 v[20:23], v0, s[4:7], s16 offen offset:3072 sc1
  s_sub_u32 s54, s54, 1
  s_cbranch_scc1 K_end
  buffer_load_dword v10, s[4:7], s47 offen lds
  buffer_load_dword v10, s[4:7], s47 offen lds
  buffer_load_dword v10, s[4:7], s47 offen lds
  s_waitcnt vmcnt(3)
  v_max3_u32 v9, v19, v23, v7
  v_cmp_eq_u32 vcc, -1, v9
  s_cbranch_vccnz RF1_c678
  s_branch RF1_g678
RF1_fn:
  s_cmp_eq_u32 s20, s46
  s_cbranch_scc1 RF1_gn
  s_mov_b32 s20, s46
  s_waitcnt vmcnt(0) lgkmcnt(0)
  s_nop 7
RF1_fl:
  buffer_load_dwordx4 v[12:15], v0, s[4:7], s47 offen offset:0 sc1
  buffer_load_dwordx4 v[16:19], v0, s[4:7], s47 offen offset:1024 sc1
  buffer_load_dwordx4 v[20:23], v0, s[4:7], s47 offen offset:2048 sc1
  buffer_load_dwordx4 v[24:27], v0, s[4:7], s47 offen offset:3072 sc1
  buffer_load_dwordx4 v[28:31], v0, s[4:7], s16 offen offset:0 sc1
  buffer_load_dwordx4 v[32:35], v0, s[4:7], s16 offen offset:1024 sc1
  buffer_load_dwordx4 v[36:39], v0, s[4:7], s16 offen offset:2048 sc1
  buffer_load_dwordx4 v[40:43], v0, s[4:7], s16 offen offset:3072 sc1
  buffer_load_dwordx4 v[44:47], v0, s[4:7], s17 offen offset:0 sc1
  s_sub_u32 s54, s54, 1
  s_cbranch_scc1 K_end
  s_waitcnt vmcnt(8)
  v_max_u32 v9, v12, v13
  v_max3_u32 v9, v9, v14, v15
  s_waitcnt vmcnt(7)
  v_max3_u32 v9, v9, v16, v17
  v_max3_u32 v9, v9, v18, v19
  s_waitcnt vmcnt(6)
  v_max3_u32 v9, v9, v20, v21
  v_max3_u32 v9, v9, v22, v23
  s_waitcnt vmcnt(5)
  v_max3_u32 v9, v9, v24, v25
  v_max3_u32 v9, v9, v26, v27
  s_waitcnt vmcnt(4)
  v_max3_u32 v9, v9, v28, v29
  v_max3_u32 v9, v9, v30, v31
  s_waitcnt vmcnt(3)
  v_max3_u32 v9, v9, v32, v33
  v_max3_u32 v9, v9, v34, v35
  s_waitcnt vmcnt(2)
  v_max3_u32 v9, v9, v36, v37
  v_max3_u32 v9, v9, v38, v39
  s_waitcnt vmcnt(1)
  v_max3_u32 v9, v9, v40, v41
  v_max3_u32 v9, v9, v42, v43
  s_waitcnt vmcnt(0)
  v_max3_u32 v9, v9, v44, v45
  v_max3_u32 v9, v9, v46, v47
  v_cmp_eq_u32 vcc, -1, v9
  s_cbranch_vccnz RF1_fl
  s_barrier
  buffer_inv sc1
  s_waitcnt vmcnt(0)
  s_barrier
  s_branch RF1_in2
RF1_frq:
RF1_lrq:
  buffer_load_dwordx4 v[56:59], v0, s[4:7], s51 offen offset:0 sc1
  buffer_load_dwordx4 v[60:63], v0, s[4:7], s51 offen offset:1024 sc1
  s_sub_u32 s54, s54, 1
  s_cbranch_scc1 K_end
  s_waitcnt vmcnt(0)
  v_bitop3_b32 v9, v56, v57, s46 bitop3:0x7e
  v_bitop3_b32 v11, v58, v59, s46 bitop3:0x7e
  v_mfma_f32_16x16x32_bf16 v[40:43], v[64:67], v[56:59], 0
  v_bitop3_b32 v44, v60, v61, s46 bitop3:0x7e
  v_bitop3_b32 v45, v62, v63, s46 bitop3:0x7e
  v_mfma_f32_16x16x32_bf16 v[40:43], v[64:67], v[60:63], v[40:43]
  v_or3_b32 v9, v9, v11, v44
  v_bitop3_b32 v9, v9, v45, 1 bitop3:0xa8
  v_cmp_ne_u32 vcc, 0, v9
  s_nop 4
  v_add_f32_dpp v40, v40, v40 row_ror:8 row_mask:0xf bank_mask:0xf
  v_add_f32_dpp v41, v41, v41 row_ror:8 row_mask:0xf bank_mask:0xf
  s_cbranch_vccz RF1_rq
  s_branch RF1_lrq
RF2_go:
  s_waitcnt vmcnt(4)
RF2_go2:
  v_cmp_eq_u32 vcc, -1, v15
  v_smfmac_f32_16x16x64_bf16 v[24:27], v[12:15], a[0:7], v8
  ds_read_b128 v[40:43], v1 offset:16384
  v_smfmac_f32_16x16x64_bf16 v[28:31], v[12:15], a[8:15], v8
  s_cbranch_vccnz RF2_f0
  v_smfmac_f32_16x16x64_bf16 v[32:35], v[12:15], a[128:135], v8
  ds_read_b128 v[44:47], v1 offset:17408
  v_smfmac_f32_16x16x64_bf16 v[36:39], v[12:15], a[136:143], v8
  ds_read_b128 v[48:51], v1 offset:18432
  s_waitcnt vmcnt(3)
  v_cmp_eq_u32 vcc, -1, v19
  v_smfmac_f32_16x16x64_bf16 v[64:67], v[12:15], a[192:199], v8
  ds_read_b128 v[52:55], v1 offset:19456
  v_smfmac_f32_16x16x64_bf16 v[68:71], v[12:15], a[200:207], v8
  s_cbranch_vccnz RF2_c1
RF2_g1:
  v_smfmac_f32_16x16x64_bf16 v[24:27], v[16:19], a[16:23], v8
  buffer_load_dwordx4 v[60:63], v0, s[4:7], s16 offen offset:0 sc1
  s_waitcnt lgkmcnt(2)
  v_smfmac_f32_16x16x64_bf16 v[32:35], v[16:19], v[40:47], v8
  ds_read_b128 v[40:43], v1 offset:20480
  buffer_load_dwordx4 v[12:15], v0, s[4:7], s16 offen offset:1024 sc1
  v_smfmac_f32_16x16x64_bf16 v[28:31], v[16:19], a[24:31], v8
  ds_read_b128 v[44:47], v1 offset:21504
  s_waitcnt lgkmcnt(2)
  v_smfmac_f32_16x16x64_bf16 v[36:39], v[16:19], v[48:55], v8
  ds_read_b128 v[48:51], v1 offset:22528
  s_waitcnt vmcnt(4)
  v_cmp_eq_u32 vcc, -1, v23
  v_smfmac_f32_16x16x64_bf16 v[64:67], v[16:19], a[208:215], v8
  ds_read_b128 v[52:55], v1 offset:23552
  v_smfmac_f32_16x16x64_bf16 v[68:71], v[16:19], a[216:223], v8
  s_cbranch_vccnz RF2_c2
RF2_g2:
  v_smfmac_f32_16x16x64_bf16 v[24:27], v[20:23], a[32:39], v8
  buffer_load_dwordx4 v0, s[4:7], s52 offen offset:256 sc1 lds
  s_waitcnt lgkmcnt(2)
  v_smfmac_f32_16x16x64_bf16 v[32:35], v[20:23], v[40:47], v8
  ds_read_b128 v[40:43], v1 offset:24576
  v_smfmac_f32_16x16x64_bf16 v[28:31], v[20:23], a[40:47], v8
  ds_read_b128 v[44:47], v1 offset:25600
  buffer_load_dwordx4 v[16:19], v0, s[4:7], s16 offen offset:2048 sc1
  s_waitcnt lgkmcnt(2)
  v_smfmac_f32_16x16x64_bf16 v[36:39], v[20:23], v[48:55], v8
  ds_read_b128 v[48:51], v1 offset:26624
  s_waitcnt vmcnt(5)
  v_cmp_eq_u32 vcc, -1, v59
  v_smfmac_f32_16x16x64_bf16 v[64:67], v[20:23], a[224:231], v8
  ds_read_b128 v[52:55], v1 offset:27648
  buffer_load_dwordx4 v[4:7], v0, s[4:7], s17 offen offset:0 sc1
  v_smfmac_f32_16x16x64_bf16 v[68:71], v[20:23], a[232:239], v8
  s_cbranch_vccnz RF2_c3
RF2_g3:
  v_smfmac_f32_16x16x64_bf16 v[24:27], v[56:59], a[48:55], v8
  buffer_load_dwordx4 v[20:23], v0, s[4:7], s16 offen offset:3072 sc1
  s_waitcnt lgkmcnt(2)
  v_smfmac_f32_16x16x64_bf16 v[32:35], v[56:59], v[40:47], v8
  ds_read_b128 v[40:43], v1 offset:28672
  buffer_load_dwordx4 v0, s[4:7], s52 offen offset:1280 sc1 lds
  v_smfmac_f32_16x16x64_bf16 v[28:31], v[56:59], a[56:63], v8
  ds_read_b128 v[44:47], v1 offset:29696
  s_waitcnt lgkmcnt(2)
  v_smfmac_f32_16x16x64_bf16 v[36:39], v[56:59], v[48:55], v8
  ds_read_b128 v[48:51], v1 offset:30720
  s_waitcnt vmcnt(5)
  v_cmp_u_f32 vcc, v63, v15
  v_smfmac_f32_16x16x64_bf16 v[64:67], v[56:59], a[240:247], v8
  ds_read_b128 v[52:55], v1 offset:31744
  v_smfmac_f32_16x16x64_bf16 v[68:71], v[56:59], a[248:255], v8
  s_cbranch_vccnz RF2_c45
RF2_g45:
  v_smfmac_f32_16x16x64_bf16 v[24:27], v[60:63], a[64:71], v8
  s_waitcnt lgkmcnt(2)
  v_smfmac_f32_16x16x64_bf16 v[32:35], v[60:63], v[40:47], v8
  ds_read_b128 v[40:43], v1 offset:0
  v_smfmac_f32_16x16x64_bf16 v[28:31], v[60:63], a[72:79], v8
  ds_read_b128 v[44:47], v1 offset:1024
  buffer_load_dwordx4 v0, s[4:7], s52 offen offset:2304 sc1 lds
  s_waitcnt lgkmcnt(2)
  v_smfmac_f32_16x16x64_bf16 v[36:39], v[60:63], v[48:55], v8
  ds_read_b128 v[48:51], v1 offset:2048
  v_smfmac_f32_16x16x64_bf16 v[64:67], v[60:63], v[72:79], v8
  ds_read_b128 v[52:55], v1 offset:3072
  v_smfmac_f32_16x16x64_bf16 v[68:71], v[60:63], v[80:87], v8
  v_lshl_add_u32 v11, v0, 3, s21
  v_smfmac_f32_16x16x64_bf16 v[24:27], v[12:15], a[80:87], v8
  s_waitcnt lgkmcnt(2)
  v_smfmac_f32_16x16x64_bf16 v[32:35], v[12:15], v[40:47], v8
  ds_read_b128 v[40:43], v1 offset:4096
  v_smfmac_f32_16x16x64_bf16 v[28:31], v[12:15], a[88:95], v8
  ds_read_b128 v[44:47], v1 offset:5120
  s_waitcnt vmcnt(3) lgkmcnt(2)
  v_max_u32 v9, v19, v7
  v_smfmac_f32_16x16x64_bf16 v[36:39], v[12:15], v[48:55], v8
  ds_read_b128 v[48:51], v1 offset:6144
  s_waitcnt vmcnt(2)
  v_cmp_u_f32 vcc, v9, v23
  v_smfmac_f32_16x16x64_bf16 v[64:67], v[12:15], v[88:95], v8
  ds_read_b128 v[52:55], v1 offset:7168
  buffer_load_dwordx4 v0, s[4:7], s52 offen offset:3328 sc1 lds
  v_smfmac_f32_16x16x64_bf16 v[68:71], v[12:15], v[96:103], v8
  s_cbranch_vccnz RF2_c678
RF2_g678:
  v_smfmac_f32_16x16x64_bf16 v[24:27], v[16:19], a[96:103], v8
  s_waitcnt vmcnt(2)
  s_waitcnt lgkmcnt(2)
  s_barrier
  ds_read_b128 v[12:15], v0 offset:14336
  v_smfmac_f32_16x16x64_bf16 v[24:27], v[20:23], v[40:47], v8
  buffer_load_dword v11, s[4:7], s52 offen sc1 lds
  v_smfmac_f32_16x16x64_bf16 v[28:31], v[16:19], a[104:111], v8
  s_waitcnt lgkmcnt(1)
  v_smfmac_f32_16x16x64_bf16 v[28:31], v[20:23], v[48:55], v8
  ds_read_b128 v[60:63], v0 offset:13312
  v_smfmac_f32_16x16x64_bf16 v[24:27], v[4:7], a[112:119], v8
  ds_read_b128 v[44:47], v0 offset:8960
  v_smfmac_f32_16x16x64_bf16 v[28:31], v[4:7], a[120:127], v8
  ds_read_b128 v[56:59], v0 offset:9984
  v_smfmac_f32_16x16x64_bf16 v[32:35], v[16:19], a[144:151], v8
  v_add_f32 v24, v24, v26
  v_add_f32 v25, v25, v27
  v_smfmac_f32_16x16x64_bf16 v[32:35], v[20:23], a[160:167], v8
  v_add_f32 v28, v28, v30
  v_add_f32 v29, v29, v31
  v_smfmac_f32_16x16x64_bf16 v[32:35], v[4:7], a[176:183], v8
  v_cvt_pk_bf16_f32 v41, v24, v28
  v_cvt_pk_bf16_f32 v43, v25, v29
  v_smfmac_f32_16x16x64_bf16 v[36:39], v[16:19], a[152:159], v8
  ds_write2_b32 v3, v41, v43 offset0:0 offset1:4
  v_smfmac_f32_16x16x64_bf16 v[36:39], v[20:23], a[168:175], v8
  ds_read_b128 v[24:27], v2 offset:20736
  v_add_f32 v32, v32, v34
  v_smfmac_f32_16x16x64_bf16 v[36:39], v[4:7], a[184:191], v8
  v_add_f32 v33, v33, v35
  v_smfmac_f32_16x16x64_bf16 v[64:67], v[16:19], v[104:111], v8
  v_smfmac_f32_16x16x64_bf16 v[68:71], v[16:19], v[112:119], v8
  s_waitcnt lgkmcnt(1)
  s_barrier
  v_add_f32 v36, v36, v38
  v_smfmac_f32_16x16x64_bf16 v[64:67], v[20:23], v[120:127], v8
  ds_read_b128 v[28:31], v2 offset:21888
  v_add_f32 v37, v37, v39
  v_smfmac_f32_16x16x64_bf16 v[68:71], v[20:23], v[128:135], v8
  ds_read_b128 v[16:19], v0 offset:256
  v_cvt_pk_bf16_f32 v40, v32, v36
  v_smfmac_f32_16x16x64_bf16 v[64:67], v[4:7], v[136:143], v8
  ds_read_b128 v[20:23], v0 offset:1280
  v_cvt_pk_bf16_f32 v42, v33, v37
  v_smfmac_f32_16x16x64_bf16 v[68:71], v[4:7], v[144:151], v8
  ds_read_b128 v[48:51], v2 offset:18432
  ds_read_b128 v[4:7], v0 offset:4608
  ds_write2_b32 v3, v40, v42 offset0:144 offset1:148
  s_waitcnt lgkmcnt(6)
  v_mfma_f32_16x16x32_bf16 v[32:35], v[44:47], v[24:27], 0
  ds_read_b128 v[44:47], v0 offset:5632
  v_add_f32 v64, v64, v66
  v_mfma_f32_16x16x32_bf16 v[36:39], v[56:59], v[24:27], 0
  ds_read_b128 v[52:55], v2 offset:19584
  s_waitcnt lgkmcnt(7)
  v_add_f32 v65, v65, v67
  v_mfma_f32_16x16x32_bf16 v[32:35], v[60:63], v[28:31], v[32:35]
  v_cvt_pk_bf16_f32 v41, v64, v65
  v_mfma_f32_16x16x32_bf16 v[36:39], v[12:15], v[28:31], v[36:39]
  ds_read_b128 v[64:67], v2 offset:21312
  s_waitcnt lgkmcnt(5)
  v_add_f32 v68, v68, v70
  v_mfma_f32_16x16x32_bf16 v[32:35], v[16:19], v[48:51], v[32:35]
  s_waitcnt lgkmcnt(2)
  s_barrier
  ds_read_b128 v[12:15], v2 offset:22464
  v_add_f32 v69, v69, v71
  v_mfma_f32_16x16x32_bf16 v[36:39], v[20:23], v[48:51], v[36:39]
  ds_read_b128 v[16:19], v2 offset:19008
  s_waitcnt lgkmcnt(3)
  v_cvt_pk_bf16_f32 v43, v68, v69
  v_mfma_f32_16x16x32_bf16 v[32:35], v[4:7], v[52:55], v[32:35]
  s_waitcnt vmcnt(2)
  ds_read_b128 v[56:59], v0 offset:11008
  ds_read_b128 v[68:71], v2 offset:20160
  v_mfma_f32_16x16x32_bf16 v[36:39], v[44:47], v[52:55], v[36:39]
  s_waitcnt vmcnt(1)
  ds_read_b128 v[60:63], v0 offset:12032
  s_waitcnt lgkmcnt(5)
  v_mfma_f32_16x16x32_bf16 v[44:47], v[64:67], v[24:27], 0
  s_waitcnt lgkmcnt(4)
  v_cmp_u_f32 vcc, v32, v32
  v_max3_f32 v9, v32, v33, v34
  v_mfma_f32_16x16x32_bf16 v[44:47], v[12:15], v[28:31], v[44:47]
  s_waitcnt lgkmcnt(3)
  v_max3_f32 v9, v9, v35, v36
  v_max3_f32 v9, v9, v37, v38
  v_mfma_f32_16x16x32_bf16 v[44:47], v[16:19], v[48:51], v[44:47]
  s_cbranch_vccnz RF2_fn
RF2_gn:
  s_waitcnt lgkmcnt(1)
  v_mfma_f32_16x16x32_bf16 v[44:47], v[68:71], v[52:55], v[44:47]
  buffer_store_dwordx4 v[40:43], v0, s[4:7], s53 offen offset:2048 sc1
  ds_read_b128 v[4:7], v0 offset:23552
  ds_read_b128 v[24:27], v1 offset:8192
  v_mov_b64 v[12:13], s[62:63]
  v_mov_b64 v[14:15], s[62:63]
  v_max_f32 v9, v9, v39
  s_nop 1
  v_max3_f32 v46, v9, v44, v45
  v_max3_f32 v9, v9, v44, v45
  s_add_u32 s53, s53, 131072
  s_add_u32 s47, s47, 16384
  v_permlane32_swap_b32 v9, v46
  v_max_f32 v47, v9, v46
  v_max_f32 v9, v9, v46
  s_add_u32 s22, s47, s48
  s_nop 0
  v_permlane16_swap_b32 v9, v47
  v_max_f32 v9, v9, v47
  v_mul_f32 v46, s58, v9
  v_pk_fma_f32 v[44:45], v[44:45], s[58:59], v[46:47] op_sel_hi:[1,0,0] neg_lo:[0,0,1] neg_hi:[0,0,1]
  v_pk_fma_f32 v[32:33], v[32:33], s[58:59], v[46:47] op_sel_hi:[1,0,0] neg_lo:[0,0,1] neg_hi:[0,0,1]
  v_pk_fma_f32 v[34:35], v[34:35], s[58:59], v[46:47] op_sel_hi:[1,0,0] neg_lo:[0,0,1] neg_hi:[0,0,1]
  v_pk_fma_f32 v[36:37], v[36:37], s[58:59], v[46:47] op_sel_hi:[1,0,0] neg_lo:[0,0,1] neg_hi:[0,0,1]
  v_pk_fma_f32 v[38:39], v[38:39], s[58:59], v[46:47] op_sel_hi:[1,0,0] neg_lo:[0,0,1] neg_hi:[0,0,1]
  v_exp_f32 v44, v44
  v_exp_f32 v45, v45
  v_exp_f32 v32, v32
  v_cvt_pk_bf16_f32 v11, v44, v45
  v_exp_f32 v33, v33
  v_exp_f32 v34, v34
  v_mfma_f32_16x16x16_bf16 v[16:19], v[40:41], v[10:11], 0
  v_cvt_pk_bf16_f32 v64, v32, v33
  v_exp_f32 v35, v35
  v_mfma_f32_16x16x16_bf16 v[68:71], v[42:43], v[10:11], 0
  v_exp_f32 v36, v36
  v_cvt_pk_bf16_f32 v65, v34, v35
  v_exp_f32 v37, v37
  v_mfma_f32_16x16x16_bf16 v[20:23], v[10:11], v[12:13], 0
  ds_read_b128 v[28:31], v1 offset:9216
  v_exp_f32 v38, v38
  v_exp_f32 v39, v39
  v_cvt_pk_bf16_f32 v66, v36, v37
  v_cvt_pk_bf16_f32 v67, v38, v39
  v_mov_b64 v[32:33], 0
  v_mov_b64 v[34:35], 0
  v_mfma_f32_16x16x32_bf16 v[16:19], v[56:59], v[64:67], v[16:19]
  v_mov_b64 v[36:37], 0
  v_mov_b64 v[38:39], 0
  s_waitcnt lgkmcnt(3)
  v_mfma_f32_16x16x32_bf16 v[68:71], v[60:63], v[64:67], v[68:71]
  v_mov_b64 v[56:57], 0
  v_mov_b64 v[58:59], 0
  v_mfma_f32_16x16x32_bf16 v[20:23], v[64:67], v[12:15], v[20:23]
  v_cvt_pk_bf16_f32 v64, v16, v17
  v_cvt_pk_bf16_f32 v65, v18, v19
  v_mov_b64 v[60:61], 0
  v_mov_b64 v[62:63], 0
  v_cvt_pk_bf16_f32 v66, v68, v69
  v_cvt_pk_bf16_f32 v67, v70, v71
  ds_write_b128 v2, v[64:67] offset:20736
  s_add_u32 s52, s52, 524288
  v_mfma_f32_16x16x32_bf16 v[44:47], v[64:67], v[240:243], 0
  ds_read_b128 v[48:51], v1 offset:10240
  s_waitcnt lgkmcnt(2)
  v_smfmac_f32_16x16x64_bf16 v[32:35], v[64:67], v[24:31], v8 abid:1
  ds_read_b128 v[52:55], v1 offset:11264
  s_cmp_eq_u32 s46, 63
  v_smfmac_f32_16x16x64_bf16 v[56:59], v[64:67], v[152:159], v8 abid:1
  s_cbranch_scc1 K_end
  s_waitcnt lgkmcnt(2)
  s_barrier
  v_smfmac_f32_16x16x64_bf16 v[60:63], v[64:67], v[184:191], v8 abid:1
  ds_read_b128 v[12:15], v2 offset:21888
  ds_read_b128 v[16:19], v2 offset:18432
  ds_read_b128 v[68:71], v2 offset:19584
  s_waitcnt lgkmcnt(3)
  v_smfmac_f32_16x16x64_bf16 v[36:39], v[64:67], v[48:55], v8 abid:1
  ds_read_b128 v[24:27], v1 offset:12288
  ds_read_b128 v[28:31], v1 offset:13312
  v_rcp_f32 v20, v20
  v_rcp_f32 v21, v21
  s_waitcnt lgkmcnt(4)
  v_smfmac_f32_16x16x64_bf16 v[56:59], v[12:15], v[160:167], v8 abid:1
  ds_read_b128 v[48:51], v1 offset:14336
  s_waitcnt lgkmcnt(4)
  v_smfmac_f32_16x16x64_bf16 v[56:59], v[16:19], v[168:175], v8 abid:1
  ds_read_b128 v[52:55], v1 offset:15360
  s_waitcnt lgkmcnt(4)
  v_smfmac_f32_16x16x64_bf16 v[56:59], v[68:71], v[176:183], v8 abid:1
  ds_read_b128 v[64:67], v4 offset:23040
  v_smfmac_f32_16x16x64_bf16 v[60:63], v[12:15], v[192:199], v8 abid:1
  s_add_u32 s46, s46, 1
  s_add_u32 s56, s47, s49
  v_smfmac_f32_16x16x64_bf16 v[60:63], v[16:19], v[200:207], v8 abid:1
  v_mul_f32 v56, v56, v20
  v_mul_f32 v58, v58, v20
  v_mul_f32 v57, v57, v21
  v_mul_f32 v59, v59, v21
  v_cvt_pk_bf16_f32 v56, v56, v58
  v_cvt_pk_bf16_f32 v57, v57, v59
  v_bfi_b32 v56, 1, s46, v56
  v_bfi_b32 v57, 1, s46, v57
  buffer_store_dwordx2 v[56:57], v5, s[4:7], s68 offen sc1
  v_smfmac_f32_16x16x64_bf16 v[60:63], v[68:71], v[208:215], v8 abid:1
  s_waitcnt lgkmcnt(3)
  v_smfmac_f32_16x16x64_bf16 v[32:35], v[12:15], v[24:31], v8 abid:1
  ds_read_b128 v[24:27], v1 offset:32768
  v_smfmac_f32_16x16x64_bf16 v[32:35], v[16:19], v[216:223], v8 abid:1
  ds_read_b128 v[28:31], v1 offset:33792
  v_mul_f32 v60, v60, v20
  v_mul_f32 v62, v62, v20
  v_mul_f32 v61, v61, v21
  v_mul_f32 v63, v63, v21
  v_cvt_pk_bf16_f32 v60, v60, v62
  v_cvt_pk_bf16_f32 v61, v61, v63
  v_bfi_b32 v60, 1, s46, v60
  v_bfi_b32 v61, 1, s46, v61
  s_waitcnt lgkmcnt(3)
  v_smfmac_f32_16x16x64_bf16 v[32:35], v[68:71], v[48:55], v8 abid:1
  buffer_store_dwordx2 v[60:61], v5, s[4:7], s69 offen sc1
  v_smfmac_f32_16x16x64_bf16 v[36:39], v[12:15], v[224:231], v8 abid:1
  v_smfmac_f32_16x16x64_bf16 v[36:39], v[16:19], v[232:239], v8 abid:1
  v_mul_f32 v32, v32, v20
  v_mul_f32 v34, v34, v20
  v_mul_f32 v33, v33, v21
  v_mul_f32 v35, v35, v21
  v_cvt_pk_bf16_f32 v32, v32, v34
  v_cvt_pk_bf16_f32 v33, v33, v35
  v_bfi_b32 v32, 1, s46, v32
  v_bfi_b32 v33, 1, s46, v33
  s_waitcnt lgkmcnt(0)
  v_smfmac_f32_16x16x64_bf16 v[36:39], v[68:71], v[24:31], v8 abid:1
  buffer_store_dwordx2 v[32:33], v5, s[4:7], s70 offen sc1
  v_mfma_f32_16x16x32_bf16 v[44:47], v[12:15], v[244:247], v[44:47]
  v_mfma_f32_16x16x32_bf16 v[44:47], v[16:19], v[248:251], v[44:47]
  v_mul_f32 v36, v36, v20
  v_mul_f32 v38, v38, v20
  v_mfma_f32_16x16x32_bf16 v[44:47], v[68:71], v[252:255], v[44:47]
  v_mul_f32 v37, v37, v21
  v_mul_f32 v39, v39, v21
  v_cvt_pk_bf16_f32 v36, v36, v38
  v_cvt_pk_bf16_f32 v37, v37, v39
  v_bfi_b32 v36, 1, s46, v36
  v_bfi_b32 v37, 1, s46, v37
  buffer_store_dwordx2 v[36:37], v5, s[4:7], s71 offen sc1
  s_nop 0
  v_mul_f32 v44, v44, v20
  v_mul_f32 v45, v45, v21
  v_cvt_pk_bf16_f32 v44, v44, v45
  v_bfi_b32 v44, 1, s46, v44
  buffer_store_dword v44, v7, s[4:7], s72 offen sc1
  s_barrier
  v_mov_b64 v[24:25], 0
  v_mov_b64 v[26:27], 0
  v_mov_b64 v[28:29], 0
  v_mov_b64 v[30:31], 0
  v_mov_b64 v[32:33], 0
  v_mov_b64 v[34:35], 0
  v_mov_b64 v[36:37], 0
  v_mov_b64 v[38:39], 0
  buffer_load_dwordx4 v[56:59], v0, s[4:7], s51 offen offset:0 sc1
  buffer_load_dwordx4 v[60:63], v0, s[4:7], s51 offen offset:1024 sc1
  s_add_u32 s16, s47, 4096
  s_add_u32 s17, s47, 8192
  s_barrier
  buffer_load_dwordx4 v[12:15], v0, s[4:7], s47 offen offset:0 sc1
  s_waitcnt vmcnt(2)
  buffer_load_dwordx4 v[16:19], v0, s[4:7], s47 offen offset:1024 sc1
  v_bitop3_b32 v9, v56, v57, s46 bitop3:0x7e
  v_bitop3_b32 v11, v58, v59, s46 bitop3:0x7e
  v_mfma_f32_16x16x32_bf16 v[40:43], v[64:67], v[56:59], 0
  s_waitcnt vmcnt(2)
  v_bitop3_b32 v44, v60, v61, s46 bitop3:0x7e
  v_bitop3_b32 v45, v62, v63, s46 bitop3:0x7e
  v_mfma_f32_16x16x32_bf16 v[40:43], v[64:67], v[60:63], v[40:43]
  v_or3_b32 v9, v9, v11, v44
  v_bitop3_b32 v9, v9, v45, 1 bitop3:0xa8
  v_cmp_ne_u32 vcc, 0, v9
  s_nop 4
  v_add_f32_dpp v40, v40, v40 row_ror:8 row_mask:0xf bank_mask:0xf
  v_add_f32_dpp v41, v41, v41 row_ror:8 row_mask:0xf bank_mask:0xf
  s_cbranch_vccnz RF2_frq
RF2_rq:
  v_add_f32_dpp v46, v40, v40 row_ror:4 row_mask:0xf bank_mask:0x1
  v_add_f32_dpp v47, v41, v41 row_ror:4 row_mask:0xf bank_mask:0x1
  v_cvt_pk_bf16_f32 v9, v46, v47
  buffer_load_dwordx4 v[20:23], v0, s[4:7], s47 offen offset:2048 sc1
  buffer_load_dwordx4 v[56:59], v0, s[4:7], s47 offen offset:3072 sc1
  buffer_store_dword v9, v6, s[4:7], s56 offen sc1
  v_mov_b64 v[64:65], 0
  v_mov_b64 v[66:67], 0
  v_mov_b64 v[68:69], 0
  v_mov_b64 v[70:71], 0
  s_branch RF2_go
RF2_in:
  s_cmp_gt_u32 s60, 1
  s_cselect_b32 s55, s64, 0
  s_cmp_gt_u32 s55, 0
  s_cbranch_scc1 RF2_in1
  s_xor_b32 s55, s59, 64
RF2_in0:
  s_load_dword s60, s[42:43], s59 glc
  s_load_dword s64, s[42:43], s55 glc
  s_sub_u32 s54, s54, 1
  s_cbranch_scc1 K_end
  s_waitcnt lgkmcnt(0)
  s_cmp_gt_u32 s60, 1
  s_cbranch_scc0 RF2_in0
RF2_in1:
  s_add_u32 s16, s47, 4096
  s_add_u32 s17, s47, 8192
  buffer_load_dwordx4 v[12:15], v0, s[4:7], s47 offen offset:0 sc1
  buffer_load_dwordx4 v[16:19], v0, s[4:7], s47 offen offset:1024 sc1
  buffer_load_dwordx4 v[20:23], v0, s[4:7], s47 offen offset:2048 sc1
  buffer_load_dwordx4 v[56:59], v0, s[4:7], s47 offen offset:3072 sc1
  v_lshlrev_b32 v11, 3, v0
  s_bitcmp1_b32 s45, 0
  s_cselect_b32 s56, -1, 1
  s_mul_i32 s56, s56, 2176
  s_add_u32 s55, s52, 256
  buffer_load_dword v11, s[4:7], s55 offen sc1 lds
  s_bfe_u32 s55, s45, 0x20002
  s_mul_i32 s55, s55, 2304
  s_and_b32 s57, s45, 16
  s_lshl_b32 s57, s57, 10
  s_add_u32 s55, s55, s57
  s_add_u32 s55, s55, s47
  s_add_u32 s56, s51, s56
  s_mov_b64 exec, 0x3ffff
  buffer_load_dword v11, s[4:7], s55 offen sc1 lds
  buffer_load_dword v11, s[4:7], s56 offen sc1 lds
  s_mov_b64 exec, -1
  v_mov_b64 v[24:25], 0
  v_mov_b64 v[26:27], 0
  v_mov_b64 v[28:29], 0
  v_mov_b64 v[30:31], 0
  v_mov_b64 v[32:33], 0
  v_mov_b64 v[34:35], 0
  v_mov_b64 v[36:37], 0
  v_mov_b64 v[38:39], 0
  v_mov_b64 v[64:65], 0
  v_mov_b64 v[66:67], 0
  v_mov_b64 v[68:69], 0
  v_mov_b64 v[70:71], 0
  s_waitcnt vmcnt(3)
  s_barrier
  s_branch RF2_go2
RF2_in2:
  buffer_load_dwordx4 v[12:15], v0, s[4:7], s47 offen offset:0 sc1
  buffer_load_dwordx4 v[16:19], v0, s[4:7], s47 offen offset:1024 sc1
  buffer_load_dwordx4 v[20:23], v0, s[4:7], s47 offen offset:2048 sc1
  buffer_load_dwordx4 v[56:59], v0, s[4:7], s47 offen offset:3072 sc1
  v_mov_b64 v[24:25], 0
  v_mov_b64 v[26:27], 0
  v_mov_b64 v[28:29], 0
  v_mov_b64 v[30:31], 0
  v_mov_b64 v[32:33], 0
  v_mov_b64 v[34:35], 0
  v_mov_b64 v[36:37], 0
  v_mov_b64 v[38:39], 0
  v_mov_b64 v[64:65], 0
  v_mov_b64 v[66:67], 0
  v_mov_b64 v[68:69], 0
  v_mov_b64 v[70:71], 0
  s_waitcnt vmcnt(0)
  s_barrier
  s_branch RF2_go2
RF2_f0:
  buffer_load_dwordx4 v[12:15], v0, s[4:7], s47 offen offset:0 sc1
  s_sub_u32 s54, s54, 1
  s_cbranch_scc1 K_end
  s_nop 3
  v_mov_b64 v[24:25], 0
  v_mov_b64 v[26:27], 0
  v_mov_b64 v[28:29], 0
  v_mov_b64 v[30:31], 0
  buffer_load_dwordx4 v[16:19], v0, s[4:7], s47 offen offset:1024 sc1
  buffer_load_dwordx4 v[20:23], v0, s[4:7], s47 offen offset:2048 sc1
  buffer_load_dwordx4 v[56:59], v0, s[4:7], s47 offen offset:3072 sc1
  buffer_load_dword v10, s[4:7], s47 offen lds
  s_waitcnt vmcnt(4) lgkmcnt(0)
  s_branch RF2_go2
RF2_c1:
  buffer_load_dwordx4 v[16:19], v0, s[4:7], s47 offen offset:1024 sc1
  s_sub_u32 s54, s54, 1
  s_cbranch_scc1 K_end
  buffer_load_dwordx4 v[20:23], v0, s[4:7], s47 offen offset:2048 sc1
  buffer_load_dwordx4 v[56:59], v0, s[4:7], s47 offen offset:3072 sc1
  buffer_load_dword v10, s[4:7], s47 offen lds
  s_waitcnt vmcnt(3)
  v_max3_u32 v9, v19, v19, v19
  v_cmp_eq_u32 vcc, -1, v9
  s_cbranch_vccnz RF2_c1
  s_branch RF2_g1
RF2_c2:
  buffer_load_dwordx4 v[20:23], v0, s[4:7], s47 offen offset:2048 sc1
  s_sub_u32 s54, s54, 1
  s_cbranch_scc1 K_end
  buffer_load_dwordx4 v[56:59], v0, s[4:7], s47 offen offset:3072 sc1
  buffer_load_dword v10, s[4:7], s47 offen lds
  buffer_load_dwordx4 v[60:63], v0, s[4:7], s16 offen offset:0 sc1
  buffer_load_dwordx4 v[12:15], v0, s[4:7], s16 offen offset:1024 sc1
  s_waitcnt vmcnt(4)
  v_max3_u32 v9, v23, v23, v23
  v_cmp_eq_u32 vcc, -1, v9
  s_cbranch_vccnz RF2_c2
  s_branch RF2_g2
RF2_c3:
  buffer_load_dwordx4 v[56:59], v0, s[4:7], s47 offen offset:3072 sc1
  s_sub_u32 s54, s54, 1
  s_cbranch_scc1 K_end
  buffer_load_dword v10, s[4:7], s47 offen lds
  buffer_load_dwordx4 v[60:63], v0, s[4:7], s16 offen offset:0 sc1
  buffer_load_dwordx4 v[12:15], v0, s[4:7], s16 offen offset:1024 sc1
  buffer_load_dword v10, s[4:7], s47 offen lds
  buffer_load_dwordx4 v[16:19], v0, s[4:7], s16 offen offset:2048 sc1
  buffer_load_dwordx4 v[4:7], v0, s[4:7], s17 offen offset:0 sc1
  s_waitcnt vmcnt(6)
  v_max3_u32 v9, v59, v59, v59
  v_cmp_eq_u32 vcc, -1, v9
  s_cbranch_vccnz RF2_c3
  s_branch RF2_g3
RF2_c45:
  buffer_load_dwordx4 v[60:63], v0, s[4:7], s16 offen offset:0 sc1
  buffer_load_dwordx4 v[12:15], v0, s[4:7], s16 offen offset:1024 sc1
  s_sub_u32 s54, s54, 1
  s_cbranch_scc1 K_end
  buffer_load_dword v10, s[4:7], s47 offen lds
  buffer_load_dwordx4 v[16:19], v0, s[4:7], s16 offen offset:2048 sc1
  buffer_load_dwordx4 v[4:7], v0, s[4:7], s17 offen offset:0 sc1
  buffer_load_dwordx4 v[20:23], v0, s[4:7], s16 offen offset:3072 sc1
  buffer_load_dword v10, s[4:7], s47 offen lds
  s_waitcnt vmcnt(5)
  v_max3_u32 v9, v63, v15, v63
  v_cmp_eq_u32 vcc, -1, v9
  s_cbranch_vccnz RF2_c45
  s_branch RF2_g45
RF2_c678:
  buffer_load_dwordx4 v[16:19], v0, s[4:7], s16 offen offset:2048 sc1
  buffer_load_dwordx4 v[4:7], v0, s[4:7], s17 offen offset:0 sc1
  buffer_load_dwordx4 v[20:23], v0, s[4:7], s16 offen offset:3072 sc1
  s_sub_u32 s54, s54, 1
  s_cbranch_scc1 K_end
  buffer_load_dword v10, s[4:7], s47 offen lds
  buffer_load_dword v10, s[4:7], s47 offen lds
  buffer_load_dword v10, s[4:7], s47 offen lds
  s_waitcnt vmcnt(3)
  v_max3_u32 v9, v19, v23, v7
  v_cmp_eq_u32 vcc, -1, v9
  s_cbranch_vccnz RF2_c678
  s_branch RF2_g678
RF2_fn:
  s_cmp_eq_u32 s20, s46
  s_cbranch_scc1 RF2_gn
  s_mov_b32 s20, s46
  s_waitcnt vmcnt(0) lgkmcnt(0)
  s_nop 7
RF2_fl:
  buffer_load_dwordx4 v[12:15], v0, s[4:7], s47 offen offset:0 sc1
  buffer_load_dwordx4 v[16:19], v0, s[4:7], s47 offen offset:1024 sc1
  buffer_load_dwordx4 v[20:23], v0, s[4:7], s47 offen offset:2048 sc1
  buffer_load_dwordx4 v[24:27], v0, s[4:7], s47 offen offset:3072 sc1
  buffer_load_dwordx4 v[28:31], v0, s[4:7], s16 offen offset:0 sc1
  buffer_load_dwordx4 v[32:35], v0, s[4:7], s16 offen offset:1024 sc1
  buffer_load_dwordx4 v[36:39], v0, s[4:7], s16 offen offset:2048 sc1
  buffer_load_dwordx4 v[40:43], v0, s[4:7], s16 offen offset:3072 sc1
  buffer_load_dwordx4 v[44:47], v0, s[4:7], s17 offen offset:0 sc1
  s_sub_u32 s54, s54, 1
  s_cbranch_scc1 K_end
  s_waitcnt vmcnt(8)
  v_max_u32 v9, v12, v13
  v_max3_u32 v9, v9, v14, v15
  s_waitcnt vmcnt(7)
  v_max3_u32 v9, v9, v16, v17
  v_max3_u32 v9, v9, v18, v19
  s_waitcnt vmcnt(6)
  v_max3_u32 v9, v9, v20, v21
  v_max3_u32 v9, v9, v22, v23
  s_waitcnt vmcnt(5)
  v_max3_u32 v9, v9, v24, v25
  v_max3_u32 v9, v9, v26, v27
  s_waitcnt vmcnt(4)
  v_max3_u32 v9, v9, v28, v29
  v_max3_u32 v9, v9, v30, v31
  s_waitcnt vmcnt(3)
  v_max3_u32 v9, v9, v32, v33
  v_max3_u32 v9, v9, v34, v35
  s_waitcnt vmcnt(2)
  v_max3_u32 v9, v9, v36, v37
  v_max3_u32 v9, v9, v38, v39
  s_waitcnt vmcnt(1)
  v_max3_u32 v9, v9, v40, v41
  v_max3_u32 v9, v9, v42, v43
  s_waitcnt vmcnt(0)
  v_max3_u32 v9, v9, v44, v45
  v_max3_u32 v9, v9, v46, v47
  v_cmp_eq_u32 vcc, -1, v9
  s_cbranch_vccnz RF2_fl
  s_barrier
  buffer_inv sc1
  s_waitcnt vmcnt(0)
  s_barrier
  s_branch RF2_in2
RF2_frq:
RF2_lrq:
  buffer_load_dwordx4 v[56:59], v0, s[4:7], s51 offen offset:0 sc1
  buffer_load_dwordx4 v[60:63], v0, s[4:7], s51 offen offset:1024 sc1
  s_sub_u32 s54, s54, 1
  s_cbranch_scc1 K_end
  s_waitcnt vmcnt(0)
  v_bitop3_b32 v9, v56, v57, s46 bitop3:0x7e
  v_bitop3_b32 v11, v58, v59, s46 bitop3:0x7e
  v_mfma_f32_16x16x32_bf16 v[40:43], v[64:67], v[56:59], 0
  v_bitop3_b32 v44, v60, v61, s46 bitop3:0x7e
  v_bitop3_b32 v45, v62, v63, s46 bitop3:0x7e
  v_mfma_f32_16x16x32_bf16 v[40:43], v[64:67], v[60:63], v[40:43]
  v_or3_b32 v9, v9, v11, v44
  v_bitop3_b32 v9, v9, v45, 1 bitop3:0xa8
  v_cmp_ne_u32 vcc, 0, v9
  s_nop 4
  v_add_f32_dpp v40, v40, v40 row_ror:8 row_mask:0xf bank_mask:0xf
  v_add_f32_dpp v41, v41, v41 row_ror:8 row_mask:0xf bank_mask:0xf
  s_cbranch_vccz RF2_rq
  s_branch RF2_lrq
RF3_go:
  s_waitcnt vmcnt(4)
RF3_go2:
  v_cmp_eq_u32 vcc, -1, v15
  v_smfmac_f32_16x16x64_bf16 v[24:27], v[12:15], a[0:7], v8
  ds_read_b128 v[40:43], v1 offset:16384
  v_smfmac_f32_16x16x64_bf16 v[28:31], v[12:15], a[8:15], v8
  s_cbranch_vccnz RF3_f0
  v_smfmac_f32_16x16x64_bf16 v[32:35], v[12:15], a[128:135], v8
  ds_read_b128 v[44:47], v1 offset:17408
  v_smfmac_f32_16x16x64_bf16 v[36:39], v[12:15], a[136:143], v8
  ds_read_b128 v[48:51], v1 offset:18432
  s_waitcnt vmcnt(3)
  v_cmp_eq_u32 vcc, -1, v19
  v_smfmac_f32_16x16x64_bf16 v[64:67], v[12:15], a[192:199], v8
  ds_read_b128 v[52:55], v1 offset:19456
  v_smfmac_f32_16x16x64_bf16 v[68:71], v[12:15], a[200:207], v8
  s_cbranch_vccnz RF3_c1
RF3_g1:
  v_smfmac_f32_16x16x64_bf16 v[24:27], v[16:19], a[16:23], v8
  buffer_load_dwordx4 v[60:63], v0, s[4:7], s16 offen offset:0 sc1
  s_waitcnt lgkmcnt(2)
  v_smfmac_f32_16x16x64_bf16 v[32:35], v[16:19], v[40:47], v8
  ds_read_b128 v[40:43], v1 offset:20480
  buffer_load_dwordx4 v[12:15], v0, s[4:7], s16 offen offset:1024 sc1
  v_smfmac_f32_16x16x64_bf16 v[28:31], v[16:19], a[24:31], v8
  ds_read_b128 v[44:47], v1 offset:21504
  s_waitcnt lgkmcnt(2)
  v_smfmac_f32_16x16x64_bf16 v[36:39], v[16:19], v[48:55], v8
  ds_read_b128 v[48:51], v1 offset:22528
  s_waitcnt vmcnt(4)
  v_cmp_eq_u32 vcc, -1, v23
  v_smfmac_f32_16x16x64_bf16 v[64:67], v[16:19], a[208:215], v8
  ds_read_b128 v[52:55], v1 offset:23552
  v_smfmac_f32_16x16x64_bf16 v[68:71], v[16:19], a[216:223], v8
  s_cbranch_vccnz RF3_c2
RF3_g2:
  v_smfmac_f32_16x16x64_bf16 v[24:27], v[20:23], a[32:39], v8
  buffer_load_dwordx4 v0, s[4:7], s52 offen offset:256 sc1 lds
  s_waitcnt lgkmcnt(2)
  v_smfmac_f32_16x16x64_bf16 v[32:35], v[20:23], v[40:47], v8
  ds_read_b128 v[40:43], v1 offset:24576
  v_smfmac_f32_16x16x64_bf16 v[28:31], v[20:23], a[40:47], v8
  ds_read_b128 v[44:47], v1 offset:25600
  buffer_load_dwordx4 v[16:19], v0, s[4:7], s16 offen offset:2048 sc1
  s_waitcnt lgkmcnt(2)
  v_smfmac_f32_16x16x64_bf16 v[36:39], v[20:23], v[48:55], v8
  ds_read_b128 v[48:51], v1 offset:26624
  s_waitcnt vmcnt(5)
  v_cmp_eq_u32 vcc, -1, v59
  v_smfmac_f32_16x16x64_bf16 v[64:67], v[20:23], a[224:231], v8
  ds_read_b128 v[52:55], v1 offset:27648
  buffer_load_dwordx4 v[4:7], v0, s[4:7], s17 offen offset:0 sc1
  v_smfmac_f32_16x16x64_bf16 v[68:71], v[20:23], a[232:239], v8
  s_cbranch_vccnz RF3_c3
RF3_g3:
  v_smfmac_f32_16x16x64_bf16 v[24:27], v[56:59], a[48:55], v8
  buffer_load_dwordx4 v[20:23], v0, s[4:7], s16 offen offset:3072 sc1
  s_waitcnt lgkmcnt(2)
  v_smfmac_f32_16x16x64_bf16 v[32:35], v[56:59], v[40:47], v8
  ds_read_b128 v[40:43], v1 offset:28672
  buffer_load_dwordx4 v0, s[4:7], s52 offen offset:1280 sc1 lds
  v_smfmac_f32_16x16x64_bf16 v[28:31], v[56:59], a[56:63], v8
  ds_read_b128 v[44:47], v1 offset:29696
  s_waitcnt lgkmcnt(2)
  v_smfmac_f32_16x16x64_bf16 v[36:39], v[56:59], v[48:55], v8
  ds_read_b128 v[48:51], v1 offset:30720
  s_waitcnt vmcnt(5)
  v_cmp_u_f32 vcc, v63, v15
  v_smfmac_f32_16x16x64_bf16 v[64:67], v[56:59], a[240:247], v8
  ds_read_b128 v[52:55], v1 offset:31744
  v_smfmac_f32_16x16x64_bf16 v[68:71], v[56:59], a[248:255], v8
  s_cbranch_vccnz RF3_c45
RF3_g45:
  v_smfmac_f32_16x16x64_bf16 v[24:27], v[60:63], a[64:71], v8
  s_waitcnt lgkmcnt(2)
  v_smfmac_f32_16x16x64_bf16 v[32:35], v[60:63], v[40:47], v8
  ds_read_b128 v[40:43], v1 offset:0
  v_smfmac_f32_16x16x64_bf16 v[28:31], v[60:63], a[72:79], v8
  ds_read_b128 v[44:47], v1 offset:1024
  buffer_load_dwordx4 v0, s[4:7], s52 offen offset:2304 sc1 lds
  s_waitcnt lgkmcnt(2)
  v_smfmac_f32_16x16x64_bf16 v[36:39], v[60:63], v[48:55], v8
  ds_read_b128 v[48:51], v1 offset:2048
  v_smfmac_f32_16x16x64_bf16 v[64:67], v[60:63], v[72:79], v8
  ds_read_b128 v[52:55], v1 offset:3072
  v_smfmac_f32_16x16x64_bf16 v[68:71], v[60:63], v[80:87], v8
  v_smfmac_f32_16x16x64_bf16 v[24:27], v[12:15], a[80:87], v8
  s_waitcnt lgkmcnt(2)
  v_smfmac_f32_16x16x64_bf16 v[32:35], v[12:15], v[40:47], v8
  ds_read_b128 v[40:43], v1 offset:4096
  v_smfmac_f32_16x16x64_bf16 v[28:31], v[12:15], a[88:95], v8
  ds_read_b128 v[44:47], v1 offset:5120
  s_waitcnt vmcnt(3) lgkmcnt(2)
  v_max_u32 v9, v19, v7
  v_smfmac_f32_16x16x64_bf16 v[36:39], v[12:15], v[48:55], v8
  ds_read_b128 v[48:51], v1 offset:6144
  s_waitcnt vmcnt(2)
  v_cmp_u_f32 vcc, v9, v23
  v_smfmac_f32_16x16x64_bf16 v[64:67], v[12:15], v[88:95], v8
  ds_read_b128 v[52:55], v1 offset:7168
  buffer_load_dwordx4 v0, s[4:7], s52 offen offset:3328 sc1 lds
  v_smfmac_f32_16x16x64_bf16 v[68:71], v[12:15], v[96:103], v8
  s_cbranch_vccnz RF3_c678
RF3_g678:
  v_smfmac_f32_16x16x64_bf16 v[24:27], v[16:19], a[96:103], v8
  s_waitcnt vmcnt(2)
  s_waitcnt lgkmcnt(2)
  s_barrier
  ds_read_b128 v[12:15], v0 offset:9984
  v_smfmac_f32_16x16x64_bf16 v[24:27], v[20:23], v[40:47], v8
  v_smfmac_f32_16x16x64_bf16 v[28:31], v[16:19], a[104:111], v8
  s_waitcnt lgkmcnt(1)
  v_smfmac_f32_16x16x64_bf16 v[28:31], v[20:23], v[48:55], v8
  ds_read_b128 v[60:63], v0 offset:8960
  v_smfmac_f32_16x16x64_bf16 v[24:27], v[4:7], a[112:119], v8
  ds_read_b128 v[44:47], v0 offset:13312
  v_smfmac_f32_16x16x64_bf16 v[28:31], v[4:7], a[120:127], v8
  ds_read_b128 v[56:59], v0 offset:14336
  v_smfmac_f32_16x16x64_bf16 v[32:35], v[16:19], a[144:151], v8
  v_add_f32 v24, v24, v26
  v_add_f32 v25, v25, v27
  v_smfmac_f32_16x16x64_bf16 v[32:35], v[20:23], a[160:167], v8
  v_add_f32 v28, v28, v30
  v_add_f32 v29, v29, v31
  v_smfmac_f32_16x16x64_bf16 v[32:35], v[4:7], a[176:183], v8
  v_cvt_pk_bf16_f32 v41, v24, v28
  v_cvt_pk_bf16_f32 v43, v25, v29
  v_smfmac_f32_16x16x64_bf16 v[36:39], v[16:19], a[152:159], v8
  ds_write2_b32 v3, v41, v43 offset0:0 offset1:4
  v_smfmac_f32_16x16x64_bf16 v[36:39], v[20:23], a[168:175], v8
  ds_read_b128 v[24:27], v2 offset:21888
  v_add_f32 v32, v32, v34
  v_smfmac_f32_16x16x64_bf16 v[36:39], v[4:7], a[184:191], v8
  v_add_f32 v33, v33, v35
  v_smfmac_f32_16x16x64_bf16 v[64:67], v[16:19], v[104:111], v8
  v_smfmac_f32_16x16x64_bf16 v[68:71], v[16:19], v[112:119], v8
  s_waitcnt lgkmcnt(1)
  s_barrier
  v_add_f32 v36, v36, v38
  v_smfmac_f32_16x16x64_bf16 v[64:67], v[20:23], v[120:127], v8
  ds_read_b128 v[28:31], v2 offset:20736
  v_add_f32 v37, v37, v39
  v_smfmac_f32_16x16x64_bf16 v[68:71], v[20:23], v[128:135], v8
  ds_read_b128 v[16:19], v0 offset:4608
  v_cvt_pk_bf16_f32 v40, v32, v36
  v_smfmac_f32_16x16x64_bf16 v[64:67], v[4:7], v[136:143], v8
  ds_read_b128 v[20:23], v0 offset:5632
  v_cvt_pk_bf16_f32 v42, v33, v37
  v_smfmac_f32_16x16x64_bf16 v[68:71], v[4:7], v[144:151], v8
  ds_read_b128 v[48:51], v2 offset:19584
  ds_read_b128 v[4:7], v0 offset:256
  ds_write2_b32 v3, v40, v42 offset0:144 offset1:148
  s_waitcnt lgkmcnt(6)
  v_mfma_f32_16x16x32_bf16 v[32:35], v[44:47], v[24:27], 0
  ds_read_b128 v[44:47], v0 offset:1280
  v_add_f32 v64, v64, v66
  v_mfma_f32_16x16x32_bf16 v[36:39], v[56:59], v[24:27], 0
  ds_read_b128 v[52:55], v2 offset:18432
  s_waitcnt lgkmcnt(7)
  v_add_f32 v65, v65, v67
  v_mfma_f32_16x16x32_bf16 v[32:35], v[60:63], v[28:31], v[32:35]
  v_cvt_pk_bf16_f32 v41, v64, v65
  v_mfma_f32_16x16x32_bf16 v[36:39], v[12:15], v[28:31], v[36:39]
  ds_read_b128 v[64:67], v2 offset:22464
  s_waitcnt lgkmcnt(5)
  v_add_f32 v68, v68, v70
  v_mfma_f32_16x16x32_bf16 v[32:35], v[16:19], v[48:51], v[32:35]
  s_waitcnt lgkmcnt(2)
  s_barrier
  ds_read_b128 v[12:15], v2 offset:21312
  v_add_f32 v69, v69, v71
  v_mfma_f32_16x16x32_bf16 v[36:39], v[20:23], v[48:51], v[36:39]
  ds_read_b128 v[16:19], v2 offset:20160
  s_waitcnt lgkmcnt(3)
  v_cvt_pk_bf16_f32 v43, v68, v69
  v_mfma_f32_16x16x32_bf16 v[32:35], v[4:7], v[52:55], v[32:35]
  s_waitcnt vmcnt(1)
  ds_read_b128 v[56:59], v0 offset:15360
  ds_read_b128 v[68:71], v2 offset:19008
  v_mfma_f32_16x16x32_bf16 v[36:39], v[44:47], v[52:55], v[36:39]
  s_waitcnt vmcnt(0)
  ds_read_b128 v[60:63], v0 offset:16384
  s_waitcnt lgkmcnt(5)
  v_mfma_f32_16x16x32_bf16 v[44:47], v[64:67], v[24:27], 0
  s_waitcnt lgkmcnt(4)
  v_cmp_u_f32 vcc, v32, v32
  v_max3_f32 v9, v32, v33, v34
  v_mfma_f32_16x16x32_bf16 v[44:47], v[12:15], v[28:31], v[44:47]
  s_waitcnt lgkmcnt(3)
  v_max3_f32 v9, v9, v35, v36
  v_max3_f32 v9, v9, v37, v38
  v_mfma_f32_16x16x32_bf16 v[44:47], v[16:19], v[48:51], v[44:47]
  s_cbranch_vccnz RF3_fn
RF3_gn:
  s_waitcnt lgkmcnt(1)
  v_mfma_f32_16x16x32_bf16 v[44:47], v[68:71], v[52:55], v[44:47]
  buffer_store_dwordx4 v[40:43], v0, s[4:7], s53 offen offset:3072 sc1
  ds_read_b128 v[4:7], v0 offset:23552
  ds_read_b128 v[24:27], v1 offset:8192
  v_mov_b64 v[12:13], s[62:63]
  v_mov_b64 v[14:15], s[62:63]
  v_max_f32 v9, v9, v39
  s_nop 1
  v_max3_f32 v46, v9, v44, v45
  v_max3_f32 v9, v9, v44, v45
  s_add_u32 s53, s53, 131072
  s_add_u32 s47, s47, 16384
  v_permlane32_swap_b32 v9, v46
  v_max_f32 v47, v9, v46
  v_max_f32 v9, v9, v46
  s_add_u32 s22, s47, s48
  s_nop 0
  v_permlane16_swap_b32 v9, v47
  v_max_f32 v9, v9, v47
  v_mul_f32 v46, s58, v9
  v_pk_fma_f32 v[44:45], v[44:45], s[58:59], v[46:47] op_sel_hi:[1,0,0] neg_lo:[0,0,1] neg_hi:[0,0,1]
  v_pk_fma_f32 v[32:33], v[32:33], s[58:59], v[46:47] op_sel_hi:[1,0,0] neg_lo:[0,0,1] neg_hi:[0,0,1]
  v_pk_fma_f32 v[34:35], v[34:35], s[58:59], v[46:47] op_sel_hi:[1,0,0] neg_lo:[0,0,1] neg_hi:[0,0,1]
  v_pk_fma_f32 v[36:37], v[36:37], s[58:59], v[46:47] op_sel_hi:[1,0,0] neg_lo:[0,0,1] neg_hi:[0,0,1]
  v_pk_fma_f32 v[38:39], v[38:39], s[58:59], v[46:47] op_sel_hi:[1,0,0] neg_lo:[0,0,1] neg_hi:[0,0,1]
  v_exp_f32 v44, v44
  v_exp_f32 v45, v45
  v_exp_f32 v32, v32
  v_cvt_pk_bf16_f32 v11, v44, v45
  v_exp_f32 v33, v33
  v_exp_f32 v34, v34
  v_mfma_f32_16x16x16_bf16 v[16:19], v[40:41], v[10:11], 0
  v_cvt_pk_bf16_f32 v64, v32, v33
  v_exp_f32 v35, v35
  v_mfma_f32_16x16x16_bf16 v[68:71], v[42:43], v[10:11], 0
  v_add_u32 v9, s46, 1
  s_waitcnt lgkmcnt(1)
  buffer_store_dword v9, v6, s[4:7], s61 offen sc1
  v_exp_f32 v36, v36
  v_cvt_pk_bf16_f32 v65, v34, v35
  v_exp_f32 v37, v37
  v_mfma_f32_16x16x16_bf16 v[20:23], v[10:11], v[12:13], 0
  ds_read_b128 v[28:31], v1 offset:9216
  v_exp_f32 v38, v38
  v_exp_f32 v39, v39
  v_cvt_pk_bf16_f32 v66, v36, v37
  v_cvt_pk_bf16_f32 v67, v38, v39
  v_mov_b64 v[32:33], 0
  v_mov_b64 v[34:35], 0
  v_mfma_f32_16x16x32_bf16 v[16:19], v[56:59], v[64:67], v[16:19]
  v_mov_b64 v[36:37], 0
  v_mov_b64 v[38:39], 0
  v_mfma_f32_16x16x32_bf16 v[68:71], v[60:63], v[64:67], v[68:71]
  v_mov_b64 v[56:57], 0
  v_mov_b64 v[58:59], 0
  v_mfma_f32_16x16x32_bf16 v[20:23], v[64:67], v[12:15], v[20:23]
  v_cvt_pk_bf16_f32 v64, v16, v17
  v_cvt_pk_bf16_f32 v65, v18, v19
  v_mov_b64 v[60:61], 0
  v_mov_b64 v[62:63], 0
  v_cvt_pk_bf16_f32 v66, v68, v69
  v_cvt_pk_bf16_f32 v67, v70, v71
  ds_write_b128 v2, v[64:67] offset:21888
  s_add_u32 s52, s52, 524288
  v_mfma_f32_16x16x32_bf16 v[44:47], v[64:67], v[240:243], 0
  ds_read_b128 v[48:51], v1 offset:10240
  s_waitcnt lgkmcnt(2)
  v_smfmac_f32_16x16x64_bf16 v[32:35], v[64:67], v[24:31], v8 abid:1
  ds_read_b128 v[52:55], v1 offset:11264
  s_cmp_eq_u32 s46, 63
  v_smfmac_f32_16x16x64_bf16 v[56:59], v[64:67], v[152:159], v8 abid:1
  s_cbranch_scc1 K_end
  s_waitcnt lgkmcnt(2)
  s_barrier
  v_smfmac_f32_16x16x64_bf16 v[60:63], v[64:67], v[184:191], v8 abid:1
  ds_read_b128 v[12:15], v2 offset:20736
  ds_read_b128 v[16:19], v2 offset:19584
  ds_read_b128 v[68:71], v2 offset:18432
  s_waitcnt lgkmcnt(3)
  v_smfmac_f32_16x16x64_bf16 v[36:39], v[64:67], v[48:55], v8 abid:1
  ds_read_b128 v[24:27], v1 offset:12288
  ds_read_b128 v[28:31], v1 offset:13312
  v_rcp_f32 v20, v20
  v_rcp_f32 v21, v21
  s_waitcnt lgkmcnt(4)
  v_smfmac_f32_16x16x64_bf16 v[56:59], v[12:15], v[160:167], v8 abid:1
  ds_read_b128 v[48:51], v1 offset:14336
  s_waitcnt lgkmcnt(4)
  v_smfmac_f32_16x16x64_bf16 v[56:59], v[16:19], v[168:175], v8 abid:1
  ds_read_b128 v[52:55], v1 offset:15360
  s_waitcnt lgkmcnt(4)
  v_smfmac_f32_16x16x64_bf16 v[56:59], v[68:71], v[176:183], v8 abid:1
  ds_read_b128 v[64:67], v4 offset:23296
  v_smfmac_f32_16x16x64_bf16 v[60:63], v[12:15], v[192:199], v8 abid:1
  s_add_u32 s46, s46, 1
  s_add_u32 s56, s47, s49
  s_and_b32 s19, s46, s18
  v_smfmac_f32_16x16x64_bf16 v[60:63], v[16:19], v[200:207], v8 abid:1
  v_mul_f32 v56, v56, v20
  v_mul_f32 v58, v58, v20
  v_mul_f32 v57, v57, v21
  v_mul_f32 v59, v59, v21
  v_cvt_pk_bf16_f32 v56, v56, v58
  v_cvt_pk_bf16_f32 v57, v57, v59
  v_bfi_b32 v56, 1, s46, v56
  v_bfi_b32 v57, 1, s46, v57
  buffer_store_dwordx2 v[56:57], v5, s[4:7], s68 offen sc1
  v_smfmac_f32_16x16x64_bf16 v[60:63], v[68:71], v[208:215], v8 abid:1
  s_waitcnt lgkmcnt(3)
  v_smfmac_f32_16x16x64_bf16 v[32:35], v[12:15], v[24:31], v8 abid:1
  ds_read_b128 v[24:27], v1 offset:32768
  v_smfmac_f32_16x16x64_bf16 v[32:35], v[16:19], v[216:223], v8 abid:1
  ds_read_b128 v[28:31], v1 offset:33792
  v_mul_f32 v60, v60, v20
  v_mul_f32 v62, v62, v20
  v_mul_f32 v61, v61, v21
  v_mul_f32 v63, v63, v21
  v_cvt_pk_bf16_f32 v60, v60, v62
  v_cvt_pk_bf16_f32 v61, v61, v63
  v_bfi_b32 v60, 1, s46, v60
  v_bfi_b32 v61, 1, s46, v61
  s_waitcnt lgkmcnt(3)
  v_smfmac_f32_16x16x64_bf16 v[32:35], v[68:71], v[48:55], v8 abid:1
  buffer_store_dwordx2 v[60:61], v5, s[4:7], s69 offen sc1
  v_smfmac_f32_16x16x64_bf16 v[36:39], v[12:15], v[224:231], v8 abid:1
  v_smfmac_f32_16x16x64_bf16 v[36:39], v[16:19], v[232:239], v8 abid:1
  v_mul_f32 v32, v32, v20
  v_mul_f32 v34, v34, v20
  v_mul_f32 v33, v33, v21
  v_mul_f32 v35, v35, v21
  v_cvt_pk_bf16_f32 v32, v32, v34
  v_cvt_pk_bf16_f32 v33, v33, v35
  v_bfi_b32 v32, 1, s46, v32
  v_bfi_b32 v33, 1, s46, v33
  s_waitcnt lgkmcnt(0)
  v_smfmac_f32_16x16x64_bf16 v[36:39], v[68:71], v[24:31], v8 abid:1
  buffer_store_dwordx2 v[32:33], v5, s[4:7], s70 offen sc1
  v_mfma_f32_16x16x32_bf16 v[44:47], v[12:15], v[244:247], v[44:47]
  v_mfma_f32_16x16x32_bf16 v[44:47], v[16:19], v[248:251], v[44:47]
  v_mul_f32 v36, v36, v20
  v_mul_f32 v38, v38, v20
  v_mfma_f32_16x16x32_bf16 v[44:47], v[68:71], v[252:255], v[44:47]
  v_mul_f32 v37, v37, v21
  v_mul_f32 v39, v39, v21
  v_cvt_pk_bf16_f32 v36, v36, v38
  v_cvt_pk_bf16_f32 v37, v37, v39
  v_bfi_b32 v36, 1, s46, v36
  v_bfi_b32 v37, 1, s46, v37
  buffer_store_dwordx2 v[36:37], v5, s[4:7], s71 offen sc1
  s_nop 0
  v_mul_f32 v44, v44, v20
  v_mul_f32 v45, v45, v21
  v_cvt_pk_bf16_f32 v44, v44, v45
  v_bfi_b32 v44, 1, s46, v44
  buffer_store_dword v44, v7, s[4:7], s72 offen sc1
  s_add_u32 s55, s46, 1
RF3_fc:
  s_cmp_gt_u32 s60, s55
  s_cbranch_scc0 RF3_flg
  s_barrier
  s_load_dword s60, s[42:43], s59 glc
  v_mov_b64 v[24:25], 0
  v_mov_b64 v[26:27], 0
  v_mov_b64 v[28:29], 0
  v_mov_b64 v[30:31], 0
  v_mov_b64 v[32:33], 0
  v_mov_b64 v[34:35], 0
  v_mov_b64 v[36:37], 0
  v_mov_b64 v[38:39], 0
  s_add_u32 s16, s47, 4096
  s_add_u32 s17, s47, 8192
  buffer_load_dwordx4 v[56:59], v0, s[4:7], s51 offen offset:0 sc1
  buffer_load_dwordx4 v[60:63], v0, s[4:7], s51 offen offset:1024 sc1
  s_barrier
  buffer_load_dwordx4 v[12:15], v0, s[4:7], s47 offen offset:0 sc1
  s_waitcnt vmcnt(2)
  buffer_load_dwordx4 v[16:19], v0, s[4:7], s47 offen offset:1024 sc1
  v_bitop3_b32 v9, v56, v57, s19 bitop3:0x7e
  v_bitop3_b32 v11, v58, v59, s19 bitop3:0x7e
  v_mfma_f32_16x16x32_bf16 v[40:43], v[64:67], v[56:59], 0
  s_waitcnt vmcnt(2)
  v_bitop3_b32 v44, v60, v61, s19 bitop3:0x7e
  v_bitop3_b32 v45, v62, v63, s19 bitop3:0x7e
  v_mfma_f32_16x16x32_bf16 v[40:43], v[64:67], v[60:63], v[40:43]
  v_or3_b32 v9, v9, v11, v44
  v_bitop3_b32 v9, v9, v45, 1 bitop3:0xa8
  v_cmp_ne_u32 vcc, 0, v9
  s_nop 4
  v_add_f32_dpp v40, v40, v40 row_ror:8 row_mask:0xf bank_mask:0xf
  v_add_f32_dpp v41, v41, v41 row_ror:8 row_mask:0xf bank_mask:0xf
  s_cbranch_vccnz RF3_frq
RF3_rq:
  v_add_f32_dpp v46, v40, v40 row_ror:4 row_mask:0xf bank_mask:0x1
  v_add_f32_dpp v47, v41, v41 row_ror:4 row_mask:0xf bank_mask:0x1
  v_cvt_pk_bf16_f32 v9, v46, v47
  buffer_load_dwordx4 v[20:23], v0, s[4:7], s47 offen offset:2048 sc1
  buffer_load_dwordx4 v[56:59], v0, s[4:7], s47 offen offset:3072 sc1
  buffer_store_dword v9, v6, s[4:7], s56 offen sc1
  v_mov_b64 v[64:65], 0
  v_mov_b64 v[66:67], 0
  v_mov_b64 v[68:69], 0
  v_mov_b64 v[70:71], 0
  s_branch RF3_go
RF3_in:
  s_cmp_gt_u32 s60, 1
  s_cselect_b32 s55, s64, 0
  s_cmp_gt_u32 s55, 0
  s_cbranch_scc1 RF3_in1
  s_xor_b32 s55, s59, 64
RF3_in0:
  s_load_dword s60, s[42:43], s59 glc
  s_load_dword s64, s[42:43], s55 glc
  s_sub_u32 s54, s54, 1
  s_cbranch_scc1 K_end
  s_waitcnt lgkmcnt(0)
  s_cmp_gt_u32 s60, 1
  s_cbranch_scc0 RF3_in0
RF3_in1:
  s_add_u32 s16, s47, 4096
  s_add_u32 s17, s47, 8192
  buffer_load_dwordx4 v[12:15], v0, s[4:7], s47 offen offset:0 sc1
  buffer_load_dwordx4 v[16:19], v0, s[4:7], s47 offen offset:1024 sc1
  buffer_load_dwordx4 v[20:23], v0, s[4:7], s47 offen offset:2048 sc1
  buffer_load_dwordx4 v[56:59], v0, s[4:7], s47 offen offset:3072 sc1
  v_lshlrev_b32 v11, 3, v0
  s_bitcmp1_b32 s45, 0
  s_cselect_b32 s56, -1, 1
  s_mul_i32 s56, s56, 2176
  s_add_u32 s55, s52, -3840
  s_xor_b32 s55, s55, 16384
  s_cmp_gt_u32 s64, 0
  s_cselect_b32 s55, s55, 1073741824
  buffer_load_dword v11, s[4:7], s55 offen sc1 lds
  s_add_u32 s56, s51, s56
  s_mov_b64 exec, 0x3ffff
  buffer_load_dword v11, s[4:7], s56 offen sc1 lds
  s_mov_b64 exec, -1
  v_mov_b64 v[24:25], 0
  v_mov_b64 v[26:27], 0
  v_mov_b64 v[28:29], 0
  v_mov_b64 v[30:31], 0
  v_mov_b64 v[32:33], 0
  v_mov_b64 v[34:35], 0
  v_mov_b64 v[36:37], 0
  v_mov_b64 v[38:39], 0
  v_mov_b64 v[64:65], 0
  v_mov_b64 v[66:67], 0
  v_mov_b64 v[68:69], 0
  v_mov_b64 v[70:71], 0
  s_waitcnt vmcnt(2)
  s_barrier
  s_branch RF3_go2
RF3_in2:
  buffer_load_dwordx4 v[12:15], v0, s[4:7], s47 offen offset:0 sc1
  buffer_load_dwordx4 v[16:19], v0, s[4:7], s47 offen offset:1024 sc1
  buffer_load_dwordx4 v[20:23], v0, s[4:7], s47 offen offset:2048 sc1
  buffer_load_dwordx4 v[56:59], v0, s[4:7], s47 offen offset:3072 sc1
  v_mov_b64 v[24:25], 0
  v_mov_b64 v[26:27], 0
  v_mov_b64 v[28:29], 0
  v_mov_b64 v[30:31], 0
  v_mov_b64 v[32:33], 0
  v_mov_b64 v[34:35], 0
  v_mov_b64 v[36:37], 0
  v_mov_b64 v[38:39], 0
  v_mov_b64 v[64:65], 0
  v_mov_b64 v[66:67], 0
  v_mov_b64 v[68:69], 0
  v_mov_b64 v[70:71], 0
  s_waitcnt vmcnt(0)
  s_barrier
  s_branch RF3_go2
RF3_f0:
  buffer_load_dwordx4 v[12:15], v0, s[4:7], s47 offen offset:0 sc1
  s_sub_u32 s54, s54, 1
  s_cbranch_scc1 K_end
  s_nop 3
  v_mov_b64 v[24:25], 0
  v_mov_b64 v[26:27], 0
  v_mov_b64 v[28:29], 0
  v_mov_b64 v[30:31], 0
  buffer_load_dwordx4 v[16:19], v0, s[4:7], s47 offen offset:1024 sc1
  buffer_load_dwordx4 v[20:23], v0, s[4:7], s47 offen offset:2048 sc1
  buffer_load_dwordx4 v[56:59], v0, s[4:7], s47 offen offset:3072 sc1
  buffer_load_dword v10, s[4:7], s47 offen lds
  s_waitcnt vmcnt(4) lgkmcnt(0)
  s_branch RF3_go2
RF3_c1:
  buffer_load_dwordx4 v[16:19], v0, s[4:7], s47 offen offset:1024 sc1
  s_sub_u32 s54, s54, 1
  s_cbranch_scc1 K_end
  buffer_load_dwordx4 v[20:23], v0, s[4:7], s47 offen offset:2048 sc1
  buffer_load_dwordx4 v[56:59], v0, s[4:7], s47 offen offset:3072 sc1
  buffer_load_dword v10, s[4:7], s47 offen lds
  s_waitcnt vmcnt(3)
  v_max3_u32 v9, v19, v19, v19
  v_cmp_eq_u32 vcc, -1, v9
  s_cbranch_vccnz RF3_c1
  s_branch RF3_g1
RF3_c2:
  buffer_load_dwordx4 v[20:23], v0, s[4:7], s47 offen offset:2048 sc1
  s_sub_u32 s54, s54, 1
  s_cbranch_scc1 K_end
  buffer_load_dwordx4 v[56:59], v0, s[4:7], s47 offen offset:3072 sc1
  buffer_load_dword v10, s[4:7], s47 offen lds
  buffer_load_dwordx4 v[60:63], v0, s[4:7], s16 offen offset:0 sc1
  buffer_load_dwordx4 v[12:15], v0, s[4:7], s16 offen offset:1024 sc1
  s_waitcnt vmcnt(4)
  v_max3_u32 v9, v23, v23, v23
  v_cmp_eq_u32 vcc, -1, v9
  s_cbranch_vccnz RF3_c2
  s_branch RF3_g2
RF3_c3:
  buffer_load_dwordx4 v[56:59], v0, s[4:7], s47 offen offset:3072 sc1
  s_sub_u32 s54, s54, 1
  s_cbranch_scc1 K_end
  buffer_load_dword v10, s[4:7], s47 offen lds
  buffer_load_dwordx4 v[60:63], v0, s[4:7], s16 offen offset:0 sc1
  buffer_load_dwordx4 v[12:15], v0, s[4:7], s16 offen offset:1024 sc1
  buffer_load_dword v10, s[4:7], s47 offen lds
  buffer_load_dwordx4 v[16:19], v0, s[4:7], s16 offen offset:2048 sc1
  buffer_load_dwordx4 v[4:7], v0, s[4:7], s17 offen offset:0 sc1
  s_waitcnt vmcnt(6)
  v_max3_u32 v9, v59, v59, v59
  v_cmp_eq_u32 vcc, -1, v9
  s_cbranch_vccnz RF3_c3
  s_branch RF3_g3
RF3_c45:
  buffer_load_dwordx4 v[60:63], v0, s[4:7], s16 offen offset:0 sc1
  buffer_load_dwordx4 v[12:15], v0, s[4:7], s16 offen offset:1024 sc1
  s_sub_u32 s54, s54, 1
  s_cbranch_scc1 K_end
  buffer_load_dword v10, s[4:7], s47 offen lds
  buffer_load_dwordx4 v[16:19], v0, s[4:7], s16 offen offset:2048 sc1
  buffer_load_dwordx4 v[4:7], v0, s[4:7], s17 offen offset:0 sc1
  buffer_load_dwordx4 v[20:23], v0, s[4:7], s16 offen offset:3072 sc1
  buffer_load_dword v10, s[4:7], s47 offen lds
  s_waitcnt vmcnt(5)
  v_max3_u32 v9, v63, v15, v63
  v_cmp_eq_u32 vcc, -1, v9
  s_cbranch_vccnz RF3_c45
  s_branch RF3_g45
RF3_c678:
  buffer_load_dwordx4 v[16:19], v0, s[4:7], s16 offen offset:2048 sc1
  buffer_load_dwordx4 v[4:7], v0, s[4:7], s17 offen offset:0 sc1
  buffer_load_dwordx4 v[20:23], v0, s[4:7], s16 offen offset:3072 sc1
  s_sub_u32 s54, s54, 1
  s_cbranch_scc1 K_end
  buffer_load_dword v10, s[4:7], s47 offen lds
  buffer_load_dword v10, s[4:7], s47 offen lds
  buffer_load_dword v10, s[4:7], s47 offen lds
  s_waitcnt vmcnt(3)
  v_max3_u32 v9, v19, v23, v7
  v_cmp_eq_u32 vcc, -1, v9
  s_cbranch_vccnz RF3_c678
  s_branch RF3_g678
RF3_fn:
  s_cmp_eq_u32 s20, s46
  s_cbranch_scc1 RF3_gn
  s_mov_b32 s20, s46
  s_waitcnt vmcnt(0) lgkmcnt(0)
  s_nop 7
RF3_fl:
  buffer_load_dwordx4 v[12:15], v0, s[4:7], s47 offen offset:0 sc1
  buffer_load_dwordx4 v[16:19], v0, s[4:7], s47 offen offset:1024 sc1
  buffer_load_dwordx4 v[20:23], v0, s[4:7], s47 offen offset:2048 sc1
  buffer_load_dwordx4 v[24:27], v0, s[4:7], s47 offen offset:3072 sc1
  buffer_load_dwordx4 v[28:31], v0, s[4:7], s16 offen offset:0 sc1
  buffer_load_dwordx4 v[32:35], v0, s[4:7], s16 offen offset:1024 sc1
  buffer_load_dwordx4 v[36:39], v0, s[4:7], s16 offen offset:2048 sc1
  buffer_load_dwordx4 v[40:43], v0, s[4:7], s16 offen offset:3072 sc1
  buffer_load_dwordx4 v[44:47], v0, s[4:7], s17 offen offset:0 sc1
  s_sub_u32 s54, s54, 1
  s_cbranch_scc1 K_end
  s_waitcnt vmcnt(8)
  v_max_u32 v9, v12, v13
  v_max3_u32 v9, v9, v14, v15
  s_waitcnt vmcnt(7)
  v_max3_u32 v9, v9, v16, v17
  v_max3_u32 v9, v9, v18, v19
  s_waitcnt vmcnt(6)
  v_max3_u32 v9, v9, v20, v21
  v_max3_u32 v9, v9, v22, v23
  s_waitcnt vmcnt(5)
  v_max3_u32 v9, v9, v24, v25
  v_max3_u32 v9, v9, v26, v27
  s_waitcnt vmcnt(4)
  v_max3_u32 v9, v9, v28, v29
  v_max3_u32 v9, v9, v30, v31
  s_waitcnt vmcnt(3)
  v_max3_u32 v9, v9, v32, v33
  v_max3_u32 v9, v9, v34, v35
  s_waitcnt vmcnt(2)
  v_max3_u32 v9, v9, v36, v37
  v_max3_u32 v9, v9, v38, v39
  s_waitcnt vmcnt(1)
  v_max3_u32 v9, v9, v40, v41
  v_max3_u32 v9, v9, v42, v43
  s_waitcnt vmcnt(0)
  v_max3_u32 v9, v9, v44, v45
  v_max3_u32 v9, v9, v46, v47
  v_cmp_eq_u32 vcc, -1, v9
  s_cbranch_vccnz RF3_fl
  s_barrier
  buffer_inv sc1
  s_waitcnt vmcnt(0)
  s_barrier
  s_branch RF3_in2
RF3_frq:
RF3_lrq:
  buffer_load_dwordx4 v[56:59], v0, s[4:7], s51 offen offset:0 sc1
  buffer_load_dwordx4 v[60:63], v0, s[4:7], s51 offen offset:1024 sc1
  s_sub_u32 s54, s54, 1
  s_cbranch_scc1 K_end
  s_waitcnt vmcnt(0)
  v_bitop3_b32 v9, v56, v57, s19 bitop3:0x7e
  v_bitop3_b32 v11, v58, v59, s19 bitop3:0x7e
  v_mfma_f32_16x16x32_bf16 v[40:43], v[64:67], v[56:59], 0
  v_bitop3_b32 v44, v60, v61, s19 bitop3:0x7e
  v_bitop3_b32 v45, v62, v63, s19 bitop3:0x7e
  v_mfma_f32_16x16x32_bf16 v[40:43], v[64:67], v[60:63], v[40:43]
  v_or3_b32 v9, v9, v11, v44
  v_bitop3_b32 v9, v9, v45, 1 bitop3:0xa8
  v_cmp_ne_u32 vcc, 0, v9
  s_nop 4
  v_add_f32_dpp v40, v40, v40 row_ror:8 row_mask:0xf bank_mask:0xf
  v_add_f32_dpp v41, v41, v41 row_ror:8 row_mask:0xf bank_mask:0xf
  s_cbranch_vccz RF3_rq
  s_branch RF3_lrq
RF3_flg:
  s_load_dword s60, s[42:43], s59 glc
  s_sub_u32 s54, s54, 1
  s_cbranch_scc1 K_end
  s_waitcnt lgkmcnt(0)
  s_branch RF3_fc
K_again:
  s_waitcnt vmcnt(0)
  s_barrier
  s_mov_b32 s75, 1
  v_mbcnt_lo_u32_b32 v0, -1, 0
  v_mbcnt_hi_u32_b32 v0, -1, v0
  s_lshl_b32 s28, s44, 6
  v_add_u32 v0, s28, v0
  s_and_b32 s3, s2, 7
  s_branch K_go
W_start:
  v_and_b32 v2, 63, v0
  v_lshlrev_b32 v1, 4, v2
  v_and_b32 v3, 15, v2
  v_lshrrev_b32 v4, 4, v2
  v_mov_b32 v12, -1
  v_mov_b32 v13, -1
  v_mov_b32 v14, -1
  v_mov_b32 v15, -1
  v_lshlrev_b32 v8, 4, v0
  v_mov_b32 v9, 1073741824
  v_cmp_eq_u32 vcc, 0, v0
  s_nop 1
  v_cndmask_b32 v9, v9, 0, vcc
  v_mov_b32 v10, 0
  s_cmp_eq_u32 s3, 1
  s_cbranch_scc1 Q_start
  s_sub_u32 s46, s3, 3
  s_cmp_lt_u32 s46, 2
  s_cbranch_scc1 A_start
  s_cmp_eq_u32 s3, 2
  s_cbranch_scc0 F_start
  s_sub_u32 s47, s3, 4
  s_max_i32 s47, s47, 0
  s_lshl_b32 s48, s45, 2
  s_add_u32 s47, s47, s48
  s_lshl_b32 s47, s47, 12
  s_mul_i32 s46, s45, 73728
  s_add_u32 s46, s46, 12582912
  buffer_store_dwordx4 v[12:15], v8, s[4:7], s46 offen sc1
  s_add_u32 s46, s46, 4096
  buffer_store_dwordx4 v[12:15], v8, s[4:7], s46 offen sc1
  s_add_u32 s46, s46, 4096
  buffer_store_dwordx4 v[12:15], v8, s[4:7], s46 offen sc1
  s_add_u32 s46, s46, 4096
  buffer_store_dwordx4 v[12:15], v8, s[4:7], s46 offen sc1
  s_add_u32 s46, s46, 4096
  buffer_store_dwordx4 v[12:15], v8, s[4:7], s46 offen sc1
  s_add_u32 s46, s46, 4096
  buffer_store_dwordx4 v[12:15], v8, s[4:7], s46 offen sc1
  s_add_u32 s46, s46, 4096
  buffer_store_dwordx4 v[12:15], v8, s[4:7], s46 offen sc1
  s_add_u32 s46, s46, 4096
  buffer_store_dwordx4 v[12:15], v8, s[4:7], s46 offen sc1
  s_add_u32 s46, s46, 4096
  buffer_store_dwordx4 v[12:15], v8, s[4:7], s46 offen sc1
  s_add_u32 s46, s46, 4096
  buffer_store_dwordx4 v[12:15], v8, s[4:7], s46 offen sc1
  s_add_u32 s46, s46, 4096
  buffer_store_dwordx4 v[12:15], v8, s[4:7], s46 offen sc1
  s_add_u32 s46, s46, 4096
  buffer_store_dwordx4 v[12:15], v8, s[4:7], s46 offen sc1
  s_add_u32 s46, s46, 4096
  buffer_store_dwordx4 v[12:15], v8, s[4:7], s46 offen sc1
  s_add_u32 s46, s46, 4096
  buffer_store_dwordx4 v[12:15], v8, s[4:7], s46 offen sc1
  s_add_u32 s46, s46, 4096
  buffer_store_dwordx4 v[12:15], v8, s[4:7], s46 offen sc1
  s_add_u32 s46, s46, 4096
  buffer_store_dwordx4 v[12:15], v8, s[4:7], s46 offen sc1
  s_add_u32 s46, s46, 4096
  buffer_store_dwordx4 v[12:15], v8, s[4:7], s46 offen sc1
  s_add_u32 s46, s46, 4096
  buffer_store_dwordx4 v[12:15], v8, s[4:7], s46 offen sc1
  s_add_u32 s46, s46, 4096
  buffer_store_dword v10, v9, s[4:7], 0 offen offset:2048 sc1
  s_lshl_b32 s46, s45, 15
  s_add_u32 s46, s46, 100712448
  s_add_u32 s47, s46, 0
  buffer_store_dwordx4 v[12:15], v8, s[4:7], s47 offen sc1
  s_add_u32 s47, s46, 4096
  buffer_store_dwordx4 v[12:15], v8, s[4:7], s47 offen sc1
  s_add_u32 s47, s46, 8192
  buffer_store_dwordx4 v[12:15], v8, s[4:7], s47 offen sc1
  s_add_u32 s47, s46, 16384
  buffer_store_dwordx4 v[12:15], v8, s[4:7], s47 offen sc1
  s_add_u32 s47, s46, 20480
  buffer_store_dwordx4 v[12:15], v8, s[4:7], s47 offen sc1
  s_add_u32 s47, s46, 24576
  buffer_store_dwordx4 v[12:15], v8, s[4:7], s47 offen sc1
  buffer_store_dword v10, v9, s[4:7], 0 offen offset:2304 sc1
  buffer_store_dword v10, v9, s[4:7], 0 offen offset:2432 sc1
  v_and_b32 v12, 63, v0
  v_and_b32 v13, 15, v12
  v_lshrrev_b32 v14, 4, v12
  v_lshlrev_b32 v0, 4, v12
  v_mov_b32 v10, 0
  s_mul_i32 s55, s44, 34816
  s_add_u32 s55, s55, 24576
  v_add_u32 v1, s55, v0
  v_and_b32 v15, 1, v14
  v_lshrrev_b32 v16, 1, v14
  v_and_b32 v17, 3, v13
  v_lshrrev_b32 v18, 2, v13
  v_mul_u32_u24 v3, 144, v18
  v_lshl_add_u32 v3, v14, 5, v3
  v_lshl_add_u32 v3, v17, 2, v3
  s_mul_i32 s55, s44, 1152
  s_add_u32 s55, s55, 18432
  v_add_u32 v3, s55, v3
  v_and_b32 v4, 0xf0, v0
  v_mul_u32_u24 v2, 144, v14
  v_lshl_add_u32 v2, v18, 5, v2
  v_and_b32 v19, 1, v13
  v_lshl_add_u32 v2, v19, 4, v2
  v_lshrrev_b32 v19, 3, v12
  v_mul_u32_u24 v5, 2176, v19
  v_and_b32 v19, 7, v12
  v_lshl_add_u32 v5, v19, 3, v5
  v_mul_u32_u24 v7, 2176, v14
  v_lshl_add_u32 v7, v13, 2, v7
  v_mov_b32 v21, 0x88884444
  v_mov_b32 v22, 0xDDDDEEEE
  v_and_b32 v19, 2, v13
  v_cmp_eq_u32 vcc, 0, v19
  s_nop 1
  v_cndmask_b32 v8, v22, v21, vcc
  v_lshlrev_b32 v19, 4, v14
  v_lshl_add_u32 v19, v13, 2, v19
  v_mul_u32_u24 v20, 1152, v15
  v_lshl_add_u32 v20, v13, 3, v20
  v_lshl_add_u32 v20, v16, 2, v20
  v_mov_b32 v21, 1073741824
  v_cmp_gt_u32 vcc, 4, v13
  s_nop 1
  v_cndmask_b32 v28, v21, v19, vcc
  v_cndmask_b32 v20, v21, v20, vcc
  v_add_u32 v19, 32752, v19
  v_cmp_eq_u32 vcc, 1, v18
  s_nop 1
  v_cndmask_b32 v6, v28, v19, vcc
  s_lshr_b32 s55, s45, 3
  s_lshl_b32 s55, s55, 1
  s_and_b32 s56, s45, 1
  s_add_u32 s55, s55, s56
  s_lshl_b32 s56, s44, 3
  s_add_u32 s55, s55, s56
  s_bfe_u32 s56, s45, 0x20001
  s_lshl_b32 s48, s55, 8
  s_lshl_b32 s57, s56, 6
  s_add_u32 s48, s48, s57
  s_mul_i32 s56, s56, 2304
  s_lshl_b32 s55, s55, 5
  s_add_u32 s64, s55, s56
  s_lshl_b32 s49, s45, 6
  s_add_u32 s49, s49, 8192
  s_and_b32 s56, s45, 3
  s_mul_i32 s56, s56, 2304
  s_lshr_b32 s55, s45, 2
  s_lshl_b32 s55, s55, 5
  s_add_u32 s55, s55, s56
  s_add_u32 s65, s55, 1024
  s_add_u32 s55, s45, 128
  s_mul_i32 s51, s55, 2176
  s_add_u32 s51, s51, 15728640
  s_cmp_eq_u32 s44, 3
  s_cselect_b32 s55, 16, 0
  s_cmp_lt_u32 s45, s55
  s_cselect_b32 s49, s49, 1073741824
  s_cselect_b32 s51, s51, 1073741824
  s_lshl_b32 s55, s44, 5
  s_add_u32 s55, s55, s45
  s_mul_i32 s50, s55, 2176
  s_add_u32 s50, s50, 15728640
  s_lshl_b32 s56, s45, 6
  s_add_u32 s56, s56, 15728640
  s_mul_i32 s55, s44, 17408
  s_add_u32 s68, s55, s56
  s_add_u32 s69, s68, 69632
  s_add_u32 s70, s68, 139264
  s_add_u32 s71, s68, 208896
  s_mul_i32 s55, s44, 8704
  s_add_u32 s55, s55, s56
  s_add_u32 s72, s55, 278528
  s_mov_b32 s8, s18
  s_mov_b32 s9, s19
  s_mov_b32 s10, 9216
  s_mov_b32 s11, 0x20000
  buffer_load_dword v22, v20, s[8:11], s64 offen
  buffer_load_dword v23, v20, s[8:11], s65 offen
  v_mov_b32 v24, 0
  v_mov_b32 v25, 0
  v_mov_b32 v26, 0
  v_mov_b32 v27, 0
  v_mov_b32 v29, -1
  buffer_store_dwordx4 v[24:27], v0, s[4:7], s50 offen offset:0 sc1
  buffer_store_dwordx4 v[24:27], v0, s[4:7], s50 offen offset:1024 sc1
  buffer_store_dwordx4 v[24:27], v0, s[4:7], s51 offen offset:0 sc1
  buffer_store_dwordx4 v[24:27], v0, s[4:7], s51 offen offset:1024 sc1
  s_add_u32 s55, s48, 100679680
  buffer_store_dword v29, v28, s[4:7], s55 offen sc1
  s_add_u32 s55, s49, 100679680
  buffer_store_dword v29, v28, s[4:7], s55 offen sc1
  s_add_u32 s55, s48, 100696064
  buffer_store_dword v29, v28, s[4:7], s55 offen sc1
  s_add_u32 s55, s49, 100696064
  buffer_store_dword v29, v28, s[4:7], s55 offen sc1
  s_add_u32 s55, s48, 100663296
  s_waitcnt vmcnt(9)
  buffer_store_dword v22, v28, s[4:7], s55 offen sc1
  s_add_u32 s55, s49, 100663296
  s_waitcnt vmcnt(9)
  buffer_store_dword v23, v28, s[4:7], s55 offen sc1
  s_waitcnt vmcnt(0)
  s_barrier
  s_cmp_eq_u32 s44, 0
  s_cbranch_scc0 arr_136
  s_getreg_b32 s28, hwreg(HW_REG_XCC_ID, 0, 3)
  s_cmp_eq_u32 s75, 0
  s_cselect_b32 s28, s28, s2
  s_lshl_b32 s28, s28, 2
  s_lshl_b32 s28, 1, s28
  s_lshr_b32 s29, s2, 3
  s_lshl_b32 s29, s29, 2
  v_mov_b32 v24, s28
  s_lshl_b32 s28, s75, 7
  s_add_u32 s29, s29, s28
  v_mov_b32 v25, s29
  s_mov_b64 exec, 1
  global_atomic_add v25, v24, s[40:41] sc1
  s_mov_b64 exec, -1
arr_136:
  s_mov_b32 s50, 0x40000
  s_mov_b32 s46, 0x11111111
  s_cmp_eq_u32 s44, 0
  s_cbranch_scc0 gb_137_w
  s_branch gb_137_l
gb_137:
  s_sleep 64
gb_137_l:
  v_mbcnt_lo_u32_b32 v12, -1, 0
  v_and_b32 v12, 31, v12
  v_lshlrev_b32 v12, 2, v12
  v_lshl_add_u32 v12, s75, 7, v12
  global_load_dword v13, v12, s[40:41] sc1
  s_sub_u32 s50, s50, 1
  s_cbranch_scc1 K_end
  s_waitcnt vmcnt(0)
gb_137_c:
  v_mul_lo_u32 v14, v13, s46
  v_cmp_le_i32 vcc, 0, v14
  s_cbranch_vccnz gb_137
  v_cmp_ne_u32 vcc, s46, v13
  s_cmp_lg_u64 vcc, 0
  s_cselect_b32 s46, 1, 0
  v_mov_b32 v12, 163836
  v_mov_b32 v13, s46
  ds_write_b32 v12, v13
  s_waitcnt lgkmcnt(0)
gb_137_w:
  s_barrier
  v_mov_b32 v12, 163836
  ds_read_b32 v13, v12
  s_waitcnt lgkmcnt(0)
  v_readfirstlane_b32 s46, v13
  s_cmp_gt_u32 s46, s75
  s_cbranch_scc1 K_again
  v_mbcnt_lo_u32_b32 v0, -1, 0
  v_mbcnt_hi_u32_b32 v0, -1, v0
  s_lshl_b32 s28, s44, 6
  v_add_u32 v0, s28, v0
  v_and_b32 v2, 63, v0
  v_lshlrev_b32 v1, 4, v2
  v_and_b32 v3, 15, v2
  v_lshrrev_b32 v4, 4, v2
  v_mov_b32 v12, -1
  v_mov_b32 v13, -1
  v_mov_b32 v14, -1
  v_mov_b32 v15, -1
  v_lshlrev_b32 v8, 4, v0
  v_mov_b32 v9, 1073741824
  v_cmp_eq_u32 vcc, 0, v0
  s_nop 1
  v_cndmask_b32 v9, v9, 0, vcc
  v_mov_b32 v10, 0
  s_mov_b32 s50, 0x1000
  s_cmp_eq_u32 s44, 0
  s_cbranch_scc0 Y_go
  s_branch Y_l
Y_w:
  s_sleep 127
Y_l:
  buffer_load_dword v32, off, s[4:7], 0 offset:2048 sc1
  s_sub_u32 s50, s50, 1
  s_cbranch_scc1 K_end
  s_waitcnt vmcnt(0)
  v_readfirstlane_b32 s46, v32
  s_cmp_lt_u32 s46, 16
  s_cbranch_scc1 Y_w
Y_go:
  s_barrier
  s_lshl_b32 s46, 8, 22
  s_lshl_b32 s47, s75, 27
  s_add_u32 s74, s46, s47
  s_add_u32 s74, s74, 4194304
  s_mul_i32 s46, s45, 37120
  s_add_u32 s46, s46, s74
  s_add_u32 s47, s46, 0
  buffer_store_dwordx4 v[12:15], v8, s[4:7], s47 offen sc1
  s_add_u32 s47, s46, 4096
  buffer_store_dwordx4 v[12:15], v8, s[4:7], s47 offen sc1
  s_add_u32 s47, s46, 8192
  buffer_store_dwordx4 v[12:15], v8, s[4:7], s47 offen sc1
  s_add_u32 s47, s46, 12288
  buffer_store_dwordx4 v[12:15], v8, s[4:7], s47 offen sc1
  s_add_u32 s47, s46, 16384
  buffer_store_dwordx4 v[12:15], v8, s[4:7], s47 offen sc1
  s_add_u32 s47, s46, 20480
  buffer_store_dwordx4 v[12:15], v8, s[4:7], s47 offen sc1
  s_add_u32 s47, s46, 24576
  buffer_store_dwordx4 v[12:15], v8, s[4:7], s47 offen sc1
  s_add_u32 s47, s46, 28672
  buffer_store_dwordx4 v[12:15], v8, s[4:7], s47 offen sc1
  s_add_u32 s47, s46, 32768
  buffer_store_dwordx4 v[12:15], v8, s[4:7], s47 offen sc1
  s_add_u32 s47, s46, 2097152
  buffer_store_dwordx4 v[12:15], v8, s[4:7], s47 offen sc1
  s_add_u32 s47, s46, 2101248
  buffer_store_dwordx4 v[12:15], v8, s[4:7], s47 offen sc1
  s_add_u32 s47, s46, 2105344
  buffer_store_dwordx4 v[12:15], v8, s[4:7], s47 offen sc1
  s_add_u32 s47, s46, 2109440
  buffer_store_dwordx4 v[12:15], v8, s[4:7], s47 offen sc1
  s_add_u32 s47, s46, 2113536
  buffer_store_dwordx4 v[12:15], v8, s[4:7], s47 offen sc1
  s_add_u32 s47, s46, 2117632
  buffer_store_dwordx4 v[12:15], v8, s[4:7], s47 offen sc1
  s_add_u32 s47, s46, 2121728
  buffer_store_dwordx4 v[12:15], v8, s[4:7], s47 offen sc1
  s_add_u32 s47, s46, 2125824
  buffer_store_dwordx4 v[12:15], v8, s[4:7], s47 offen sc1
  s_add_u32 s47, s46, 2129920
  buffer_store_dwordx4 v[12:15], v8, s[4:7], s47 offen sc1
rf_138:
  v_mov_b32 v10, 1
  s_waitcnt vmcnt(0)
  s_barrier
  buffer_atomic_add v10, v9, s[4:7], 0 offen offset:2304 sc1
  s_mov_b32 s3, 1
  s_branch K_end
  s_mov_b32 s50, 0x1000
  s_cmp_eq_u32 s44, 0
  s_cbranch_scc0 Z_go
  s_branch Z_l
Z_w:
  s_sleep 127
Z_l:
  buffer_load_dword v32, off, s[4:7], 0 offset:2048 sc1
  s_sub_u32 s50, s50, 1
  s_cbranch_scc1 K_end
  s_waitcnt vmcnt(0)
  v_readfirstlane_b32 s46, v32
  s_cmp_lt_u32 s46, 40
  s_cbranch_scc1 Z_w
Z_go:
  s_barrier
  s_mov_b32 s50, 0x1000
  s_cmp_eq_u32 s44, 0
  s_cbranch_scc0 X_go
  s_branch X_l
X_w:
  s_sleep 16
X_l:
  buffer_load_dword v32, off, s[4:7], 0 offset:2304 sc1
  s_sub_u32 s50, s50, 1
  s_cbranch_scc1 K_end
  s_waitcnt vmcnt(0)
  v_readfirstlane_b32 s46, v32
  s_cmp_lt_u32 s46, 32
  s_cbranch_scc1 X_w
X_go:
  s_barrier
  s_mov_b32 s3, 1
  s_branch F_ld
Q_start:
  s_lshl_b32 s56, s45, 6
  buffer_store_dword v10, v9, s[4:7], s56 offen sc1
  s_cmp_ge_u32 s44, 2
  s_cselect_b32 s8, s24, s22
  s_cselect_b32 s9, s25, s23
  s_lshl_b32 s46, s45, 1
  s_and_b32 s47, s44, 1
  s_add_u32 s53, s46, s47
  s_mov_b32 s10, 4718592
  s_mov_b32 s11, 0x20000
  v_lshrrev_b32 v5, 3, v2
  v_lshlrev_b32 v5, 13, v5
  v_and_b32 v6, 7, v2
  v_lshl_add_u32 v5, v6, 4, v5
  s_lshl_b32 s52, s53, 7
  s_mul_i32 s55, s44, 36864
  v_and_b32 v6, 3, v3
  v_lshlrev_b32 v6, 3, v6
  v_and_b32 v7, 1, v4
  v_lshl_add_u32 v6, v7, 5, v6
  v_lshrrev_b32 v7, 1, v4
  v_lshrrev_b32 v8, 2, v3
  v_lshl_add_u32 v7, v7, 3, v8
  v_lshl_add_u32 v6, v7, 7, v6
  v_add_u32 v6, s55, v6
  s_add_u32 m0, s55, 0
  s_nop 0
  buffer_load_dwordx4 v5, s[8:11], s52 offen lds
  s_add_u32 s52, s52, 65536
  s_add_u32 m0, s55, 1024
  s_nop 0
  buffer_load_dwordx4 v5, s[8:11], s52 offen lds
  s_add_u32 s52, s52, 65536
  s_add_u32 m0, s55, 2048
  s_nop 0
  buffer_load_dwordx4 v5, s[8:11], s52 offen lds
  s_add_u32 s52, s52, 65536
  s_add_u32 m0, s55, 3072
  s_nop 0
  buffer_load_dwordx4 v5, s[8:11], s52 offen lds
  s_add_u32 s52, s52, 65536
  s_add_u32 m0, s55, 4096
  s_nop 0
  buffer_load_dwordx4 v5, s[8:11], s52 offen lds
  s_add_u32 s52, s52, 65536
  s_add_u32 m0, s55, 5120
  s_nop 0
  buffer_load_dwordx4 v5, s[8:11], s52 offen lds
  s_add_u32 s52, s52, 65536
  s_add_u32 m0, s55, 6144
  s_nop 0
  buffer_load_dwordx4 v5, s[8:11], s52 offen lds
  s_add_u32 s52, s52, 65536
  s_add_u32 m0, s55, 7168
  s_nop 0
  buffer_load_dwordx4 v5, s[8:11], s52 offen lds
  s_add_u32 s52, s52, 65536
  s_waitcnt vmcnt(8)
  s_barrier
  s_cmp_eq_u32 s44, 0
  s_cbranch_scc0 arr_143
  s_getreg_b32 s28, hwreg(HW_REG_XCC_ID, 0, 3)
  s_cmp_eq_u32 s75, 0
  s_cselect_b32 s28, s28, s2
  s_lshl_b32 s28, s28, 2
  s_lshl_b32 s28, 1, s28
  s_lshr_b32 s29, s2, 3
  s_lshl_b32 s29, s29, 2
  v_mov_b32 v16, s28
  s_lshl_b32 s28, s75, 7
  s_add_u32 s29, s29, s28
  v_mov_b32 v17, s29
  s_mov_b64 exec, 1
  global_atomic_add v17, v16, s[40:41] sc1
  s_mov_b64 exec, -1
arr_143:
  s_add_u32 m0, s55, 8192
  s_nop 0
  buffer_load_dwordx4 v5, s[8:11], s52 offen lds
  s_add_u32 s52, s52, 65536
  s_add_u32 m0, s55, 9216
  s_nop 0
  buffer_load_dwordx4 v5, s[8:11], s52 offen lds
  s_add_u32 s52, s52, 65536
  s_add_u32 m0, s55, 10240
  s_nop 0
  buffer_load_dwordx4 v5, s[8:11], s52 offen lds
  s_add_u32 s52, s52, 65536
  s_add_u32 m0, s55, 11264
  s_nop 0
  buffer_load_dwordx4 v5, s[8:11], s52 offen lds
  s_add_u32 s52, s52, 65536
  s_add_u32 m0, s55, 12288
  s_nop 0
  buffer_load_dwordx4 v5, s[8:11], s52 offen lds
  s_add_u32 s52, s52, 65536
  s_add_u32 m0, s55, 13312
  s_nop 0
  buffer_load_dwordx4 v5, s[8:11], s52 offen lds
  s_add_u32 s52, s52, 65536
  s_add_u32 m0, s55, 14336
  s_nop 0
  buffer_load_dwordx4 v5, s[8:11], s52 offen lds
  s_add_u32 s52, s52, 65536
  s_add_u32 m0, s55, 15360
  s_nop 0
  buffer_load_dwordx4 v5, s[8:11], s52 offen lds
  s_add_u32 s52, s52, 65536
  s_add_u32 m0, s55, 16384
  s_nop 0
  buffer_load_dwordx4 v5, s[8:11], s52 offen lds
  s_add_u32 s52, s52, 65536
  s_add_u32 m0, s55, 17408
  s_nop 0
  buffer_load_dwordx4 v5, s[8:11], s52 offen lds
  s_add_u32 s52, s52, 65536
  s_add_u32 m0, s55, 18432
  s_nop 0
  buffer_load_dwordx4 v5, s[8:11], s52 offen lds
  s_add_u32 s52, s52, 65536
  s_add_u32 m0, s55, 19456
  s_nop 0
  buffer_load_dwordx4 v5, s[8:11], s52 offen lds
  s_add_u32 s52, s52, 65536
  s_add_u32 m0, s55, 20480
  s_nop 0
  buffer_load_dwordx4 v5, s[8:11], s52 offen lds
  s_add_u32 s52, s52, 65536
  s_add_u32 m0, s55, 21504
  s_nop 0
  buffer_load_dwordx4 v5, s[8:11], s52 offen lds
  s_add_u32 s52, s52, 65536
  s_add_u32 m0, s55, 22528
  s_nop 0
  buffer_load_dwordx4 v5, s[8:11], s52 offen lds
  s_add_u32 s52, s52, 65536
  s_add_u32 m0, s55, 23552
  s_nop 0
  buffer_load_dwordx4 v5, s[8:11], s52 offen lds
  s_add_u32 s52, s52, 65536
  s_add_u32 m0, s55, 24576
  s_nop 0
  buffer_load_dwordx4 v5, s[8:11], s52 offen lds
  s_add_u32 s52, s52, 65536
  s_add_u32 m0, s55, 25600
  s_nop 0
  buffer_load_dwordx4 v5, s[8:11], s52 offen lds
  s_add_u32 s52, s52, 65536
  s_add_u32 m0, s55, 26624
  s_nop 0
  buffer_load_dwordx4 v5, s[8:11], s52 offen lds
  s_add_u32 s52, s52, 65536
  s_add_u32 m0, s55, 27648
  s_nop 0
  buffer_load_dwordx4 v5, s[8:11], s52 offen lds
  s_add_u32 s52, s52, 65536
  s_add_u32 m0, s55, 28672
  s_nop 0
  buffer_load_dwordx4 v5, s[8:11], s52 offen lds
  s_add_u32 s52, s52, 65536
  s_add_u32 m0, s55, 29696
  s_nop 0
  buffer_load_dwordx4 v5, s[8:11], s52 offen lds
  s_add_u32 s52, s52, 65536
  s_add_u32 m0, s55, 30720
  s_nop 0
  buffer_load_dwordx4 v5, s[8:11], s52 offen lds
  s_add_u32 s52, s52, 65536
  s_add_u32 m0, s55, 31744
  s_nop 0
  buffer_load_dwordx4 v5, s[8:11], s52 offen lds
  s_add_u32 s52, s52, 65536
  s_add_u32 m0, s55, 32768
  s_nop 0
  buffer_load_dwordx4 v5, s[8:11], s52 offen lds
  s_add_u32 s52, s52, 65536
  s_add_u32 m0, s55, 33792
  s_nop 0
  buffer_load_dwordx4 v5, s[8:11], s52 offen lds
  s_add_u32 s52, s52, 65536
  s_add_u32 m0, s55, 34816
  s_nop 0
  buffer_load_dwordx4 v5, s[8:11], s52 offen lds
  s_add_u32 s52, s52, 65536
  s_add_u32 m0, s55, 35840
  s_nop 0
  buffer_load_dwordx4 v5, s[8:11], s52 offen lds
  s_add_u32 s52, s52, 65536
  s_waitcnt vmcnt(34)
  ds_read_b64_tr_b16 a[0:1], v6 offset:0
  ds_read_b64_tr_b16 a[2:3], v6 offset:512
  ds_read_b64_tr_b16 a[4:5], v6 offset:64
  ds_read_b64_tr_b16 a[6:7], v6 offset:576
  s_waitcnt lgkmcnt(0)
  s_add_u32 m0, s55, 0
  s_nop 0
  buffer_load_dwordx4 v5, s[8:11], s52 offen lds
  s_add_u32 s52, s52, 65536
  s_add_u32 m0, s55, 1024
  s_nop 0
  buffer_load_dwordx4 v5, s[8:11], s52 offen lds
  s_add_u32 s52, s52, 65536
  s_waitcnt vmcnt(34)
  ds_read_b64_tr_b16 a[8:9], v6 offset:2048
  ds_read_b64_tr_b16 a[10:11], v6 offset:2560
  ds_read_b64_tr_b16 a[12:13], v6 offset:2112
  ds_read_b64_tr_b16 a[14:15], v6 offset:2624
  s_waitcnt lgkmcnt(0)
  s_add_u32 m0, s55, 2048
  s_nop 0
  buffer_load_dwordx4 v5, s[8:11], s52 offen lds
  s_add_u32 s52, s52, 65536
  s_add_u32 m0, s55, 3072
  s_nop 0
  buffer_load_dwordx4 v5, s[8:11], s52 offen lds
  s_add_u32 s52, s52, 65536
  s_waitcnt vmcnt(34)
  ds_read_b64_tr_b16 a[16:17], v6 offset:4096
  ds_read_b64_tr_b16 a[18:19], v6 offset:4608
  ds_read_b64_tr_b16 a[20:21], v6 offset:4160
  ds_read_b64_tr_b16 a[22:23], v6 offset:4672
  s_waitcnt lgkmcnt(0)
  s_add_u32 m0, s55, 4096
  s_nop 0
  buffer_load_dwordx4 v5, s[8:11], s52 offen lds
  s_add_u32 s52, s52, 65536
  s_add_u32 m0, s55, 5120
  s_nop 0
  buffer_load_dwordx4 v5, s[8:11], s52 offen lds
  s_add_u32 s52, s52, 65536
  s_waitcnt vmcnt(34)
  ds_read_b64_tr_b16 a[24:25], v6 offset:6144
  ds_read_b64_tr_b16 a[26:27], v6 offset:6656
  ds_read_b64_tr_b16 a[28:29], v6 offset:6208
  ds_read_b64_tr_b16 a[30:31], v6 offset:6720
  s_waitcnt lgkmcnt(0)
  s_add_u32 m0, s55, 6144
  s_nop 0
  buffer_load_dwordx4 v5, s[8:11], s52 offen lds
  s_add_u32 s52, s52, 65536
  s_add_u32 m0, s55, 7168
  s_nop 0
  buffer_load_dwordx4 v5, s[8:11], s52 offen lds
  s_add_u32 s52, s52, 65536
  s_waitcnt vmcnt(34)
  ds_read_b64_tr_b16 a[32:33], v6 offset:8192
  ds_read_b64_tr_b16 a[34:35], v6 offset:8704
  ds_read_b64_tr_b16 a[36:37], v6 offset:8256
  ds_read_b64_tr_b16 a[38:39], v6 offset:8768
  s_waitcnt lgkmcnt(0)
  s_add_u32 m0, s55, 8192
  s_nop 0
  buffer_load_dwordx4 v5, s[8:11], s52 offen lds
  s_add_u32 s52, s52, 65536
  s_add_u32 m0, s55, 9216
  s_nop 0
  buffer_load_dwordx4 v5, s[8:11], s52 offen lds
  s_add_u32 s52, s52, 65536
  s_waitcnt vmcnt(34)
  ds_read_b64_tr_b16 a[40:41], v6 offset:10240
  ds_read_b64_tr_b16 a[42:43], v6 offset:10752
  ds_read_b64_tr_b16 a[44:45], v6 offset:10304
  ds_read_b64_tr_b16 a[46:47], v6 offset:10816
  s_waitcnt lgkmcnt(0)
  s_add_u32 m0, s55, 10240
  s_nop 0
  buffer_load_dwordx4 v5, s[8:11], s52 offen lds
  s_add_u32 s52, s52, 65536
  s_add_u32 m0, s55, 11264
  s_nop 0
  buffer_load_dwordx4 v5, s[8:11], s52 offen lds
  s_add_u32 s52, s52, 65536
  s_waitcnt vmcnt(34)
  ds_read_b64_tr_b16 a[48:49], v6 offset:12288
  ds_read_b64_tr_b16 a[50:51], v6 offset:12800
  ds_read_b64_tr_b16 a[52:53], v6 offset:12352
  ds_read_b64_tr_b16 a[54:55], v6 offset:12864
  s_waitcnt lgkmcnt(0)
  s_add_u32 m0, s55, 12288
  s_nop 0
  buffer_load_dwordx4 v5, s[8:11], s52 offen lds
  s_add_u32 s52, s52, 65536
  s_add_u32 m0, s55, 13312
  s_nop 0
  buffer_load_dwordx4 v5, s[8:11], s52 offen lds
  s_add_u32 s52, s52, 65536
  s_waitcnt vmcnt(34)
  ds_read_b64_tr_b16 a[56:57], v6 offset:14336
  ds_read_b64_tr_b16 a[58:59], v6 offset:14848
  ds_read_b64_tr_b16 a[60:61], v6 offset:14400
  ds_read_b64_tr_b16 a[62:63], v6 offset:14912
  s_waitcnt lgkmcnt(0)
  s_add_u32 m0, s55, 14336
  s_nop 0
  buffer_load_dwordx4 v5, s[8:11], s52 offen lds
  s_add_u32 s52, s52, 65536
  s_add_u32 m0, s55, 15360
  s_nop 0
  buffer_load_dwordx4 v5, s[8:11], s52 offen lds
  s_add_u32 s52, s52, 65536
  s_waitcnt vmcnt(34)
  ds_read_b64_tr_b16 a[64:65], v6 offset:16384
  ds_read_b64_tr_b16 a[66:67], v6 offset:16896
  ds_read_b64_tr_b16 a[68:69], v6 offset:16448
  ds_read_b64_tr_b16 a[70:71], v6 offset:16960
  s_waitcnt lgkmcnt(0)
  s_add_u32 m0, s55, 16384
  s_nop 0
  buffer_load_dwordx4 v5, s[8:11], s52 offen lds
  s_add_u32 s52, s52, 65536
  s_add_u32 m0, s55, 17408
  s_nop 0
  buffer_load_dwordx4 v5, s[8:11], s52 offen lds
  s_add_u32 s52, s52, 65536
  s_waitcnt vmcnt(34)
  ds_read_b64_tr_b16 a[72:73], v6 offset:18432
  ds_read_b64_tr_b16 a[74:75], v6 offset:18944
  ds_read_b64_tr_b16 a[76:77], v6 offset:18496
  ds_read_b64_tr_b16 a[78:79], v6 offset:19008
  s_waitcnt lgkmcnt(0)
  s_add_u32 m0, s55, 18432
  s_nop 0
  buffer_load_dwordx4 v5, s[8:11], s52 offen lds
  s_add_u32 s52, s52, 65536
  s_add_u32 m0, s55, 19456
  s_nop 0
  buffer_load_dwordx4 v5, s[8:11], s52 offen lds
  s_add_u32 s52, s52, 65536
  s_waitcnt vmcnt(34)
  ds_read_b64_tr_b16 a[80:81], v6 offset:20480
  ds_read_b64_tr_b16 a[82:83], v6 offset:20992
  ds_read_b64_tr_b16 a[84:85], v6 offset:20544
  ds_read_b64_tr_b16 a[86:87], v6 offset:21056
  s_waitcnt lgkmcnt(0)
  s_add_u32 m0, s55, 20480
  s_nop 0
  buffer_load_dwordx4 v5, s[8:11], s52 offen lds
  s_add_u32 s52, s52, 65536
  s_add_u32 m0, s55, 21504
  s_nop 0
  buffer_load_dwordx4 v5, s[8:11], s52 offen lds
  s_add_u32 s52, s52, 65536
  s_waitcnt vmcnt(34)
  ds_read_b64_tr_b16 a[88:89], v6 offset:22528
  ds_read_b64_tr_b16 a[90:91], v6 offset:23040
  ds_read_b64_tr_b16 a[92:93], v6 offset:22592
  ds_read_b64_tr_b16 a[94:95], v6 offset:23104
  s_waitcnt lgkmcnt(0)
  s_add_u32 m0, s55, 22528
  s_nop 0
  buffer_load_dwordx4 v5, s[8:11], s52 offen lds
  s_add_u32 s52, s52, 65536
  s_add_u32 m0, s55, 23552
  s_nop 0
  buffer_load_dwordx4 v5, s[8:11], s52 offen lds
  s_add_u32 s52, s52, 65536
  s_waitcnt vmcnt(34)
  ds_read_b64_tr_b16 a[96:97], v6 offset:24576
  ds_read_b64_tr_b16 a[98:99], v6 offset:25088
  ds_read_b64_tr_b16 a[100:101], v6 offset:24640
  ds_read_b64_tr_b16 a[102:103], v6 offset:25152
  s_waitcnt lgkmcnt(0)
  s_add_u32 m0, s55, 24576
  s_nop 0
  buffer_load_dwordx4 v5, s[8:11], s52 offen lds
  s_add_u32 s52, s52, 65536
  s_add_u32 m0, s55, 25600
  s_nop 0
  buffer_load_dwordx4 v5, s[8:11], s52 offen lds
  s_add_u32 s52, s52, 65536
  s_waitcnt vmcnt(34)
  ds_read_b64_tr_b16 a[104:105], v6 offset:26624
  ds_read_b64_tr_b16 a[106:107], v6 offset:27136
  ds_read_b64_tr_b16 a[108:109], v6 offset:26688
  ds_read_b64_tr_b16 a[110:111], v6 offset:27200
  s_waitcnt lgkmcnt(0)
  s_add_u32 m0, s55, 26624
  s_nop 0
  buffer_load_dwordx4 v5, s[8:11], s52 offen lds
  s_add_u32 s52, s52, 65536
  s_add_u32 m0, s55, 27648
  s_nop 0
  buffer_load_dwordx4 v5, s[8:11], s52 offen lds
  s_add_u32 s52, s52, 65536
  s_waitcnt vmcnt(34)
  ds_read_b64_tr_b16 a[112:113], v6 offset:28672
  ds_read_b64_tr_b16 a[114:115], v6 offset:29184
  ds_read_b64_tr_b16 a[116:117], v6 offset:28736
  ds_read_b64_tr_b16 a[118:119], v6 offset:29248
  s_waitcnt lgkmcnt(0)
  s_add_u32 m0, s55, 28672
  s_nop 0
  buffer_load_dwordx4 v5, s[8:11], s52 offen lds
  s_add_u32 s52, s52, 65536
  s_add_u32 m0, s55, 29696
  s_nop 0
  buffer_load_dwordx4 v5, s[8:11], s52 offen lds
  s_add_u32 s52, s52, 65536
  s_waitcnt vmcnt(34)
  ds_read_b64_tr_b16 a[120:121], v6 offset:30720
  ds_read_b64_tr_b16 a[122:123], v6 offset:31232
  ds_read_b64_tr_b16 a[124:125], v6 offset:30784
  ds_read_b64_tr_b16 a[126:127], v6 offset:31296
  s_waitcnt lgkmcnt(0)
  s_add_u32 m0, s55, 30720
  s_nop 0
  buffer_load_dwordx4 v5, s[8:11], s52 offen lds
  s_add_u32 s52, s52, 65536
  s_add_u32 m0, s55, 31744
  s_nop 0
  buffer_load_dwordx4 v5, s[8:11], s52 offen lds
  s_add_u32 s52, s52, 65536
  s_waitcnt vmcnt(34)
  ds_read_b64_tr_b16 a[128:129], v6 offset:32768
  ds_read_b64_tr_b16 a[130:131], v6 offset:33280
  ds_read_b64_tr_b16 a[132:133], v6 offset:32832
  ds_read_b64_tr_b16 a[134:135], v6 offset:33344
  s_waitcnt lgkmcnt(0)
  s_add_u32 m0, s55, 32768
  s_nop 0
  buffer_load_dwordx4 v5, s[8:11], s52 offen lds
  s_add_u32 s52, s52, 65536
  s_add_u32 m0, s55, 33792
  s_nop 0
  buffer_load_dwordx4 v5, s[8:11], s52 offen lds
  s_add_u32 s52, s52, 65536
  s_waitcnt vmcnt(34)
  ds_read_b64_tr_b16 a[136:137], v6 offset:34816
  ds_read_b64_tr_b16 a[138:139], v6 offset:35328
  ds_read_b64_tr_b16 a[140:141], v6 offset:34880
  ds_read_b64_tr_b16 a[142:143], v6 offset:35392
  s_waitcnt lgkmcnt(0)
  s_add_u32 m0, s55, 34816
  s_nop 0
  buffer_load_dwordx4 v5, s[8:11], s52 offen lds
  s_add_u32 s52, s52, 65536
  s_add_u32 m0, s55, 35840
  s_nop 0
  buffer_load_dwordx4 v5, s[8:11], s52 offen lds
  s_add_u32 s52, s52, 65536
  s_waitcnt vmcnt(34)
  ds_read_b64_tr_b16 a[144:145], v6 offset:0
  ds_read_b64_tr_b16 a[146:147], v6 offset:512
  ds_read_b64_tr_b16 a[148:149], v6 offset:64
  ds_read_b64_tr_b16 a[150:151], v6 offset:576
  s_waitcnt vmcnt(32)
  ds_read_b64_tr_b16 a[152:153], v6 offset:2048
  ds_read_b64_tr_b16 a[154:155], v6 offset:2560
  ds_read_b64_tr_b16 a[156:157], v6 offset:2112
  ds_read_b64_tr_b16 a[158:159], v6 offset:2624
  s_waitcnt vmcnt(30)
  ds_read_b64_tr_b16 a[160:161], v6 offset:4096
  ds_read_b64_tr_b16 a[162:163], v6 offset:4608
  ds_read_b64_tr_b16 a[164:165], v6 offset:4160
  ds_read_b64_tr_b16 a[166:167], v6 offset:4672
  s_waitcnt vmcnt(28)
  ds_read_b64_tr_b16 a[168:169], v6 offset:6144
  ds_read_b64_tr_b16 a[170:171], v6 offset:6656
  ds_read_b64_tr_b16 a[172:173], v6 offset:6208
  ds_read_b64_tr_b16 a[174:175], v6 offset:6720
  s_waitcnt vmcnt(26)
  ds_read_b64_tr_b16 a[176:177], v6 offset:8192
  ds_read_b64_tr_b16 a[178:179], v6 offset:8704
  ds_read_b64_tr_b16 a[180:181], v6 offset:8256
  ds_read_b64_tr_b16 a[182:183], v6 offset:8768
  s_waitcnt vmcnt(24)
  ds_read_b64_tr_b16 a[184:185], v6 offset:10240
  ds_read_b64_tr_b16 a[186:187], v6 offset:10752
  ds_read_b64_tr_b16 a[188:189], v6 offset:10304
  ds_read_b64_tr_b16 a[190:191], v6 offset:10816
  s_waitcnt vmcnt(22)
  ds_read_b64_tr_b16 a[192:193], v6 offset:12288
  ds_read_b64_tr_b16 a[194:195], v6 offset:12800
  ds_read_b64_tr_b16 a[196:197], v6 offset:12352
  ds_read_b64_tr_b16 a[198:199], v6 offset:12864
  s_waitcnt vmcnt(20)
  ds_read_b64_tr_b16 a[200:201], v6 offset:14336
  ds_read_b64_tr_b16 a[202:203], v6 offset:14848
  ds_read_b64_tr_b16 a[204:205], v6 offset:14400
  ds_read_b64_tr_b16 a[206:207], v6 offset:14912
  s_waitcnt vmcnt(18)
  ds_read_b64_tr_b16 a[208:209], v6 offset:16384
  ds_read_b64_tr_b16 a[210:211], v6 offset:16896
  ds_read_b64_tr_b16 a[212:213], v6 offset:16448
  ds_read_b64_tr_b16 a[214:215], v6 offset:16960
  s_waitcnt vmcnt(16)
  ds_read_b64_tr_b16 a[216:217], v6 offset:18432
  ds_read_b64_tr_b16 a[218:219], v6 offset:18944
  ds_read_b64_tr_b16 a[220:221], v6 offset:18496
  ds_read_b64_tr_b16 a[222:223], v6 offset:19008
  s_waitcnt vmcnt(14)
  ds_read_b64_tr_b16 a[224:225], v6 offset:20480
  ds_read_b64_tr_b16 a[226:227], v6 offset:20992
  ds_read_b64_tr_b16 a[228:229], v6 offset:20544
  ds_read_b64_tr_b16 a[230:231], v6 offset:21056
  s_waitcnt vmcnt(12)
  ds_read_b64_tr_b16 a[232:233], v6 offset:22528
  ds_read_b64_tr_b16 a[234:235], v6 offset:23040
  ds_read_b64_tr_b16 a[236:237], v6 offset:22592
  ds_read_b64_tr_b16 a[238:239], v6 offset:23104
  s_waitcnt vmcnt(10)
  ds_read_b64_tr_b16 a[240:241], v6 offset:24576
  ds_read_b64_tr_b16 a[242:243], v6 offset:25088
  ds_read_b64_tr_b16 a[244:245], v6 offset:24640
  ds_read_b64_tr_b16 a[246:247], v6 offset:25152
  s_waitcnt vmcnt(8)
  ds_read_b64_tr_b16 a[248:249], v6 offset:26624
  ds_read_b64_tr_b16 a[250:251], v6 offset:27136
  ds_read_b64_tr_b16 a[252:253], v6 offset:26688
  ds_read_b64_tr_b16 a[254:255], v6 offset:27200
  s_waitcnt vmcnt(6)
  ds_read_b64_tr_b16 v[224:225], v6 offset:28672
  ds_read_b64_tr_b16 v[226:227], v6 offset:29184
  ds_read_b64_tr_b16 v[228:229], v6 offset:28736
  ds_read_b64_tr_b16 v[230:231], v6 offset:29248
  s_waitcnt vmcnt(4)
  ds_read_b64_tr_b16 v[232:233], v6 offset:30720
  ds_read_b64_tr_b16 v[234:235], v6 offset:31232
  ds_read_b64_tr_b16 v[236:237], v6 offset:30784
  ds_read_b64_tr_b16 v[238:239], v6 offset:31296
  s_waitcnt vmcnt(2)
  ds_read_b64_tr_b16 v[240:241], v6 offset:32768
  ds_read_b64_tr_b16 v[242:243], v6 offset:33280
  ds_read_b64_tr_b16 v[244:245], v6 offset:32832
  ds_read_b64_tr_b16 v[246:247], v6 offset:33344
  s_waitcnt vmcnt(0)
  ds_read_b64_tr_b16 v[248:249], v6 offset:34816
  ds_read_b64_tr_b16 v[250:251], v6 offset:35328
  ds_read_b64_tr_b16 v[252:253], v6 offset:34880
  ds_read_b64_tr_b16 v[254:255], v6 offset:35392
  s_waitcnt lgkmcnt(0)
  s_mov_b32 s50, 0x40000
  s_mov_b32 s46, 0x11111111
  s_cmp_eq_u32 s44, 0
  s_cbranch_scc0 gb_176_w
  s_branch gb_176_l
gb_176:
  s_sleep 8
gb_176_l:
  v_mbcnt_lo_u32_b32 v16, -1, 0
  v_and_b32 v16, 31, v16
  v_lshlrev_b32 v16, 2, v16
  v_lshl_add_u32 v16, s75, 7, v16
  global_load_dword v17, v16, s[40:41] sc1
  s_sub_u32 s50, s50, 1
  s_cbranch_scc1 K_end
  s_waitcnt vmcnt(0)
gb_176_c:
  v_mul_lo_u32 v18, v17, s46
  v_cmp_le_i32 vcc, 0, v18
  s_cbranch_vccnz gb_176
  v_cmp_ne_u32 vcc, s46, v17
  s_cmp_lg_u64 vcc, 0
  s_cselect_b32 s46, 1, 0
  v_mov_b32 v16, 163836
  v_mov_b32 v17, s46
  ds_write_b32 v16, v17
  s_waitcnt lgkmcnt(0)
gb_176_w:
  s_barrier
  v_mov_b32 v16, 163836
  ds_read_b32 v17, v16
  s_waitcnt lgkmcnt(0)
  v_readfirstlane_b32 s46, v17
  s_cmp_gt_u32 s46, s75
  s_cbranch_scc1 K_again
  v_and_b32 v6, 7, v2
  v_lshrrev_b32 v7, 4, v2
  v_lshl_add_u32 v6, v7, 3, v6
  v_lshlrev_b32 v6, 4, v6
  v_bfe_u32 v7, v2, 3, 1
  v_lshl_add_u32 v6, v7, 10, v6
  s_mul_i32 s46, s44, 9216
  s_add_u32 s52, s46, 1048576
  s_lshl_b32 s47, s53, 13
  s_lshr_b32 s48, s44, 1
  s_lshl_b32 s48, s48, 11
  s_add_u32 s47, s47, s48
  s_add_u32 s55, s47, 58195968
  s_lshl_b32 s54, s45, 2
  s_add_u32 s54, s54, s44
  s_lshl_b32 s54, s54, 10
  s_add_u32 s54, s54, 4194304
  s_add_u32 s47, s46, 0
  s_add_u32 m0, s47, 0
  s_add_u32 s49, s52, 0
  buffer_load_dwordx4 v1, s[4:7], s49 offen offset:0 sc1 lds
  buffer_load_dwordx4 v1, s[4:7], s49 offen offset:1024 sc1 lds
  buffer_load_dwordx4 v1, s[4:7], s49 offen offset:2048 sc1 lds
  buffer_load_dwordx4 v1, s[4:7], s49 offen offset:3072 sc1 lds
  s_add_u32 m0, s47, 4096
  s_add_u32 s49, s52, 4096
  buffer_load_dwordx4 v1, s[4:7], s49 offen offset:0 sc1 lds
  buffer_load_dwordx4 v1, s[4:7], s49 offen offset:1024 sc1 lds
  buffer_load_dwordx4 v1, s[4:7], s49 offen offset:2048 sc1 lds
  buffer_load_dwordx4 v1, s[4:7], s49 offen offset:3072 sc1 lds
  s_add_u32 m0, s47, 8192
  s_add_u32 s49, s52, 8192
  buffer_load_dwordx4 v1, s[4:7], s49 offen offset:0 sc1 lds
  s_add_u32 s52, s52, 36864
  s_add_u32 s47, s46, 36864
  s_add_u32 m0, s47, 0
  s_add_u32 s49, s52, 0
  buffer_load_dwordx4 v1, s[4:7], s49 offen offset:0 sc1 lds
  buffer_load_dwordx4 v1, s[4:7], s49 offen offset:1024 sc1 lds
  buffer_load_dwordx4 v1, s[4:7], s49 offen offset:2048 sc1 lds
  buffer_load_dwordx4 v1, s[4:7], s49 offen offset:3072 sc1 lds
  s_add_u32 m0, s47, 4096
  s_add_u32 s49, s52, 4096
  buffer_load_dwordx4 v1, s[4:7], s49 offen offset:0 sc1 lds
  buffer_load_dwordx4 v1, s[4:7], s49 offen offset:1024 sc1 lds
  buffer_load_dwordx4 v1, s[4:7], s49 offen offset:2048 sc1 lds
  buffer_load_dwordx4 v1, s[4:7], s49 offen offset:3072 sc1 lds
  s_add_u32 m0, s47, 8192
  s_add_u32 s49, s52, 8192
  buffer_load_dwordx4 v1, s[4:7], s49 offen offset:0 sc1 lds
  s_add_u32 s52, s52, 36864
  s_mov_b32 s51, 0
  s_mov_b32 s59, 0
  v_mov_b32 v5, v1
  s_waitcnt vmcnt(9)
  s_barrier
  ds_read_b128 v[32:35], v5 offset:0
  ds_read_b128 v[36:39], v5 offset:1024
  ds_read_b128 v[40:43], v5 offset:2048
  ds_read_b128 v[44:47], v5 offset:3072
  s_cmp_ge_u32 s44, 2
  s_cbranch_scc1 QV_loop
QK_loop:
  ds_read_b128 v[48:51], v5 offset:4096
  s_waitcnt lgkmcnt(4)
  v_mfma_f32_32x32x16_bf16 v[64:79], a[0:3], v[32:35], 0
  v_mfma_f32_32x32x16_bf16 v[80:95], a[4:7], v[32:35], 0
  s_add_u32 s48, s55, 4096
  s_add_u32 s47, s59, 73728
  s_cmp_ge_u32 s47, 147456
  s_cselect_b32 s49, 147456, 0
  s_sub_u32 s47, s47, s49
  s_add_u32 s47, s47, s46
  ds_read_b128 v[52:55], v5 offset:5120
  s_waitcnt lgkmcnt(4)
  v_mfma_f32_32x32x16_bf16 v[64:79], a[8:11], v[36:39], v[64:79]
  v_mfma_f32_32x32x16_bf16 v[80:95], a[12:15], v[36:39], v[80:95]
  v_cvt_pk_bf16_f32 v128, v96, v100
  v_cvt_pk_bf16_f32 v129, v97, v101
  v_cvt_pk_bf16_f32 v130, v98, v102
  v_cvt_pk_bf16_f32 v131, v99, v103
  ds_read_b128 v[56:59], v5 offset:6144
  s_waitcnt lgkmcnt(4)
  v_mfma_f32_32x32x16_bf16 v[64:79], a[16:19], v[40:43], v[64:79]
  v_mfma_f32_32x32x16_bf16 v[80:95], a[20:23], v[40:43], v[80:95]
  buffer_store_dwordx4 v[128:131], v6, s[4:7], s55 offen offset:0 sc1
  ds_read_b128 v[60:63], v5 offset:7168
  s_waitcnt lgkmcnt(4)
  v_mfma_f32_32x32x16_bf16 v[64:79], a[24:27], v[44:47], v[64:79]
  v_mfma_f32_32x32x16_bf16 v[80:95], a[28:31], v[44:47], v[80:95]
  v_cvt_pk_bf16_f32 v132, v104, v108
  v_cvt_pk_bf16_f32 v133, v105, v109
  v_cvt_pk_bf16_f32 v134, v106, v110
  v_cvt_pk_bf16_f32 v135, v107, v111
  ds_read_b128 v[32:35], v5 offset:8192
  s_waitcnt lgkmcnt(4)
  v_mfma_f32_32x32x16_bf16 v[64:79], a[32:35], v[48:51], v[64:79]
  v_mfma_f32_32x32x16_bf16 v[80:95], a[36:39], v[48:51], v[80:95]
  buffer_store_dwordx4 v[132:135], v6, s[4:7], s55 offen offset:512 sc1
  ds_read_b128 v[36:39], v5 offset:9216
  s_waitcnt lgkmcnt(4)
  v_mfma_f32_32x32x16_bf16 v[64:79], a[40:43], v[52:55], v[64:79]
  v_mfma_f32_32x32x16_bf16 v[80:95], a[44:47], v[52:55], v[80:95]
  v_cvt_pk_bf16_f32 v136, v112, v116
  v_cvt_pk_bf16_f32 v137, v113, v117
  v_cvt_pk_bf16_f32 v138, v114, v118
  v_cvt_pk_bf16_f32 v139, v115, v119
  ds_read_b128 v[40:43], v5 offset:10240
  s_waitcnt lgkmcnt(4)
  v_mfma_f32_32x32x16_bf16 v[64:79], a[48:51], v[56:59], v[64:79]
  v_mfma_f32_32x32x16_bf16 v[80:95], a[52:55], v[56:59], v[80:95]
  buffer_store_dwordx4 v[136:139], v6, s[4:7], s48 offen offset:0 sc1
  ds_read_b128 v[44:47], v5 offset:11264
  s_waitcnt lgkmcnt(4)
  v_mfma_f32_32x32x16_bf16 v[64:79], a[56:59], v[60:63], v[64:79]
  v_mfma_f32_32x32x16_bf16 v[80:95], a[60:63], v[60:63], v[80:95]
  v_cvt_pk_bf16_f32 v140, v120, v124
  v_cvt_pk_bf16_f32 v141, v121, v125
  v_cvt_pk_bf16_f32 v142, v122, v126
  v_cvt_pk_bf16_f32 v143, v123, v127
  ds_read_b128 v[48:51], v5 offset:12288
  s_waitcnt lgkmcnt(4)
  v_mfma_f32_32x32x16_bf16 v[64:79], a[64:67], v[32:35], v[64:79]
  v_mfma_f32_32x32x16_bf16 v[80:95], a[68:71], v[32:35], v[80:95]
  buffer_store_dwordx4 v[140:143], v6, s[4:7], s48 offen offset:512 sc1
  ds_read_b128 v[52:55], v5 offset:13312
  s_waitcnt lgkmcnt(4)
  v_mfma_f32_32x32x16_bf16 v[64:79], a[72:75], v[36:39], v[64:79]
  v_mfma_f32_32x32x16_bf16 v[80:95], a[76:79], v[36:39], v[80:95]
  buffer_store_dwordx4 v[12:15], v1, s[4:7], s54 offen sc1
  s_add_u32 s54, s54, 131072
  ds_read_b128 v[56:59], v5 offset:14336
  s_waitcnt lgkmcnt(4)
  v_mfma_f32_32x32x16_bf16 v[64:79], a[80:83], v[40:43], v[64:79]
  v_mfma_f32_32x32x16_bf16 v[80:95], a[84:87], v[40:43], v[80:95]
  s_add_u32 m0, s47, 0
  s_add_u32 s49, s52, 0
  buffer_load_dwordx4 v1, s[4:7], s49 offen offset:0 sc1 lds
  ds_read_b128 v[60:63], v5 offset:15360
  s_waitcnt lgkmcnt(4)
  v_mfma_f32_32x32x16_bf16 v[64:79], a[88:91], v[44:47], v[64:79]
  v_mfma_f32_32x32x16_bf16 v[80:95], a[92:95], v[44:47], v[80:95]
  ds_read_b128 v[32:35], v5 offset:16384
  s_waitcnt lgkmcnt(4)
  v_mfma_f32_32x32x16_bf16 v[64:79], a[96:99], v[48:51], v[64:79]
  v_mfma_f32_32x32x16_bf16 v[80:95], a[100:103], v[48:51], v[80:95]
  buffer_load_dwordx4 v1, s[4:7], s49 offen offset:1024 sc1 lds
  ds_read_b128 v[36:39], v5 offset:17408
  s_waitcnt lgkmcnt(4)
  v_mfma_f32_32x32x16_bf16 v[64:79], a[104:107], v[52:55], v[64:79]
  v_mfma_f32_32x32x16_bf16 v[80:95], a[108:111], v[52:55], v[80:95]
  ds_read_b128 v[40:43], v5 offset:18432
  s_waitcnt lgkmcnt(4)
  v_mfma_f32_32x32x16_bf16 v[64:79], a[112:115], v[56:59], v[64:79]
  v_mfma_f32_32x32x16_bf16 v[80:95], a[116:119], v[56:59], v[80:95]
  buffer_load_dwordx4 v1, s[4:7], s49 offen offset:2048 sc1 lds
  ds_read_b128 v[44:47], v5 offset:19456
  s_waitcnt lgkmcnt(4)
  v_mfma_f32_32x32x16_bf16 v[64:79], a[120:123], v[60:63], v[64:79]
  v_mfma_f32_32x32x16_bf16 v[80:95], a[124:127], v[60:63], v[80:95]
  ds_read_b128 v[48:51], v5 offset:20480
  s_waitcnt lgkmcnt(4)
  v_mfma_f32_32x32x16_bf16 v[64:79], a[128:131], v[32:35], v[64:79]
  v_mfma_f32_32x32x16_bf16 v[80:95], a[132:135], v[32:35], v[80:95]
  buffer_load_dwordx4 v1, s[4:7], s49 offen offset:3072 sc1 lds
  ds_read_b128 v[52:55], v5 offset:21504
  s_waitcnt lgkmcnt(4)
  v_mfma_f32_32x32x16_bf16 v[64:79], a[136:139], v[36:39], v[64:79]
  v_mfma_f32_32x32x16_bf16 v[80:95], a[140:143], v[36:39], v[80:95]
  ds_read_b128 v[56:59], v5 offset:22528
  s_waitcnt lgkmcnt(4)
  v_mfma_f32_32x32x16_bf16 v[64:79], a[144:147], v[40:43], v[64:79]
  v_mfma_f32_32x32x16_bf16 v[80:95], a[148:151], v[40:43], v[80:95]
  s_add_u32 m0, s47, 4096
  s_add_u32 s49, s52, 4096
  buffer_load_dwordx4 v1, s[4:7], s49 offen offset:0 sc1 lds
  ds_read_b128 v[60:63], v5 offset:23552
  s_waitcnt lgkmcnt(4)
  v_mfma_f32_32x32x16_bf16 v[64:79], a[152:155], v[44:47], v[64:79]
  v_mfma_f32_32x32x16_bf16 v[80:95], a[156:159], v[44:47], v[80:95]
  ds_read_b128 v[32:35], v5 offset:24576
  s_waitcnt lgkmcnt(4)
  v_mfma_f32_32x32x16_bf16 v[64:79], a[160:163], v[48:51], v[64:79]
  v_mfma_f32_32x32x16_bf16 v[80:95], a[164:167], v[48:51], v[80:95]
  buffer_load_dwordx4 v1, s[4:7], s49 offen offset:1024 sc1 lds
  ds_read_b128 v[36:39], v5 offset:25600
  s_waitcnt lgkmcnt(4)
  v_mfma_f32_32x32x16_bf16 v[64:79], a[168:171], v[52:55], v[64:79]
  v_mfma_f32_32x32x16_bf16 v[80:95], a[172:175], v[52:55], v[80:95]
  ds_read_b128 v[40:43], v5 offset:26624
  s_waitcnt lgkmcnt(4)
  v_mfma_f32_32x32x16_bf16 v[64:79], a[176:179], v[56:59], v[64:79]
  v_mfma_f32_32x32x16_bf16 v[80:95], a[180:183], v[56:59], v[80:95]
  buffer_load_dwordx4 v1, s[4:7], s49 offen offset:2048 sc1 lds
  ds_read_b128 v[44:47], v5 offset:27648
  s_waitcnt lgkmcnt(4)
  v_mfma_f32_32x32x16_bf16 v[64:79], a[184:187], v[60:63], v[64:79]
  v_mfma_f32_32x32x16_bf16 v[80:95], a[188:191], v[60:63], v[80:95]
  ds_read_b128 v[48:51], v5 offset:28672
  s_waitcnt lgkmcnt(4)
  v_mfma_f32_32x32x16_bf16 v[64:79], a[192:195], v[32:35], v[64:79]
  v_mfma_f32_32x32x16_bf16 v[80:95], a[196:199], v[32:35], v[80:95]
  buffer_load_dwordx4 v1, s[4:7], s49 offen offset:3072 sc1 lds
  ds_read_b128 v[52:55], v5 offset:29696
  s_waitcnt lgkmcnt(4)
  v_mfma_f32_32x32x16_bf16 v[64:79], a[200:203], v[36:39], v[64:79]
  v_mfma_f32_32x32x16_bf16 v[80:95], a[204:207], v[36:39], v[80:95]
  ds_read_b128 v[56:59], v5 offset:30720
  s_waitcnt lgkmcnt(4)
  v_mfma_f32_32x32x16_bf16 v[64:79], a[208:211], v[40:43], v[64:79]
  v_mfma_f32_32x32x16_bf16 v[80:95], a[212:215], v[40:43], v[80:95]
  s_add_u32 m0, s47, 8192
  s_add_u32 s49, s52, 8192
  buffer_load_dwordx4 v1, s[4:7], s49 offen offset:0 sc1 lds
  ds_read_b128 v[60:63], v5 offset:31744
  s_waitcnt lgkmcnt(4)
  v_mfma_f32_32x32x16_bf16 v[64:79], a[216:219], v[44:47], v[64:79]
  v_mfma_f32_32x32x16_bf16 v[80:95], a[220:223], v[44:47], v[80:95]
  ds_read_b128 v[32:35], v5 offset:32768
  s_waitcnt lgkmcnt(4)
  v_mfma_f32_32x32x16_bf16 v[64:79], a[224:227], v[48:51], v[64:79]
  v_mfma_f32_32x32x16_bf16 v[80:95], a[228:231], v[48:51], v[80:95]
  s_add_u32 s52, s52, 36864
  s_add_u32 s55, s55, 524288
  s_add_u32 s59, s59, 36864
  s_cmp_ge_u32 s59, 147456
  s_cselect_b32 s59, 0, s59
  v_mov_b32 v10, s51
  ds_read_b128 v[36:39], v5 offset:33792
  s_waitcnt lgkmcnt(4)
  v_mfma_f32_32x32x16_bf16 v[64:79], a[232:235], v[52:55], v[64:79]
  v_mfma_f32_32x32x16_bf16 v[80:95], a[236:239], v[52:55], v[80:95]
  ds_read_b128 v[40:43], v5 offset:34816
  s_waitcnt lgkmcnt(4)
  v_mfma_f32_32x32x16_bf16 v[64:79], a[240:243], v[56:59], v[64:79]
  v_mfma_f32_32x32x16_bf16 v[80:95], a[244:247], v[56:59], v[80:95]
  s_waitcnt vmcnt(9)
  s_barrier
  buffer_store_dword v10, v9, s[4:7], s56 offen sc1
  s_add_u32 s51, s51, 1
  ds_read_b128 v[44:47], v5 offset:35840
  s_waitcnt lgkmcnt(4)
  v_mfma_f32_32x32x16_bf16 v[64:79], a[248:251], v[60:63], v[64:79]
  v_mfma_f32_32x32x16_bf16 v[80:95], a[252:255], v[60:63], v[80:95]
  v_add_u32 v5, s59, v1
  ds_read_b128 v[48:51], v5 offset:0
  s_waitcnt lgkmcnt(4)
  v_mfma_f32_32x32x16_bf16 v[64:79], v[224:227], v[32:35], v[64:79]
  v_mfma_f32_32x32x16_bf16 v[80:95], v[228:231], v[32:35], v[80:95]
  ds_read_b128 v[52:55], v5 offset:1024
  s_waitcnt lgkmcnt(4)
  v_mfma_f32_32x32x16_bf16 v[64:79], v[232:235], v[36:39], v[64:79]
  v_mfma_f32_32x32x16_bf16 v[80:95], v[236:239], v[36:39], v[80:95]
  ds_read_b128 v[56:59], v5 offset:2048
  s_waitcnt lgkmcnt(4)
  v_mfma_f32_32x32x16_bf16 v[64:79], v[240:243], v[40:43], v[64:79]
  v_mfma_f32_32x32x16_bf16 v[80:95], v[244:247], v[40:43], v[80:95]
  ds_read_b128 v[60:63], v5 offset:3072
  s_waitcnt lgkmcnt(4)
  v_mfma_f32_32x32x16_bf16 v[64:79], v[248:251], v[44:47], v[64:79]
  v_mfma_f32_32x32x16_bf16 v[80:95], v[252:255], v[44:47], v[80:95]
  ds_read_b128 v[32:35], v5 offset:4096
  s_waitcnt lgkmcnt(4)
  v_mfma_f32_32x32x16_bf16 v[96:111], a[0:3], v[48:51], 0
  v_mfma_f32_32x32x16_bf16 v[112:127], a[4:7], v[48:51], 0
  s_add_u32 s48, s55, 4096
  s_add_u32 s47, s59, 73728
  s_cmp_ge_u32 s47, 147456
  s_cselect_b32 s49, 147456, 0
  s_sub_u32 s47, s47, s49
  s_add_u32 s47, s47, s46
  ds_read_b128 v[36:39], v5 offset:5120
  s_waitcnt lgkmcnt(4)
  v_mfma_f32_32x32x16_bf16 v[96:111], a[8:11], v[52:55], v[96:111]
  v_mfma_f32_32x32x16_bf16 v[112:127], a[12:15], v[52:55], v[112:127]
  v_cvt_pk_bf16_f32 v128, v64, v68
  v_cvt_pk_bf16_f32 v129, v65, v69
  v_cvt_pk_bf16_f32 v130, v66, v70
  v_cvt_pk_bf16_f32 v131, v67, v71
  ds_read_b128 v[40:43], v5 offset:6144
  s_waitcnt lgkmcnt(4)
  v_mfma_f32_32x32x16_bf16 v[96:111], a[16:19], v[56:59], v[96:111]
  v_mfma_f32_32x32x16_bf16 v[112:127], a[20:23], v[56:59], v[112:127]
  buffer_store_dwordx4 v[128:131], v6, s[4:7], s55 offen offset:0 sc1
  ds_read_b128 v[44:47], v5 offset:7168
  s_waitcnt lgkmcnt(4)
  v_mfma_f32_32x32x16_bf16 v[96:111], a[24:27], v[60:63], v[96:111]
  v_mfma_f32_32x32x16_bf16 v[112:127], a[28:31], v[60:63], v[112:127]
  v_cvt_pk_bf16_f32 v132, v72, v76
  v_cvt_pk_bf16_f32 v133, v73, v77
  v_cvt_pk_bf16_f32 v134, v74, v78
  v_cvt_pk_bf16_f32 v135, v75, v79
  ds_read_b128 v[48:51], v5 offset:8192
  s_waitcnt lgkmcnt(4)
  v_mfma_f32_32x32x16_bf16 v[96:111], a[32:35], v[32:35], v[96:111]
  v_mfma_f32_32x32x16_bf16 v[112:127], a[36:39], v[32:35], v[112:127]
  buffer_store_dwordx4 v[132:135], v6, s[4:7], s55 offen offset:512 sc1
  ds_read_b128 v[52:55], v5 offset:9216
  s_waitcnt lgkmcnt(4)
  v_mfma_f32_32x32x16_bf16 v[96:111], a[40:43], v[36:39], v[96:111]
  v_mfma_f32_32x32x16_bf16 v[112:127], a[44:47], v[36:39], v[112:127]
  v_cvt_pk_bf16_f32 v136, v80, v84
  v_cvt_pk_bf16_f32 v137, v81, v85
  v_cvt_pk_bf16_f32 v138, v82, v86
  v_cvt_pk_bf16_f32 v139, v83, v87
  ds_read_b128 v[56:59], v5 offset:10240
  s_waitcnt lgkmcnt(4)
  v_mfma_f32_32x32x16_bf16 v[96:111], a[48:51], v[40:43], v[96:111]
  v_mfma_f32_32x32x16_bf16 v[112:127], a[52:55], v[40:43], v[112:127]
  buffer_store_dwordx4 v[136:139], v6, s[4:7], s48 offen offset:0 sc1
  ds_read_b128 v[60:63], v5 offset:11264
  s_waitcnt lgkmcnt(4)
  v_mfma_f32_32x32x16_bf16 v[96:111], a[56:59], v[44:47], v[96:111]
  v_mfma_f32_32x32x16_bf16 v[112:127], a[60:63], v[44:47], v[112:127]
  v_cvt_pk_bf16_f32 v140, v88, v92
  v_cvt_pk_bf16_f32 v141, v89, v93
  v_cvt_pk_bf16_f32 v142, v90, v94
  v_cvt_pk_bf16_f32 v143, v91, v95
  ds_read_b128 v[32:35], v5 offset:12288
  s_waitcnt lgkmcnt(4)
  v_mfma_f32_32x32x16_bf16 v[96:111], a[64:67], v[48:51], v[96:111]
  v_mfma_f32_32x32x16_bf16 v[112:127], a[68:71], v[48:51], v[112:127]
  buffer_store_dwordx4 v[140:143], v6, s[4:7], s48 offen offset:512 sc1
  ds_read_b128 v[36:39], v5 offset:13312
  s_waitcnt lgkmcnt(4)
  v_mfma_f32_32x32x16_bf16 v[96:111], a[72:75], v[52:55], v[96:111]
  v_mfma_f32_32x32x16_bf16 v[112:127], a[76:79], v[52:55], v[112:127]
  buffer_store_dwordx4 v[12:15], v1, s[4:7], s54 offen sc1
  s_add_u32 s54, s54, 131072
  ds_read_b128 v[40:43], v5 offset:14336
  s_waitcnt lgkmcnt(4)
  v_mfma_f32_32x32x16_bf16 v[96:111], a[80:83], v[56:59], v[96:111]
  v_mfma_f32_32x32x16_bf16 v[112:127], a[84:87], v[56:59], v[112:127]
  s_add_u32 m0, s47, 0
  s_add_u32 s49, s52, 0
  buffer_load_dwordx4 v1, s[4:7], s49 offen offset:0 sc1 lds
  ds_read_b128 v[44:47], v5 offset:15360
  s_waitcnt lgkmcnt(4)
  v_mfma_f32_32x32x16_bf16 v[96:111], a[88:91], v[60:63], v[96:111]
  v_mfma_f32_32x32x16_bf16 v[112:127], a[92:95], v[60:63], v[112:127]
  ds_read_b128 v[48:51], v5 offset:16384
  s_waitcnt lgkmcnt(4)
  v_mfma_f32_32x32x16_bf16 v[96:111], a[96:99], v[32:35], v[96:111]
  v_mfma_f32_32x32x16_bf16 v[112:127], a[100:103], v[32:35], v[112:127]
  buffer_load_dwordx4 v1, s[4:7], s49 offen offset:1024 sc1 lds
  ds_read_b128 v[52:55], v5 offset:17408
  s_waitcnt lgkmcnt(4)
  v_mfma_f32_32x32x16_bf16 v[96:111], a[104:107], v[36:39], v[96:111]
  v_mfma_f32_32x32x16_bf16 v[112:127], a[108:111], v[36:39], v[112:127]
  ds_read_b128 v[56:59], v5 offset:18432
  s_waitcnt lgkmcnt(4)
  v_mfma_f32_32x32x16_bf16 v[96:111], a[112:115], v[40:43], v[96:111]
  v_mfma_f32_32x32x16_bf16 v[112:127], a[116:119], v[40:43], v[112:127]
  buffer_load_dwordx4 v1, s[4:7], s49 offen offset:2048 sc1 lds
  ds_read_b128 v[60:63], v5 offset:19456
  s_waitcnt lgkmcnt(4)
  v_mfma_f32_32x32x16_bf16 v[96:111], a[120:123], v[44:47], v[96:111]
  v_mfma_f32_32x32x16_bf16 v[112:127], a[124:127], v[44:47], v[112:127]
  ds_read_b128 v[32:35], v5 offset:20480
  s_waitcnt lgkmcnt(4)
  v_mfma_f32_32x32x16_bf16 v[96:111], a[128:131], v[48:51], v[96:111]
  v_mfma_f32_32x32x16_bf16 v[112:127], a[132:135], v[48:51], v[112:127]
  buffer_load_dwordx4 v1, s[4:7], s49 offen offset:3072 sc1 lds
  ds_read_b128 v[36:39], v5 offset:21504
  s_waitcnt lgkmcnt(4)
  v_mfma_f32_32x32x16_bf16 v[96:111], a[136:139], v[52:55], v[96:111]
  v_mfma_f32_32x32x16_bf16 v[112:127], a[140:143], v[52:55], v[112:127]
  ds_read_b128 v[40:43], v5 offset:22528
  s_waitcnt lgkmcnt(4)
  v_mfma_f32_32x32x16_bf16 v[96:111], a[144:147], v[56:59], v[96:111]
  v_mfma_f32_32x32x16_bf16 v[112:127], a[148:151], v[56:59], v[112:127]
  s_add_u32 m0, s47, 4096
  s_add_u32 s49, s52, 4096
  buffer_load_dwordx4 v1, s[4:7], s49 offen offset:0 sc1 lds
  ds_read_b128 v[44:47], v5 offset:23552
  s_waitcnt lgkmcnt(4)
  v_mfma_f32_32x32x16_bf16 v[96:111], a[152:155], v[60:63], v[96:111]
  v_mfma_f32_32x32x16_bf16 v[112:127], a[156:159], v[60:63], v[112:127]
  ds_read_b128 v[48:51], v5 offset:24576
  s_waitcnt lgkmcnt(4)
  v_mfma_f32_32x32x16_bf16 v[96:111], a[160:163], v[32:35], v[96:111]
  v_mfma_f32_32x32x16_bf16 v[112:127], a[164:167], v[32:35], v[112:127]
  buffer_load_dwordx4 v1, s[4:7], s49 offen offset:1024 sc1 lds
  ds_read_b128 v[52:55], v5 offset:25600
  s_waitcnt lgkmcnt(4)
  v_mfma_f32_32x32x16_bf16 v[96:111], a[168:171], v[36:39], v[96:111]
  v_mfma_f32_32x32x16_bf16 v[112:127], a[172:175], v[36:39], v[112:127]
  ds_read_b128 v[56:59], v5 offset:26624
  s_waitcnt lgkmcnt(4)
  v_mfma_f32_32x32x16_bf16 v[96:111], a[176:179], v[40:43], v[96:111]
  v_mfma_f32_32x32x16_bf16 v[112:127], a[180:183], v[40:43], v[112:127]
  buffer_load_dwordx4 v1, s[4:7], s49 offen offset:2048 sc1 lds
  ds_read_b128 v[60:63], v5 offset:27648
  s_waitcnt lgkmcnt(4)
  v_mfma_f32_32x32x16_bf16 v[96:111], a[184:187], v[44:47], v[96:111]
  v_mfma_f32_32x32x16_bf16 v[112:127], a[188:191], v[44:47], v[112:127]
  ds_read_b128 v[32:35], v5 offset:28672
  s_waitcnt lgkmcnt(4)
  v_mfma_f32_32x32x16_bf16 v[96:111], a[192:195], v[48:51], v[96:111]
  v_mfma_f32_32x32x16_bf16 v[112:127], a[196:199], v[48:51], v[112:127]
  buffer_load_dwordx4 v1, s[4:7], s49 offen offset:3072 sc1 lds
  ds_read_b128 v[36:39], v5 offset:29696
  s_waitcnt lgkmcnt(4)
  v_mfma_f32_32x32x16_bf16 v[96:111], a[200:203], v[52:55], v[96:111]
  v_mfma_f32_32x32x16_bf16 v[112:127], a[204:207], v[52:55], v[112:127]
  ds_read_b128 v[40:43], v5 offset:30720
  s_waitcnt lgkmcnt(4)
  v_mfma_f32_32x32x16_bf16 v[96:111], a[208:211], v[56:59], v[96:111]
  v_mfma_f32_32x32x16_bf16 v[112:127], a[212:215], v[56:59], v[112:127]
  s_add_u32 m0, s47, 8192
  s_add_u32 s49, s52, 8192
  buffer_load_dwordx4 v1, s[4:7], s49 offen offset:0 sc1 lds
  ds_read_b128 v[44:47], v5 offset:31744
  s_waitcnt lgkmcnt(4)
  v_mfma_f32_32x32x16_bf16 v[96:111], a[216:219], v[60:63], v[96:111]
  v_mfma_f32_32x32x16_bf16 v[112:127], a[220:223], v[60:63], v[112:127]
  ds_read_b128 v[48:51], v5 offset:32768
  s_waitcnt lgkmcnt(4)
  v_mfma_f32_32x32x16_bf16 v[96:111], a[224:227], v[32:35], v[96:111]
  v_mfma_f32_32x32x16_bf16 v[112:127], a[228:231], v[32:35], v[112:127]
  s_add_u32 s52, s52, 36864
  s_add_u32 s55, s55, 524288
  s_add_u32 s59, s59, 36864
  s_cmp_ge_u32 s59, 147456
  s_cselect_b32 s59, 0, s59
  v_mov_b32 v10, s51
  ds_read_b128 v[52:55], v5 offset:33792
  s_waitcnt lgkmcnt(4)
  v_mfma_f32_32x32x16_bf16 v[96:111], a[232:235], v[36:39], v[96:111]
  v_mfma_f32_32x32x16_bf16 v[112:127], a[236:239], v[36:39], v[112:127]
  ds_read_b128 v[56:59], v5 offset:34816
  s_waitcnt lgkmcnt(4)
  v_mfma_f32_32x32x16_bf16 v[96:111], a[240:243], v[40:43], v[96:111]
  v_mfma_f32_32x32x16_bf16 v[112:127], a[244:247], v[40:43], v[112:127]
  s_waitcnt vmcnt(9)
  s_barrier
  buffer_store_dword v10, v9, s[4:7], s56 offen sc1
  s_add_u32 s51, s51, 1
  ds_read_b128 v[60:63], v5 offset:35840
  s_waitcnt lgkmcnt(4)
  v_mfma_f32_32x32x16_bf16 v[96:111], a[248:251], v[44:47], v[96:111]
  v_mfma_f32_32x32x16_bf16 v[112:127], a[252:255], v[44:47], v[112:127]
  v_add_u32 v5, s59, v1
  ds_read_b128 v[32:35], v5 offset:0
  s_waitcnt lgkmcnt(4)
  v_mfma_f32_32x32x16_bf16 v[96:111], v[224:227], v[48:51], v[96:111]
  v_mfma_f32_32x32x16_bf16 v[112:127], v[228:231], v[48:51], v[112:127]
  ds_read_b128 v[36:39], v5 offset:1024
  s_waitcnt lgkmcnt(4)
  v_mfma_f32_32x32x16_bf16 v[96:111], v[232:235], v[52:55], v[96:111]
  v_mfma_f32_32x32x16_bf16 v[112:127], v[236:239], v[52:55], v[112:127]
  ds_read_b128 v[40:43], v5 offset:2048
  s_waitcnt lgkmcnt(4)
  v_mfma_f32_32x32x16_bf16 v[96:111], v[240:243], v[56:59], v[96:111]
  v_mfma_f32_32x32x16_bf16 v[112:127], v[244:247], v[56:59], v[112:127]
  ds_read_b128 v[44:47], v5 offset:3072
  s_waitcnt lgkmcnt(4)
  v_mfma_f32_32x32x16_bf16 v[96:111], v[248:251], v[60:63], v[96:111]
  v_mfma_f32_32x32x16_bf16 v[112:127], v[252:255], v[60:63], v[112:127]
  s_cmp_lt_u32 s51, 64
  s_cbranch_scc1 QK_loop
  s_add_u32 s48, s55, 4096
  s_nop 0
  v_cvt_pk_bf16_f32 v128, v96, v100
  v_cvt_pk_bf16_f32 v129, v97, v101
  v_cvt_pk_bf16_f32 v130, v98, v102
  v_cvt_pk_bf16_f32 v131, v99, v103
  buffer_store_dwordx4 v[128:131], v6, s[4:7], s55 offen offset:0 sc1
  v_cvt_pk_bf16_f32 v132, v104, v108
  v_cvt_pk_bf16_f32 v133, v105, v109
  v_cvt_pk_bf16_f32 v134, v106, v110
  v_cvt_pk_bf16_f32 v135, v107, v111
  buffer_store_dwordx4 v[132:135], v6, s[4:7], s55 offen offset:512 sc1
  v_cvt_pk_bf16_f32 v136, v112, v116
  v_cvt_pk_bf16_f32 v137, v113, v117
  v_cvt_pk_bf16_f32 v138, v114, v118
  v_cvt_pk_bf16_f32 v139, v115, v119
  buffer_store_dwordx4 v[136:139], v6, s[4:7], s48 offen offset:0 sc1
  v_cvt_pk_bf16_f32 v140, v120, v124
  v_cvt_pk_bf16_f32 v141, v121, v125
  v_cvt_pk_bf16_f32 v142, v122, v126
  v_cvt_pk_bf16_f32 v143, v123, v127
  buffer_store_dwordx4 v[140:143], v6, s[4:7], s48 offen offset:512 sc1
  s_branch Q_tail
QV_loop:
  ds_read_b128 v[48:51], v5 offset:4096
  s_waitcnt lgkmcnt(4)
  v_mfma_f32_32x32x16_bf16 v[64:79], v[32:35], a[0:3], 0
  v_mfma_f32_32x32x16_bf16 v[80:95], v[32:35], a[4:7], 0
  s_add_u32 s48, s55, 4096
  s_add_u32 s47, s59, 73728
  s_cmp_ge_u32 s47, 147456
  s_cselect_b32 s49, 147456, 0
  s_sub_u32 s47, s47, s49
  s_add_u32 s47, s47, s46
  ds_read_b128 v[52:55], v5 offset:5120
  s_waitcnt lgkmcnt(4)
  v_mfma_f32_32x32x16_bf16 v[64:79], v[36:39], a[8:11], v[64:79]
  v_mfma_f32_32x32x16_bf16 v[80:95], v[36:39], a[12:15], v[80:95]
  v_cvt_pk_bf16_f32 v128, v96, v97
  v_cvt_pk_bf16_f32 v129, v98, v99
  v_cvt_pk_bf16_f32 v130, v100, v101
  v_cvt_pk_bf16_f32 v131, v102, v103
  ds_read_b128 v[56:59], v5 offset:6144
  s_waitcnt lgkmcnt(4)
  v_mfma_f32_32x32x16_bf16 v[64:79], v[40:43], a[16:19], v[64:79]
  v_mfma_f32_32x32x16_bf16 v[80:95], v[40:43], a[20:23], v[80:95]
  buffer_store_dwordx4 v[128:131], v6, s[4:7], s55 offen offset:0 sc1
  ds_read_b128 v[60:63], v5 offset:7168
  s_waitcnt lgkmcnt(4)
  v_mfma_f32_32x32x16_bf16 v[64:79], v[44:47], a[24:27], v[64:79]
  v_mfma_f32_32x32x16_bf16 v[80:95], v[44:47], a[28:31], v[80:95]
  v_cvt_pk_bf16_f32 v132, v104, v105
  v_cvt_pk_bf16_f32 v133, v106, v107
  v_cvt_pk_bf16_f32 v134, v108, v109
  v_cvt_pk_bf16_f32 v135, v110, v111
  ds_read_b128 v[32:35], v5 offset:8192
  s_waitcnt lgkmcnt(4)
  v_mfma_f32_32x32x16_bf16 v[64:79], v[48:51], a[32:35], v[64:79]
  v_mfma_f32_32x32x16_bf16 v[80:95], v[48:51], a[36:39], v[80:95]
  buffer_store_dwordx4 v[132:135], v6, s[4:7], s55 offen offset:512 sc1
  ds_read_b128 v[36:39], v5 offset:9216
  s_waitcnt lgkmcnt(4)
  v_mfma_f32_32x32x16_bf16 v[64:79], v[52:55], a[40:43], v[64:79]
  v_mfma_f32_32x32x16_bf16 v[80:95], v[52:55], a[44:47], v[80:95]
  v_cvt_pk_bf16_f32 v136, v112, v113
  v_cvt_pk_bf16_f32 v137, v114, v115
  v_cvt_pk_bf16_f32 v138, v116, v117
  v_cvt_pk_bf16_f32 v139, v118, v119
  ds_read_b128 v[40:43], v5 offset:10240
  s_waitcnt lgkmcnt(4)
  v_mfma_f32_32x32x16_bf16 v[64:79], v[56:59], a[48:51], v[64:79]
  v_mfma_f32_32x32x16_bf16 v[80:95], v[56:59], a[52:55], v[80:95]
  buffer_store_dwordx4 v[136:139], v6, s[4:7], s48 offen offset:0 sc1
  ds_read_b128 v[44:47], v5 offset:11264
  s_waitcnt lgkmcnt(4)
  v_mfma_f32_32x32x16_bf16 v[64:79], v[60:63], a[56:59], v[64:79]
  v_mfma_f32_32x32x16_bf16 v[80:95], v[60:63], a[60:63], v[80:95]
  v_cvt_pk_bf16_f32 v140, v120, v121
  v_cvt_pk_bf16_f32 v141, v122, v123
  v_cvt_pk_bf16_f32 v142, v124, v125
  v_cvt_pk_bf16_f32 v143, v126, v127
  ds_read_b128 v[48:51], v5 offset:12288
  s_waitcnt lgkmcnt(4)
  v_mfma_f32_32x32x16_bf16 v[64:79], v[32:35], a[64:67], v[64:79]
  v_mfma_f32_32x32x16_bf16 v[80:95], v[32:35], a[68:71], v[80:95]
  buffer_store_dwordx4 v[140:143], v6, s[4:7], s48 offen offset:512 sc1
  ds_read_b128 v[52:55], v5 offset:13312
  s_waitcnt lgkmcnt(4)
  v_mfma_f32_32x32x16_bf16 v[64:79], v[36:39], a[72:75], v[64:79]
  v_mfma_f32_32x32x16_bf16 v[80:95], v[36:39], a[76:79], v[80:95]
  buffer_store_dwordx4 v[12:15], v1, s[4:7], s54 offen sc1
  s_add_u32 s54, s54, 131072
  ds_read_b128 v[56:59], v5 offset:14336
  s_waitcnt lgkmcnt(4)
  v_mfma_f32_32x32x16_bf16 v[64:79], v[40:43], a[80:83], v[64:79]
  v_mfma_f32_32x32x16_bf16 v[80:95], v[40:43], a[84:87], v[80:95]
  s_add_u32 m0, s47, 0
  s_add_u32 s49, s52, 0
  buffer_load_dwordx4 v1, s[4:7], s49 offen offset:0 sc1 lds
  ds_read_b128 v[60:63], v5 offset:15360
  s_waitcnt lgkmcnt(4)
  v_mfma_f32_32x32x16_bf16 v[64:79], v[44:47], a[88:91], v[64:79]
  v_mfma_f32_32x32x16_bf16 v[80:95], v[44:47], a[92:95], v[80:95]
  ds_read_b128 v[32:35], v5 offset:16384
  s_waitcnt lgkmcnt(4)
  v_mfma_f32_32x32x16_bf16 v[64:79], v[48:51], a[96:99], v[64:79]
  v_mfma_f32_32x32x16_bf16 v[80:95], v[48:51], a[100:103], v[80:95]
  buffer_load_dwordx4 v1, s[4:7], s49 offen offset:1024 sc1 lds
  ds_read_b128 v[36:39], v5 offset:17408
  s_waitcnt lgkmcnt(4)
  v_mfma_f32_32x32x16_bf16 v[64:79], v[52:55], a[104:107], v[64:79]
  v_mfma_f32_32x32x16_bf16 v[80:95], v[52:55], a[108:111], v[80:95]
  ds_read_b128 v[40:43], v5 offset:18432
  s_waitcnt lgkmcnt(4)
  v_mfma_f32_32x32x16_bf16 v[64:79], v[56:59], a[112:115], v[64:79]
  v_mfma_f32_32x32x16_bf16 v[80:95], v[56:59], a[116:119], v[80:95]
  buffer_load_dwordx4 v1, s[4:7], s49 offen offset:2048 sc1 lds
  ds_read_b128 v[44:47], v5 offset:19456
  s_waitcnt lgkmcnt(4)
  v_mfma_f32_32x32x16_bf16 v[64:79], v[60:63], a[120:123], v[64:79]
  v_mfma_f32_32x32x16_bf16 v[80:95], v[60:63], a[124:127], v[80:95]
  ds_read_b128 v[48:51], v5 offset:20480
  s_waitcnt lgkmcnt(4)
  v_mfma_f32_32x32x16_bf16 v[64:79], v[32:35], a[128:131], v[64:79]
  v_mfma_f32_32x32x16_bf16 v[80:95], v[32:35], a[132:135], v[80:95]
  buffer_load_dwordx4 v1, s[4:7], s49 offen offset:3072 sc1 lds
  ds_read_b128 v[52:55], v5 offset:21504
  s_waitcnt lgkmcnt(4)
  v_mfma_f32_32x32x16_bf16 v[64:79], v[36:39], a[136:139], v[64:79]
  v_mfma_f32_32x32x16_bf16 v[80:95], v[36:39], a[140:143], v[80:95]
  ds_read_b128 v[56:59], v5 offset:22528
  s_waitcnt lgkmcnt(4)
  v_mfma_f32_32x32x16_bf16 v[64:79], v[40:43], a[144:147], v[64:79]
  v_mfma_f32_32x32x16_bf16 v[80:95], v[40:43], a[148:151], v[80:95]
  s_add_u32 m0, s47, 4096
  s_add_u32 s49, s52, 4096
  buffer_load_dwordx4 v1, s[4:7], s49 offen offset:0 sc1 lds
  ds_read_b128 v[60:63], v5 offset:23552
  s_waitcnt lgkmcnt(4)
  v_mfma_f32_32x32x16_bf16 v[64:79], v[44:47], a[152:155], v[64:79]
  v_mfma_f32_32x32x16_bf16 v[80:95], v[44:47], a[156:159], v[80:95]
  ds_read_b128 v[32:35], v5 offset:24576
  s_waitcnt lgkmcnt(4)
  v_mfma_f32_32x32x16_bf16 v[64:79], v[48:51], a[160:163], v[64:79]
  v_mfma_f32_32x32x16_bf16 v[80:95], v[48:51], a[164:167], v[80:95]
  buffer_load_dwordx4 v1, s[4:7], s49 offen offset:1024 sc1 lds
  ds_read_b128 v[36:39], v5 offset:25600
  s_waitcnt lgkmcnt(4)
  v_mfma_f32_32x32x16_bf16 v[64:79], v[52:55], a[168:171], v[64:79]
  v_mfma_f32_32x32x16_bf16 v[80:95], v[52:55], a[172:175], v[80:95]
  ds_read_b128 v[40:43], v5 offset:26624
  s_waitcnt lgkmcnt(4)
  v_mfma_f32_32x32x16_bf16 v[64:79], v[56:59], a[176:179], v[64:79]
  v_mfma_f32_32x32x16_bf16 v[80:95], v[56:59], a[180:183], v[80:95]
  buffer_load_dwordx4 v1, s[4:7], s49 offen offset:2048 sc1 lds
  ds_read_b128 v[44:47], v5 offset:27648
  s_waitcnt lgkmcnt(4)
  v_mfma_f32_32x32x16_bf16 v[64:79], v[60:63], a[184:187], v[64:79]
  v_mfma_f32_32x32x16_bf16 v[80:95], v[60:63], a[188:191], v[80:95]
  ds_read_b128 v[48:51], v5 offset:28672
  s_waitcnt lgkmcnt(4)
  v_mfma_f32_32x32x16_bf16 v[64:79], v[32:35], a[192:195], v[64:79]
  v_mfma_f32_32x32x16_bf16 v[80:95], v[32:35], a[196:199], v[80:95]
  buffer_load_dwordx4 v1, s[4:7], s49 offen offset:3072 sc1 lds
  ds_read_b128 v[52:55], v5 offset:29696
  s_waitcnt lgkmcnt(4)
  v_mfma_f32_32x32x16_bf16 v[64:79], v[36:39], a[200:203], v[64:79]
  v_mfma_f32_32x32x16_bf16 v[80:95], v[36:39], a[204:207], v[80:95]
  ds_read_b128 v[56:59], v5 offset:30720
  s_waitcnt lgkmcnt(4)
  v_mfma_f32_32x32x16_bf16 v[64:79], v[40:43], a[208:211], v[64:79]
  v_mfma_f32_32x32x16_bf16 v[80:95], v[40:43], a[212:215], v[80:95]
  s_add_u32 m0, s47, 8192
  s_add_u32 s49, s52, 8192
  buffer_load_dwordx4 v1, s[4:7], s49 offen offset:0 sc1 lds
  ds_read_b128 v[60:63], v5 offset:31744
  s_waitcnt lgkmcnt(4)
  v_mfma_f32_32x32x16_bf16 v[64:79], v[44:47], a[216:219], v[64:79]
  v_mfma_f32_32x32x16_bf16 v[80:95], v[44:47], a[220:223], v[80:95]
  ds_read_b128 v[32:35], v5 offset:32768
  s_waitcnt lgkmcnt(4)
  v_mfma_f32_32x32x16_bf16 v[64:79], v[48:51], a[224:227], v[64:79]
  v_mfma_f32_32x32x16_bf16 v[80:95], v[48:51], a[228:231], v[80:95]
  s_add_u32 s52, s52, 36864
  s_add_u32 s55, s55, 524288
  s_add_u32 s59, s59, 36864
  s_cmp_ge_u32 s59, 147456
  s_cselect_b32 s59, 0, s59
  v_mov_b32 v10, s51
  ds_read_b128 v[36:39], v5 offset:33792
  s_waitcnt lgkmcnt(4)
  v_mfma_f32_32x32x16_bf16 v[64:79], v[52:55], a[232:235], v[64:79]
  v_mfma_f32_32x32x16_bf16 v[80:95], v[52:55], a[236:239], v[80:95]
  ds_read_b128 v[40:43], v5 offset:34816
  s_waitcnt lgkmcnt(4)
  v_mfma_f32_32x32x16_bf16 v[64:79], v[56:59], a[240:243], v[64:79]
  v_mfma_f32_32x32x16_bf16 v[80:95], v[56:59], a[244:247], v[80:95]
  s_waitcnt vmcnt(9)
  s_barrier
  buffer_store_dword v10, v9, s[4:7], s56 offen sc1
  s_add_u32 s51, s51, 1
  ds_read_b128 v[44:47], v5 offset:35840
  s_waitcnt lgkmcnt(4)
  v_mfma_f32_32x32x16_bf16 v[64:79], v[60:63], a[248:251], v[64:79]
  v_mfma_f32_32x32x16_bf16 v[80:95], v[60:63], a[252:255], v[80:95]
  v_add_u32 v5, s59, v1
  ds_read_b128 v[48:51], v5 offset:0
  s_waitcnt lgkmcnt(4)
  v_mfma_f32_32x32x16_bf16 v[64:79], v[32:35], v[224:227], v[64:79]
  v_mfma_f32_32x32x16_bf16 v[80:95], v[32:35], v[228:231], v[80:95]
  ds_read_b128 v[52:55], v5 offset:1024
  s_waitcnt lgkmcnt(4)
  v_mfma_f32_32x32x16_bf16 v[64:79], v[36:39], v[232:235], v[64:79]
  v_mfma_f32_32x32x16_bf16 v[80:95], v[36:39], v[236:239], v[80:95]
  ds_read_b128 v[56:59], v5 offset:2048
  s_waitcnt lgkmcnt(4)
  v_mfma_f32_32x32x16_bf16 v[64:79], v[40:43], v[240:243], v[64:79]
  v_mfma_f32_32x32x16_bf16 v[80:95], v[40:43], v[244:247], v[80:95]
  ds_read_b128 v[60:63], v5 offset:3072
  s_waitcnt lgkmcnt(4)
  v_mfma_f32_32x32x16_bf16 v[64:79], v[44:47], v[248:251], v[64:79]
  v_mfma_f32_32x32x16_bf16 v[80:95], v[44:47], v[252:255], v[80:95]
  ds_read_b128 v[32:35], v5 offset:4096
  s_waitcnt lgkmcnt(4)
  v_mfma_f32_32x32x16_bf16 v[96:111], v[48:51], a[0:3], 0
  v_mfma_f32_32x32x16_bf16 v[112:127], v[48:51], a[4:7], 0
  s_add_u32 s48, s55, 4096
  s_add_u32 s47, s59, 73728
  s_cmp_ge_u32 s47, 147456
  s_cselect_b32 s49, 147456, 0
  s_sub_u32 s47, s47, s49
  s_add_u32 s47, s47, s46
  ds_read_b128 v[36:39], v5 offset:5120
  s_waitcnt lgkmcnt(4)
  v_mfma_f32_32x32x16_bf16 v[96:111], v[52:55], a[8:11], v[96:111]
  v_mfma_f32_32x32x16_bf16 v[112:127], v[52:55], a[12:15], v[112:127]
  v_cvt_pk_bf16_f32 v128, v64, v65
  v_cvt_pk_bf16_f32 v129, v66, v67
  v_cvt_pk_bf16_f32 v130, v68, v69
  v_cvt_pk_bf16_f32 v131, v70, v71
  ds_read_b128 v[40:43], v5 offset:6144
  s_waitcnt lgkmcnt(4)
  v_mfma_f32_32x32x16_bf16 v[96:111], v[56:59], a[16:19], v[96:111]
  v_mfma_f32_32x32x16_bf16 v[112:127], v[56:59], a[20:23], v[112:127]
  buffer_store_dwordx4 v[128:131], v6, s[4:7], s55 offen offset:0 sc1
  ds_read_b128 v[44:47], v5 offset:7168
  s_waitcnt lgkmcnt(4)
  v_mfma_f32_32x32x16_bf16 v[96:111], v[60:63], a[24:27], v[96:111]
  v_mfma_f32_32x32x16_bf16 v[112:127], v[60:63], a[28:31], v[112:127]
  v_cvt_pk_bf16_f32 v132, v72, v73
  v_cvt_pk_bf16_f32 v133, v74, v75
  v_cvt_pk_bf16_f32 v134, v76, v77
  v_cvt_pk_bf16_f32 v135, v78, v79
  ds_read_b128 v[48:51], v5 offset:8192
  s_waitcnt lgkmcnt(4)
  v_mfma_f32_32x32x16_bf16 v[96:111], v[32:35], a[32:35], v[96:111]
  v_mfma_f32_32x32x16_bf16 v[112:127], v[32:35], a[36:39], v[112:127]
  buffer_store_dwordx4 v[132:135], v6, s[4:7], s55 offen offset:512 sc1
  ds_read_b128 v[52:55], v5 offset:9216
  s_waitcnt lgkmcnt(4)
  v_mfma_f32_32x32x16_bf16 v[96:111], v[36:39], a[40:43], v[96:111]
  v_mfma_f32_32x32x16_bf16 v[112:127], v[36:39], a[44:47], v[112:127]
  v_cvt_pk_bf16_f32 v136, v80, v81
  v_cvt_pk_bf16_f32 v137, v82, v83
  v_cvt_pk_bf16_f32 v138, v84, v85
  v_cvt_pk_bf16_f32 v139, v86, v87
  ds_read_b128 v[56:59], v5 offset:10240
  s_waitcnt lgkmcnt(4)
  v_mfma_f32_32x32x16_bf16 v[96:111], v[40:43], a[48:51], v[96:111]
  v_mfma_f32_32x32x16_bf16 v[112:127], v[40:43], a[52:55], v[112:127]
  buffer_store_dwordx4 v[136:139], v6, s[4:7], s48 offen offset:0 sc1
  ds_read_b128 v[60:63], v5 offset:11264
  s_waitcnt lgkmcnt(4)
  v_mfma_f32_32x32x16_bf16 v[96:111], v[44:47], a[56:59], v[96:111]
  v_mfma_f32_32x32x16_bf16 v[112:127], v[44:47], a[60:63], v[112:127]
  v_cvt_pk_bf16_f32 v140, v88, v89
  v_cvt_pk_bf16_f32 v141, v90, v91
  v_cvt_pk_bf16_f32 v142, v92, v93
  v_cvt_pk_bf16_f32 v143, v94, v95
  ds_read_b128 v[32:35], v5 offset:12288
  s_waitcnt lgkmcnt(4)
  v_mfma_f32_32x32x16_bf16 v[96:111], v[48:51], a[64:67], v[96:111]
  v_mfma_f32_32x32x16_bf16 v[112:127], v[48:51], a[68:71], v[112:127]
  buffer_store_dwordx4 v[140:143], v6, s[4:7], s48 offen offset:512 sc1
  ds_read_b128 v[36:39], v5 offset:13312
  s_waitcnt lgkmcnt(4)
  v_mfma_f32_32x32x16_bf16 v[96:111], v[52:55], a[72:75], v[96:111]
  v_mfma_f32_32x32x16_bf16 v[112:127], v[52:55], a[76:79], v[112:127]
  buffer_store_dwordx4 v[12:15], v1, s[4:7], s54 offen sc1
  s_add_u32 s54, s54, 131072
  ds_read_b128 v[40:43], v5 offset:14336
  s_waitcnt lgkmcnt(4)
  v_mfma_f32_32x32x16_bf16 v[96:111], v[56:59], a[80:83], v[96:111]
  v_mfma_f32_32x32x16_bf16 v[112:127], v[56:59], a[84:87], v[112:127]
  s_add_u32 m0, s47, 0
  s_add_u32 s49, s52, 0
  buffer_load_dwordx4 v1, s[4:7], s49 offen offset:0 sc1 lds
  ds_read_b128 v[44:47], v5 offset:15360
  s_waitcnt lgkmcnt(4)
  v_mfma_f32_32x32x16_bf16 v[96:111], v[60:63], a[88:91], v[96:111]
  v_mfma_f32_32x32x16_bf16 v[112:127], v[60:63], a[92:95], v[112:127]
  ds_read_b128 v[48:51], v5 offset:16384
  s_waitcnt lgkmcnt(4)
  v_mfma_f32_32x32x16_bf16 v[96:111], v[32:35], a[96:99], v[96:111]
  v_mfma_f32_32x32x16_bf16 v[112:127], v[32:35], a[100:103], v[112:127]
  buffer_load_dwordx4 v1, s[4:7], s49 offen offset:1024 sc1 lds
  ds_read_b128 v[52:55], v5 offset:17408
  s_waitcnt lgkmcnt(4)
  v_mfma_f32_32x32x16_bf16 v[96:111], v[36:39], a[104:107], v[96:111]
  v_mfma_f32_32x32x16_bf16 v[112:127], v[36:39], a[108:111], v[112:127]
  ds_read_b128 v[56:59], v5 offset:18432
  s_waitcnt lgkmcnt(4)
  v_mfma_f32_32x32x16_bf16 v[96:111], v[40:43], a[112:115], v[96:111]
  v_mfma_f32_32x32x16_bf16 v[112:127], v[40:43], a[116:119], v[112:127]
  buffer_load_dwordx4 v1, s[4:7], s49 offen offset:2048 sc1 lds
  ds_read_b128 v[60:63], v5 offset:19456
  s_waitcnt lgkmcnt(4)
  v_mfma_f32_32x32x16_bf16 v[96:111], v[44:47], a[120:123], v[96:111]
  v_mfma_f32_32x32x16_bf16 v[112:127], v[44:47], a[124:127], v[112:127]
  ds_read_b128 v[32:35], v5 offset:20480
  s_waitcnt lgkmcnt(4)
  v_mfma_f32_32x32x16_bf16 v[96:111], v[48:51], a[128:131], v[96:111]
  v_mfma_f32_32x32x16_bf16 v[112:127], v[48:51], a[132:135], v[112:127]
  buffer_load_dwordx4 v1, s[4:7], s49 offen offset:3072 sc1 lds
  ds_read_b128 v[36:39], v5 offset:21504
  s_waitcnt lgkmcnt(4)
  v_mfma_f32_32x32x16_bf16 v[96:111], v[52:55], a[136:139], v[96:111]
  v_mfma_f32_32x32x16_bf16 v[112:127], v[52:55], a[140:143], v[112:127]
  ds_read_b128 v[40:43], v5 offset:22528
  s_waitcnt lgkmcnt(4)
  v_mfma_f32_32x32x16_bf16 v[96:111], v[56:59], a[144:147], v[96:111]
  v_mfma_f32_32x32x16_bf16 v[112:127], v[56:59], a[148:151], v[112:127]
  s_add_u32 m0, s47, 4096
  s_add_u32 s49, s52, 4096
  buffer_load_dwordx4 v1, s[4:7], s49 offen offset:0 sc1 lds
  ds_read_b128 v[44:47], v5 offset:23552
  s_waitcnt lgkmcnt(4)
  v_mfma_f32_32x32x16_bf16 v[96:111], v[60:63], a[152:155], v[96:111]
  v_mfma_f32_32x32x16_bf16 v[112:127], v[60:63], a[156:159], v[112:127]
  ds_read_b128 v[48:51], v5 offset:24576
  s_waitcnt lgkmcnt(4)
  v_mfma_f32_32x32x16_bf16 v[96:111], v[32:35], a[160:163], v[96:111]
  v_mfma_f32_32x32x16_bf16 v[112:127], v[32:35], a[164:167], v[112:127]
  buffer_load_dwordx4 v1, s[4:7], s49 offen offset:1024 sc1 lds
  ds_read_b128 v[52:55], v5 offset:25600
  s_waitcnt lgkmcnt(4)
  v_mfma_f32_32x32x16_bf16 v[96:111], v[36:39], a[168:171], v[96:111]
  v_mfma_f32_32x32x16_bf16 v[112:127], v[36:39], a[172:175], v[112:127]
  ds_read_b128 v[56:59], v5 offset:26624
  s_waitcnt lgkmcnt(4)
  v_mfma_f32_32x32x16_bf16 v[96:111], v[40:43], a[176:179], v[96:111]
  v_mfma_f32_32x32x16_bf16 v[112:127], v[40:43], a[180:183], v[112:127]
  buffer_load_dwordx4 v1, s[4:7], s49 offen offset:2048 sc1 lds
  ds_read_b128 v[60:63], v5 offset:27648
  s_waitcnt lgkmcnt(4)
  v_mfma_f32_32x32x16_bf16 v[96:111], v[44:47], a[184:187], v[96:111]
  v_mfma_f32_32x32x16_bf16 v[112:127], v[44:47], a[188:191], v[112:127]
  ds_read_b128 v[32:35], v5 offset:28672
  s_waitcnt lgkmcnt(4)
  v_mfma_f32_32x32x16_bf16 v[96:111], v[48:51], a[192:195], v[96:111]
  v_mfma_f32_32x32x16_bf16 v[112:127], v[48:51], a[196:199], v[112:127]
  buffer_load_dwordx4 v1, s[4:7], s49 offen offset:3072 sc1 lds
  ds_read_b128 v[36:39], v5 offset:29696
  s_waitcnt lgkmcnt(4)
  v_mfma_f32_32x32x16_bf16 v[96:111], v[52:55], a[200:203], v[96:111]
  v_mfma_f32_32x32x16_bf16 v[112:127], v[52:55], a[204:207], v[112:127]
  ds_read_b128 v[40:43], v5 offset:30720
  s_waitcnt lgkmcnt(4)
  v_mfma_f32_32x32x16_bf16 v[96:111], v[56:59], a[208:211], v[96:111]
  v_mfma_f32_32x32x16_bf16 v[112:127], v[56:59], a[212:215], v[112:127]
  s_add_u32 m0, s47, 8192
  s_add_u32 s49, s52, 8192
  buffer_load_dwordx4 v1, s[4:7], s49 offen offset:0 sc1 lds
  ds_read_b128 v[44:47], v5 offset:31744
  s_waitcnt lgkmcnt(4)
  v_mfma_f32_32x32x16_bf16 v[96:111], v[60:63], a[216:219], v[96:111]
  v_mfma_f32_32x32x16_bf16 v[112:127], v[60:63], a[220:223], v[112:127]
  ds_read_b128 v[48:51], v5 offset:32768
  s_waitcnt lgkmcnt(4)
  v_mfma_f32_32x32x16_bf16 v[96:111], v[32:35], a[224:227], v[96:111]
  v_mfma_f32_32x32x16_bf16 v[112:127], v[32:35], a[228:231], v[112:127]
  s_add_u32 s52, s52, 36864
  s_add_u32 s55, s55, 524288
  s_add_u32 s59, s59, 36864
  s_cmp_ge_u32 s59, 147456
  s_cselect_b32 s59, 0, s59
  v_mov_b32 v10, s51
  ds_read_b128 v[52:55], v5 offset:33792
  s_waitcnt lgkmcnt(4)
  v_mfma_f32_32x32x16_bf16 v[96:111], v[36:39], a[232:235], v[96:111]
  v_mfma_f32_32x32x16_bf16 v[112:127], v[36:39], a[236:239], v[112:127]
  ds_read_b128 v[56:59], v5 offset:34816
  s_waitcnt lgkmcnt(4)
  v_mfma_f32_32x32x16_bf16 v[96:111], v[40:43], a[240:243], v[96:111]
  v_mfma_f32_32x32x16_bf16 v[112:127], v[40:43], a[244:247], v[112:127]
  s_waitcnt vmcnt(9)
  s_barrier
  buffer_store_dword v10, v9, s[4:7], s56 offen sc1
  s_add_u32 s51, s51, 1
  ds_read_b128 v[60:63], v5 offset:35840
  s_waitcnt lgkmcnt(4)
  v_mfma_f32_32x32x16_bf16 v[96:111], v[44:47], a[248:251], v[96:111]
  v_mfma_f32_32x32x16_bf16 v[112:127], v[44:47], a[252:255], v[112:127]
  v_add_u32 v5, s59, v1
  ds_read_b128 v[32:35], v5 offset:0
  s_waitcnt lgkmcnt(4)
  v_mfma_f32_32x32x16_bf16 v[96:111], v[48:51], v[224:227], v[96:111]
  v_mfma_f32_32x32x16_bf16 v[112:127], v[48:51], v[228:231], v[112:127]
  ds_read_b128 v[36:39], v5 offset:1024
  s_waitcnt lgkmcnt(4)
  v_mfma_f32_32x32x16_bf16 v[96:111], v[52:55], v[232:235], v[96:111]
  v_mfma_f32_32x32x16_bf16 v[112:127], v[52:55], v[236:239], v[112:127]
  ds_read_b128 v[40:43], v5 offset:2048
  s_waitcnt lgkmcnt(4)
  v_mfma_f32_32x32x16_bf16 v[96:111], v[56:59], v[240:243], v[96:111]
  v_mfma_f32_32x32x16_bf16 v[112:127], v[56:59], v[244:247], v[112:127]
  ds_read_b128 v[44:47], v5 offset:3072
  s_waitcnt lgkmcnt(4)
  v_mfma_f32_32x32x16_bf16 v[96:111], v[60:63], v[248:251], v[96:111]
  v_mfma_f32_32x32x16_bf16 v[112:127], v[60:63], v[252:255], v[112:127]
  s_cmp_lt_u32 s51, 64
  s_cbranch_scc1 QV_loop
  s_add_u32 s48, s55, 4096
  s_nop 0
  v_cvt_pk_bf16_f32 v128, v96, v97
  v_cvt_pk_bf16_f32 v129, v98, v99
  v_cvt_pk_bf16_f32 v130, v100, v101
  v_cvt_pk_bf16_f32 v131, v102, v103
  buffer_store_dwordx4 v[128:131], v6, s[4:7], s55 offen offset:0 sc1
  v_cvt_pk_bf16_f32 v132, v104, v105
  v_cvt_pk_bf16_f32 v133, v106, v107
  v_cvt_pk_bf16_f32 v134, v108, v109
  v_cvt_pk_bf16_f32 v135, v110, v111
  buffer_store_dwordx4 v[132:135], v6, s[4:7], s55 offen offset:512 sc1
  v_cvt_pk_bf16_f32 v136, v112, v113
  v_cvt_pk_bf16_f32 v137, v114, v115
  v_cvt_pk_bf16_f32 v138, v116, v117
  v_cvt_pk_bf16_f32 v139, v118, v119
  buffer_store_dwordx4 v[136:139], v6, s[4:7], s48 offen offset:0 sc1
  v_cvt_pk_bf16_f32 v140, v120, v121
  v_cvt_pk_bf16_f32 v141, v122, v123
  v_cvt_pk_bf16_f32 v142, v124, v125
  v_cvt_pk_bf16_f32 v143, v126, v127
  buffer_store_dwordx4 v[140:143], v6, s[4:7], s48 offen offset:512 sc1
Q_tail:
  v_mov_b32 v10, 128
  s_waitcnt vmcnt(0) lgkmcnt(0)
  s_barrier
  buffer_store_dword v10, v9, s[4:7], s56 offen sc1
  s_cmp_eq_u32 s45, 0
  s_cbranch_scc0 Z_np
  buffer_load_dword v32, off, s[4:7], 0 offset:2048 sc1
  v_mov_b32 v33, 54
  s_waitcnt vmcnt(0)
  v_cmp_lt_u32 vcc, 47, v32
  s_nop 1
  v_cndmask_b32 v33, v33, 57, vcc
  v_cmp_lt_u32 vcc, 50, v32
  s_nop 1
  v_cndmask_b32 v33, v33, 60, vcc
  buffer_store_dword v33, v9, s[4:7], 0 offen offset:2432 sc1
Z_np:
  s_lshl_b32 s46, 8, 22
  s_lshl_b32 s47, s75, 27
  s_add_u32 s74, s46, s47
  s_add_u32 s74, s74, 4194304
  s_mov_b32 s50, 0x1000
  s_cmp_eq_u32 s44, 0
  s_cbranch_scc0 V_go
  s_branch V_l
V_w:
  s_sleep 16
V_l:
  buffer_load_dword v32, off, s[4:7], 0 offset:2304 sc1
  s_sub_u32 s50, s50, 1
  s_cbranch_scc1 K_end
  s_waitcnt vmcnt(0)
  v_readfirstlane_b32 s46, v32
  s_cmp_lt_u32 s46, 32
  s_cbranch_scc1 V_w
V_go:
  s_barrier
  v_mbcnt_lo_u32_b32 v0, -1, 0
  v_mbcnt_hi_u32_b32 v0, -1, v0
  s_lshl_b32 s28, s44, 6
  v_add_u32 v0, s28, v0
  v_and_b32 v2, 63, v0
  v_lshlrev_b32 v1, 4, v2
  v_and_b32 v3, 15, v2
  v_lshrrev_b32 v4, 4, v2
  v_mov_b32 v12, -1
  v_mov_b32 v13, -1
  v_mov_b32 v14, -1
  v_mov_b32 v15, -1
  v_lshlrev_b32 v8, 4, v0
  v_mov_b32 v9, 1073741824
  v_cmp_eq_u32 vcc, 0, v0
  s_nop 1
  v_cndmask_b32 v9, v9, 0, vcc
  v_mov_b32 v10, 0
  s_mov_b32 s3, 2
  s_branch A_ld
  s_branch K_end
AI_fl:
  buffer_load_dword v22, off, s[4:7], s70 sc1
  s_sub_u32 s50, s50, 1
  s_cbranch_scc1 K_end
  s_waitcnt vmcnt(0)
  v_readfirstlane_b32 s68, v22
  s_branch AI_dm
A_start:
  s_lshl_b32 s46, s3, 22
  s_lshl_b32 s47, s75, 27
  s_add_u32 s74, s46, s47
  s_add_u32 s74, s74, 4194304
  s_mul_i32 s46, s45, 37120
  s_add_u32 s46, s46, s74
  s_cmp_eq_u32 s75, 0
  s_cbranch_scc0 rf_178_f
  s_add_u32 s47, s46, 0
  buffer_store_dwordx4 v[12:15], v8, s[4:7], s47 offen
  s_add_u32 s47, s46, 4096
  buffer_store_dwordx4 v[12:15], v8, s[4:7], s47 offen
  s_add_u32 s47, s46, 8192
  buffer_store_dwordx4 v[12:15], v8, s[4:7], s47 offen
  s_add_u32 s47, s46, 12288
  buffer_store_dwordx4 v[12:15], v8, s[4:7], s47 offen
  s_add_u32 s47, s46, 16384
  buffer_store_dwordx4 v[12:15], v8, s[4:7], s47 offen
  s_add_u32 s47, s46, 20480
  buffer_store_dwordx4 v[12:15], v8, s[4:7], s47 offen
  s_add_u32 s47, s46, 24576
  buffer_store_dwordx4 v[12:15], v8, s[4:7], s47 offen
  s_add_u32 s47, s46, 28672
  buffer_store_dwordx4 v[12:15], v8, s[4:7], s47 offen
  s_add_u32 s47, s46, 32768
  buffer_store_dwordx4 v[12:15], v8, s[4:7], s47 offen
  s_add_u32 s47, s46, 2097152
  buffer_store_dwordx4 v[12:15], v8, s[4:7], s47 offen
  s_add_u32 s47, s46, 2101248
  buffer_store_dwordx4 v[12:15], v8, s[4:7], s47 offen
  s_add_u32 s47, s46, 2105344
  buffer_store_dwordx4 v[12:15], v8, s[4:7], s47 offen
  s_add_u32 s47, s46, 2109440
  buffer_store_dwordx4 v[12:15], v8, s[4:7], s47 offen
  s_add_u32 s47, s46, 2113536
  buffer_store_dwordx4 v[12:15], v8, s[4:7], s47 offen
  s_add_u32 s47, s46, 2117632
  buffer_store_dwordx4 v[12:15], v8, s[4:7], s47 offen
  s_add_u32 s47, s46, 2121728
  buffer_store_dwordx4 v[12:15], v8, s[4:7], s47 offen
  s_add_u32 s47, s46, 2125824
  buffer_store_dwordx4 v[12:15], v8, s[4:7], s47 offen
  s_add_u32 s47, s46, 2129920
  buffer_store_dwordx4 v[12:15], v8, s[4:7], s47 offen
  s_branch rf_178
rf_178_f:
  s_add_u32 s47, s46, 0
  buffer_store_dwordx4 v[12:15], v8, s[4:7], s47 offen sc1
  s_add_u32 s47, s46, 4096
  buffer_store_dwordx4 v[12:15], v8, s[4:7], s47 offen sc1
  s_add_u32 s47, s46, 8192
  buffer_store_dwordx4 v[12:15], v8, s[4:7], s47 offen sc1
  s_add_u32 s47, s46, 12288
  buffer_store_dwordx4 v[12:15], v8, s[4:7], s47 offen sc1
  s_add_u32 s47, s46, 16384
  buffer_store_dwordx4 v[12:15], v8, s[4:7], s47 offen sc1
  s_add_u32 s47, s46, 20480
  buffer_store_dwordx4 v[12:15], v8, s[4:7], s47 offen sc1
  s_add_u32 s47, s46, 24576
  buffer_store_dwordx4 v[12:15], v8, s[4:7], s47 offen sc1
  s_add_u32 s47, s46, 28672
  buffer_store_dwordx4 v[12:15], v8, s[4:7], s47 offen sc1
  s_add_u32 s47, s46, 32768
  buffer_store_dwordx4 v[12:15], v8, s[4:7], s47 offen sc1
  s_add_u32 s47, s46, 2097152
  buffer_store_dwordx4 v[12:15], v8, s[4:7], s47 offen sc1
  s_add_u32 s47, s46, 2101248
  buffer_store_dwordx4 v[12:15], v8, s[4:7], s47 offen sc1
  s_add_u32 s47, s46, 2105344
  buffer_store_dwordx4 v[12:15], v8, s[4:7], s47 offen sc1
  s_add_u32 s47, s46, 2109440
  buffer_store_dwordx4 v[12:15], v8, s[4:7], s47 offen sc1
  s_add_u32 s47, s46, 2113536
  buffer_store_dwordx4 v[12:15], v8, s[4:7], s47 offen sc1
  s_add_u32 s47, s46, 2117632
  buffer_store_dwordx4 v[12:15], v8, s[4:7], s47 offen sc1
  s_add_u32 s47, s46, 2121728
  buffer_store_dwordx4 v[12:15], v8, s[4:7], s47 offen sc1
  s_add_u32 s47, s46, 2125824
  buffer_store_dwordx4 v[12:15], v8, s[4:7], s47 offen sc1
  s_add_u32 s47, s46, 2129920
  buffer_store_dwordx4 v[12:15], v8, s[4:7], s47 offen sc1
rf_178:
A_ld:
  s_mov_b32 s8, s26
  s_mov_b32 s9, s27
  s_mov_b32 s10, 4718592
  s_mov_b32 s11, 0x20000
  s_mul_i32 s46, s45, 147456
  s_mul_i32 s47, s44, 36864
  s_add_u32 s46, s46, s47
  s_add_u32 m0, s47, 0
  s_add_u32 s48, s46, 0
  buffer_load_dwordx4 v1, s[8:11], s48 offen offset:0 lds
  buffer_load_dwordx4 v1, s[8:11], s48 offen offset:1024 lds
  buffer_load_dwordx4 v1, s[8:11], s48 offen offset:2048 lds
  buffer_load_dwordx4 v1, s[8:11], s48 offen offset:3072 lds
  s_add_u32 m0, s47, 4096
  s_add_u32 s48, s46, 4096
  buffer_load_dwordx4 v1, s[8:11], s48 offen offset:0 lds
  buffer_load_dwordx4 v1, s[8:11], s48 offen offset:1024 lds
  buffer_load_dwordx4 v1, s[8:11], s48 offen offset:2048 lds
  buffer_load_dwordx4 v1, s[8:11], s48 offen offset:3072 lds
  s_cmp_eq_u32 s3, 2
  s_cbranch_scc1 A_ld2
  s_waitcnt vmcnt(8)
  s_barrier
  s_cmp_eq_u32 s44, 0
  s_cbranch_scc0 arr_179
  s_getreg_b32 s28, hwreg(HW_REG_XCC_ID, 0, 3)
  s_cmp_eq_u32 s75, 0
  s_cselect_b32 s28, s28, s2
  s_lshl_b32 s28, s28, 2
  s_lshl_b32 s28, 1, s28
  s_lshr_b32 s29, s2, 3
  s_lshl_b32 s29, s29, 2
  v_mov_b32 v18, s28
  s_lshl_b32 s28, s75, 7
  s_add_u32 s29, s29, s28
  v_mov_b32 v19, s29
  s_mov_b64 exec, 1
  global_atomic_add v19, v18, s[40:41] sc1
  s_mov_b64 exec, -1
arr_179:
A_ld2:
  s_add_u32 m0, s47, 8192
  s_add_u32 s48, s46, 8192
  buffer_load_dwordx4 v1, s[8:11], s48 offen offset:0 lds
  buffer_load_dwordx4 v1, s[8:11], s48 offen offset:1024 lds
  buffer_load_dwordx4 v1, s[8:11], s48 offen offset:2048 lds
  buffer_load_dwordx4 v1, s[8:11], s48 offen offset:3072 lds
  s_add_u32 m0, s47, 12288
  s_add_u32 s48, s46, 12288
  buffer_load_dwordx4 v1, s[8:11], s48 offen offset:0 lds
  buffer_load_dwordx4 v1, s[8:11], s48 offen offset:1024 lds
  buffer_load_dwordx4 v1, s[8:11], s48 offen offset:2048 lds
  buffer_load_dwordx4 v1, s[8:11], s48 offen offset:3072 lds
  s_add_u32 m0, s47, 16384
  s_add_u32 s48, s46, 16384
  buffer_load_dwordx4 v1, s[8:11], s48 offen offset:0 lds
  buffer_load_dwordx4 v1, s[8:11], s48 offen offset:1024 lds
  buffer_load_dwordx4 v1, s[8:11], s48 offen offset:2048 lds
  buffer_load_dwordx4 v1, s[8:11], s48 offen offset:3072 lds
  s_add_u32 m0, s47, 20480
  s_add_u32 s48, s46, 20480
  buffer_load_dwordx4 v1, s[8:11], s48 offen offset:0 lds
  buffer_load_dwordx4 v1, s[8:11], s48 offen offset:1024 lds
  buffer_load_dwordx4 v1, s[8:11], s48 offen offset:2048 lds
  buffer_load_dwordx4 v1, s[8:11], s48 offen offset:3072 lds
  s_add_u32 m0, s47, 24576
  s_add_u32 s48, s46, 24576
  buffer_load_dwordx4 v1, s[8:11], s48 offen offset:0 lds
  buffer_load_dwordx4 v1, s[8:11], s48 offen offset:1024 lds
  buffer_load_dwordx4 v1, s[8:11], s48 offen offset:2048 lds
  buffer_load_dwordx4 v1, s[8:11], s48 offen offset:3072 lds
  s_add_u32 m0, s47, 28672
  s_add_u32 s48, s46, 28672
  buffer_load_dwordx4 v1, s[8:11], s48 offen offset:0 lds
  buffer_load_dwordx4 v1, s[8:11], s48 offen offset:1024 lds
  buffer_load_dwordx4 v1, s[8:11], s48 offen offset:2048 lds
  buffer_load_dwordx4 v1, s[8:11], s48 offen offset:3072 lds
  s_add_u32 m0, s47, 32768
  s_add_u32 s48, s46, 32768
  buffer_load_dwordx4 v1, s[8:11], s48 offen offset:0 lds
  buffer_load_dwordx4 v1, s[8:11], s48 offen offset:1024 lds
  buffer_load_dwordx4 v1, s[8:11], s48 offen offset:2048 lds
  buffer_load_dwordx4 v1, s[8:11], s48 offen offset:3072 lds
  v_lshrrev_b32 v5, 1, v4
  v_lshlrev_b32 v5, 4, v5
  v_and_b32 v6, 1, v4
  v_lshl_add_u32 v5, v6, 2, v5
  v_lshrrev_b32 v6, 2, v3
  v_add_u32 v5, v5, v6
  v_mul_u32_u24 v5, 1152, v5
  s_mul_i32 s46, s44, 288
  v_add_u32 v5, s46, v5
  v_and_b32 v6, 3, v3
  v_lshl_add_u32 v16, v6, 4, v5
  v_lshl_add_u32 v8, v6, 3, v5
  v_add_u32 v8, 256, v8
  s_waitcnt vmcnt(0)
  s_barrier
  ds_read_b64_tr_b16 a[0:1], v16 offset:0
  ds_read_b64_tr_b16 a[2:3], v16 offset:9216
  ds_read_b64_tr_b16 a[16:17], v16 offset:8
  ds_read_b64_tr_b16 a[18:19], v16 offset:9224
  ds_read_b64_tr_b16 a[32:33], v16 offset:64
  ds_read_b64_tr_b16 a[34:35], v16 offset:9280
  ds_read_b64_tr_b16 a[48:49], v16 offset:72
  ds_read_b64_tr_b16 a[50:51], v16 offset:9288
  ds_read_b64_tr_b16 a[64:65], v16 offset:128
  ds_read_b64_tr_b16 a[66:67], v16 offset:9344
  ds_read_b64_tr_b16 a[80:81], v16 offset:136
  ds_read_b64_tr_b16 a[82:83], v16 offset:9352
  ds_read_b64_tr_b16 a[96:97], v16 offset:192
  ds_read_b64_tr_b16 a[98:99], v16 offset:9408
  ds_read_b64_tr_b16 a[112:113], v16 offset:200
  ds_read_b64_tr_b16 a[114:115], v16 offset:9416
  ds_read_b64_tr_b16 a[128:129], v8 offset:0
  ds_read_b64_tr_b16 a[130:131], v8 offset:9216
  v_add_u32 v16, 36864, v16
  v_add_u32 v8, 36864, v8
  ds_read_b64_tr_b16 a[4:5], v16 offset:0
  ds_read_b64_tr_b16 a[6:7], v16 offset:9216
  ds_read_b64_tr_b16 a[20:21], v16 offset:8
  ds_read_b64_tr_b16 a[22:23], v16 offset:9224
  ds_read_b64_tr_b16 a[36:37], v16 offset:64
  ds_read_b64_tr_b16 a[38:39], v16 offset:9280
  ds_read_b64_tr_b16 a[52:53], v16 offset:72
  ds_read_b64_tr_b16 a[54:55], v16 offset:9288
  ds_read_b64_tr_b16 a[68:69], v16 offset:128
  ds_read_b64_tr_b16 a[70:71], v16 offset:9344
  ds_read_b64_tr_b16 a[84:85], v16 offset:136
  ds_read_b64_tr_b16 a[86:87], v16 offset:9352
  ds_read_b64_tr_b16 a[100:101], v16 offset:192
  ds_read_b64_tr_b16 a[102:103], v16 offset:9408
  ds_read_b64_tr_b16 a[116:117], v16 offset:200
  ds_read_b64_tr_b16 a[118:119], v16 offset:9416
  ds_read_b64_tr_b16 a[132:133], v8 offset:0
  ds_read_b64_tr_b16 a[134:135], v8 offset:9216
  v_add_u32 v16, 36864, v16
  v_add_u32 v8, 36864, v8
  ds_read_b64_tr_b16 a[8:9], v16 offset:0
  ds_read_b64_tr_b16 a[10:11], v16 offset:9216
  ds_read_b64_tr_b16 a[24:25], v16 offset:8
  ds_read_b64_tr_b16 a[26:27], v16 offset:9224
  ds_read_b64_tr_b16 a[40:41], v16 offset:64
  ds_read_b64_tr_b16 a[42:43], v16 offset:9280
  ds_read_b64_tr_b16 a[56:57], v16 offset:72
  ds_read_b64_tr_b16 a[58:59], v16 offset:9288
  ds_read_b64_tr_b16 a[72:73], v16 offset:128
  ds_read_b64_tr_b16 a[74:75], v16 offset:9344
  ds_read_b64_tr_b16 a[88:89], v16 offset:136
  ds_read_b64_tr_b16 a[90:91], v16 offset:9352
  ds_read_b64_tr_b16 a[104:105], v16 offset:192
  ds_read_b64_tr_b16 a[106:107], v16 offset:9408
  ds_read_b64_tr_b16 a[120:121], v16 offset:200
  ds_read_b64_tr_b16 a[122:123], v16 offset:9416
  ds_read_b64_tr_b16 a[136:137], v8 offset:0
  ds_read_b64_tr_b16 a[138:139], v8 offset:9216
  v_add_u32 v16, 36864, v16
  v_add_u32 v8, 36864, v8
  ds_read_b64_tr_b16 a[12:13], v16 offset:0
  ds_read_b64_tr_b16 a[14:15], v16 offset:9216
  ds_read_b64_tr_b16 a[28:29], v16 offset:8
  ds_read_b64_tr_b16 a[30:31], v16 offset:9224
  ds_read_b64_tr_b16 a[44:45], v16 offset:64
  ds_read_b64_tr_b16 a[46:47], v16 offset:9280
  ds_read_b64_tr_b16 a[60:61], v16 offset:72
  ds_read_b64_tr_b16 a[62:63], v16 offset:9288
  ds_read_b64_tr_b16 a[76:77], v16 offset:128
  ds_read_b64_tr_b16 a[78:79], v16 offset:9344
  ds_read_b64_tr_b16 a[92:93], v16 offset:136
  ds_read_b64_tr_b16 a[94:95], v16 offset:9352
  ds_read_b64_tr_b16 a[108:109], v16 offset:192
  ds_read_b64_tr_b16 a[110:111], v16 offset:9408
  ds_read_b64_tr_b16 a[124:125], v16 offset:200
  ds_read_b64_tr_b16 a[126:127], v16 offset:9416
  ds_read_b64_tr_b16 a[140:141], v8 offset:0
  ds_read_b64_tr_b16 a[142:143], v8 offset:9216
  v_add_u32 v16, 36864, v16
  v_add_u32 v8, 36864, v8
  s_waitcnt lgkmcnt(0)
  s_barrier
  s_mov_b32 s12, s20
  s_mov_b32 s13, s21
  s_mov_b32 s14, 4718592
  s_mov_b32 s15, 0x20000
  v_lshlrev_b32 v5, 2, v4
  v_xor_b32 v5, v5, v3
  v_lshlrev_b32 v5, 4, v5
  v_lshl_add_u32 v5, v4, 13, v5
  s_mul_i32 s47, s44, 36864
  s_mul_i32 s46, s44, 1179648
  s_lshl_b32 s48, s45, 8
  s_add_u32 s46, s46, s48
  s_add_u32 m0, s47, 0
  s_add_u32 s48, s46, 0
  buffer_load_dwordx4 v5, s[12:15], s48 offen lds
  s_add_u32 m0, s47, 1024
  s_add_u32 s48, s46, 32768
  buffer_load_dwordx4 v5, s[12:15], s48 offen lds
  s_add_u32 m0, s47, 2048
  s_add_u32 s48, s46, 65536
  buffer_load_dwordx4 v5, s[12:15], s48 offen lds
  s_add_u32 m0, s47, 3072
  s_add_u32 s48, s46, 98304
  buffer_load_dwordx4 v5, s[12:15], s48 offen lds
  s_add_u32 m0, s47, 4096
  s_add_u32 s48, s46, 131072
  buffer_load_dwordx4 v5, s[12:15], s48 offen lds
  s_add_u32 m0, s47, 5120
  s_add_u32 s48, s46, 163840
  buffer_load_dwordx4 v5, s[12:15], s48 offen lds
  s_add_u32 m0, s47, 6144
  s_add_u32 s48, s46, 196608
  buffer_load_dwordx4 v5, s[12:15], s48 offen lds
  s_add_u32 m0, s47, 7168
  s_add_u32 s48, s46, 229376
  buffer_load_dwordx4 v5, s[12:15], s48 offen lds
  s_add_u32 m0, s47, 8192
  s_add_u32 s48, s46, 262144
  buffer_load_dwordx4 v5, s[12:15], s48 offen lds
  s_add_u32 m0, s47, 9216
  s_add_u32 s48, s46, 294912
  buffer_load_dwordx4 v5, s[12:15], s48 offen lds
  s_add_u32 m0, s47, 10240
  s_add_u32 s48, s46, 327680
  buffer_load_dwordx4 v5, s[12:15], s48 offen lds
  s_add_u32 m0, s47, 11264
  s_add_u32 s48, s46, 360448
  buffer_load_dwordx4 v5, s[12:15], s48 offen lds
  s_add_u32 m0, s47, 12288
  s_add_u32 s48, s46, 393216
  buffer_load_dwordx4 v5, s[12:15], s48 offen lds
  s_add_u32 m0, s47, 13312
  s_add_u32 s48, s46, 425984
  buffer_load_dwordx4 v5, s[12:15], s48 offen lds
  s_add_u32 m0, s47, 14336
  s_add_u32 s48, s46, 458752
  buffer_load_dwordx4 v5, s[12:15], s48 offen lds
  s_add_u32 m0, s47, 15360
  s_add_u32 s48, s46, 491520
  buffer_load_dwordx4 v5, s[12:15], s48 offen lds
  s_add_u32 m0, s47, 16384
  s_add_u32 s48, s46, 524288
  buffer_load_dwordx4 v5, s[12:15], s48 offen lds
  s_add_u32 m0, s47, 17408
  s_add_u32 s48, s46, 557056
  buffer_load_dwordx4 v5, s[12:15], s48 offen lds
  s_add_u32 m0, s47, 18432
  s_add_u32 s48, s46, 589824
  buffer_load_dwordx4 v5, s[12:15], s48 offen lds
  s_add_u32 m0, s47, 19456
  s_add_u32 s48, s46, 622592
  buffer_load_dwordx4 v5, s[12:15], s48 offen lds
  s_add_u32 m0, s47, 20480
  s_add_u32 s48, s46, 655360
  buffer_load_dwordx4 v5, s[12:15], s48 offen lds
  s_add_u32 m0, s47, 21504
  s_add_u32 s48, s46, 688128
  buffer_load_dwordx4 v5, s[12:15], s48 offen lds
  s_add_u32 m0, s47, 22528
  s_add_u32 s48, s46, 720896
  buffer_load_dwordx4 v5, s[12:15], s48 offen lds
  s_add_u32 m0, s47, 23552
  s_add_u32 s48, s46, 753664
  buffer_load_dwordx4 v5, s[12:15], s48 offen lds
  s_add_u32 m0, s47, 24576
  s_add_u32 s48, s46, 786432
  buffer_load_dwordx4 v5, s[12:15], s48 offen lds
  s_add_u32 m0, s47, 25600
  s_add_u32 s48, s46, 819200
  buffer_load_dwordx4 v5, s[12:15], s48 offen lds
  s_add_u32 m0, s47, 26624
  s_add_u32 s48, s46, 851968
  buffer_load_dwordx4 v5, s[12:15], s48 offen lds
  s_add_u32 m0, s47, 27648
  s_add_u32 s48, s46, 884736
  buffer_load_dwordx4 v5, s[12:15], s48 offen lds
  s_add_u32 m0, s47, 28672
  s_add_u32 s48, s46, 917504
  buffer_load_dwordx4 v5, s[12:15], s48 offen lds
  s_add_u32 m0, s47, 29696
  s_add_u32 s48, s46, 950272
  buffer_load_dwordx4 v5, s[12:15], s48 offen lds
  s_add_u32 m0, s47, 30720
  s_add_u32 s48, s46, 983040
  buffer_load_dwordx4 v5, s[12:15], s48 offen lds
  s_add_u32 m0, s47, 31744
  s_add_u32 s48, s46, 1015808
  buffer_load_dwordx4 v5, s[12:15], s48 offen lds
  s_add_u32 m0, s47, 32768
  s_add_u32 s48, s46, 1048576
  buffer_load_dwordx4 v5, s[12:15], s48 offen lds
  s_add_u32 m0, s47, 33792
  s_add_u32 s48, s46, 1081344
  buffer_load_dwordx4 v5, s[12:15], s48 offen lds
  s_add_u32 m0, s47, 34816
  s_add_u32 s48, s46, 1114112
  buffer_load_dwordx4 v5, s[12:15], s48 offen lds
  s_add_u32 m0, s47, 35840
  s_add_u32 s48, s46, 1146880
  buffer_load_dwordx4 v5, s[12:15], s48 offen lds
  v_lshrrev_b32 v5, 2, v3
  v_xor_b32 v6, s44, v5
  v_lshlrev_b32 v6, 6, v6
  v_lshl_add_u32 v6, v5, 8, v6
  v_lshrrev_b32 v5, 1, v4
  v_lshl_add_u32 v6, v5, 11, v6
  v_and_b32 v5, 1, v4
  v_lshl_add_u32 v6, v5, 5, v6
  v_and_b32 v5, 3, v3
  v_lshl_add_u32 v6, v5, 3, v6
  s_waitcnt vmcnt(0)
  s_barrier
  ds_read_b64_tr_b16 a[144:145], v6 offset:0
  ds_read_b64_tr_b16 a[146:147], v6 offset:1024
  ds_read_b64_tr_b16 a[148:149], v6 offset:4096
  ds_read_b64_tr_b16 a[150:151], v6 offset:5120
  ds_read_b64_tr_b16 a[152:153], v6 offset:8192
  ds_read_b64_tr_b16 a[154:155], v6 offset:9216
  ds_read_b64_tr_b16 a[156:157], v6 offset:12288
  ds_read_b64_tr_b16 a[158:159], v6 offset:13312
  ds_read_b64_tr_b16 a[160:161], v6 offset:16384
  ds_read_b64_tr_b16 a[162:163], v6 offset:17408
  ds_read_b64_tr_b16 a[164:165], v6 offset:20480
  ds_read_b64_tr_b16 a[166:167], v6 offset:21504
  ds_read_b64_tr_b16 a[168:169], v6 offset:24576
  ds_read_b64_tr_b16 a[170:171], v6 offset:25600
  ds_read_b64_tr_b16 a[172:173], v6 offset:28672
  ds_read_b64_tr_b16 a[174:175], v6 offset:29696
  ds_read_b64_tr_b16 a[176:177], v6 offset:32768
  ds_read_b64_tr_b16 a[178:179], v6 offset:33792
  ds_read_b64_tr_b16 a[180:181], v6 offset:36864
  ds_read_b64_tr_b16 a[182:183], v6 offset:37888
  ds_read_b64_tr_b16 a[184:185], v6 offset:40960
  ds_read_b64_tr_b16 a[186:187], v6 offset:41984
  ds_read_b64_tr_b16 a[188:189], v6 offset:45056
  ds_read_b64_tr_b16 a[190:191], v6 offset:46080
  v_add_u32 v6, 49152, v6
  ds_read_b64_tr_b16 a[192:193], v6 offset:0
  ds_read_b64_tr_b16 a[194:195], v6 offset:1024
  ds_read_b64_tr_b16 a[196:197], v6 offset:4096
  ds_read_b64_tr_b16 a[198:199], v6 offset:5120
  ds_read_b64_tr_b16 a[200:201], v6 offset:8192
  ds_read_b64_tr_b16 a[202:203], v6 offset:9216
  ds_read_b64_tr_b16 a[204:205], v6 offset:12288
  ds_read_b64_tr_b16 a[206:207], v6 offset:13312
  ds_read_b64_tr_b16 a[208:209], v6 offset:16384
  ds_read_b64_tr_b16 a[210:211], v6 offset:17408
  ds_read_b64_tr_b16 a[212:213], v6 offset:20480
  ds_read_b64_tr_b16 a[214:215], v6 offset:21504
  ds_read_b64_tr_b16 a[216:217], v6 offset:24576
  ds_read_b64_tr_b16 a[218:219], v6 offset:25600
  ds_read_b64_tr_b16 a[220:221], v6 offset:28672
  ds_read_b64_tr_b16 a[222:223], v6 offset:29696
  ds_read_b64_tr_b16 a[224:225], v6 offset:32768
  ds_read_b64_tr_b16 a[226:227], v6 offset:33792
  ds_read_b64_tr_b16 a[228:229], v6 offset:36864
  ds_read_b64_tr_b16 a[230:231], v6 offset:37888
  ds_read_b64_tr_b16 a[232:233], v6 offset:40960
  ds_read_b64_tr_b16 a[234:235], v6 offset:41984
  ds_read_b64_tr_b16 a[236:237], v6 offset:45056
  ds_read_b64_tr_b16 a[238:239], v6 offset:46080
  v_add_u32 v6, 49152, v6
  ds_read_b64_tr_b16 a[240:241], v6 offset:0
  ds_read_b64_tr_b16 a[242:243], v6 offset:1024
  ds_read_b64_tr_b16 a[244:245], v6 offset:4096
  ds_read_b64_tr_b16 a[246:247], v6 offset:5120
  ds_read_b64_tr_b16 a[248:249], v6 offset:8192
  ds_read_b64_tr_b16 a[250:251], v6 offset:9216
  ds_read_b64_tr_b16 a[252:253], v6 offset:12288
  ds_read_b64_tr_b16 a[254:255], v6 offset:13312
  ds_read_b64_tr_b16 v[224:225], v6 offset:16384
  ds_read_b64_tr_b16 v[226:227], v6 offset:17408
  ds_read_b64_tr_b16 v[228:229], v6 offset:20480
  ds_read_b64_tr_b16 v[230:231], v6 offset:21504
  ds_read_b64_tr_b16 v[232:233], v6 offset:24576
  ds_read_b64_tr_b16 v[234:235], v6 offset:25600
  ds_read_b64_tr_b16 v[236:237], v6 offset:28672
  ds_read_b64_tr_b16 v[238:239], v6 offset:29696
  ds_read_b64_tr_b16 v[240:241], v6 offset:32768
  ds_read_b64_tr_b16 v[242:243], v6 offset:33792
  ds_read_b64_tr_b16 v[244:245], v6 offset:36864
  ds_read_b64_tr_b16 v[246:247], v6 offset:37888
  ds_read_b64_tr_b16 v[248:249], v6 offset:40960
  ds_read_b64_tr_b16 v[250:251], v6 offset:41984
  ds_read_b64_tr_b16 v[252:253], v6 offset:45056
  ds_read_b64_tr_b16 v[254:255], v6 offset:46080
  v_add_u32 v6, 49152, v6
  s_waitcnt lgkmcnt(0)
  v_mov_b32 v5, 0x3f80
  v_mov_b32 v6, 0x3f800000
  v_and_b32 v7, 1, v3
  v_cmp_eq_u32 vcc, 0, v7
  s_nop 1
  v_cndmask_b32 v5, v6, v5, vcc
  v_lshrrev_b32 v7, 1, v3
  v_cmp_eq_u32 vcc, 0, v7
  s_nop 1
  v_cndmask_b32 v24, 0, v5, vcc
  v_cmp_eq_u32 vcc, 1, v7
  s_nop 1
  v_cndmask_b32 v25, 0, v5, vcc
  v_cmp_eq_u32 vcc, 2, v7
  s_nop 1
  v_cndmask_b32 v26, 0, v5, vcc
  v_cmp_eq_u32 vcc, 3, v7
  s_nop 1
  v_cndmask_b32 v27, 0, v5, vcc
  v_lshrrev_b32 v5, 1, v4
  v_lshlrev_b32 v11, 4, v3
  v_lshl_add_u32 v11, v5, 8, v11
  v_and_b32 v5, 1, v4
  v_lshl_add_u32 v11, v5, 3, v11
  v_add_u32 v11, 4096, v11
  v_mul_u32_u24 v12, 37120, v4
  v_lshl_add_u32 v12, v3, 4, v12
  s_mul_i32 s47, s45, 37120
  s_add_u32 s61, s74, s47
  s_mul_i32 s47, s44, 4608
  s_add_u32 s61, s61, s47
  s_lshl_b32 s63, s44, 5
  s_add_u32 s63, s63, s45
  s_lshl_b32 s47, s63, 8
  s_add_u32 s62, s74, s47
  s_mov_b32 s64, 0
  s_mov_b32 s66, 0
  s_mov_b32 s50, 0x40000
  s_mov_b32 s46, 0x11111111
  s_cmp_eq_u32 s44, 0
  s_cbranch_scc0 gb_180_w
  s_branch gb_180_l
gb_180:
  s_sleep 8
gb_180_l:
  v_mbcnt_lo_u32_b32 v32, -1, 0
  v_and_b32 v32, 31, v32
  v_lshlrev_b32 v32, 2, v32
  v_lshl_add_u32 v32, s75, 7, v32
  global_load_dword v33, v32, s[40:41] sc1
  s_sub_u32 s50, s50, 1
  s_cbranch_scc1 K_end
  s_waitcnt vmcnt(0)
gb_180_c:
  v_mul_lo_u32 v34, v33, s46
  v_cmp_le_i32 vcc, 0, v34
  s_cbranch_vccnz gb_180
  v_cmp_ne_u32 vcc, s46, v33
  s_cmp_lg_u64 vcc, 0
  s_cselect_b32 s46, 1, 0
  v_mov_b32 v32, 163836
  v_mov_b32 v33, s46
  ds_write_b32 v32, v33
  s_waitcnt lgkmcnt(0)
gb_180_w:
  s_barrier
  v_mov_b32 v32, 163836
  ds_read_b32 v33, v32
  s_waitcnt lgkmcnt(0)
  v_readfirstlane_b32 s46, v33
  s_cmp_gt_u32 s46, s75
  s_cbranch_scc1 K_again
  s_mov_b32 s8, s16
  s_mov_b32 s9, s17
  s_mov_b32 s10, 2359296
  s_mov_b32 s11, 0x20000
  s_mov_b32 s29, 64
  s_mov_b32 s38, 52
  s_cmp_eq_u32 s3, 2
  s_cbranch_scc0 AI_zn
AI_zl:
  buffer_load_dword v32, off, s[4:7], 0 offset:2432 sc1
  s_sub_u32 s50, s50, 1
  s_cbranch_scc1 K_end
  s_waitcnt vmcnt(0)
  v_readfirstlane_b32 s28, v32
AI_zg:
  s_cmp_eq_u32 s28, 0
  s_cbranch_scc1 AI_zl
  s_sub_u32 s29, s28, 2
  s_add_u32 s38, s28, 1
AI_zn:
  s_sub_u32 s67, s3, 3
  s_cselect_b32 s67, s28, s67
  s_mov_b32 s30, 0
  s_mov_b32 s68, 0
  s_mov_b32 s69, 0
  s_lshl_b32 s70, s45, 6
  s_mov_b32 s50, 0x100000
  s_barrier
  s_lshl_b32 s46, s45, 2
  s_add_u32 s46, s46, s44
  s_lshl_b32 s52, s46, 12
  s_add_u32 s52, s52, 58720256
  s_mul_i32 s54, s44, 9216
  s_add_u32 s53, s54, 1048576
  s_add_u32 s54, s54, 40960
  s_lshl_b32 s55, s46, 10
  s_add_u32 s55, s55, 4194304
  s_mul_i32 s48, s67, 36864
  s_add_u32 s53, s53, s48
  s_mov_b32 s48, s53
  s_add_u32 m0, s54, 0
  s_nop 0
  buffer_load_dwordx4 v1, s[4:7], s48 offen offset:0 sc1 lds
  buffer_load_dwordx4 v1, s[4:7], s48 offen offset:1024 sc1 lds
  buffer_load_dwordx4 v1, s[4:7], s48 offen offset:2048 sc1 lds
  buffer_load_dwordx4 v1, s[4:7], s48 offen offset:3072 sc1 lds
  s_add_u32 m0, s54, 4096
  s_add_u32 s48, s48, 4096
  buffer_load_dwordx4 v1, s[4:7], s48 offen offset:0 sc1 lds
  buffer_load_dwordx4 v1, s[4:7], s48 offen offset:1024 sc1 lds
  buffer_load_dwordx4 v1, s[4:7], s48 offen offset:2048 sc1 lds
  buffer_load_dwordx4 v1, s[4:7], s48 offen offset:3072 sc1 lds
  s_add_u32 m0, s54, 8192
  s_add_u32 s48, s48, 4096
  buffer_load_dwordx4 v1, s[4:7], s48 offen offset:0 sc1 lds
  s_mov_b32 s51, 36864
  s_mov_b32 s60, 0
AI_dm:
  s_cmp_gt_u32 s68, s67
  s_cbranch_scc0 AI_fl
  s_cmp_lt_u32 s67, 64
  s_cselect_b32 s47, s67, 0x800
  s_lshl_b32 s46, s44, 12
  s_add_u32 m0, s46, 24576
  s_lshl_b32 s48, s47, 19
  s_add_u32 s48, s48, s52
  s_lshl_b32 s47, s47, 17
  s_add_u32 s59, s47, s55
  buffer_load_dwordx4 v1, s[4:7], s48 offen offset:0 sc1 lds
  buffer_load_dwordx4 v1, s[4:7], s48 offen offset:1024 sc1 lds
  buffer_load_dwordx4 v1, s[4:7], s48 offen offset:2048 sc1 lds
  buffer_load_dwordx4 v1, s[4:7], s48 offen offset:3072 sc1 lds
  s_mul_i32 s56, s67, 36864
  s_lshl_b32 s47, s63, 8
  s_add_u32 s57, s56, s47
  s_add_u32 s57, s57, 12582912
  s_lshl_b32 s47, s63, 4
  s_add_u32 s56, s56, s47
  s_add_u32 s73, s56, 19328
  s_cmp_ge_u32 s63, 72
  s_cselect_b32 s47, 17280, 0
  s_add_u32 s56, s56, s47
  s_cmp_lt_u32 s63, 16
  s_cselect_b32 s72, 1, 0
  s_cselect_b32 s73, s73, 1073741824
  v_mul_u32_u24 v13, 1152, v3
  v_lshl_add_u32 v13, v4, 3, v13
  v_mov_b32 v5, 1073741824
  v_cmp_gt_u32 vcc, 2, v4
  s_nop 1
  v_cndmask_b32 v13, v5, v13, vcc
  v_cmp_eq_u32 vcc, 0, v4
  s_nop 1
  v_cndmask_b32 v10, v5, v1, vcc
  s_lshl_b32 s46, s44, 10
  v_add_u32 v16, s46, v1
  v_add_u32 v21, 40960, v1
  s_lshl_b32 s46, s44, 11
  v_add_u32 v9, s46, v1
  v_and_b32 v14, 7, v2
  v_lshl_add_u32 v14, v4, 3, v14
  v_lshlrev_b32 v14, 4, v14
  v_bfe_u32 v7, v2, 3, 1
  v_lshl_add_u32 v14, v7, 10, v14
  v_add_u32 v14, s46, v14
  s_lshr_b32 s49, s44, 1
  s_lshl_b32 s46, s49, 10
  v_add_u32 v23, s46, v1
  v_lshrrev_b32 v6, 2, v3
  v_mul_u32_u24 v20, 144, v6
  v_lshl_add_u32 v20, v4, 5, v20
  v_and_b32 v5, 3, v3
  v_lshl_add_u32 v20, v5, 2, v20
  s_mul_i32 s46, s44, 576
  s_add_u32 s46, s46, 20480
  v_add_u32 v20, s46, v20
  v_mul_u32_u24 v15, 144, v4
  v_lshl_add_u32 v15, v6, 5, v15
  v_and_b32 v5, 1, v3
  v_lshl_add_u32 v15, v5, 4, v15
  s_lshl_b32 s47, s49, 4
  v_add_u32 v5, s47, v3
  v_lshlrev_b32 v6, 2, v4
  v_sub_u32 v5, v5, v6
  v_mov_b32 v6, 0xf149f2ca
  v_mov_b32 v18, 0
  v_cmp_le_i32 vcc, 0, v5
  s_nop 1
  v_cndmask_b32 v32, v6, 0, vcc
  v_cmp_le_i32 vcc, 1, v5
  s_nop 1
  v_cndmask_b32 v33, v6, 0, vcc
  v_cmp_le_i32 vcc, 2, v5
  s_nop 1
  v_cndmask_b32 v34, v6, 0, vcc
  v_cmp_le_i32 vcc, 3, v5
  s_nop 1
  v_cndmask_b32 v35, v6, 0, vcc
  v_cmp_le_i32 vcc, 16, v5
  s_nop 1
  v_cndmask_b32 v36, v6, 0, vcc
  v_cmp_le_i32 vcc, 17, v5
  s_nop 1
  v_cndmask_b32 v37, v6, 0, vcc
  v_cmp_le_i32 vcc, 18, v5
  s_nop 1
  v_cndmask_b32 v38, v6, 0, vcc
  v_cmp_le_i32 vcc, 19, v5
  s_nop 1
  v_cndmask_b32 v39, v6, 0, vcc
  s_and_b32 s46, s44, 1
  s_lshl_b32 s47, s46, 13
  v_add_u32 v2, s47, v1
  s_lshl_b32 s47, s46, 11
  v_add_u32 v3, s47, v1
  s_mov_b32 s58, 0x3e0293ee
  s_waitcnt vmcnt(0)
  s_cmp_eq_u32 s75, 0
  s_cbranch_scc0 AF_in
A_in:
  v_mov_b32 v22, 0
  v_mov_b32 v4, 0
  s_barrier
  ds_read_b128 v[104:107], v21 offset:0
  ds_read_b128 v[108:111], v21 offset:1024
  ds_read_b128 v[112:115], v21 offset:2048
  ds_read_b128 v[116:119], v21 offset:3072
  ds_read_b128 v[120:123], v21 offset:4096
A_loop:
  ds_read_b128 v[124:127], v21 offset:5120
  s_waitcnt lgkmcnt(5)
  v_mfma_f32_32x32x16_bf16 v[40:55], a[144:147], v[104:107], 0
  s_mul_i32 s31, s30, 36864
  s_cmp_lt_u32 s67, s29
  s_cselect_b32 s30, 2, 3
  s_cmp_eq_u32 s67, 61
  s_cselect_b32 s30, 2, s30
  s_mul_i32 s48, s30, 36864
  s_add_u32 s53, s53, s48
  ds_read_b128 v[128:131], v21 offset:6144
  s_waitcnt lgkmcnt(5)
  v_mfma_f32_32x32x16_bf16 v[40:55], a[148:151], v[108:111], v[40:55]
  ds_read_b128 v[56:59], v1 offset:24576
  s_add_u32 s54, s54, s51
  s_add_u32 s48, s67, s30
  s_cmp_lt_u32 s48, 64
  s_cselect_b32 s48, s53, 1073741824
  ds_read_b128 v[132:135], v21 offset:7168
  s_waitcnt lgkmcnt(6)
  v_mfma_f32_32x32x16_bf16 v[40:55], a[152:155], v[112:115], v[40:55]
  s_waitcnt vmcnt(5)
  v_readfirstlane_b32 s69, v22
  v_readfirstlane_b32 s28, v4
  ds_read_b128 v[104:107], v21 offset:8192
  s_waitcnt lgkmcnt(6)
  v_mfma_f32_32x32x16_bf16 v[40:55], a[156:159], v[116:119], v[40:55]
  ds_read_b128 v[60:63], v1 offset:25600
  s_cmp_gt_u32 s69, s67
  s_cselect_b32 s46, s59, 1073741824
  buffer_load_dwordx4 v[28:31], v1, s[4:7], s46 offen sc1
  ds_read_b128 v[108:111], v21 offset:9216
  s_waitcnt lgkmcnt(7)
  v_mfma_f32_32x32x16_bf16 v[40:55], a[160:163], v[120:123], v[40:55]
  s_add_u32 m0, s54, 0
  s_nop 0
  buffer_load_dwordx4 v1, s[4:7], s48 offen offset:0 sc1 lds
  ds_read_b128 v[112:115], v21 offset:10240
  s_waitcnt lgkmcnt(7)
  v_mfma_f32_32x32x16_bf16 v[40:55], a[164:167], v[124:127], v[40:55]
  ds_read_b128 v[64:67], v1 offset:28672
  ds_read_b128 v[116:119], v21 offset:11264
  s_waitcnt lgkmcnt(8)
  v_mfma_f32_32x32x16_bf16 v[40:55], a[168:171], v[128:131], v[40:55]
  ds_read_b128 v[120:123], v21 offset:12288
  s_waitcnt lgkmcnt(7)
  v_mfma_f32_32x32x16_bf16 v[40:55], a[172:175], v[132:135], v[40:55]
  ds_read_b128 v[68:71], v1 offset:29696
  buffer_load_dwordx4 v1, s[4:7], s48 offen offset:1024 sc1 lds
  ds_read_b128 v[124:127], v21 offset:13312
  s_waitcnt lgkmcnt(8)
  v_mfma_f32_32x32x16_bf16 v[40:55], a[176:179], v[104:107], v[40:55]
  ds_read_b128 v[128:131], v21 offset:14336
  s_waitcnt lgkmcnt(7)
  v_mfma_f32_32x32x16_bf16 v[40:55], a[180:183], v[108:111], v[40:55]
  ds_read_b128 v[72:75], v1 offset:32768
  ds_read_b128 v[132:135], v21 offset:15360
  s_waitcnt lgkmcnt(8)
  v_mfma_f32_32x32x16_bf16 v[40:55], a[184:187], v[112:115], v[40:55]
  buffer_load_dwordx4 v1, s[4:7], s48 offen offset:2048 sc1 lds
  ds_read_b128 v[104:107], v21 offset:16384
  s_waitcnt lgkmcnt(7)
  v_mfma_f32_32x32x16_bf16 v[40:55], a[188:191], v[116:119], v[40:55]
  ds_read_b128 v[76:79], v1 offset:33792
  ds_read_b128 v[108:111], v21 offset:17408
  s_waitcnt lgkmcnt(8)
  v_mfma_f32_32x32x16_bf16 v[40:55], a[192:195], v[120:123], v[40:55]
  ds_read_b128 v[112:115], v21 offset:18432
  s_waitcnt lgkmcnt(7)
  v_mfma_f32_32x32x16_bf16 v[40:55], a[196:199], v[124:127], v[40:55]
  ds_read_b128 v[80:83], v1 offset:36864
  buffer_load_dwordx4 v1, s[4:7], s48 offen offset:3072 sc1 lds
  ds_read_b128 v[116:119], v21 offset:19456
  s_waitcnt lgkmcnt(8)
  v_mfma_f32_32x32x16_bf16 v[40:55], a[200:203], v[128:131], v[40:55]
  ds_read_b128 v[120:123], v21 offset:20480
  s_waitcnt lgkmcnt(7)
  v_mfma_f32_32x32x16_bf16 v[40:55], a[204:207], v[132:135], v[40:55]
  ds_read_b128 v[84:87], v1 offset:37888
  ds_read_b128 v[124:127], v21 offset:21504
  s_waitcnt lgkmcnt(8)
  v_mfma_f32_32x32x16_bf16 v[40:55], a[208:211], v[104:107], v[40:55]
  s_add_u32 m0, s54, 4096
  s_add_u32 s48, s48, 4096
  buffer_load_dwordx4 v1, s[4:7], s48 offen offset:0 sc1 lds
  ds_read_b128 v[128:131], v21 offset:22528
  s_waitcnt lgkmcnt(7)
  v_mfma_f32_32x32x16_bf16 v[40:55], a[212:215], v[108:111], v[40:55]
  ds_read_b128 v[88:91], v2 offset:26624
  ds_read_b128 v[132:135], v21 offset:23552
  s_waitcnt lgkmcnt(8)
  v_mfma_f32_32x32x16_bf16 v[40:55], a[216:219], v[112:115], v[40:55]
  ds_read_b128 v[104:107], v21 offset:24576
  s_waitcnt lgkmcnt(7)
  v_mfma_f32_32x32x16_bf16 v[40:55], a[220:223], v[116:119], v[40:55]
  ds_read_b128 v[92:95], v2 offset:27648
  buffer_load_dwordx4 v1, s[4:7], s48 offen offset:1024 sc1 lds
  ds_read_b128 v[108:111], v21 offset:25600
  s_waitcnt lgkmcnt(8)
  v_mfma_f32_32x32x16_bf16 v[40:55], a[224:227], v[120:123], v[40:55]
  ds_read_b128 v[112:115], v21 offset:26624
  s_waitcnt lgkmcnt(7)
  v_mfma_f32_32x32x16_bf16 v[40:55], a[228:231], v[124:127], v[40:55]
  ds_read_b128 v[96:99], v2 offset:30720
  ds_read_b128 v[116:119], v21 offset:27648
  s_waitcnt lgkmcnt(8)
  v_mfma_f32_32x32x16_bf16 v[40:55], a[232:235], v[128:131], v[40:55]
  buffer_load_dwordx4 v1, s[4:7], s48 offen offset:2048 sc1 lds
  ds_read_b128 v[120:123], v21 offset:28672
  s_waitcnt lgkmcnt(7)
  v_mfma_f32_32x32x16_bf16 v[40:55], a[236:239], v[132:135], v[40:55]
  ds_read_b128 v[100:103], v2 offset:31744
  ds_read_b128 v[124:127], v21 offset:29696
  s_waitcnt lgkmcnt(8)
  v_mfma_f32_32x32x16_bf16 v[40:55], a[240:243], v[104:107], v[40:55]
  ds_read_b128 v[128:131], v21 offset:30720
  s_waitcnt lgkmcnt(7)
  v_mfma_f32_32x32x16_bf16 v[40:55], a[244:247], v[108:111], v[40:55]
  buffer_load_dwordx4 v1, s[4:7], s48 offen offset:3072 sc1 lds
  ds_read_b128 v[132:135], v21 offset:31744
  s_waitcnt lgkmcnt(7)
  v_mfma_f32_32x32x16_bf16 v[40:55], a[248:251], v[112:115], v[40:55]
  ds_read_b128 v[104:107], v21 offset:32768
  s_waitcnt lgkmcnt(6)
  v_mfma_f32_32x32x16_bf16 v[40:55], a[252:255], v[116:119], v[40:55]
  ds_read_b128 v[108:111], v21 offset:33792
  s_waitcnt lgkmcnt(6)
  v_mfma_f32_32x32x16_bf16 v[40:55], v[224:227], v[120:123], v[40:55]
  s_add_u32 m0, s54, 8192
  s_add_u32 s48, s48, 4096
  buffer_load_dwordx4 v1, s[4:7], s48 offen offset:0 sc1 lds
  ds_read_b128 v[112:115], v21 offset:34816
  s_waitcnt lgkmcnt(5)
  v_mfma_f32_32x32x16_bf16 v[40:55], v[228:231], v[124:127], v[40:55]
  ds_read_b128 v[116:119], v21 offset:35840
  s_waitcnt lgkmcnt(5)
  v_mfma_f32_32x32x16_bf16 v[40:55], v[232:235], v[128:131], v[40:55]
  s_waitcnt lgkmcnt(4)
  v_mfma_f32_32x32x16_bf16 v[40:55], v[236:239], v[132:135], v[40:55]
  s_waitcnt lgkmcnt(3)
  v_mfma_f32_32x32x16_bf16 v[40:55], v[240:243], v[104:107], v[40:55]
  v_add_u32 v21, s51, v21
  s_sub_u32 s51, 0, s51
  s_waitcnt lgkmcnt(2)
  v_mfma_f32_32x32x16_bf16 v[40:55], v[244:247], v[108:111], v[40:55]
  s_waitcnt lgkmcnt(1)
  v_mfma_f32_32x32x16_bf16 v[40:55], v[248:251], v[112:115], v[40:55]
  s_waitcnt lgkmcnt(0)
  v_mfma_f32_32x32x16_bf16 v[40:55], v[252:255], v[116:119], v[40:55]
  s_nop 11
  v_cvt_pk_bf16_f32 v40, v40, v44
  v_cvt_pk_bf16_f32 v41, v41, v45
  v_cvt_pk_bf16_f32 v42, v42, v46
  v_cvt_pk_bf16_f32 v43, v43, v47
  ds_write_b128 v14, v[40:43] offset:0
  v_cvt_pk_bf16_f32 v48, v48, v52
  v_cvt_pk_bf16_f32 v49, v49, v53
  v_cvt_pk_bf16_f32 v50, v50, v54
  v_cvt_pk_bf16_f32 v51, v51, v55
  ds_write_b128 v14, v[48:51] offset:512
  s_waitcnt lgkmcnt(0)
  s_barrier
  ds_read_b128 v[40:43], v23 offset:0
  ds_read_b128 v[44:47], v23 offset:2048
  ds_read_b128 v[48:51], v23 offset:4096
  ds_read_b128 v[52:55], v23 offset:6144
  s_cmp_gt_u32 s69, s67
  s_cbranch_scc0 A_wt
  s_waitcnt vmcnt(9)
A_chk:
  v_max3_u32 v17, v28, v29, v30
  v_max_u32 v17, v17, v31
  v_cmp_eq_u32 vcc, -1, v17
  s_cbranch_vccnz A_pollk
  ds_write2_b32 v20, v28, v30 offset0:0 offset1:4
  ds_write_b128 v16, v[28:31] offset:16384
  s_add_u32 s67, s67, s30
  s_waitcnt lgkmcnt(5)
  v_mfma_f32_16x16x32_bf16 v[104:107], v[56:59], v[40:43], v[32:35]
  v_mfma_f32_16x16x32_bf16 v[108:111], v[60:63], v[40:43], v[36:39]
  s_waitcnt lgkmcnt(4)
  v_mfma_f32_16x16x32_bf16 v[104:107], v[64:67], v[44:47], v[104:107]
  s_cmp_lg_u32 s72, 0
  s_cselect_b64 vcc, -1, 0
  s_cmp_eq_u32 s60, 0
  s_waitcnt lgkmcnt(0)
  s_barrier
  ds_read_b128 v[116:119], v15 offset:20480
  ds_read_b128 v[120:123], v15 offset:21056
  v_mfma_f32_16x16x32_bf16 v[108:111], v[68:71], v[44:47], v[108:111]
  ds_read_b128 v[124:127], v15 offset:21632
  v_mfma_f32_16x16x32_bf16 v[104:107], v[72:75], v[48:51], v[104:107]
  ds_read_b128 v[128:131], v15 offset:22208
  v_mfma_f32_16x16x32_bf16 v[108:111], v[76:79], v[48:51], v[108:111]
  ds_read_b128 v[132:135], v3 offset:16384
  v_mfma_f32_16x16x32_bf16 v[104:107], v[80:83], v[52:55], v[104:107]
  ds_read_b128 v[136:139], v3 offset:17408
  v_mfma_f32_16x16x32_bf16 v[108:111], v[84:87], v[52:55], v[108:111]
  s_cbranch_scc0 A_sp
  s_waitcnt lgkmcnt(5)
  v_mfma_f32_16x16x32_bf16 v[112:115], v[116:119], v[40:43], 0
  s_waitcnt lgkmcnt(4)
  v_mfma_f32_16x16x32_bf16 v[112:115], v[120:123], v[44:47], v[112:115]
  v_max3_f32 v5, v104, v105, v106
  v_max3_f32 v5, v5, v107, v108
  s_waitcnt lgkmcnt(3)
  v_mfma_f32_16x16x32_bf16 v[112:115], v[124:127], v[48:51], v[112:115]
  v_max3_f32 v5, v5, v109, v110
  v_max_f32 v5, v5, v111
  s_waitcnt lgkmcnt(2)
  v_mfma_f32_16x16x32_bf16 v[112:115], v[128:131], v[52:55], v[112:115]
  s_nop 7
  v_max3_f32 v5, v5, v112, v113
  v_mov_b32 v6, v5
  s_nop 1
  v_permlane32_swap_b32 v5, v6
  v_max_f32 v5, v5, v6
  v_mov_b32 v6, v5
  s_nop 1
  v_permlane16_swap_b32 v5, v6
  v_max_f32 v5, v5, v6
  v_mul_f32 v6, s58, v5
  v_pk_fma_f32 v[104:105], v[104:105], s[58:59], v[6:7] op_sel_hi:[1,0,0] neg_lo:[0,0,1] neg_hi:[0,0,1]
  v_pk_fma_f32 v[106:107], v[106:107], s[58:59], v[6:7] op_sel_hi:[1,0,0] neg_lo:[0,0,1] neg_hi:[0,0,1]
  v_pk_fma_f32 v[108:109], v[108:109], s[58:59], v[6:7] op_sel_hi:[1,0,0] neg_lo:[0,0,1] neg_hi:[0,0,1]
  v_pk_fma_f32 v[110:111], v[110:111], s[58:59], v[6:7] op_sel_hi:[1,0,0] neg_lo:[0,0,1] neg_hi:[0,0,1]
  v_pk_fma_f32 v[112:113], v[112:113], s[58:59], v[6:7] op_sel_hi:[1,0,0] neg_lo:[0,0,1] neg_hi:[0,0,1]
  v_exp_f32 v104, v104
  v_exp_f32 v105, v105
  v_exp_f32 v106, v106
  v_exp_f32 v107, v107
  v_exp_f32 v108, v108
  v_exp_f32 v109, v109
  v_exp_f32 v110, v110
  v_exp_f32 v111, v111
  v_exp_f32 v112, v112
  v_exp_f32 v113, v113
  v_cvt_pk_bf16_f32 v116, v104, v105
  v_cvt_pk_bf16_f32 v117, v106, v107
  v_cvt_pk_bf16_f32 v118, v108, v109
  v_cvt_pk_bf16_f32 v119, v110, v111
  v_cvt_pk_bf16_f32 v19, v112, v113
  v_pk_add_f32 v[114:115], v[104:105], v[106:107]
  v_mfma_f32_16x16x32_bf16 v[56:59], v[88:91], v[116:119], 0
  v_pk_add_f32 v[114:115], v[114:115], v[108:109]
  v_mfma_f32_16x16x32_bf16 v[60:63], v[92:95], v[116:119], 0
  v_pk_add_f32 v[114:115], v[114:115], v[110:111]
  v_mfma_f32_16x16x32_bf16 v[64:67], v[96:99], v[116:119], 0
  v_pk_add_f32 v[114:115], v[114:115], v[112:113]
  v_mfma_f32_16x16x32_bf16 v[68:71], v[100:103], v[116:119], 0
  v_add_f32 v5, v114, v115
  s_waitcnt lgkmcnt(1)
  v_mfma_f32_16x16x16_bf16 v[56:59], v[132:133], v[18:19], v[56:59]
  v_mfma_f32_16x16x16_bf16 v[60:63], v[134:135], v[18:19], v[60:63]
  s_waitcnt lgkmcnt(0)
  v_mfma_f32_16x16x16_bf16 v[64:67], v[136:137], v[18:19], v[64:67]
  v_mfma_f32_16x16x16_bf16 v[68:71], v[138:139], v[18:19], v[68:71]
  v_mov_b32 v6, v5
  s_nop 1
  v_permlane32_swap_b32 v5, v6
  v_add_f32 v5, v5, v6
  v_mov_b32 v6, v5
  s_nop 1
  v_permlane16_swap_b32 v5, v6
  v_add_f32 v5, v5, v6
  v_rcp_f32 v6, v5
  s_nop 0
  v_pk_mul_f32 v[56:57], v[56:57], v[6:7] op_sel_hi:[1,0]
  v_pk_mul_f32 v[58:59], v[58:59], v[6:7] op_sel_hi:[1,0]
  v_pk_mul_f32 v[60:61], v[60:61], v[6:7] op_sel_hi:[1,0]
  v_pk_mul_f32 v[62:63], v[62:63], v[6:7] op_sel_hi:[1,0]
  v_cvt_pk_bf16_f32 v56, v56, v57
  v_cvt_pk_bf16_f32 v57, v58, v59
  v_cvt_pk_bf16_f32 v58, v60, v61
  v_cvt_pk_bf16_f32 v59, v62, v63
  ds_write_b128 v9, v[56:59] offset:8192
  v_pk_mul_f32 v[64:65], v[64:65], v[6:7] op_sel_hi:[1,0]
  v_pk_mul_f32 v[66:67], v[66:67], v[6:7] op_sel_hi:[1,0]
  v_pk_mul_f32 v[68:69], v[68:69], v[6:7] op_sel_hi:[1,0]
  v_pk_mul_f32 v[70:71], v[70:71], v[6:7] op_sel_hi:[1,0]
  v_cvt_pk_bf16_f32 v64, v64, v65
  v_cvt_pk_bf16_f32 v65, v66, v67
  v_cvt_pk_bf16_f32 v66, v68, v69
  v_cvt_pk_bf16_f32 v67, v70, v71
  ds_write_b128 v9, v[64:67] offset:9216
A_jn:
A_dm:
  s_cmp_gt_u32 s68, s67
  s_cbranch_scc0 A_fl
  s_cmp_lt_u32 s67, 64
  s_cselect_b32 s47, s67, 0x800
  s_lshl_b32 s46, s44, 12
  s_add_u32 m0, s46, 24576
  s_lshl_b32 s48, s47, 19
  s_add_u32 s48, s48, s52
  s_lshl_b32 s47, s47, 17
  s_add_u32 s59, s47, s55
  s_cmp_eq_u32 s67, 66
  s_cselect_b32 s46, s3, 2
  s_cmp_lg_u32 s46, 2
  s_cselect_b32 s46, 4096, 0
  v_add_u32 v5, s46, v1
  s_cselect_b32 s46, 18432, 0
  s_add_u32 s56, s56, s46
  s_add_u32 s57, s57, s46
  s_add_u32 s71, s61, 18432
  s_mov_b32 s60, 1
  s_waitcnt lgkmcnt(0)
  s_barrier
A_p2:
  ds_read_b128 v[56:59], v5 offset:8192
  ds_read_b128 v[60:63], v5 offset:9216
  ds_read_b128 v[64:67], v5 offset:10240
  ds_read_b128 v[68:71], v5 offset:11264
  ds_read_b128 v[72:75], v5 offset:12288
  ds_read_b128 v[76:79], v5 offset:13312
  ds_read_b128 v[80:83], v5 offset:14336
  ds_read_b128 v[84:87], v5 offset:15360
  buffer_load_dwordx4 v1, s[4:7], s48 offen offset:0 sc1 lds
  s_waitcnt lgkmcnt(7)
  v_mfma_f32_16x16x32_bf16 v[140:143], a[0:3], v[56:59], 0
  buffer_load_dwordx2 v[220:221], v13, s[8:11], s56 offen
  v_mfma_f32_16x16x32_bf16 v[144:147], a[16:19], v[56:59], 0
  v_mfma_f32_16x16x32_bf16 v[148:151], a[32:35], v[56:59], 0
  buffer_load_dwordx4 v1, s[4:7], s48 offen offset:1024 sc1 lds
  s_waitcnt lgkmcnt(6)
  v_mfma_f32_16x16x32_bf16 v[140:143], a[4:7], v[60:63], v[140:143]
  buffer_load_dwordx2 v[222:223], v13, s[8:11], s73 offen
  v_mfma_f32_16x16x32_bf16 v[144:147], a[20:23], v[60:63], v[144:147]
  v_mfma_f32_16x16x32_bf16 v[148:151], a[36:39], v[60:63], v[148:151]
  buffer_load_dwordx4 v1, s[4:7], s48 offen offset:2048 sc1 lds
  s_waitcnt lgkmcnt(5)
  v_mfma_f32_16x16x32_bf16 v[140:143], a[8:11], v[64:67], v[140:143]
  v_mfma_f32_16x16x32_bf16 v[144:147], a[24:27], v[64:67], v[144:147]
  v_mfma_f32_16x16x32_bf16 v[148:151], a[40:43], v[64:67], v[148:151]
  buffer_load_dwordx4 v1, s[4:7], s48 offen offset:3072 sc1 lds
  s_waitcnt lgkmcnt(4)
  v_mfma_f32_16x16x32_bf16 v[140:143], a[12:15], v[68:71], v[140:143]
  v_mfma_f32_16x16x32_bf16 v[144:147], a[28:31], v[68:71], v[144:147]
  v_mfma_f32_16x16x32_bf16 v[148:151], a[44:47], v[68:71], v[148:151]
  v_mfma_f32_16x16x32_bf16 v[152:155], a[48:51], v[56:59], 0
  v_mfma_f32_16x16x32_bf16 v[156:159], a[64:67], v[56:59], 0
  v_mfma_f32_16x16x32_bf16 v[160:163], a[80:83], v[56:59], 0
  v_mfma_f32_16x16x32_bf16 v[152:155], a[52:55], v[60:63], v[152:155]
  v_cvt_pk_bf16_f32 v140, v140, v141
  v_cvt_pk_bf16_f32 v141, v142, v143
  v_mfma_f32_16x16x32_bf16 v[156:159], a[68:71], v[60:63], v[156:159]
  v_cvt_pk_bf16_f32 v142, v144, v145
  v_cvt_pk_bf16_f32 v143, v146, v147
  v_mfma_f32_16x16x32_bf16 v[160:163], a[84:87], v[60:63], v[160:163]
  v_bfi_b32 v140, 1, s64, v140
  v_bfi_b32 v141, 1, s64, v141
  v_mfma_f32_16x16x32_bf16 v[152:155], a[56:59], v[64:67], v[152:155]
  v_bfi_b32 v142, 1, s64, v142
  v_bfi_b32 v143, 1, s64, v143
  v_mfma_f32_16x16x32_bf16 v[156:159], a[72:75], v[64:67], v[156:159]
  buffer_store_dwordx4 v[140:143], v1, s[4:7], s61 offen offset:0
  v_mfma_f32_16x16x32_bf16 v[160:163], a[88:91], v[64:67], v[160:163]
  v_mfma_f32_16x16x32_bf16 v[152:155], a[60:63], v[68:71], v[152:155]
  v_mfma_f32_16x16x32_bf16 v[156:159], a[76:79], v[68:71], v[156:159]
  v_mfma_f32_16x16x32_bf16 v[160:163], a[92:95], v[68:71], v[160:163]
  v_mfma_f32_16x16x32_bf16 v[164:167], a[96:99], v[56:59], 0
  v_mfma_f32_16x16x32_bf16 v[168:171], a[112:115], v[56:59], 0
  v_mfma_f32_16x16x32_bf16 v[172:175], a[128:131], v[56:59], 0
  v_mfma_f32_16x16x32_bf16 v[164:167], a[100:103], v[60:63], v[164:167]
  v_cvt_pk_bf16_f32 v148, v148, v149
  v_cvt_pk_bf16_f32 v149, v150, v151
  v_mfma_f32_16x16x32_bf16 v[168:171], a[116:119], v[60:63], v[168:171]
  v_cvt_pk_bf16_f32 v150, v152, v153
  v_cvt_pk_bf16_f32 v151, v154, v155
  v_mfma_f32_16x16x32_bf16 v[172:175], a[132:135], v[60:63], v[172:175]
  v_bfi_b32 v148, 1, s64, v148
  v_bfi_b32 v149, 1, s64, v149
  v_mfma_f32_16x16x32_bf16 v[164:167], a[104:107], v[64:67], v[164:167]
  v_bfi_b32 v150, 1, s64, v150
  v_bfi_b32 v151, 1, s64, v151
  v_mfma_f32_16x16x32_bf16 v[168:171], a[120:123], v[64:67], v[168:171]
  buffer_store_dwordx4 v[148:151], v1, s[4:7], s61 offen offset:1024
  v_cvt_pk_bf16_f32 v156, v156, v157
  v_mfma_f32_16x16x32_bf16 v[172:175], a[136:139], v[64:67], v[172:175]
  v_cvt_pk_bf16_f32 v157, v158, v159
  v_cvt_pk_bf16_f32 v158, v160, v161
  v_mfma_f32_16x16x32_bf16 v[164:167], a[108:111], v[68:71], v[164:167]
  v_cvt_pk_bf16_f32 v159, v162, v163
  v_bfi_b32 v156, 1, s64, v156
  v_mfma_f32_16x16x32_bf16 v[168:171], a[124:127], v[68:71], v[168:171]
  v_bfi_b32 v157, 1, s64, v157
  v_bfi_b32 v158, 1, s64, v158
  v_mfma_f32_16x16x32_bf16 v[172:175], a[140:143], v[68:71], v[172:175]
  v_bfi_b32 v159, 1, s64, v159
  buffer_store_dwordx4 v[156:159], v1, s[4:7], s61 offen offset:2048
  s_waitcnt lgkmcnt(3)
  v_mfma_f32_16x16x32_bf16 v[176:179], a[0:3], v[72:75], 0
  v_mfma_f32_16x16x32_bf16 v[180:183], a[16:19], v[72:75], 0
  v_mfma_f32_16x16x32_bf16 v[184:187], a[32:35], v[72:75], 0
  s_waitcnt lgkmcnt(2)
  v_mfma_f32_16x16x32_bf16 v[176:179], a[4:7], v[76:79], v[176:179]
  v_cvt_pk_bf16_f32 v164, v164, v165
  v_cvt_pk_bf16_f32 v165, v166, v167
  v_mfma_f32_16x16x32_bf16 v[180:183], a[20:23], v[76:79], v[180:183]
  v_cvt_pk_bf16_f32 v166, v168, v169
  v_cvt_pk_bf16_f32 v167, v170, v171
  v_mfma_f32_16x16x32_bf16 v[184:187], a[36:39], v[76:79], v[184:187]
  v_bfi_b32 v164, 1, s64, v164
  v_bfi_b32 v165, 1, s64, v165
  s_waitcnt lgkmcnt(1)
  v_mfma_f32_16x16x32_bf16 v[176:179], a[8:11], v[80:83], v[176:179]
  v_bfi_b32 v166, 1, s64, v166
  v_bfi_b32 v167, 1, s64, v167
  v_mfma_f32_16x16x32_bf16 v[180:183], a[24:27], v[80:83], v[180:183]
  buffer_store_dwordx4 v[164:167], v1, s[4:7], s61 offen offset:3072
  v_cvt_pk_bf16_f32 v172, v172, v173
  v_mfma_f32_16x16x32_bf16 v[184:187], a[40:43], v[80:83], v[184:187]
  v_cvt_pk_bf16_f32 v173, v174, v175
  v_bfi_b32 v172, 1, s64, v172
  s_waitcnt lgkmcnt(0)
  v_mfma_f32_16x16x32_bf16 v[176:179], a[12:15], v[84:87], v[176:179]
  v_bfi_b32 v173, 1, s64, v173
  buffer_store_dwordx2 v[172:173], v11, s[4:7], s61 offen
  s_cmp_ge_u32 s67, 66
  s_cbranch_scc1 A_hf
  v_mfma_f32_16x16x32_bf16 v[180:183], a[28:31], v[84:87], v[180:183]
  v_mfma_f32_16x16x32_bf16 v[184:187], a[44:47], v[84:87], v[184:187]
  s_cmp_lt_u32 s67, 64
  s_cselect_b32 s46, 0, 1073741824
  buffer_load_dword v4, off, s[4:7], s46 offset:2432 sc1
  buffer_load_dword v22, off, s[4:7], s46 offset:2048 sc1
  v_mfma_f32_16x16x32_bf16 v[188:191], a[48:51], v[72:75], 0
  v_mfma_f32_16x16x32_bf16 v[192:195], a[64:67], v[72:75], 0
  v_mfma_f32_16x16x32_bf16 v[196:199], a[80:83], v[72:75], 0
  v_mfma_f32_16x16x32_bf16 v[188:191], a[52:55], v[76:79], v[188:191]
  v_cvt_pk_bf16_f32 v176, v176, v177
  v_cvt_pk_bf16_f32 v177, v178, v179
  v_mfma_f32_16x16x32_bf16 v[192:195], a[68:71], v[76:79], v[192:195]
  v_cvt_pk_bf16_f32 v178, v180, v181
  v_cvt_pk_bf16_f32 v179, v182, v183
  v_mfma_f32_16x16x32_bf16 v[196:199], a[84:87], v[76:79], v[196:199]
  v_bfi_b32 v176, 1, s64, v176
  v_bfi_b32 v177, 1, s64, v177
  v_mfma_f32_16x16x32_bf16 v[188:191], a[56:59], v[80:83], v[188:191]
  v_bfi_b32 v178, 1, s64, v178
  v_bfi_b32 v179, 1, s64, v179
  v_mfma_f32_16x16x32_bf16 v[192:195], a[72:75], v[80:83], v[192:195]
  buffer_store_dwordx4 v[176:179], v1, s[4:7], s71 offen offset:0
  v_mfma_f32_16x16x32_bf16 v[196:199], a[88:91], v[80:83], v[196:199]
  v_mfma_f32_16x16x32_bf16 v[188:191], a[60:63], v[84:87], v[188:191]
  v_mfma_f32_16x16x32_bf16 v[192:195], a[76:79], v[84:87], v[192:195]
  v_mfma_f32_16x16x32_bf16 v[196:199], a[92:95], v[84:87], v[196:199]
  v_mfma_f32_16x16x32_bf16 v[200:203], a[96:99], v[72:75], 0
  v_mfma_f32_16x16x32_bf16 v[204:207], a[112:115], v[72:75], 0
  v_mfma_f32_16x16x32_bf16 v[208:211], a[128:131], v[72:75], 0
  v_mfma_f32_16x16x32_bf16 v[200:203], a[100:103], v[76:79], v[200:203]
  v_cvt_pk_bf16_f32 v184, v184, v185
  v_cvt_pk_bf16_f32 v185, v186, v187
  v_mfma_f32_16x16x32_bf16 v[204:207], a[116:119], v[76:79], v[204:207]
  v_cvt_pk_bf16_f32 v186, v188, v189
  v_cvt_pk_bf16_f32 v187, v190, v191
  v_mfma_f32_16x16x32_bf16 v[208:211], a[132:135], v[76:79], v[208:211]
  v_bfi_b32 v184, 1, s64, v184
  v_bfi_b32 v185, 1, s64, v185
  v_mfma_f32_16x16x32_bf16 v[200:203], a[104:107], v[80:83], v[200:203]
  v_bfi_b32 v186, 1, s64, v186
  v_bfi_b32 v187, 1, s64, v187
  s_waitcnt vmcnt(8)
  s_barrier
  v_mfma_f32_16x16x32_bf16 v[204:207], a[120:123], v[80:83], v[204:207]
  buffer_store_dwordx4 v[184:187], v1, s[4:7], s71 offen offset:1024
  v_cvt_pk_bf16_f32 v192, v192, v193
  ds_read_b128 v[104:107], v21 offset:0
  v_mfma_f32_16x16x32_bf16 v[208:211], a[136:139], v[80:83], v[208:211]
  v_cvt_pk_bf16_f32 v193, v194, v195
  v_cvt_pk_bf16_f32 v194, v196, v197
  ds_read_b128 v[108:111], v21 offset:1024
  v_mfma_f32_16x16x32_bf16 v[200:203], a[108:111], v[84:87], v[200:203]
  v_cvt_pk_bf16_f32 v195, v198, v199
  v_bfi_b32 v192, 1, s64, v192
  ds_read_b128 v[112:115], v21 offset:2048
  v_mfma_f32_16x16x32_bf16 v[204:207], a[124:127], v[84:87], v[204:207]
  v_bfi_b32 v193, 1, s64, v193
  v_bfi_b32 v194, 1, s64, v194
  ds_read_b128 v[116:119], v21 offset:3072
  v_mfma_f32_16x16x32_bf16 v[208:211], a[140:143], v[84:87], v[208:211]
  v_bfi_b32 v195, 1, s64, v195
  buffer_store_dwordx4 v[192:195], v1, s[4:7], s71 offen offset:2048
  ds_read_b128 v[120:123], v21 offset:4096
  v_cvt_pk_bf16_f32 v200, v200, v201
  v_cvt_pk_bf16_f32 v201, v202, v203
  v_cvt_pk_bf16_f32 v202, v204, v205
  v_cvt_pk_bf16_f32 v203, v206, v207
  v_bfi_b32 v200, 1, s64, v200
  v_bfi_b32 v201, 1, s64, v201
  v_bfi_b32 v202, 1, s64, v202
  v_bfi_b32 v203, 1, s64, v203
  buffer_store_dwordx4 v[200:203], v1, s[4:7], s71 offen offset:3072
  v_cvt_pk_bf16_f32 v208, v208, v209
  v_cvt_pk_bf16_f32 v209, v210, v211
  v_bfi_b32 v208, 1, s64, v208
  v_bfi_b32 v209, 1, s64, v209
  buffer_store_dwordx2 v[208:209], v11, s[4:7], s71 offen
A_hf:
  s_xor_b32 s61, s61, 2097152
  s_mov_b32 s65, s64
  s_add_u32 s66, s66, 1
  s_lshr_b32 s64, s66, 1
A_le:
  s_cmp_lt_u32 s67, s38
  s_cbranch_scc1 A_loop
  s_cmp_eq_u32 s29, 64
  s_cbranch_scc1 A_zg
  s_mul_i32 s31, s30, 36864
  s_cmp_ge_u32 s67, 66
  s_cselect_b32 s31, 18432, s31
  s_cselect_b32 s72, 0, s72
  s_cselect_b32 s46, s63, 0
  s_cmp_ge_u32 s46, 72
  s_cbranch_scc1 A_fe
A_wx:
  s_add_u32 s46, s62, 0
  buffer_load_dwordx4 v[148:151], v12, s[4:7], s46 offen sc1
  s_add_u32 s46, s62, 148480
  buffer_load_dwordx4 v[152:155], v12, s[4:7], s46 offen sc1
  s_add_u32 s46, s62, 296960
  buffer_load_dwordx4 v[156:159], v12, s[4:7], s46 offen sc1
  s_add_u32 s46, s62, 445440
  buffer_load_dwordx4 v[160:163], v12, s[4:7], s46 offen sc1
  s_add_u32 s46, s62, 593920
  buffer_load_dwordx4 v[164:167], v12, s[4:7], s46 offen sc1
  s_add_u32 s46, s62, 742400
  buffer_load_dwordx4 v[168:171], v12, s[4:7], s46 offen sc1
  s_add_u32 s46, s62, 890880
  buffer_load_dwordx4 v[172:175], v12, s[4:7], s46 offen sc1
  s_add_u32 s46, s62, 1039360
  buffer_load_dwordx4 v[176:179], v12, s[4:7], s46 offen sc1
  s_cmp_eq_u32 s72, 0
  s_cbranch_scc1 A_n2
  s_add_u32 s46, s62, 32768
  buffer_load_dwordx4 v[180:183], v12, s[4:7], s46 offen sc1
  s_add_u32 s46, s62, 181248
  buffer_load_dwordx4 v[184:187], v12, s[4:7], s46 offen sc1
  s_add_u32 s46, s62, 329728
  buffer_load_dwordx4 v[188:191], v12, s[4:7], s46 offen sc1
  s_add_u32 s46, s62, 478208
  buffer_load_dwordx4 v[192:195], v12, s[4:7], s46 offen sc1
  s_add_u32 s46, s62, 626688
  buffer_load_dwordx4 v[196:199], v12, s[4:7], s46 offen sc1
  s_add_u32 s46, s62, 775168
  buffer_load_dwordx4 v[200:203], v12, s[4:7], s46 offen sc1
  s_add_u32 s46, s62, 923648
  buffer_load_dwordx4 v[204:207], v12, s[4:7], s46 offen sc1
  s_add_u32 s46, s62, 1072128
  buffer_load_dwordx4 v[208:211], v12, s[4:7], s46 offen sc1
A_n2:
  s_mov_b32 s60, 0
  s_waitcnt vmcnt(0)
  v_readfirstlane_b32 s69, v22
  s_cmp_gt_u32 s69, s67
  s_cselect_b32 s46, s59, 1073741824
  buffer_load_dwordx4 v[28:31], v1, s[4:7], s46 offen sc1
Ab_s0:
  v_mfma_f32_16x16x32_bf16 v[212:215], v[24:27], v[148:151], 0
  v_bitop3_b32 v7, v148, v149, s65 bitop3:0x7e
  v_bitop3_b32 v8, v150, v151, s65 bitop3:0x7e
  v_bitop3_b32 v7, v7, v8, 1 bitop3:0xa8
  v_cmp_ne_u32 s[16:17], 0, v7
  v_mfma_f32_16x16x32_bf16 v[212:215], v[24:27], v[152:155], v[212:215]
  v_bitop3_b32 v7, v152, v153, s65 bitop3:0x7e
  v_bitop3_b32 v8, v154, v155, s65 bitop3:0x7e
  v_bitop3_b32 v7, v7, v8, 1 bitop3:0xa8
  v_cmp_ne_u32 s[18:19], 0, v7
  v_mfma_f32_16x16x32_bf16 v[212:215], v[24:27], v[156:159], v[212:215]
  v_bitop3_b32 v7, v156, v157, s65 bitop3:0x7e
  v_bitop3_b32 v8, v158, v159, s65 bitop3:0x7e
  s_or_b64 s[36:37], s[18:19], s[16:17]
  v_bitop3_b32 v7, v7, v8, 1 bitop3:0xa8
  v_cmp_ne_u32 s[20:21], 0, v7
  v_mfma_f32_16x16x32_bf16 v[212:215], v[24:27], v[160:163], v[212:215]
  v_bitop3_b32 v7, v160, v161, s65 bitop3:0x7e
  v_bitop3_b32 v8, v162, v163, s65 bitop3:0x7e
  s_or_b64 s[36:37], s[20:21], s[36:37]
  v_bitop3_b32 v7, v7, v8, 1 bitop3:0xa8
  v_cmp_ne_u32 s[22:23], 0, v7
  v_mfma_f32_16x16x32_bf16 v[212:215], v[24:27], v[164:167], v[212:215]
  v_bitop3_b32 v7, v164, v165, s65 bitop3:0x7e
  v_bitop3_b32 v8, v166, v167, s65 bitop3:0x7e
  s_or_b64 s[36:37], s[22:23], s[36:37]
  v_bitop3_b32 v7, v7, v8, 1 bitop3:0xa8
  v_cmp_ne_u32 s[24:25], 0, v7
  v_mfma_f32_16x16x32_bf16 v[212:215], v[24:27], v[168:171], v[212:215]
  v_bitop3_b32 v7, v168, v169, s65 bitop3:0x7e
  v_bitop3_b32 v8, v170, v171, s65 bitop3:0x7e
  s_or_b64 s[36:37], s[24:25], s[36:37]
  v_bitop3_b32 v7, v7, v8, 1 bitop3:0xa8
  v_cmp_ne_u32 s[26:27], 0, v7
  v_mfma_f32_16x16x32_bf16 v[212:215], v[24:27], v[172:175], v[212:215]
  v_bitop3_b32 v7, v172, v173, s65 bitop3:0x7e
  v_bitop3_b32 v8, v174, v175, s65 bitop3:0x7e
  s_or_b64 s[36:37], s[26:27], s[36:37]
  v_bitop3_b32 v7, v7, v8, 1 bitop3:0xa8
  v_cmp_ne_u32 s[32:33], 0, v7
  v_mfma_f32_16x16x32_bf16 v[212:215], v[24:27], v[176:179], v[212:215]
  v_bitop3_b32 v7, v176, v177, s65 bitop3:0x7e
  v_bitop3_b32 v8, v178, v179, s65 bitop3:0x7e
  s_or_b64 s[36:37], s[32:33], s[36:37]
  v_bitop3_b32 v7, v7, v8, 1 bitop3:0xa8
  v_cmp_ne_u32 s[34:35], 0, v7
  s_or_b64 s[36:37], s[36:37], s[34:35]
  s_cbranch_scc1 Ab_r0
  s_nop 0
  v_cvt_pk_bf16_f32 v212, v212, v213
  v_cvt_pk_bf16_f32 v213, v214, v215
  v_lshlrev_b32 v148, 16, v212
  v_and_b32 v149, 0xffff0000, v212
  v_lshlrev_b32 v150, 16, v220
  v_and_b32 v151, 0xffff0000, v220
  v_pk_add_f32 v[148:149], v[148:149], v[150:151]
  v_cvt_pk_bf16_f32 v212, v148, v149
  v_lshlrev_b32 v148, 16, v213
  v_and_b32 v149, 0xffff0000, v213
  v_lshlrev_b32 v150, 16, v221
  v_and_b32 v151, 0xffff0000, v221
  v_pk_add_f32 v[148:149], v[148:149], v[150:151]
  v_cvt_pk_bf16_f32 v213, v148, v149
  v_permlane16_swap_b32 v212, v214
  s_nop 0
  v_permlane16_swap_b32 v213, v215
  buffer_store_dwordx4 v[212:215], v10, s[4:7], s57 offen sc1
  s_cmp_eq_u32 s72, 0
  s_cbranch_scc1 Ab_e
Ab_s1:
  v_mfma_f32_16x16x32_bf16 v[216:219], v[24:27], v[180:183], 0
  v_bitop3_b32 v7, v180, v181, s65 bitop3:0x7e
  v_bitop3_b32 v8, v182, v183, s65 bitop3:0x7e
  v_bitop3_b32 v7, v7, v8, 1 bitop3:0xa8
  v_cmp_ne_u32 s[16:17], 0, v7
  v_mfma_f32_16x16x32_bf16 v[216:219], v[24:27], v[184:187], v[216:219]
  v_bitop3_b32 v7, v184, v185, s65 bitop3:0x7e
  v_bitop3_b32 v8, v186, v187, s65 bitop3:0x7e
  v_bitop3_b32 v7, v7, v8, 1 bitop3:0xa8
  v_cmp_ne_u32 s[18:19], 0, v7
  v_mfma_f32_16x16x32_bf16 v[216:219], v[24:27], v[188:191], v[216:219]
  v_bitop3_b32 v7, v188, v189, s65 bitop3:0x7e
  v_bitop3_b32 v8, v190, v191, s65 bitop3:0x7e
  s_or_b64 s[36:37], s[18:19], s[16:17]
  v_bitop3_b32 v7, v7, v8, 1 bitop3:0xa8
  v_cmp_ne_u32 s[20:21], 0, v7
  v_mfma_f32_16x16x32_bf16 v[216:219], v[24:27], v[192:195], v[216:219]
  v_bitop3_b32 v7, v192, v193, s65 bitop3:0x7e
  v_bitop3_b32 v8, v194, v195, s65 bitop3:0x7e
  s_or_b64 s[36:37], s[20:21], s[36:37]
  v_bitop3_b32 v7, v7, v8, 1 bitop3:0xa8
  v_cmp_ne_u32 s[22:23], 0, v7
  v_mfma_f32_16x16x32_bf16 v[216:219], v[24:27], v[196:199], v[216:219]
  v_bitop3_b32 v7, v196, v197, s65 bitop3:0x7e
  v_bitop3_b32 v8, v198, v199, s65 bitop3:0x7e
  s_or_b64 s[36:37], s[22:23], s[36:37]
  v_bitop3_b32 v7, v7, v8, 1 bitop3:0xa8
  v_cmp_ne_u32 s[24:25], 0, v7
  v_mfma_f32_16x16x32_bf16 v[216:219], v[24:27], v[200:203], v[216:219]
  v_bitop3_b32 v7, v200, v201, s65 bitop3:0x7e
  v_bitop3_b32 v8, v202, v203, s65 bitop3:0x7e
  s_or_b64 s[36:37], s[24:25], s[36:37]
  v_bitop3_b32 v7, v7, v8, 1 bitop3:0xa8
  v_cmp_ne_u32 s[26:27], 0, v7
  v_mfma_f32_16x16x32_bf16 v[216:219], v[24:27], v[204:207], v[216:219]
  v_bitop3_b32 v7, v204, v205, s65 bitop3:0x7e
  v_bitop3_b32 v8, v206, v207, s65 bitop3:0x7e
  s_or_b64 s[36:37], s[26:27], s[36:37]
  v_bitop3_b32 v7, v7, v8, 1 bitop3:0xa8
  v_cmp_ne_u32 s[32:33], 0, v7
  v_mfma_f32_16x16x32_bf16 v[216:219], v[24:27], v[208:211], v[216:219]
  v_bitop3_b32 v7, v208, v209, s65 bitop3:0x7e
  v_bitop3_b32 v8, v210, v211, s65 bitop3:0x7e
  s_or_b64 s[36:37], s[32:33], s[36:37]
  v_bitop3_b32 v7, v7, v8, 1 bitop3:0xa8
  v_cmp_ne_u32 s[34:35], 0, v7
  s_or_b64 s[36:37], s[36:37], s[34:35]
  s_cbranch_scc1 Ab_r1
  s_nop 0
  v_cvt_pk_bf16_f32 v216, v216, v217
  v_cvt_pk_bf16_f32 v217, v218, v219
  v_lshlrev_b32 v180, 16, v216
  v_and_b32 v181, 0xffff0000, v216
  v_lshlrev_b32 v182, 16, v222
  v_and_b32 v183, 0xffff0000, v222
  v_pk_add_f32 v[180:181], v[180:181], v[182:183]
  v_cvt_pk_bf16_f32 v216, v180, v181
  v_lshlrev_b32 v180, 16, v217
  v_and_b32 v181, 0xffff0000, v217
  v_lshlrev_b32 v182, 16, v223
  v_and_b32 v183, 0xffff0000, v223
  v_pk_add_f32 v[180:181], v[180:181], v[182:183]
  v_cvt_pk_bf16_f32 v217, v180, v181
  v_permlane16_swap_b32 v216, v218
  s_nop 0
  v_permlane16_swap_b32 v217, v219
  s_add_u32 s46, s57, 32768
  buffer_store_dwordx4 v[216:219], v10, s[4:7], s46 offen sc1
Ab_e:
  s_add_u32 s56, s56, s31
  s_add_u32 s73, s73, s31
  s_add_u32 s57, s57, s31
  s_xor_b32 s62, s62, 2097152
  s_cmp_lt_u32 s67, 64
  s_cbranch_scc1 A_mo
A_fe:
  s_cmp_eq_u32 s67, 0
  s_cbranch_scc0 K_end
  s_xor_b32 s61, s61, 2097152
  s_add_u32 s61, s61, 18432
  s_xor_b32 s62, s62, 2097152
  s_add_u32 s62, s62, 18432
  s_mov_b32 s64, s65
  s_mov_b32 s67, 66
  v_add_u32 v5, 4096, v1
  s_branch A_p2
A_mo:
  s_cmp_lt_u32 s67, s38
  s_cbranch_scc0 A_loop
  s_cmp_gt_u32 s69, s67
  s_cbranch_scc0 A_pollk
  s_waitcnt vmcnt(2)
  s_cmp_eq_u32 s72, 0
  s_cbranch_scc0 A_chk
  s_waitcnt vmcnt(1)
  s_branch A_chk
A_wt:
  s_cmp_eq_u32 s60, 0
  s_cbranch_scc1 A_pollk
  buffer_load_dword v22, off, s[4:7], 0 offset:2048 sc1
  s_branch A_wx
A_pollk:
  s_sub_u32 s50, s50, 1
  s_cbranch_scc1 K_end
  s_cmp_ge_u32 s67, 61
  s_cbranch_scc1 A_pk
  s_cmp_gt_u32 s69, s67
  s_cbranch_scc1 A_pk
  s_waitcnt vmcnt(0)
  buffer_load_dword v22, off, s[4:7], 0 offset:2048 sc1
  s_waitcnt vmcnt(0)
  v_readfirstlane_b32 s69, v22
  s_cmp_gt_u32 s69, s67
  s_cbranch_scc1 A_pk
  s_cmp_ge_u32 s69, 63
  s_cbranch_scc1 A_pollk
  s_sleep 4
  s_branch A_pollk
A_pk:
  buffer_load_dwordx4 v[28:31], v1, s[4:7], s59 offen sc1
  s_waitcnt vmcnt(0)
  s_branch A_chk
A_sp:
  s_add_u32 s46, s62, 0
  buffer_load_dwordx4 v[148:151], v12, s[4:7], s46 offen sc1
  s_cbranch_vccz A_q0
  s_add_u32 s46, s62, 32768
  buffer_load_dwordx4 v[180:183], v12, s[4:7], s46 offen sc1
A_q0:
  s_waitcnt lgkmcnt(5)
  v_mfma_f32_16x16x32_bf16 v[112:115], v[116:119], v[40:43], 0
  s_add_u32 s46, s62, 148480
  buffer_load_dwordx4 v[152:155], v12, s[4:7], s46 offen sc1
  s_cbranch_vccz A_q1
  s_add_u32 s46, s62, 181248
  buffer_load_dwordx4 v[184:187], v12, s[4:7], s46 offen sc1
A_q1:
  s_waitcnt lgkmcnt(4)
  v_mfma_f32_16x16x32_bf16 v[112:115], v[120:123], v[44:47], v[112:115]
  v_max3_f32 v5, v104, v105, v106
  v_max3_f32 v5, v5, v107, v108
  s_waitcnt lgkmcnt(3)
  v_mfma_f32_16x16x32_bf16 v[112:115], v[124:127], v[48:51], v[112:115]
  v_max3_f32 v5, v5, v109, v110
  v_max_f32 v5, v5, v111
  s_waitcnt lgkmcnt(2)
  v_mfma_f32_16x16x32_bf16 v[112:115], v[128:131], v[52:55], v[112:115]
  s_add_u32 s46, s62, 296960
  buffer_load_dwordx4 v[156:159], v12, s[4:7], s46 offen sc1
  s_nop 1
  s_cbranch_vccz A_q2
  s_add_u32 s46, s62, 329728
  buffer_load_dwordx4 v[188:191], v12, s[4:7], s46 offen sc1
A_q2:
  s_nop 2
  v_max3_f32 v5, v5, v112, v113
  v_mov_b32 v6, v5
  s_add_u32 s46, s62, 445440
  buffer_load_dwordx4 v[160:163], v12, s[4:7], s46 offen sc1
  s_cbranch_vccz A_q3
  s_add_u32 s46, s62, 478208
  buffer_load_dwordx4 v[192:195], v12, s[4:7], s46 offen sc1
A_q3:
  v_permlane32_swap_b32 v5, v6
  v_max_f32 v5, v5, v6
  v_mov_b32 v6, v5
  s_add_u32 s46, s62, 593920
  buffer_load_dwordx4 v[164:167], v12, s[4:7], s46 offen sc1
  s_cbranch_vccz A_q4
  s_add_u32 s46, s62, 626688
  buffer_load_dwordx4 v[196:199], v12, s[4:7], s46 offen sc1
A_q4:
  v_permlane16_swap_b32 v5, v6
  v_max_f32 v5, v5, v6
  v_mul_f32 v6, s58, v5
  s_add_u32 s46, s62, 742400
  buffer_load_dwordx4 v[168:171], v12, s[4:7], s46 offen sc1
  s_cbranch_vccz A_q5
  s_add_u32 s46, s62, 775168
  buffer_load_dwordx4 v[200:203], v12, s[4:7], s46 offen sc1
A_q5:
  v_pk_fma_f32 v[104:105], v[104:105], s[58:59], v[6:7] op_sel_hi:[1,0,0] neg_lo:[0,0,1] neg_hi:[0,0,1]
  v_pk_fma_f32 v[106:107], v[106:107], s[58:59], v[6:7] op_sel_hi:[1,0,0] neg_lo:[0,0,1] neg_hi:[0,0,1]
  v_pk_fma_f32 v[108:109], v[108:109], s[58:59], v[6:7] op_sel_hi:[1,0,0] neg_lo:[0,0,1] neg_hi:[0,0,1]
  v_pk_fma_f32 v[110:111], v[110:111], s[58:59], v[6:7] op_sel_hi:[1,0,0] neg_lo:[0,0,1] neg_hi:[0,0,1]
  v_pk_fma_f32 v[112:113], v[112:113], s[58:59], v[6:7] op_sel_hi:[1,0,0] neg_lo:[0,0,1] neg_hi:[0,0,1]
  v_exp_f32 v104, v104
  v_exp_f32 v105, v105
  s_add_u32 s46, s62, 890880
  buffer_load_dwordx4 v[172:175], v12, s[4:7], s46 offen sc1
  s_cbranch_vccz A_q6
  s_add_u32 s46, s62, 923648
  buffer_load_dwordx4 v[204:207], v12, s[4:7], s46 offen sc1
A_q6:
  v_exp_f32 v106, v106
  v_exp_f32 v107, v107
  v_exp_f32 v108, v108
  v_exp_f32 v109, v109
  s_add_u32 s46, s62, 1039360
  buffer_load_dwordx4 v[176:179], v12, s[4:7], s46 offen sc1
  s_cbranch_vccz A_q7
  s_add_u32 s46, s62, 1072128
  buffer_load_dwordx4 v[208:211], v12, s[4:7], s46 offen sc1
A_q7:
  v_exp_f32 v110, v110
  v_exp_f32 v111, v111
  v_exp_f32 v112, v112
  v_exp_f32 v113, v113
  v_cvt_pk_bf16_f32 v116, v104, v105
  v_cvt_pk_bf16_f32 v117, v106, v107
  v_cvt_pk_bf16_f32 v118, v108, v109
  v_cvt_pk_bf16_f32 v119, v110, v111
  v_cvt_pk_bf16_f32 v19, v112, v113
  v_pk_add_f32 v[114:115], v[104:105], v[106:107]
  v_mfma_f32_16x16x32_bf16 v[56:59], v[88:91], v[116:119], 0
  v_pk_add_f32 v[114:115], v[114:115], v[108:109]
  v_mfma_f32_16x16x32_bf16 v[60:63], v[92:95], v[116:119], 0
  v_pk_add_f32 v[114:115], v[114:115], v[110:111]
  v_mfma_f32_16x16x32_bf16 v[64:67], v[96:99], v[116:119], 0
  v_pk_add_f32 v[114:115], v[114:115], v[112:113]
  v_mfma_f32_16x16x32_bf16 v[68:71], v[100:103], v[116:119], 0
  v_add_f32 v5, v114, v115
  s_waitcnt lgkmcnt(1)
  v_mfma_f32_16x16x16_bf16 v[56:59], v[132:133], v[18:19], v[56:59]
  v_mfma_f32_16x16x16_bf16 v[60:63], v[134:135], v[18:19], v[60:63]
  s_waitcnt lgkmcnt(0)
  v_mfma_f32_16x16x16_bf16 v[64:67], v[136:137], v[18:19], v[64:67]
  v_mfma_f32_16x16x16_bf16 v[68:71], v[138:139], v[18:19], v[68:71]
  v_mov_b32 v6, v5
  s_nop 1
  v_permlane32_swap_b32 v5, v6
  v_add_f32 v5, v5, v6
  v_mov_b32 v6, v5
  s_nop 1
  v_permlane16_swap_b32 v5, v6
  v_add_f32 v5, v5, v6
  v_rcp_f32 v6, v5
  s_nop 0
  v_pk_mul_f32 v[56:57], v[56:57], v[6:7] op_sel_hi:[1,0]
  v_pk_mul_f32 v[58:59], v[58:59], v[6:7] op_sel_hi:[1,0]
  v_pk_mul_f32 v[60:61], v[60:61], v[6:7] op_sel_hi:[1,0]
  v_pk_mul_f32 v[62:63], v[62:63], v[6:7] op_sel_hi:[1,0]
  v_cvt_pk_bf16_f32 v56, v56, v57
  v_cvt_pk_bf16_f32 v57, v58, v59
  v_cvt_pk_bf16_f32 v58, v60, v61
  v_cvt_pk_bf16_f32 v59, v62, v63
  ds_write_b128 v9, v[56:59] offset:8192
  v_pk_mul_f32 v[64:65], v[64:65], v[6:7] op_sel_hi:[1,0]
  v_pk_mul_f32 v[66:67], v[66:67], v[6:7] op_sel_hi:[1,0]
  v_pk_mul_f32 v[68:69], v[68:69], v[6:7] op_sel_hi:[1,0]
  v_pk_mul_f32 v[70:71], v[70:71], v[6:7] op_sel_hi:[1,0]
  v_cvt_pk_bf16_f32 v64, v64, v65
  v_cvt_pk_bf16_f32 v65, v66, v67
  v_cvt_pk_bf16_f32 v66, v68, v69
  v_cvt_pk_bf16_f32 v67, v70, v71
  ds_write_b128 v9, v[64:67] offset:9216
  s_waitcnt vmcnt(0)
Aa_s0:
  v_mfma_f32_16x16x32_bf16 v[212:215], v[24:27], v[148:151], 0
  v_bitop3_b32 v7, v148, v149, s65 bitop3:0x7e
  v_bitop3_b32 v8, v150, v151, s65 bitop3:0x7e
  v_or_b32 v17, v7, v8
  v_mfma_f32_16x16x32_bf16 v[212:215], v[24:27], v[152:155], v[212:215]
  v_bitop3_b32 v7, v152, v153, s65 bitop3:0x7e
  v_bitop3_b32 v8, v154, v155, s65 bitop3:0x7e
  v_or3_b32 v17, v17, v7, v8
  v_mfma_f32_16x16x32_bf16 v[212:215], v[24:27], v[156:159], v[212:215]
  v_bitop3_b32 v7, v156, v157, s65 bitop3:0x7e
  v_bitop3_b32 v8, v158, v159, s65 bitop3:0x7e
  v_or3_b32 v17, v17, v7, v8
  v_mfma_f32_16x16x32_bf16 v[212:215], v[24:27], v[160:163], v[212:215]
  v_bitop3_b32 v7, v160, v161, s65 bitop3:0x7e
  v_bitop3_b32 v8, v162, v163, s65 bitop3:0x7e
  v_or3_b32 v17, v17, v7, v8
  v_mfma_f32_16x16x32_bf16 v[212:215], v[24:27], v[164:167], v[212:215]
  v_bitop3_b32 v7, v164, v165, s65 bitop3:0x7e
  v_bitop3_b32 v8, v166, v167, s65 bitop3:0x7e
  v_or3_b32 v17, v17, v7, v8
  v_mfma_f32_16x16x32_bf16 v[212:215], v[24:27], v[168:171], v[212:215]
  v_bitop3_b32 v7, v168, v169, s65 bitop3:0x7e
  v_bitop3_b32 v8, v170, v171, s65 bitop3:0x7e
  v_or3_b32 v17, v17, v7, v8
  v_mfma_f32_16x16x32_bf16 v[212:215], v[24:27], v[172:175], v[212:215]
  v_bitop3_b32 v7, v172, v173, s65 bitop3:0x7e
  v_bitop3_b32 v8, v174, v175, s65 bitop3:0x7e
  v_or3_b32 v17, v17, v7, v8
  v_mfma_f32_16x16x32_bf16 v[212:215], v[24:27], v[176:179], v[212:215]
  v_bitop3_b32 v7, v176, v177, s65 bitop3:0x7e
  v_bitop3_b32 v8, v178, v179, s65 bitop3:0x7e
  v_or3_b32 v17, v17, v7, v8
  v_and_b32 v17, 1, v17
  v_cmp_ne_u32 vcc, 0, v17
  s_cbranch_vccnz Aa_r0
  s_nop 1
  v_cvt_pk_bf16_f32 v212, v212, v213
  v_cvt_pk_bf16_f32 v213, v214, v215
  v_lshlrev_b32 v148, 16, v212
  v_and_b32 v149, 0xffff0000, v212
  v_lshlrev_b32 v150, 16, v220
  v_and_b32 v151, 0xffff0000, v220
  v_pk_add_f32 v[148:149], v[148:149], v[150:151]
  v_cvt_pk_bf16_f32 v212, v148, v149
  v_lshlrev_b32 v148, 16, v213
  v_and_b32 v149, 0xffff0000, v213
  v_lshlrev_b32 v150, 16, v221
  v_and_b32 v151, 0xffff0000, v221
  v_pk_add_f32 v[148:149], v[148:149], v[150:151]
  v_cvt_pk_bf16_f32 v213, v148, v149
  v_permlane16_swap_b32 v212, v214
  s_nop 0
  v_permlane16_swap_b32 v213, v215
  buffer_store_dwordx4 v[212:215], v10, s[4:7], s57 offen sc1
  s_cmp_eq_u32 s72, 0
  s_cbranch_scc1 Aa_e
Aa_s1:
  v_mfma_f32_16x16x32_bf16 v[216:219], v[24:27], v[180:183], 0
  v_bitop3_b32 v7, v180, v181, s65 bitop3:0x7e
  v_bitop3_b32 v8, v182, v183, s65 bitop3:0x7e
  v_or_b32 v17, v7, v8
  v_mfma_f32_16x16x32_bf16 v[216:219], v[24:27], v[184:187], v[216:219]
  v_bitop3_b32 v7, v184, v185, s65 bitop3:0x7e
  v_bitop3_b32 v8, v186, v187, s65 bitop3:0x7e
  v_or3_b32 v17, v17, v7, v8
  v_mfma_f32_16x16x32_bf16 v[216:219], v[24:27], v[188:191], v[216:219]
  v_bitop3_b32 v7, v188, v189, s65 bitop3:0x7e
  v_bitop3_b32 v8, v190, v191, s65 bitop3:0x7e
  v_or3_b32 v17, v17, v7, v8
  v_mfma_f32_16x16x32_bf16 v[216:219], v[24:27], v[192:195], v[216:219]
  v_bitop3_b32 v7, v192, v193, s65 bitop3:0x7e
  v_bitop3_b32 v8, v194, v195, s65 bitop3:0x7e
  v_or3_b32 v17, v17, v7, v8
  v_mfma_f32_16x16x32_bf16 v[216:219], v[24:27], v[196:199], v[216:219]
  v_bitop3_b32 v7, v196, v197, s65 bitop3:0x7e
  v_bitop3_b32 v8, v198, v199, s65 bitop3:0x7e
  v_or3_b32 v17, v17, v7, v8
  v_mfma_f32_16x16x32_bf16 v[216:219], v[24:27], v[200:203], v[216:219]
  v_bitop3_b32 v7, v200, v201, s65 bitop3:0x7e
  v_bitop3_b32 v8, v202, v203, s65 bitop3:0x7e
  v_or3_b32 v17, v17, v7, v8
  v_mfma_f32_16x16x32_bf16 v[216:219], v[24:27], v[204:207], v[216:219]
  v_bitop3_b32 v7, v204, v205, s65 bitop3:0x7e
  v_bitop3_b32 v8, v206, v207, s65 bitop3:0x7e
  v_or3_b32 v17, v17, v7, v8
  v_mfma_f32_16x16x32_bf16 v[216:219], v[24:27], v[208:211], v[216:219]
  v_bitop3_b32 v7, v208, v209, s65 bitop3:0x7e
  v_bitop3_b32 v8, v210, v211, s65 bitop3:0x7e
  v_or3_b32 v17, v17, v7, v8
  v_and_b32 v17, 1, v17
  v_cmp_ne_u32 vcc, 0, v17
  s_cbranch_vccnz Aa_r1
  s_nop 1
  v_cvt_pk_bf16_f32 v216, v216, v217
  v_cvt_pk_bf16_f32 v217, v218, v219
  v_lshlrev_b32 v180, 16, v216
  v_and_b32 v181, 0xffff0000, v216
  v_lshlrev_b32 v182, 16, v222
  v_and_b32 v183, 0xffff0000, v222
  v_pk_add_f32 v[180:181], v[180:181], v[182:183]
  v_cvt_pk_bf16_f32 v216, v180, v181
  v_lshlrev_b32 v180, 16, v217
  v_and_b32 v181, 0xffff0000, v217
  v_lshlrev_b32 v182, 16, v223
  v_and_b32 v183, 0xffff0000, v223
  v_pk_add_f32 v[180:181], v[180:181], v[182:183]
  v_cvt_pk_bf16_f32 v217, v180, v181
  v_permlane16_swap_b32 v216, v218
  s_nop 0
  v_permlane16_swap_b32 v217, v219
  s_add_u32 s46, s57, 32768
  buffer_store_dwordx4 v[216:219], v10, s[4:7], s46 offen sc1
Aa_e:
  s_add_u32 s56, s56, s31
  s_add_u32 s73, s73, s31
  s_add_u32 s57, s57, s31
  s_xor_b32 s62, s62, 2097152
  s_branch A_jn
Ab_r0:
  s_cmp_lg_u64 s[16:17], 0
  s_cbranch_scc0 Ab_r0_0
  s_add_u32 s46, s62, 0
  buffer_load_dwordx4 v[148:151], v12, s[4:7], s46 offen sc1
Ab_r0_0:
  s_cmp_lg_u64 s[18:19], 0
  s_cbranch_scc0 Ab_r0_1
  s_add_u32 s46, s62, 148480
  buffer_load_dwordx4 v[152:155], v12, s[4:7], s46 offen sc1
Ab_r0_1:
  s_cmp_lg_u64 s[20:21], 0
  s_cbranch_scc0 Ab_r0_2
  s_add_u32 s46, s62, 296960
  buffer_load_dwordx4 v[156:159], v12, s[4:7], s46 offen sc1
Ab_r0_2:
  s_cmp_lg_u64 s[22:23], 0
  s_cbranch_scc0 Ab_r0_3
  s_add_u32 s46, s62, 445440
  buffer_load_dwordx4 v[160:163], v12, s[4:7], s46 offen sc1
Ab_r0_3:
  s_cmp_lg_u64 s[24:25], 0
  s_cbranch_scc0 Ab_r0_4
  s_add_u32 s46, s62, 593920
  buffer_load_dwordx4 v[164:167], v12, s[4:7], s46 offen sc1
Ab_r0_4:
  s_cmp_lg_u64 s[26:27], 0
  s_cbranch_scc0 Ab_r0_5
  s_add_u32 s46, s62, 742400
  buffer_load_dwordx4 v[168:171], v12, s[4:7], s46 offen sc1
Ab_r0_5:
  s_cmp_lg_u64 s[32:33], 0
  s_cbranch_scc0 Ab_r0_6
  s_add_u32 s46, s62, 890880
  buffer_load_dwordx4 v[172:175], v12, s[4:7], s46 offen sc1
Ab_r0_6:
  s_cmp_lg_u64 s[34:35], 0
  s_cbranch_scc0 Ab_r0_7
  s_add_u32 s46, s62, 1039360
  buffer_load_dwordx4 v[176:179], v12, s[4:7], s46 offen sc1
Ab_r0_7:
  s_sub_u32 s50, s50, 1
  s_cbranch_scc1 K_end
  s_waitcnt vmcnt(0)
  s_branch Ab_s0
Ab_r1:
  s_cmp_lg_u64 s[16:17], 0
  s_cbranch_scc0 Ab_r1_0
  s_add_u32 s46, s62, 32768
  buffer_load_dwordx4 v[180:183], v12, s[4:7], s46 offen sc1
Ab_r1_0:
  s_cmp_lg_u64 s[18:19], 0
  s_cbranch_scc0 Ab_r1_1
  s_add_u32 s46, s62, 181248
  buffer_load_dwordx4 v[184:187], v12, s[4:7], s46 offen sc1
Ab_r1_1:
  s_cmp_lg_u64 s[20:21], 0
  s_cbranch_scc0 Ab_r1_2
  s_add_u32 s46, s62, 329728
  buffer_load_dwordx4 v[188:191], v12, s[4:7], s46 offen sc1
Ab_r1_2:
  s_cmp_lg_u64 s[22:23], 0
  s_cbranch_scc0 Ab_r1_3
  s_add_u32 s46, s62, 478208
  buffer_load_dwordx4 v[192:195], v12, s[4:7], s46 offen sc1
Ab_r1_3:
  s_cmp_lg_u64 s[24:25], 0
  s_cbranch_scc0 Ab_r1_4
  s_add_u32 s46, s62, 626688
  buffer_load_dwordx4 v[196:199], v12, s[4:7], s46 offen sc1
Ab_r1_4:
  s_cmp_lg_u64 s[26:27], 0
  s_cbranch_scc0 Ab_r1_5
  s_add_u32 s46, s62, 775168
  buffer_load_dwordx4 v[200:203], v12, s[4:7], s46 offen sc1
Ab_r1_5:
  s_cmp_lg_u64 s[32:33], 0
  s_cbranch_scc0 Ab_r1_6
  s_add_u32 s46, s62, 923648
  buffer_load_dwordx4 v[204:207], v12, s[4:7], s46 offen sc1
Ab_r1_6:
  s_cmp_lg_u64 s[34:35], 0
  s_cbranch_scc0 Ab_r1_7
  s_add_u32 s46, s62, 1072128
  buffer_load_dwordx4 v[208:211], v12, s[4:7], s46 offen sc1
Ab_r1_7:
  s_sub_u32 s50, s50, 1
  s_cbranch_scc1 K_end
  s_waitcnt vmcnt(0)
  s_branch Ab_s1
Aa_r0:
  s_add_u32 s46, s62, 0
  buffer_load_dwordx4 v[148:151], v12, s[4:7], s46 offen sc1
  s_add_u32 s46, s62, 148480
  buffer_load_dwordx4 v[152:155], v12, s[4:7], s46 offen sc1
  s_add_u32 s46, s62, 296960
  buffer_load_dwordx4 v[156:159], v12, s[4:7], s46 offen sc1
  s_add_u32 s46, s62, 445440
  buffer_load_dwordx4 v[160:163], v12, s[4:7], s46 offen sc1
  s_add_u32 s46, s62, 593920
  buffer_load_dwordx4 v[164:167], v12, s[4:7], s46 offen sc1
  s_add_u32 s46, s62, 742400
  buffer_load_dwordx4 v[168:171], v12, s[4:7], s46 offen sc1
  s_add_u32 s46, s62, 890880
  buffer_load_dwordx4 v[172:175], v12, s[4:7], s46 offen sc1
  s_add_u32 s46, s62, 1039360
  buffer_load_dwordx4 v[176:179], v12, s[4:7], s46 offen sc1
  s_sub_u32 s50, s50, 1
  s_cbranch_scc1 K_end
  s_waitcnt vmcnt(0)
  s_branch Aa_s0
Aa_r1:
  s_add_u32 s46, s62, 32768
  buffer_load_dwordx4 v[180:183], v12, s[4:7], s46 offen sc1
  s_add_u32 s46, s62, 181248
  buffer_load_dwordx4 v[184:187], v12, s[4:7], s46 offen sc1
  s_add_u32 s46, s62, 329728
  buffer_load_dwordx4 v[188:191], v12, s[4:7], s46 offen sc1
  s_add_u32 s46, s62, 478208
  buffer_load_dwordx4 v[192:195], v12, s[4:7], s46 offen sc1
  s_add_u32 s46, s62, 626688
  buffer_load_dwordx4 v[196:199], v12, s[4:7], s46 offen sc1
  s_add_u32 s46, s62, 775168
  buffer_load_dwordx4 v[200:203], v12, s[4:7], s46 offen sc1
  s_add_u32 s46, s62, 923648
  buffer_load_dwordx4 v[204:207], v12, s[4:7], s46 offen sc1
  s_add_u32 s46, s62, 1072128
  buffer_load_dwordx4 v[208:211], v12, s[4:7], s46 offen sc1
  s_sub_u32 s50, s50, 1
  s_cbranch_scc1 K_end
  s_waitcnt vmcnt(0)
  s_branch Aa_s1
A_zl:
  buffer_load_dword v4, off, s[4:7], 0 offset:2432 sc1
  s_sub_u32 s50, s50, 1
  s_cbranch_scc1 K_end
  s_waitcnt vmcnt(0)
  v_readfirstlane_b32 s28, v4
A_zg:
  s_cmp_eq_u32 s28, 0
  s_cbranch_scc1 A_zl
  s_sub_u32 s29, s28, 2
  s_add_u32 s38, s28, 1
  s_branch A_le
A_fl:
  buffer_load_dword v22, off, s[4:7], s70 sc1
  s_sub_u32 s50, s50, 1
  s_cbranch_scc1 K_end
  s_waitcnt vmcnt(0)
  v_readfirstlane_b32 s68, v22
  s_branch A_dm
AF_in:
  v_mov_b32 v22, 0
  v_mov_b32 v4, 0
  s_barrier
  ds_read_b128 v[104:107], v21 offset:0
  ds_read_b128 v[108:111], v21 offset:1024
  ds_read_b128 v[112:115], v21 offset:2048
  ds_read_b128 v[116:119], v21 offset:3072
  ds_read_b128 v[120:123], v21 offset:4096
AF_loop:
  ds_read_b128 v[124:127], v21 offset:5120
  s_waitcnt lgkmcnt(5)
  v_mfma_f32_32x32x16_bf16 v[40:55], a[144:147], v[104:107], 0
  s_mul_i32 s31, s30, 36864
  s_cmp_lt_u32 s67, s29
  s_cselect_b32 s30, 2, 3
  s_cmp_eq_u32 s67, 61
  s_cselect_b32 s30, 2, s30
  s_mul_i32 s48, s30, 36864
  s_add_u32 s53, s53, s48
  ds_read_b128 v[128:131], v21 offset:6144
  s_waitcnt lgkmcnt(5)
  v_mfma_f32_32x32x16_bf16 v[40:55], a[148:151], v[108:111], v[40:55]
  ds_read_b128 v[56:59], v1 offset:24576
  s_add_u32 s54, s54, s51
  s_add_u32 s48, s67, s30
  s_cmp_lt_u32 s48, 64
  s_cselect_b32 s48, s53, 1073741824
  ds_read_b128 v[132:135], v21 offset:7168
  s_waitcnt lgkmcnt(6)
  v_mfma_f32_32x32x16_bf16 v[40:55], a[152:155], v[112:115], v[40:55]
  s_waitcnt vmcnt(5)
  v_readfirstlane_b32 s69, v22
  v_readfirstlane_b32 s28, v4
  ds_read_b128 v[104:107], v21 offset:8192
  s_waitcnt lgkmcnt(6)
  v_mfma_f32_32x32x16_bf16 v[40:55], a[156:159], v[116:119], v[40:55]
  ds_read_b128 v[60:63], v1 offset:25600
  s_cmp_gt_u32 s69, s67
  s_cselect_b32 s46, s59, 1073741824
  buffer_load_dwordx4 v[28:31], v1, s[4:7], s46 offen sc1
  ds_read_b128 v[108:111], v21 offset:9216
  s_waitcnt lgkmcnt(7)
  v_mfma_f32_32x32x16_bf16 v[40:55], a[160:163], v[120:123], v[40:55]
  s_add_u32 m0, s54, 0
  s_nop 0
  buffer_load_dwordx4 v1, s[4:7], s48 offen offset:0 sc1 lds
  ds_read_b128 v[112:115], v21 offset:10240
  s_waitcnt lgkmcnt(7)
  v_mfma_f32_32x32x16_bf16 v[40:55], a[164:167], v[124:127], v[40:55]
  ds_read_b128 v[64:67], v1 offset:28672
  ds_read_b128 v[116:119], v21 offset:11264
  s_waitcnt lgkmcnt(8)
  v_mfma_f32_32x32x16_bf16 v[40:55], a[168:171], v[128:131], v[40:55]
  ds_read_b128 v[120:123], v21 offset:12288
  s_waitcnt lgkmcnt(7)
  v_mfma_f32_32x32x16_bf16 v[40:55], a[172:175], v[132:135], v[40:55]
  ds_read_b128 v[68:71], v1 offset:29696
  buffer_load_dwordx4 v1, s[4:7], s48 offen offset:1024 sc1 lds
  ds_read_b128 v[124:127], v21 offset:13312
  s_waitcnt lgkmcnt(8)
  v_mfma_f32_32x32x16_bf16 v[40:55], a[176:179], v[104:107], v[40:55]
  ds_read_b128 v[128:131], v21 offset:14336
  s_waitcnt lgkmcnt(7)
  v_mfma_f32_32x32x16_bf16 v[40:55], a[180:183], v[108:111], v[40:55]
  ds_read_b128 v[72:75], v1 offset:32768
  ds_read_b128 v[132:135], v21 offset:15360
  s_waitcnt lgkmcnt(8)
  v_mfma_f32_32x32x16_bf16 v[40:55], a[184:187], v[112:115], v[40:55]
  buffer_load_dwordx4 v1, s[4:7], s48 offen offset:2048 sc1 lds
  ds_read_b128 v[104:107], v21 offset:16384
  s_waitcnt lgkmcnt(7)
  v_mfma_f32_32x32x16_bf16 v[40:55], a[188:191], v[116:119], v[40:55]
  ds_read_b128 v[76:79], v1 offset:33792
  ds_read_b128 v[108:111], v21 offset:17408
  s_waitcnt lgkmcnt(8)
  v_mfma_f32_32x32x16_bf16 v[40:55], a[192:195], v[120:123], v[40:55]
  ds_read_b128 v[112:115], v21 offset:18432
  s_waitcnt lgkmcnt(7)
  v_mfma_f32_32x32x16_bf16 v[40:55], a[196:199], v[124:127], v[40:55]
  ds_read_b128 v[80:83], v1 offset:36864
  buffer_load_dwordx4 v1, s[4:7], s48 offen offset:3072 sc1 lds
  ds_read_b128 v[116:119], v21 offset:19456
  s_waitcnt lgkmcnt(8)
  v_mfma_f32_32x32x16_bf16 v[40:55], a[200:203], v[128:131], v[40:55]
  ds_read_b128 v[120:123], v21 offset:20480
  s_waitcnt lgkmcnt(7)
  v_mfma_f32_32x32x16_bf16 v[40:55], a[204:207], v[132:135], v[40:55]
  ds_read_b128 v[84:87], v1 offset:37888
  ds_read_b128 v[124:127], v21 offset:21504
  s_waitcnt lgkmcnt(8)
  v_mfma_f32_32x32x16_bf16 v[40:55], a[208:211], v[104:107], v[40:55]
  s_add_u32 m0, s54, 4096
  s_add_u32 s48, s48, 4096
  buffer_load_dwordx4 v1, s[4:7], s48 offen offset:0 sc1 lds
  ds_read_b128 v[128:131], v21 offset:22528
  s_waitcnt lgkmcnt(7)
  v_mfma_f32_32x32x16_bf16 v[40:55], a[212:215], v[108:111], v[40:55]
  ds_read_b128 v[88:91], v2 offset:26624
  ds_read_b128 v[132:135], v21 offset:23552
  s_waitcnt lgkmcnt(8)
  v_mfma_f32_32x32x16_bf16 v[40:55], a[216:219], v[112:115], v[40:55]
  ds_read_b128 v[104:107], v21 offset:24576
  s_waitcnt lgkmcnt(7)
  v_mfma_f32_32x32x16_bf16 v[40:55], a[220:223], v[116:119], v[40:55]
  ds_read_b128 v[92:95], v2 offset:27648
  buffer_load_dwordx4 v1, s[4:7], s48 offen offset:1024 sc1 lds
  ds_read_b128 v[108:111], v21 offset:25600
  s_waitcnt lgkmcnt(8)
  v_mfma_f32_32x32x16_bf16 v[40:55], a[224:227], v[120:123], v[40:55]
  ds_read_b128 v[112:115], v21 offset:26624
  s_waitcnt lgkmcnt(7)
  v_mfma_f32_32x32x16_bf16 v[40:55], a[228:231], v[124:127], v[40:55]
  ds_read_b128 v[96:99], v2 offset:30720
  ds_read_b128 v[116:119], v21 offset:27648
  s_waitcnt lgkmcnt(8)
  v_mfma_f32_32x32x16_bf16 v[40:55], a[232:235], v[128:131], v[40:55]
  buffer_load_dwordx4 v1, s[4:7], s48 offen offset:2048 sc1 lds
  ds_read_b128 v[120:123], v21 offset:28672
  s_waitcnt lgkmcnt(7)
  v_mfma_f32_32x32x16_bf16 v[40:55], a[236:239], v[132:135], v[40:55]
  ds_read_b128 v[100:103], v2 offset:31744
  ds_read_b128 v[124:127], v21 offset:29696
  s_waitcnt lgkmcnt(8)
  v_mfma_f32_32x32x16_bf16 v[40:55], a[240:243], v[104:107], v[40:55]
  ds_read_b128 v[128:131], v21 offset:30720
  s_waitcnt lgkmcnt(7)
  v_mfma_f32_32x32x16_bf16 v[40:55], a[244:247], v[108:111], v[40:55]
  buffer_load_dwordx4 v1, s[4:7], s48 offen offset:3072 sc1 lds
  ds_read_b128 v[132:135], v21 offset:31744
  s_waitcnt lgkmcnt(7)
  v_mfma_f32_32x32x16_bf16 v[40:55], a[248:251], v[112:115], v[40:55]
  ds_read_b128 v[104:107], v21 offset:32768
  s_waitcnt lgkmcnt(6)
  v_mfma_f32_32x32x16_bf16 v[40:55], a[252:255], v[116:119], v[40:55]
  ds_read_b128 v[108:111], v21 offset:33792
  s_waitcnt lgkmcnt(6)
  v_mfma_f32_32x32x16_bf16 v[40:55], v[224:227], v[120:123], v[40:55]
  s_add_u32 m0, s54, 8192
  s_add_u32 s48, s48, 4096
  buffer_load_dwordx4 v1, s[4:7], s48 offen offset:0 sc1 lds
  ds_read_b128 v[112:115], v21 offset:34816
  s_waitcnt lgkmcnt(5)
  v_mfma_f32_32x32x16_bf16 v[40:55], v[228:231], v[124:127], v[40:55]
  ds_read_b128 v[116:119], v21 offset:35840
  s_waitcnt lgkmcnt(5)
  v_mfma_f32_32x32x16_bf16 v[40:55], v[232:235], v[128:131], v[40:55]
  s_waitcnt lgkmcnt(4)
  v_mfma_f32_32x32x16_bf16 v[40:55], v[236:239], v[132:135], v[40:55]
  s_waitcnt lgkmcnt(3)
  v_mfma_f32_32x32x16_bf16 v[40:55], v[240:243], v[104:107], v[40:55]
  v_add_u32 v21, s51, v21
  s_sub_u32 s51, 0, s51
  s_waitcnt lgkmcnt(2)
  v_mfma_f32_32x32x16_bf16 v[40:55], v[244:247], v[108:111], v[40:55]
  s_waitcnt lgkmcnt(1)
  v_mfma_f32_32x32x16_bf16 v[40:55], v[248:251], v[112:115], v[40:55]
  s_waitcnt lgkmcnt(0)
  v_mfma_f32_32x32x16_bf16 v[40:55], v[252:255], v[116:119], v[40:55]
  s_nop 11
  v_cvt_pk_bf16_f32 v40, v40, v44
  v_cvt_pk_bf16_f32 v41, v41, v45
  v_cvt_pk_bf16_f32 v42, v42, v46
  v_cvt_pk_bf16_f32 v43, v43, v47
  ds_write_b128 v14, v[40:43] offset:0
  v_cvt_pk_bf16_f32 v48, v48, v52
  v_cvt_pk_bf16_f32 v49, v49, v53
  v_cvt_pk_bf16_f32 v50, v50, v54
  v_cvt_pk_bf16_f32 v51, v51, v55
  ds_write_b128 v14, v[48:51] offset:512
  s_waitcnt lgkmcnt(0)
  s_barrier
  ds_read_b128 v[40:43], v23 offset:0
  ds_read_b128 v[44:47], v23 offset:2048
  ds_read_b128 v[48:51], v23 offset:4096
  ds_read_b128 v[52:55], v23 offset:6144
  s_cmp_gt_u32 s69, s67
  s_cbranch_scc0 AF_wt
  s_waitcnt vmcnt(9)
AF_chk:
  v_max3_u32 v17, v28, v29, v30
  v_max_u32 v17, v17, v31
  v_cmp_eq_u32 vcc, -1, v17
  s_cbranch_vccnz AF_pollk
  ds_write2_b32 v20, v28, v30 offset0:0 offset1:4
  ds_write_b128 v16, v[28:31] offset:16384
  s_add_u32 s67, s67, s30
  s_waitcnt lgkmcnt(5)
  v_mfma_f32_16x16x32_bf16 v[104:107], v[56:59], v[40:43], v[32:35]
  v_mfma_f32_16x16x32_bf16 v[108:111], v[60:63], v[40:43], v[36:39]
  s_waitcnt lgkmcnt(4)
  v_mfma_f32_16x16x32_bf16 v[104:107], v[64:67], v[44:47], v[104:107]
  s_cmp_lg_u32 s72, 0
  s_cselect_b64 vcc, -1, 0
  s_cmp_eq_u32 s60, 0
  s_waitcnt lgkmcnt(0)
  s_barrier
  ds_read_b128 v[116:119], v15 offset:20480
  ds_read_b128 v[120:123], v15 offset:21056
  v_mfma_f32_16x16x32_bf16 v[108:111], v[68:71], v[44:47], v[108:111]
  ds_read_b128 v[124:127], v15 offset:21632
  v_mfma_f32_16x16x32_bf16 v[104:107], v[72:75], v[48:51], v[104:107]
  ds_read_b128 v[128:131], v15 offset:22208
  v_mfma_f32_16x16x32_bf16 v[108:111], v[76:79], v[48:51], v[108:111]
  ds_read_b128 v[132:135], v3 offset:16384
  v_mfma_f32_16x16x32_bf16 v[104:107], v[80:83], v[52:55], v[104:107]
  ds_read_b128 v[136:139], v3 offset:17408
  v_mfma_f32_16x16x32_bf16 v[108:111], v[84:87], v[52:55], v[108:111]
  s_cbranch_scc0 AF_sp
  s_waitcnt lgkmcnt(5)
  v_mfma_f32_16x16x32_bf16 v[112:115], v[116:119], v[40:43], 0
  s_waitcnt lgkmcnt(4)
  v_mfma_f32_16x16x32_bf16 v[112:115], v[120:123], v[44:47], v[112:115]
  v_max3_f32 v5, v104, v105, v106
  v_max3_f32 v5, v5, v107, v108
  s_waitcnt lgkmcnt(3)
  v_mfma_f32_16x16x32_bf16 v[112:115], v[124:127], v[48:51], v[112:115]
  v_max3_f32 v5, v5, v109, v110
  v_max_f32 v5, v5, v111
  s_waitcnt lgkmcnt(2)
  v_mfma_f32_16x16x32_bf16 v[112:115], v[128:131], v[52:55], v[112:115]
  s_nop 7
  v_max3_f32 v5, v5, v112, v113
  v_mov_b32 v6, v5
  s_nop 1
  v_permlane32_swap_b32 v5, v6
  v_max_f32 v5, v5, v6
  v_mov_b32 v6, v5
  s_nop 1
  v_permlane16_swap_b32 v5, v6
  v_max_f32 v5, v5, v6
  v_mul_f32 v6, s58, v5
  v_pk_fma_f32 v[104:105], v[104:105], s[58:59], v[6:7] op_sel_hi:[1,0,0] neg_lo:[0,0,1] neg_hi:[0,0,1]
  v_pk_fma_f32 v[106:107], v[106:107], s[58:59], v[6:7] op_sel_hi:[1,0,0] neg_lo:[0,0,1] neg_hi:[0,0,1]
  v_pk_fma_f32 v[108:109], v[108:109], s[58:59], v[6:7] op_sel_hi:[1,0,0] neg_lo:[0,0,1] neg_hi:[0,0,1]
  v_pk_fma_f32 v[110:111], v[110:111], s[58:59], v[6:7] op_sel_hi:[1,0,0] neg_lo:[0,0,1] neg_hi:[0,0,1]
  v_pk_fma_f32 v[112:113], v[112:113], s[58:59], v[6:7] op_sel_hi:[1,0,0] neg_lo:[0,0,1] neg_hi:[0,0,1]
  v_exp_f32 v104, v104
  v_exp_f32 v105, v105
  v_exp_f32 v106, v106
  v_exp_f32 v107, v107
  v_exp_f32 v108, v108
  v_exp_f32 v109, v109
  v_exp_f32 v110, v110
  v_exp_f32 v111, v111
  v_exp_f32 v112, v112
  v_exp_f32 v113, v113
  v_cvt_pk_bf16_f32 v116, v104, v105
  v_cvt_pk_bf16_f32 v117, v106, v107
  v_cvt_pk_bf16_f32 v118, v108, v109
  v_cvt_pk_bf16_f32 v119, v110, v111
  v_cvt_pk_bf16_f32 v19, v112, v113
  v_pk_add_f32 v[114:115], v[104:105], v[106:107]
  v_mfma_f32_16x16x32_bf16 v[56:59], v[88:91], v[116:119], 0
  v_pk_add_f32 v[114:115], v[114:115], v[108:109]
  v_mfma_f32_16x16x32_bf16 v[60:63], v[92:95], v[116:119], 0
  v_pk_add_f32 v[114:115], v[114:115], v[110:111]
  v_mfma_f32_16x16x32_bf16 v[64:67], v[96:99], v[116:119], 0
  v_pk_add_f32 v[114:115], v[114:115], v[112:113]
  v_mfma_f32_16x16x32_bf16 v[68:71], v[100:103], v[116:119], 0
  v_add_f32 v5, v114, v115
  s_waitcnt lgkmcnt(1)
  v_mfma_f32_16x16x16_bf16 v[56:59], v[132:133], v[18:19], v[56:59]
  v_mfma_f32_16x16x16_bf16 v[60:63], v[134:135], v[18:19], v[60:63]
  s_waitcnt lgkmcnt(0)
  v_mfma_f32_16x16x16_bf16 v[64:67], v[136:137], v[18:19], v[64:67]
  v_mfma_f32_16x16x16_bf16 v[68:71], v[138:139], v[18:19], v[68:71]
  v_mov_b32 v6, v5
  s_nop 1
  v_permlane32_swap_b32 v5, v6
  v_add_f32 v5, v5, v6
  v_mov_b32 v6, v5
  s_nop 1
  v_permlane16_swap_b32 v5, v6
  v_add_f32 v5, v5, v6
  v_rcp_f32 v6, v5
  s_nop 0
  v_pk_mul_f32 v[56:57], v[56:57], v[6:7] op_sel_hi:[1,0]
  v_pk_mul_f32 v[58:59], v[58:59], v[6:7] op_sel_hi:[1,0]
  v_pk_mul_f32 v[60:61], v[60:61], v[6:7] op_sel_hi:[1,0]
  v_pk_mul_f32 v[62:63], v[62:63], v[6:7] op_sel_hi:[1,0]
  v_cvt_pk_bf16_f32 v56, v56, v57
  v_cvt_pk_bf16_f32 v57, v58, v59
  v_cvt_pk_bf16_f32 v58, v60, v61
  v_cvt_pk_bf16_f32 v59, v62, v63
  ds_write_b128 v9, v[56:59] offset:8192
  v_pk_mul_f32 v[64:65], v[64:65], v[6:7] op_sel_hi:[1,0]
  v_pk_mul_f32 v[66:67], v[66:67], v[6:7] op_sel_hi:[1,0]
  v_pk_mul_f32 v[68:69], v[68:69], v[6:7] op_sel_hi:[1,0]
  v_pk_mul_f32 v[70:71], v[70:71], v[6:7] op_sel_hi:[1,0]
  v_cvt_pk_bf16_f32 v64, v64, v65
  v_cvt_pk_bf16_f32 v65, v66, v67
  v_cvt_pk_bf16_f32 v66, v68, v69
  v_cvt_pk_bf16_f32 v67, v70, v71
  ds_write_b128 v9, v[64:67] offset:9216
AF_jn:
AF_dm:
  s_cmp_gt_u32 s68, s67
  s_cbranch_scc0 AF_fl
  s_cmp_lt_u32 s67, 64
  s_cselect_b32 s47, s67, 0x800
  s_lshl_b32 s46, s44, 12
  s_add_u32 m0, s46, 24576
  s_lshl_b32 s48, s47, 19
  s_add_u32 s48, s48, s52
  s_lshl_b32 s47, s47, 17
  s_add_u32 s59, s47, s55
  s_cmp_eq_u32 s67, 66
  s_cselect_b32 s46, s3, 2
  s_cmp_lg_u32 s46, 2
  s_cselect_b32 s46, 4096, 0
  v_add_u32 v5, s46, v1
  s_cselect_b32 s46, 18432, 0
  s_add_u32 s56, s56, s46
  s_add_u32 s57, s57, s46
  s_add_u32 s71, s61, 18432
  s_mov_b32 s60, 1
  s_waitcnt lgkmcnt(0)
  s_barrier
AF_p2:
  ds_read_b128 v[56:59], v5 offset:8192
  ds_read_b128 v[60:63], v5 offset:9216
  ds_read_b128 v[64:67], v5 offset:10240
  ds_read_b128 v[68:71], v5 offset:11264
  ds_read_b128 v[72:75], v5 offset:12288
  ds_read_b128 v[76:79], v5 offset:13312
  ds_read_b128 v[80:83], v5 offset:14336
  ds_read_b128 v[84:87], v5 offset:15360
  buffer_load_dwordx4 v1, s[4:7], s48 offen offset:0 sc1 lds
  s_waitcnt lgkmcnt(7)
  v_mfma_f32_16x16x32_bf16 v[140:143], a[0:3], v[56:59], 0
  buffer_load_dwordx2 v[220:221], v13, s[8:11], s56 offen
  v_mfma_f32_16x16x32_bf16 v[144:147], a[16:19], v[56:59], 0
  v_mfma_f32_16x16x32_bf16 v[148:151], a[32:35], v[56:59], 0
  buffer_load_dwordx4 v1, s[4:7], s48 offen offset:1024 sc1 lds
  s_waitcnt lgkmcnt(6)
  v_mfma_f32_16x16x32_bf16 v[140:143], a[4:7], v[60:63], v[140:143]
  buffer_load_dwordx2 v[222:223], v13, s[8:11], s73 offen
  v_mfma_f32_16x16x32_bf16 v[144:147], a[20:23], v[60:63], v[144:147]
  v_mfma_f32_16x16x32_bf16 v[148:151], a[36:39], v[60:63], v[148:151]
  buffer_load_dwordx4 v1, s[4:7], s48 offen offset:2048 sc1 lds
  s_waitcnt lgkmcnt(5)
  v_mfma_f32_16x16x32_bf16 v[140:143], a[8:11], v[64:67], v[140:143]
  v_mfma_f32_16x16x32_bf16 v[144:147], a[24:27], v[64:67], v[144:147]
  v_mfma_f32_16x16x32_bf16 v[148:151], a[40:43], v[64:67], v[148:151]
  buffer_load_dwordx4 v1, s[4:7], s48 offen offset:3072 sc1 lds
  s_waitcnt lgkmcnt(4)
  v_mfma_f32_16x16x32_bf16 v[140:143], a[12:15], v[68:71], v[140:143]
  v_mfma_f32_16x16x32_bf16 v[144:147], a[28:31], v[68:71], v[144:147]
  v_mfma_f32_16x16x32_bf16 v[148:151], a[44:47], v[68:71], v[148:151]
  v_mfma_f32_16x16x32_bf16 v[152:155], a[48:51], v[56:59], 0
  v_mfma_f32_16x16x32_bf16 v[156:159], a[64:67], v[56:59], 0
  v_mfma_f32_16x16x32_bf16 v[160:163], a[80:83], v[56:59], 0
  v_mfma_f32_16x16x32_bf16 v[152:155], a[52:55], v[60:63], v[152:155]
  v_cvt_pk_bf16_f32 v140, v140, v141
  v_cvt_pk_bf16_f32 v141, v142, v143
  v_mfma_f32_16x16x32_bf16 v[156:159], a[68:71], v[60:63], v[156:159]
  v_cvt_pk_bf16_f32 v142, v144, v145
  v_cvt_pk_bf16_f32 v143, v146, v147
  v_mfma_f32_16x16x32_bf16 v[160:163], a[84:87], v[60:63], v[160:163]
  v_bfi_b32 v140, 1, s64, v140
  v_bfi_b32 v141, 1, s64, v141
  v_mfma_f32_16x16x32_bf16 v[152:155], a[56:59], v[64:67], v[152:155]
  v_bfi_b32 v142, 1, s64, v142
  v_bfi_b32 v143, 1, s64, v143
  v_mfma_f32_16x16x32_bf16 v[156:159], a[72:75], v[64:67], v[156:159]
  buffer_store_dwordx4 v[140:143], v1, s[4:7], s61 offen offset:0 sc1
  v_mfma_f32_16x16x32_bf16 v[160:163], a[88:91], v[64:67], v[160:163]
  v_mfma_f32_16x16x32_bf16 v[152:155], a[60:63], v[68:71], v[152:155]
  v_mfma_f32_16x16x32_bf16 v[156:159], a[76:79], v[68:71], v[156:159]
  v_mfma_f32_16x16x32_bf16 v[160:163], a[92:95], v[68:71], v[160:163]
  v_mfma_f32_16x16x32_bf16 v[164:167], a[96:99], v[56:59], 0
  v_mfma_f32_16x16x32_bf16 v[168:171], a[112:115], v[56:59], 0
  v_mfma_f32_16x16x32_bf16 v[172:175], a[128:131], v[56:59], 0
  v_mfma_f32_16x16x32_bf16 v[164:167], a[100:103], v[60:63], v[164:167]
  v_cvt_pk_bf16_f32 v148, v148, v149
  v_cvt_pk_bf16_f32 v149, v150, v151
  v_mfma_f32_16x16x32_bf16 v[168:171], a[116:119], v[60:63], v[168:171]
  v_cvt_pk_bf16_f32 v150, v152, v153
  v_cvt_pk_bf16_f32 v151, v154, v155
  v_mfma_f32_16x16x32_bf16 v[172:175], a[132:135], v[60:63], v[172:175]
  v_bfi_b32 v148, 1, s64, v148
  v_bfi_b32 v149, 1, s64, v149
  v_mfma_f32_16x16x32_bf16 v[164:167], a[104:107], v[64:67], v[164:167]
  v_bfi_b32 v150, 1, s64, v150
  v_bfi_b32 v151, 1, s64, v151
  v_mfma_f32_16x16x32_bf16 v[168:171], a[120:123], v[64:67], v[168:171]
  buffer_store_dwordx4 v[148:151], v1, s[4:7], s61 offen offset:1024 sc1
  v_cvt_pk_bf16_f32 v156, v156, v157
  v_mfma_f32_16x16x32_bf16 v[172:175], a[136:139], v[64:67], v[172:175]
  v_cvt_pk_bf16_f32 v157, v158, v159
  v_cvt_pk_bf16_f32 v158, v160, v161
  v_mfma_f32_16x16x32_bf16 v[164:167], a[108:111], v[68:71], v[164:167]
  v_cvt_pk_bf16_f32 v159, v162, v163
  v_bfi_b32 v156, 1, s64, v156
  v_mfma_f32_16x16x32_bf16 v[168:171], a[124:127], v[68:71], v[168:171]
  v_bfi_b32 v157, 1, s64, v157
  v_bfi_b32 v158, 1, s64, v158
  v_mfma_f32_16x16x32_bf16 v[172:175], a[140:143], v[68:71], v[172:175]
  v_bfi_b32 v159, 1, s64, v159
  buffer_store_dwordx4 v[156:159], v1, s[4:7], s61 offen offset:2048 sc1
  s_waitcnt lgkmcnt(3)
  v_mfma_f32_16x16x32_bf16 v[176:179], a[0:3], v[72:75], 0
  v_mfma_f32_16x16x32_bf16 v[180:183], a[16:19], v[72:75], 0
  v_mfma_f32_16x16x32_bf16 v[184:187], a[32:35], v[72:75], 0
  s_waitcnt lgkmcnt(2)
  v_mfma_f32_16x16x32_bf16 v[176:179], a[4:7], v[76:79], v[176:179]
  v_cvt_pk_bf16_f32 v164, v164, v165
  v_cvt_pk_bf16_f32 v165, v166, v167
  v_mfma_f32_16x16x32_bf16 v[180:183], a[20:23], v[76:79], v[180:183]
  v_cvt_pk_bf16_f32 v166, v168, v169
  v_cvt_pk_bf16_f32 v167, v170, v171
  v_mfma_f32_16x16x32_bf16 v[184:187], a[36:39], v[76:79], v[184:187]
  v_bfi_b32 v164, 1, s64, v164
  v_bfi_b32 v165, 1, s64, v165
  s_waitcnt lgkmcnt(1)
  v_mfma_f32_16x16x32_bf16 v[176:179], a[8:11], v[80:83], v[176:179]
  v_bfi_b32 v166, 1, s64, v166
  v_bfi_b32 v167, 1, s64, v167
  v_mfma_f32_16x16x32_bf16 v[180:183], a[24:27], v[80:83], v[180:183]
  buffer_store_dwordx4 v[164:167], v1, s[4:7], s61 offen offset:3072 sc1
  v_cvt_pk_bf16_f32 v172, v172, v173
  v_mfma_f32_16x16x32_bf16 v[184:187], a[40:43], v[80:83], v[184:187]
  v_cvt_pk_bf16_f32 v173, v174, v175
  v_bfi_b32 v172, 1, s64, v172
  s_waitcnt lgkmcnt(0)
  v_mfma_f32_16x16x32_bf16 v[176:179], a[12:15], v[84:87], v[176:179]
  v_bfi_b32 v173, 1, s64, v173
  buffer_store_dwordx2 v[172:173], v11, s[4:7], s61 offen sc1
  s_cmp_ge_u32 s67, 66
  s_cbranch_scc1 AF_hf
  v_mfma_f32_16x16x32_bf16 v[180:183], a[28:31], v[84:87], v[180:183]
  v_mfma_f32_16x16x32_bf16 v[184:187], a[44:47], v[84:87], v[184:187]
  s_cmp_lt_u32 s67, 64
  s_cselect_b32 s46, 0, 1073741824
  buffer_load_dword v4, off, s[4:7], s46 offset:2432 sc1
  buffer_load_dword v22, off, s[4:7], s46 offset:2048 sc1
  v_mfma_f32_16x16x32_bf16 v[188:191], a[48:51], v[72:75], 0
  v_mfma_f32_16x16x32_bf16 v[192:195], a[64:67], v[72:75], 0
  v_mfma_f32_16x16x32_bf16 v[196:199], a[80:83], v[72:75], 0
  v_mfma_f32_16x16x32_bf16 v[188:191], a[52:55], v[76:79], v[188:191]
  v_cvt_pk_bf16_f32 v176, v176, v177
  v_cvt_pk_bf16_f32 v177, v178, v179
  v_mfma_f32_16x16x32_bf16 v[192:195], a[68:71], v[76:79], v[192:195]
  v_cvt_pk_bf16_f32 v178, v180, v181
  v_cvt_pk_bf16_f32 v179, v182, v183
  v_mfma_f32_16x16x32_bf16 v[196:199], a[84:87], v[76:79], v[196:199]
  v_bfi_b32 v176, 1, s64, v176
  v_bfi_b32 v177, 1, s64, v177
  v_mfma_f32_16x16x32_bf16 v[188:191], a[56:59], v[80:83], v[188:191]
  v_bfi_b32 v178, 1, s64, v178
  v_bfi_b32 v179, 1, s64, v179
  v_mfma_f32_16x16x32_bf16 v[192:195], a[72:75], v[80:83], v[192:195]
  buffer_store_dwordx4 v[176:179], v1, s[4:7], s71 offen offset:0 sc1
  v_mfma_f32_16x16x32_bf16 v[196:199], a[88:91], v[80:83], v[196:199]
  v_mfma_f32_16x16x32_bf16 v[188:191], a[60:63], v[84:87], v[188:191]
  v_mfma_f32_16x16x32_bf16 v[192:195], a[76:79], v[84:87], v[192:195]
  v_mfma_f32_16x16x32_bf16 v[196:199], a[92:95], v[84:87], v[196:199]
  v_mfma_f32_16x16x32_bf16 v[200:203], a[96:99], v[72:75], 0
  v_mfma_f32_16x16x32_bf16 v[204:207], a[112:115], v[72:75], 0
  v_mfma_f32_16x16x32_bf16 v[208:211], a[128:131], v[72:75], 0
  v_mfma_f32_16x16x32_bf16 v[200:203], a[100:103], v[76:79], v[200:203]
  v_cvt_pk_bf16_f32 v184, v184, v185
  v_cvt_pk_bf16_f32 v185, v186, v187
  v_mfma_f32_16x16x32_bf16 v[204:207], a[116:119], v[76:79], v[204:207]
  v_cvt_pk_bf16_f32 v186, v188, v189
  v_cvt_pk_bf16_f32 v187, v190, v191
  v_mfma_f32_16x16x32_bf16 v[208:211], a[132:135], v[76:79], v[208:211]
  v_bfi_b32 v184, 1, s64, v184
  v_bfi_b32 v185, 1, s64, v185
  v_mfma_f32_16x16x32_bf16 v[200:203], a[104:107], v[80:83], v[200:203]
  v_bfi_b32 v186, 1, s64, v186
  v_bfi_b32 v187, 1, s64, v187
  s_waitcnt vmcnt(8)
  s_barrier
  v_mfma_f32_16x16x32_bf16 v[204:207], a[120:123], v[80:83], v[204:207]
  buffer_store_dwordx4 v[184:187], v1, s[4:7], s71 offen offset:1024 sc1
  v_cvt_pk_bf16_f32 v192, v192, v193
  ds_read_b128 v[104:107], v21 offset:0
  v_mfma_f32_16x16x32_bf16 v[208:211], a[136:139], v[80:83], v[208:211]
  v_cvt_pk_bf16_f32 v193, v194, v195
  v_cvt_pk_bf16_f32 v194, v196, v197
  ds_read_b128 v[108:111], v21 offset:1024
  v_mfma_f32_16x16x32_bf16 v[200:203], a[108:111], v[84:87], v[200:203]
  v_cvt_pk_bf16_f32 v195, v198, v199
  v_bfi_b32 v192, 1, s64, v192
  ds_read_b128 v[112:115], v21 offset:2048
  v_mfma_f32_16x16x32_bf16 v[204:207], a[124:127], v[84:87], v[204:207]
  v_bfi_b32 v193, 1, s64, v193
  v_bfi_b32 v194, 1, s64, v194
  ds_read_b128 v[116:119], v21 offset:3072
  v_mfma_f32_16x16x32_bf16 v[208:211], a[140:143], v[84:87], v[208:211]
  v_bfi_b32 v195, 1, s64, v195
  buffer_store_dwordx4 v[192:195], v1, s[4:7], s71 offen offset:2048 sc1
  ds_read_b128 v[120:123], v21 offset:4096
  v_cvt_pk_bf16_f32 v200, v200, v201
  v_cvt_pk_bf16_f32 v201, v202, v203
  v_cvt_pk_bf16_f32 v202, v204, v205
  v_cvt_pk_bf16_f32 v203, v206, v207
  v_bfi_b32 v200, 1, s64, v200
  v_bfi_b32 v201, 1, s64, v201
  v_bfi_b32 v202, 1, s64, v202
  v_bfi_b32 v203, 1, s64, v203
  buffer_store_dwordx4 v[200:203], v1, s[4:7], s71 offen offset:3072 sc1
  v_cvt_pk_bf16_f32 v208, v208, v209
  v_cvt_pk_bf16_f32 v209, v210, v211
  v_bfi_b32 v208, 1, s64, v208
  v_bfi_b32 v209, 1, s64, v209
  buffer_store_dwordx2 v[208:209], v11, s[4:7], s71 offen sc1
AF_hf:
  s_xor_b32 s61, s61, 2097152
  s_mov_b32 s65, s64
  s_add_u32 s66, s66, 1
  s_lshr_b32 s64, s66, 1
AF_le:
  s_cmp_lt_u32 s67, s38
  s_cbranch_scc1 AF_loop
  s_cmp_eq_u32 s29, 64
  s_cbranch_scc1 AF_zg
  s_mul_i32 s31, s30, 36864
  s_cmp_ge_u32 s67, 66
  s_cselect_b32 s31, 18432, s31
  s_cselect_b32 s72, 0, s72
  s_cselect_b32 s46, s63, 0
  s_cmp_ge_u32 s46, 72
  s_cbranch_scc1 AF_fe
AF_wx:
  s_add_u32 s46, s62, 0
  buffer_load_dwordx4 v[148:151], v12, s[4:7], s46 offen sc1
  s_add_u32 s46, s62, 148480
  buffer_load_dwordx4 v[152:155], v12, s[4:7], s46 offen sc1
  s_add_u32 s46, s62, 296960
  buffer_load_dwordx4 v[156:159], v12, s[4:7], s46 offen sc1
  s_add_u32 s46, s62, 445440
  buffer_load_dwordx4 v[160:163], v12, s[4:7], s46 offen sc1
  s_add_u32 s46, s62, 593920
  buffer_load_dwordx4 v[164:167], v12, s[4:7], s46 offen sc1
  s_add_u32 s46, s62, 742400
  buffer_load_dwordx4 v[168:171], v12, s[4:7], s46 offen sc1
  s_add_u32 s46, s62, 890880
  buffer_load_dwordx4 v[172:175], v12, s[4:7], s46 offen sc1
  s_add_u32 s46, s62, 1039360
  buffer_load_dwordx4 v[176:179], v12, s[4:7], s46 offen sc1
  s_cmp_eq_u32 s72, 0
  s_cbranch_scc1 AF_n2
  s_add_u32 s46, s62, 32768
  buffer_load_dwordx4 v[180:183], v12, s[4:7], s46 offen sc1
  s_add_u32 s46, s62, 181248
  buffer_load_dwordx4 v[184:187], v12, s[4:7], s46 offen sc1
  s_add_u32 s46, s62, 329728
  buffer_load_dwordx4 v[188:191], v12, s[4:7], s46 offen sc1
  s_add_u32 s46, s62, 478208
  buffer_load_dwordx4 v[192:195], v12, s[4:7], s46 offen sc1
  s_add_u32 s46, s62, 626688
  buffer_load_dwordx4 v[196:199], v12, s[4:7], s46 offen sc1
  s_add_u32 s46, s62, 775168
  buffer_load_dwordx4 v[200:203], v12, s[4:7], s46 offen sc1
  s_add_u32 s46, s62, 923648
  buffer_load_dwordx4 v[204:207], v12, s[4:7], s46 offen sc1
  s_add_u32 s46, s62, 1072128
  buffer_load_dwordx4 v[208:211], v12, s[4:7], s46 offen sc1
AF_n2:
  s_mov_b32 s60, 0
  s_waitcnt vmcnt(0)
  v_readfirstlane_b32 s69, v22
  s_cmp_gt_u32 s69, s67
  s_cselect_b32 s46, s59, 1073741824
  buffer_load_dwordx4 v[28:31], v1, s[4:7], s46 offen sc1
AFb_s0:
  v_mfma_f32_16x16x32_bf16 v[212:215], v[24:27], v[148:151], 0
  v_bitop3_b32 v7, v148, v149, s65 bitop3:0x7e
  v_bitop3_b32 v8, v150, v151, s65 bitop3:0x7e
  v_bitop3_b32 v7, v7, v8, 1 bitop3:0xa8
  v_cmp_ne_u32 s[16:17], 0, v7
  v_mfma_f32_16x16x32_bf16 v[212:215], v[24:27], v[152:155], v[212:215]
  v_bitop3_b32 v7, v152, v153, s65 bitop3:0x7e
  v_bitop3_b32 v8, v154, v155, s65 bitop3:0x7e
  v_bitop3_b32 v7, v7, v8, 1 bitop3:0xa8
  v_cmp_ne_u32 s[18:19], 0, v7
  v_mfma_f32_16x16x32_bf16 v[212:215], v[24:27], v[156:159], v[212:215]
  v_bitop3_b32 v7, v156, v157, s65 bitop3:0x7e
  v_bitop3_b32 v8, v158, v159, s65 bitop3:0x7e
  s_or_b64 s[36:37], s[18:19], s[16:17]
  v_bitop3_b32 v7, v7, v8, 1 bitop3:0xa8
  v_cmp_ne_u32 s[20:21], 0, v7
  v_mfma_f32_16x16x32_bf16 v[212:215], v[24:27], v[160:163], v[212:215]
  v_bitop3_b32 v7, v160, v161, s65 bitop3:0x7e
  v_bitop3_b32 v8, v162, v163, s65 bitop3:0x7e
  s_or_b64 s[36:37], s[20:21], s[36:37]
  v_bitop3_b32 v7, v7, v8, 1 bitop3:0xa8
  v_cmp_ne_u32 s[22:23], 0, v7
  v_mfma_f32_16x16x32_bf16 v[212:215], v[24:27], v[164:167], v[212:215]
  v_bitop3_b32 v7, v164, v165, s65 bitop3:0x7e
  v_bitop3_b32 v8, v166, v167, s65 bitop3:0x7e
  s_or_b64 s[36:37], s[22:23], s[36:37]
  v_bitop3_b32 v7, v7, v8, 1 bitop3:0xa8
  v_cmp_ne_u32 s[24:25], 0, v7
  v_mfma_f32_16x16x32_bf16 v[212:215], v[24:27], v[168:171], v[212:215]
  v_bitop3_b32 v7, v168, v169, s65 bitop3:0x7e
  v_bitop3_b32 v8, v170, v171, s65 bitop3:0x7e
  s_or_b64 s[36:37], s[24:25], s[36:37]
  v_bitop3_b32 v7, v7, v8, 1 bitop3:0xa8
  v_cmp_ne_u32 s[26:27], 0, v7
  v_mfma_f32_16x16x32_bf16 v[212:215], v[24:27], v[172:175], v[212:215]
  v_bitop3_b32 v7, v172, v173, s65 bitop3:0x7e
  v_bitop3_b32 v8, v174, v175, s65 bitop3:0x7e
  s_or_b64 s[36:37], s[26:27], s[36:37]
  v_bitop3_b32 v7, v7, v8, 1 bitop3:0xa8
  v_cmp_ne_u32 s[32:33], 0, v7
  v_mfma_f32_16x16x32_bf16 v[212:215], v[24:27], v[176:179], v[212:215]
  v_bitop3_b32 v7, v176, v177, s65 bitop3:0x7e
  v_bitop3_b32 v8, v178, v179, s65 bitop3:0x7e
  s_or_b64 s[36:37], s[32:33], s[36:37]
  v_bitop3_b32 v7, v7, v8, 1 bitop3:0xa8
  v_cmp_ne_u32 s[34:35], 0, v7
  s_or_b64 s[36:37], s[36:37], s[34:35]
  s_cbranch_scc1 AFb_r0
  s_nop 0
  v_cvt_pk_bf16_f32 v212, v212, v213
  v_cvt_pk_bf16_f32 v213, v214, v215
  v_lshlrev_b32 v148, 16, v212
  v_and_b32 v149, 0xffff0000, v212
  v_lshlrev_b32 v150, 16, v220
  v_and_b32 v151, 0xffff0000, v220
  v_pk_add_f32 v[148:149], v[148:149], v[150:151]
  v_cvt_pk_bf16_f32 v212, v148, v149
  v_lshlrev_b32 v148, 16, v213
  v_and_b32 v149, 0xffff0000, v213
  v_lshlrev_b32 v150, 16, v221
  v_and_b32 v151, 0xffff0000, v221
  v_pk_add_f32 v[148:149], v[148:149], v[150:151]
  v_cvt_pk_bf16_f32 v213, v148, v149
  v_permlane16_swap_b32 v212, v214
  s_nop 0
  v_permlane16_swap_b32 v213, v215
  buffer_store_dwordx4 v[212:215], v10, s[4:7], s57 offen sc1
  s_cmp_eq_u32 s72, 0
  s_cbranch_scc1 AFb_e
AFb_s1:
  v_mfma_f32_16x16x32_bf16 v[216:219], v[24:27], v[180:183], 0
  v_bitop3_b32 v7, v180, v181, s65 bitop3:0x7e
  v_bitop3_b32 v8, v182, v183, s65 bitop3:0x7e
  v_bitop3_b32 v7, v7, v8, 1 bitop3:0xa8
  v_cmp_ne_u32 s[16:17], 0, v7
  v_mfma_f32_16x16x32_bf16 v[216:219], v[24:27], v[184:187], v[216:219]
  v_bitop3_b32 v7, v184, v185, s65 bitop3:0x7e
  v_bitop3_b32 v8, v186, v187, s65 bitop3:0x7e
  v_bitop3_b32 v7, v7, v8, 1 bitop3:0xa8
  v_cmp_ne_u32 s[18:19], 0, v7
  v_mfma_f32_16x16x32_bf16 v[216:219], v[24:27], v[188:191], v[216:219]
  v_bitop3_b32 v7, v188, v189, s65 bitop3:0x7e
  v_bitop3_b32 v8, v190, v191, s65 bitop3:0x7e
  s_or_b64 s[36:37], s[18:19], s[16:17]
  v_bitop3_b32 v7, v7, v8, 1 bitop3:0xa8
  v_cmp_ne_u32 s[20:21], 0, v7
  v_mfma_f32_16x16x32_bf16 v[216:219], v[24:27], v[192:195], v[216:219]
  v_bitop3_b32 v7, v192, v193, s65 bitop3:0x7e
  v_bitop3_b32 v8, v194, v195, s65 bitop3:0x7e
  s_or_b64 s[36:37], s[20:21], s[36:37]
  v_bitop3_b32 v7, v7, v8, 1 bitop3:0xa8
  v_cmp_ne_u32 s[22:23], 0, v7
  v_mfma_f32_16x16x32_bf16 v[216:219], v[24:27], v[196:199], v[216:219]
  v_bitop3_b32 v7, v196, v197, s65 bitop3:0x7e
  v_bitop3_b32 v8, v198, v199, s65 bitop3:0x7e
  s_or_b64 s[36:37], s[22:23], s[36:37]
  v_bitop3_b32 v7, v7, v8, 1 bitop3:0xa8
  v_cmp_ne_u32 s[24:25], 0, v7
  v_mfma_f32_16x16x32_bf16 v[216:219], v[24:27], v[200:203], v[216:219]
  v_bitop3_b32 v7, v200, v201, s65 bitop3:0x7e
  v_bitop3_b32 v8, v202, v203, s65 bitop3:0x7e
  s_or_b64 s[36:37], s[24:25], s[36:37]
  v_bitop3_b32 v7, v7, v8, 1 bitop3:0xa8
  v_cmp_ne_u32 s[26:27], 0, v7
  v_mfma_f32_16x16x32_bf16 v[216:219], v[24:27], v[204:207], v[216:219]
  v_bitop3_b32 v7, v204, v205, s65 bitop3:0x7e
  v_bitop3_b32 v8, v206, v207, s65 bitop3:0x7e
  s_or_b64 s[36:37], s[26:27], s[36:37]
  v_bitop3_b32 v7, v7, v8, 1 bitop3:0xa8
  v_cmp_ne_u32 s[32:33], 0, v7
  v_mfma_f32_16x16x32_bf16 v[216:219], v[24:27], v[208:211], v[216:219]
  v_bitop3_b32 v7, v208, v209, s65 bitop3:0x7e
  v_bitop3_b32 v8, v210, v211, s65 bitop3:0x7e
  s_or_b64 s[36:37], s[32:33], s[36:37]
  v_bitop3_b32 v7, v7, v8, 1 bitop3:0xa8
  v_cmp_ne_u32 s[34:35], 0, v7
  s_or_b64 s[36:37], s[36:37], s[34:35]
  s_cbranch_scc1 AFb_r1
  s_nop 0
  v_cvt_pk_bf16_f32 v216, v216, v217
  v_cvt_pk_bf16_f32 v217, v218, v219
  v_lshlrev_b32 v180, 16, v216
  v_and_b32 v181, 0xffff0000, v216
  v_lshlrev_b32 v182, 16, v222
  v_and_b32 v183, 0xffff0000, v222
  v_pk_add_f32 v[180:181], v[180:181], v[182:183]
  v_cvt_pk_bf16_f32 v216, v180, v181
  v_lshlrev_b32 v180, 16, v217
  v_and_b32 v181, 0xffff0000, v217
  v_lshlrev_b32 v182, 16, v223
  v_and_b32 v183, 0xffff0000, v223
  v_pk_add_f32 v[180:181], v[180:181], v[182:183]
  v_cvt_pk_bf16_f32 v217, v180, v181
  v_permlane16_swap_b32 v216, v218
  s_nop 0
  v_permlane16_swap_b32 v217, v219
  s_add_u32 s46, s57, 32768
  buffer_store_dwordx4 v[216:219], v10, s[4:7], s46 offen sc1
AFb_e:
  s_add_u32 s56, s56, s31
  s_add_u32 s73, s73, s31
  s_add_u32 s57, s57, s31
  s_xor_b32 s62, s62, 2097152
  s_cmp_lt_u32 s67, 64
  s_cbranch_scc1 AF_mo
AF_fe:
  s_cmp_eq_u32 s67, 0
  s_cbranch_scc0 K_end
  s_xor_b32 s61, s61, 2097152
  s_add_u32 s61, s61, 18432
  s_xor_b32 s62, s62, 2097152
  s_add_u32 s62, s62, 18432
  s_mov_b32 s64, s65
  s_mov_b32 s67, 66
  v_add_u32 v5, 4096, v1
  s_branch AF_p2
AF_mo:
  s_cmp_lt_u32 s67, s38
  s_cbranch_scc0 AF_loop
  s_cmp_gt_u32 s69, s67
  s_cbranch_scc0 AF_pollk
  s_waitcnt vmcnt(2)
  s_cmp_eq_u32 s72, 0
  s_cbranch_scc0 AF_chk
  s_waitcnt vmcnt(1)
  s_branch AF_chk
AF_wt:
  s_cmp_eq_u32 s60, 0
  s_cbranch_scc1 AF_pollk
  buffer_load_dword v22, off, s[4:7], 0 offset:2048 sc1
  s_branch AF_wx
AF_pollk:
  s_sub_u32 s50, s50, 1
  s_cbranch_scc1 K_end
  s_cmp_ge_u32 s67, 61
  s_cbranch_scc1 AF_pk
  s_cmp_gt_u32 s69, s67
  s_cbranch_scc1 AF_pk
  s_waitcnt vmcnt(0)
  buffer_load_dword v22, off, s[4:7], 0 offset:2048 sc1
  s_waitcnt vmcnt(0)
  v_readfirstlane_b32 s69, v22
  s_cmp_gt_u32 s69, s67
  s_cbranch_scc1 AF_pk
  s_cmp_ge_u32 s69, 63
  s_cbranch_scc1 AF_pollk
  s_sleep 4
  s_branch AF_pollk
AF_pk:
  buffer_load_dwordx4 v[28:31], v1, s[4:7], s59 offen sc1
  s_waitcnt vmcnt(0)
  s_branch AF_chk
AF_sp:
  s_add_u32 s46, s62, 0
  buffer_load_dwordx4 v[148:151], v12, s[4:7], s46 offen sc1
  s_cbranch_vccz AF_q0
  s_add_u32 s46, s62, 32768
  buffer_load_dwordx4 v[180:183], v12, s[4:7], s46 offen sc1
AF_q0:
  s_waitcnt lgkmcnt(5)
  v_mfma_f32_16x16x32_bf16 v[112:115], v[116:119], v[40:43], 0
  s_add_u32 s46, s62, 148480
  buffer_load_dwordx4 v[152:155], v12, s[4:7], s46 offen sc1
  s_cbranch_vccz AF_q1
  s_add_u32 s46, s62, 181248
  buffer_load_dwordx4 v[184:187], v12, s[4:7], s46 offen sc1
AF_q1:
  s_waitcnt lgkmcnt(4)
  v_mfma_f32_16x16x32_bf16 v[112:115], v[120:123], v[44:47], v[112:115]
  v_max3_f32 v5, v104, v105, v106
  v_max3_f32 v5, v5, v107, v108
  s_waitcnt lgkmcnt(3)
  v_mfma_f32_16x16x32_bf16 v[112:115], v[124:127], v[48:51], v[112:115]
  v_max3_f32 v5, v5, v109, v110
  v_max_f32 v5, v5, v111
  s_waitcnt lgkmcnt(2)
  v_mfma_f32_16x16x32_bf16 v[112:115], v[128:131], v[52:55], v[112:115]
  s_add_u32 s46, s62, 296960
  buffer_load_dwordx4 v[156:159], v12, s[4:7], s46 offen sc1
  s_nop 1
  s_cbranch_vccz AF_q2
  s_add_u32 s46, s62, 329728
  buffer_load_dwordx4 v[188:191], v12, s[4:7], s46 offen sc1
AF_q2:
  s_nop 2
  v_max3_f32 v5, v5, v112, v113
  v_mov_b32 v6, v5
  s_add_u32 s46, s62, 445440
  buffer_load_dwordx4 v[160:163], v12, s[4:7], s46 offen sc1
  s_cbranch_vccz AF_q3
  s_add_u32 s46, s62, 478208
  buffer_load_dwordx4 v[192:195], v12, s[4:7], s46 offen sc1
AF_q3:
  v_permlane32_swap_b32 v5, v6
  v_max_f32 v5, v5, v6
  v_mov_b32 v6, v5
  s_add_u32 s46, s62, 593920
  buffer_load_dwordx4 v[164:167], v12, s[4:7], s46 offen sc1
  s_cbranch_vccz AF_q4
  s_add_u32 s46, s62, 626688
  buffer_load_dwordx4 v[196:199], v12, s[4:7], s46 offen sc1
AF_q4:
  v_permlane16_swap_b32 v5, v6
  v_max_f32 v5, v5, v6
  v_mul_f32 v6, s58, v5
  s_add_u32 s46, s62, 742400
  buffer_load_dwordx4 v[168:171], v12, s[4:7], s46 offen sc1
  s_cbranch_vccz AF_q5
  s_add_u32 s46, s62, 775168
  buffer_load_dwordx4 v[200:203], v12, s[4:7], s46 offen sc1
AF_q5:
  v_pk_fma_f32 v[104:105], v[104:105], s[58:59], v[6:7] op_sel_hi:[1,0,0] neg_lo:[0,0,1] neg_hi:[0,0,1]
  v_pk_fma_f32 v[106:107], v[106:107], s[58:59], v[6:7] op_sel_hi:[1,0,0] neg_lo:[0,0,1] neg_hi:[0,0,1]
  v_pk_fma_f32 v[108:109], v[108:109], s[58:59], v[6:7] op_sel_hi:[1,0,0] neg_lo:[0,0,1] neg_hi:[0,0,1]
  v_pk_fma_f32 v[110:111], v[110:111], s[58:59], v[6:7] op_sel_hi:[1,0,0] neg_lo:[0,0,1] neg_hi:[0,0,1]
  v_pk_fma_f32 v[112:113], v[112:113], s[58:59], v[6:7] op_sel_hi:[1,0,0] neg_lo:[0,0,1] neg_hi:[0,0,1]
  v_exp_f32 v104, v104
  v_exp_f32 v105, v105
  s_add_u32 s46, s62, 890880
  buffer_load_dwordx4 v[172:175], v12, s[4:7], s46 offen sc1
  s_cbranch_vccz AF_q6
  s_add_u32 s46, s62, 923648
  buffer_load_dwordx4 v[204:207], v12, s[4:7], s46 offen sc1
AF_q6:
  v_exp_f32 v106, v106
  v_exp_f32 v107, v107
  v_exp_f32 v108, v108
  v_exp_f32 v109, v109
  s_add_u32 s46, s62, 1039360
  buffer_load_dwordx4 v[176:179], v12, s[4:7], s46 offen sc1
  s_cbranch_vccz AF_q7
  s_add_u32 s46, s62, 1072128
  buffer_load_dwordx4 v[208:211], v12, s[4:7], s46 offen sc1
AF_q7:
  v_exp_f32 v110, v110
  v_exp_f32 v111, v111
  v_exp_f32 v112, v112
  v_exp_f32 v113, v113
  v_cvt_pk_bf16_f32 v116, v104, v105
  v_cvt_pk_bf16_f32 v117, v106, v107
  v_cvt_pk_bf16_f32 v118, v108, v109
  v_cvt_pk_bf16_f32 v119, v110, v111
  v_cvt_pk_bf16_f32 v19, v112, v113
  v_pk_add_f32 v[114:115], v[104:105], v[106:107]
  v_mfma_f32_16x16x32_bf16 v[56:59], v[88:91], v[116:119], 0
  v_pk_add_f32 v[114:115], v[114:115], v[108:109]
  v_mfma_f32_16x16x32_bf16 v[60:63], v[92:95], v[116:119], 0
  v_pk_add_f32 v[114:115], v[114:115], v[110:111]
  v_mfma_f32_16x16x32_bf16 v[64:67], v[96:99], v[116:119], 0
  v_pk_add_f32 v[114:115], v[114:115], v[112:113]
  v_mfma_f32_16x16x32_bf16 v[68:71], v[100:103], v[116:119], 0
  v_add_f32 v5, v114, v115
  s_waitcnt lgkmcnt(1)
  v_mfma_f32_16x16x16_bf16 v[56:59], v[132:133], v[18:19], v[56:59]
  v_mfma_f32_16x16x16_bf16 v[60:63], v[134:135], v[18:19], v[60:63]
  s_waitcnt lgkmcnt(0)
  v_mfma_f32_16x16x16_bf16 v[64:67], v[136:137], v[18:19], v[64:67]
  v_mfma_f32_16x16x16_bf16 v[68:71], v[138:139], v[18:19], v[68:71]
  v_mov_b32 v6, v5
  s_nop 1
  v_permlane32_swap_b32 v5, v6
  v_add_f32 v5, v5, v6
  v_mov_b32 v6, v5
  s_nop 1
  v_permlane16_swap_b32 v5, v6
  v_add_f32 v5, v5, v6
  v_rcp_f32 v6, v5
  s_nop 0
  v_pk_mul_f32 v[56:57], v[56:57], v[6:7] op_sel_hi:[1,0]
  v_pk_mul_f32 v[58:59], v[58:59], v[6:7] op_sel_hi:[1,0]
  v_pk_mul_f32 v[60:61], v[60:61], v[6:7] op_sel_hi:[1,0]
  v_pk_mul_f32 v[62:63], v[62:63], v[6:7] op_sel_hi:[1,0]
  v_cvt_pk_bf16_f32 v56, v56, v57
  v_cvt_pk_bf16_f32 v57, v58, v59
  v_cvt_pk_bf16_f32 v58, v60, v61
  v_cvt_pk_bf16_f32 v59, v62, v63
  ds_write_b128 v9, v[56:59] offset:8192
  v_pk_mul_f32 v[64:65], v[64:65], v[6:7] op_sel_hi:[1,0]
  v_pk_mul_f32 v[66:67], v[66:67], v[6:7] op_sel_hi:[1,0]
  v_pk_mul_f32 v[68:69], v[68:69], v[6:7] op_sel_hi:[1,0]
  v_pk_mul_f32 v[70:71], v[70:71], v[6:7] op_sel_hi:[1,0]
  v_cvt_pk_bf16_f32 v64, v64, v65
  v_cvt_pk_bf16_f32 v65, v66, v67
  v_cvt_pk_bf16_f32 v66, v68, v69
  v_cvt_pk_bf16_f32 v67, v70, v71
  ds_write_b128 v9, v[64:67] offset:9216
  s_waitcnt vmcnt(0)
AFa_s0:
  v_mfma_f32_16x16x32_bf16 v[212:215], v[24:27], v[148:151], 0
  v_bitop3_b32 v7, v148, v149, s65 bitop3:0x7e
  v_bitop3_b32 v8, v150, v151, s65 bitop3:0x7e
  v_or_b32 v17, v7, v8
  v_mfma_f32_16x16x32_bf16 v[212:215], v[24:27], v[152:155], v[212:215]
  v_bitop3_b32 v7, v152, v153, s65 bitop3:0x7e
  v_bitop3_b32 v8, v154, v155, s65 bitop3:0x7e
  v_or3_b32 v17, v17, v7, v8
  v_mfma_f32_16x16x32_bf16 v[212:215], v[24:27], v[156:159], v[212:215]
  v_bitop3_b32 v7, v156, v157, s65 bitop3:0x7e
  v_bitop3_b32 v8, v158, v159, s65 bitop3:0x7e
  v_or3_b32 v17, v17, v7, v8
  v_mfma_f32_16x16x32_bf16 v[212:215], v[24:27], v[160:163], v[212:215]
  v_bitop3_b32 v7, v160, v161, s65 bitop3:0x7e
  v_bitop3_b32 v8, v162, v163, s65 bitop3:0x7e
  v_or3_b32 v17, v17, v7, v8
  v_mfma_f32_16x16x32_bf16 v[212:215], v[24:27], v[164:167], v[212:215]
  v_bitop3_b32 v7, v164, v165, s65 bitop3:0x7e
  v_bitop3_b32 v8, v166, v167, s65 bitop3:0x7e
  v_or3_b32 v17, v17, v7, v8
  v_mfma_f32_16x16x32_bf16 v[212:215], v[24:27], v[168:171], v[212:215]
  v_bitop3_b32 v7, v168, v169, s65 bitop3:0x7e
  v_bitop3_b32 v8, v170, v171, s65 bitop3:0x7e
  v_or3_b32 v17, v17, v7, v8
  v_mfma_f32_16x16x32_bf16 v[212:215], v[24:27], v[172:175], v[212:215]
  v_bitop3_b32 v7, v172, v173, s65 bitop3:0x7e
  v_bitop3_b32 v8, v174, v175, s65 bitop3:0x7e
  v_or3_b32 v17, v17, v7, v8
  v_mfma_f32_16x16x32_bf16 v[212:215], v[24:27], v[176:179], v[212:215]
  v_bitop3_b32 v7, v176, v177, s65 bitop3:0x7e
  v_bitop3_b32 v8, v178, v179, s65 bitop3:0x7e
  v_or3_b32 v17, v17, v7, v8
  v_and_b32 v17, 1, v17
  v_cmp_ne_u32 vcc, 0, v17
  s_cbranch_vccnz AFa_r0
  s_nop 1
  v_cvt_pk_bf16_f32 v212, v212, v213
  v_cvt_pk_bf16_f32 v213, v214, v215
  v_lshlrev_b32 v148, 16, v212
  v_and_b32 v149, 0xffff0000, v212
  v_lshlrev_b32 v150, 16, v220
  v_and_b32 v151, 0xffff0000, v220
  v_pk_add_f32 v[148:149], v[148:149], v[150:151]
  v_cvt_pk_bf16_f32 v212, v148, v149
  v_lshlrev_b32 v148, 16, v213
  v_and_b32 v149, 0xffff0000, v213
  v_lshlrev_b32 v150, 16, v221
  v_and_b32 v151, 0xffff0000, v221
  v_pk_add_f32 v[148:149], v[148:149], v[150:151]
  v_cvt_pk_bf16_f32 v213, v148, v149
  v_permlane16_swap_b32 v212, v214
  s_nop 0
  v_permlane16_swap_b32 v213, v215
  buffer_store_dwordx4 v[212:215], v10, s[4:7], s57 offen sc1
  s_cmp_eq_u32 s72, 0
  s_cbranch_scc1 AFa_e
AFa_s1:
  v_mfma_f32_16x16x32_bf16 v[216:219], v[24:27], v[180:183], 0
  v_bitop3_b32 v7, v180, v181, s65 bitop3:0x7e
  v_bitop3_b32 v8, v182, v183, s65 bitop3:0x7e
  v_or_b32 v17, v7, v8
  v_mfma_f32_16x16x32_bf16 v[216:219], v[24:27], v[184:187], v[216:219]
  v_bitop3_b32 v7, v184, v185, s65 bitop3:0x7e
  v_bitop3_b32 v8, v186, v187, s65 bitop3:0x7e
  v_or3_b32 v17, v17, v7, v8
  v_mfma_f32_16x16x32_bf16 v[216:219], v[24:27], v[188:191], v[216:219]
  v_bitop3_b32 v7, v188, v189, s65 bitop3:0x7e
  v_bitop3_b32 v8, v190, v191, s65 bitop3:0x7e
  v_or3_b32 v17, v17, v7, v8
  v_mfma_f32_16x16x32_bf16 v[216:219], v[24:27], v[192:195], v[216:219]
  v_bitop3_b32 v7, v192, v193, s65 bitop3:0x7e
  v_bitop3_b32 v8, v194, v195, s65 bitop3:0x7e
  v_or3_b32 v17, v17, v7, v8
  v_mfma_f32_16x16x32_bf16 v[216:219], v[24:27], v[196:199], v[216:219]
  v_bitop3_b32 v7, v196, v197, s65 bitop3:0x7e
  v_bitop3_b32 v8, v198, v199, s65 bitop3:0x7e
  v_or3_b32 v17, v17, v7, v8
  v_mfma_f32_16x16x32_bf16 v[216:219], v[24:27], v[200:203], v[216:219]
  v_bitop3_b32 v7, v200, v201, s65 bitop3:0x7e
  v_bitop3_b32 v8, v202, v203, s65 bitop3:0x7e
  v_or3_b32 v17, v17, v7, v8
  v_mfma_f32_16x16x32_bf16 v[216:219], v[24:27], v[204:207], v[216:219]
  v_bitop3_b32 v7, v204, v205, s65 bitop3:0x7e
  v_bitop3_b32 v8, v206, v207, s65 bitop3:0x7e
  v_or3_b32 v17, v17, v7, v8
  v_mfma_f32_16x16x32_bf16 v[216:219], v[24:27], v[208:211], v[216:219]
  v_bitop3_b32 v7, v208, v209, s65 bitop3:0x7e
  v_bitop3_b32 v8, v210, v211, s65 bitop3:0x7e
  v_or3_b32 v17, v17, v7, v8
  v_and_b32 v17, 1, v17
  v_cmp_ne_u32 vcc, 0, v17
  s_cbranch_vccnz AFa_r1
  s_nop 1
  v_cvt_pk_bf16_f32 v216, v216, v217
  v_cvt_pk_bf16_f32 v217, v218, v219
  v_lshlrev_b32 v180, 16, v216
  v_and_b32 v181, 0xffff0000, v216
  v_lshlrev_b32 v182, 16, v222
  v_and_b32 v183, 0xffff0000, v222
  v_pk_add_f32 v[180:181], v[180:181], v[182:183]
  v_cvt_pk_bf16_f32 v216, v180, v181
  v_lshlrev_b32 v180, 16, v217
  v_and_b32 v181, 0xffff0000, v217
  v_lshlrev_b32 v182, 16, v223
  v_and_b32 v183, 0xffff0000, v223
  v_pk_add_f32 v[180:181], v[180:181], v[182:183]
  v_cvt_pk_bf16_f32 v217, v180, v181
  v_permlane16_swap_b32 v216, v218
  s_nop 0
  v_permlane16_swap_b32 v217, v219
  s_add_u32 s46, s57, 32768
  buffer_store_dwordx4 v[216:219], v10, s[4:7], s46 offen sc1
AFa_e:
  s_add_u32 s56, s56, s31
  s_add_u32 s73, s73, s31
  s_add_u32 s57, s57, s31
  s_xor_b32 s62, s62, 2097152
  s_branch AF_jn
AFb_r0:
  s_cmp_lg_u64 s[16:17], 0
  s_cbranch_scc0 AFb_r0_0
  s_add_u32 s46, s62, 0
  buffer_load_dwordx4 v[148:151], v12, s[4:7], s46 offen sc1
AFb_r0_0:
  s_cmp_lg_u64 s[18:19], 0
  s_cbranch_scc0 AFb_r0_1
  s_add_u32 s46, s62, 148480
  buffer_load_dwordx4 v[152:155], v12, s[4:7], s46 offen sc1
AFb_r0_1:
  s_cmp_lg_u64 s[20:21], 0
  s_cbranch_scc0 AFb_r0_2
  s_add_u32 s46, s62, 296960
  buffer_load_dwordx4 v[156:159], v12, s[4:7], s46 offen sc1
AFb_r0_2:
  s_cmp_lg_u64 s[22:23], 0
  s_cbranch_scc0 AFb_r0_3
  s_add_u32 s46, s62, 445440
  buffer_load_dwordx4 v[160:163], v12, s[4:7], s46 offen sc1
AFb_r0_3:
  s_cmp_lg_u64 s[24:25], 0
  s_cbranch_scc0 AFb_r0_4
  s_add_u32 s46, s62, 593920
  buffer_load_dwordx4 v[164:167], v12, s[4:7], s46 offen sc1
AFb_r0_4:
  s_cmp_lg_u64 s[26:27], 0
  s_cbranch_scc0 AFb_r0_5
  s_add_u32 s46, s62, 742400
  buffer_load_dwordx4 v[168:171], v12, s[4:7], s46 offen sc1
AFb_r0_5:
  s_cmp_lg_u64 s[32:33], 0
  s_cbranch_scc0 AFb_r0_6
  s_add_u32 s46, s62, 890880
  buffer_load_dwordx4 v[172:175], v12, s[4:7], s46 offen sc1
AFb_r0_6:
  s_cmp_lg_u64 s[34:35], 0
  s_cbranch_scc0 AFb_r0_7
  s_add_u32 s46, s62, 1039360
  buffer_load_dwordx4 v[176:179], v12, s[4:7], s46 offen sc1
AFb_r0_7:
  s_sub_u32 s50, s50, 1
  s_cbranch_scc1 K_end
  s_waitcnt vmcnt(0)
  s_branch AFb_s0
AFb_r1:
  s_cmp_lg_u64 s[16:17], 0
  s_cbranch_scc0 AFb_r1_0
  s_add_u32 s46, s62, 32768
  buffer_load_dwordx4 v[180:183], v12, s[4:7], s46 offen sc1
AFb_r1_0:
  s_cmp_lg_u64 s[18:19], 0
  s_cbranch_scc0 AFb_r1_1
  s_add_u32 s46, s62, 181248
  buffer_load_dwordx4 v[184:187], v12, s[4:7], s46 offen sc1
AFb_r1_1:
  s_cmp_lg_u64 s[20:21], 0
  s_cbranch_scc0 AFb_r1_2
  s_add_u32 s46, s62, 329728
  buffer_load_dwordx4 v[188:191], v12, s[4:7], s46 offen sc1
AFb_r1_2:
  s_cmp_lg_u64 s[22:23], 0
  s_cbranch_scc0 AFb_r1_3
  s_add_u32 s46, s62, 478208
  buffer_load_dwordx4 v[192:195], v12, s[4:7], s46 offen sc1
AFb_r1_3:
  s_cmp_lg_u64 s[24:25], 0
  s_cbranch_scc0 AFb_r1_4
  s_add_u32 s46, s62, 626688
  buffer_load_dwordx4 v[196:199], v12, s[4:7], s46 offen sc1
AFb_r1_4:
  s_cmp_lg_u64 s[26:27], 0
  s_cbranch_scc0 AFb_r1_5
  s_add_u32 s46, s62, 775168
  buffer_load_dwordx4 v[200:203], v12, s[4:7], s46 offen sc1
AFb_r1_5:
  s_cmp_lg_u64 s[32:33], 0
  s_cbranch_scc0 AFb_r1_6
  s_add_u32 s46, s62, 923648
  buffer_load_dwordx4 v[204:207], v12, s[4:7], s46 offen sc1
AFb_r1_6:
  s_cmp_lg_u64 s[34:35], 0
  s_cbranch_scc0 AFb_r1_7
  s_add_u32 s46, s62, 1072128
  buffer_load_dwordx4 v[208:211], v12, s[4:7], s46 offen sc1
AFb_r1_7:
  s_sub_u32 s50, s50, 1
  s_cbranch_scc1 K_end
  s_waitcnt vmcnt(0)
  s_branch AFb_s1
AFa_r0:
  s_add_u32 s46, s62, 0
  buffer_load_dwordx4 v[148:151], v12, s[4:7], s46 offen sc1
  s_add_u32 s46, s62, 148480
  buffer_load_dwordx4 v[152:155], v12, s[4:7], s46 offen sc1
  s_add_u32 s46, s62, 296960
  buffer_load_dwordx4 v[156:159], v12, s[4:7], s46 offen sc1
  s_add_u32 s46, s62, 445440
  buffer_load_dwordx4 v[160:163], v12, s[4:7], s46 offen sc1
  s_add_u32 s46, s62, 593920
  buffer_load_dwordx4 v[164:167], v12, s[4:7], s46 offen sc1
  s_add_u32 s46, s62, 742400
  buffer_load_dwordx4 v[168:171], v12, s[4:7], s46 offen sc1
  s_add_u32 s46, s62, 890880
  buffer_load_dwordx4 v[172:175], v12, s[4:7], s46 offen sc1
  s_add_u32 s46, s62, 1039360
  buffer_load_dwordx4 v[176:179], v12, s[4:7], s46 offen sc1
  s_sub_u32 s50, s50, 1
  s_cbranch_scc1 K_end
  s_waitcnt vmcnt(0)
  s_branch AFa_s0
AFa_r1:
  s_add_u32 s46, s62, 32768
  buffer_load_dwordx4 v[180:183], v12, s[4:7], s46 offen sc1
  s_add_u32 s46, s62, 181248
  buffer_load_dwordx4 v[184:187], v12, s[4:7], s46 offen sc1
  s_add_u32 s46, s62, 329728
  buffer_load_dwordx4 v[188:191], v12, s[4:7], s46 offen sc1
  s_add_u32 s46, s62, 478208
  buffer_load_dwordx4 v[192:195], v12, s[4:7], s46 offen sc1
  s_add_u32 s46, s62, 626688
  buffer_load_dwordx4 v[196:199], v12, s[4:7], s46 offen sc1
  s_add_u32 s46, s62, 775168
  buffer_load_dwordx4 v[200:203], v12, s[4:7], s46 offen sc1
  s_add_u32 s46, s62, 923648
  buffer_load_dwordx4 v[204:207], v12, s[4:7], s46 offen sc1
  s_add_u32 s46, s62, 1072128
  buffer_load_dwordx4 v[208:211], v12, s[4:7], s46 offen sc1
  s_sub_u32 s50, s50, 1
  s_cbranch_scc1 K_end
  s_waitcnt vmcnt(0)
  s_branch AFa_s1
AF_zl:
  buffer_load_dword v4, off, s[4:7], 0 offset:2432 sc1
  s_sub_u32 s50, s50, 1
  s_cbranch_scc1 K_end
  s_waitcnt vmcnt(0)
  v_readfirstlane_b32 s28, v4
AF_zg:
  s_cmp_eq_u32 s28, 0
  s_cbranch_scc1 AF_zl
  s_sub_u32 s29, s28, 2
  s_add_u32 s38, s28, 1
  s_branch AF_le
AF_fl:
  buffer_load_dword v22, off, s[4:7], s70 sc1
  s_sub_u32 s50, s50, 1
  s_cbranch_scc1 K_end
  s_waitcnt vmcnt(0)
  v_readfirstlane_b32 s68, v22
  s_branch AF_dm
F_start:
  s_mov_b32 s8, s16
  s_mov_b32 s9, s17
  s_mov_b32 s10, 2359296
  s_mov_b32 s11, 0x20000
  s_mul_i32 s46, s45, 3
  s_add_u32 s46, s46, s3
  s_sub_u32 s46, s46, 5
  s_mul_i32 s46, s46, 3
  s_add_u32 s51, s46, s44
  s_cmp_lt_u32 s44, 3
  s_cselect_b32 s51, s51, 256
  v_and_b32 v5, 7, v2
  v_lshrrev_b32 v6, 3, v2
  v_mul_u32_u24 v7, 1152, v5
  v_lshl_add_u32 v7, v6, 4, v7
  s_mul_i32 s46, s51, 9216
  buffer_load_dwordx4 v[32:35], v7, s[8:11], s46 offen offset:0
  buffer_load_dwordx4 v[36:39], v7, s[8:11], s46 offen offset:128
  buffer_load_dwordx4 v[40:43], v7, s[8:11], s46 offen offset:256
  buffer_load_dwordx4 v[44:47], v7, s[8:11], s46 offen offset:384
  buffer_load_dwordx4 v[48:51], v7, s[8:11], s46 offen offset:512
  buffer_load_dwordx4 v[52:55], v7, s[8:11], s46 offen offset:640
  buffer_load_dwordx4 v[56:59], v7, s[8:11], s46 offen offset:768
  buffer_load_dwordx4 v[60:63], v7, s[8:11], s46 offen offset:896
  buffer_load_dwordx4 v[64:67], v7, s[8:11], s46 offen offset:1024
  s_sub_u32 s47, s3, 4
  s_max_i32 s47, s47, 0
  s_lshl_b32 s48, s45, 2
  s_add_u32 s47, s47, s48
  s_lshl_b32 s47, s47, 12
  s_lshl_b32 s46, s3, 22
  s_lshl_b32 s47, s75, 27
  s_add_u32 s74, s46, s47
  s_add_u32 s74, s74, 4194304
  s_mul_i32 s46, s45, 18688
  s_add_u32 s46, s46, s74
  s_cmp_eq_u32 s75, 0
  s_cbranch_scc0 rf_189_f
  s_add_u32 s47, s46, 0
  buffer_store_dwordx4 v[12:15], v8, s[4:7], s47 offen
  s_add_u32 s47, s46, 4096
  buffer_store_dwordx4 v[12:15], v8, s[4:7], s47 offen
  s_add_u32 s47, s46, 8192
  buffer_store_dwordx4 v[12:15], v8, s[4:7], s47 offen
  s_add_u32 s47, s46, 12288
  buffer_store_dwordx4 v[12:15], v8, s[4:7], s47 offen
  s_add_u32 s47, s46, 16384
  buffer_store_dwordx4 v[12:15], v8, s[4:7], s47 offen
  s_add_u32 s47, s46, 2097152
  buffer_store_dwordx4 v[12:15], v8, s[4:7], s47 offen
  s_add_u32 s47, s46, 2101248
  buffer_store_dwordx4 v[12:15], v8, s[4:7], s47 offen
  s_add_u32 s47, s46, 2105344
  buffer_store_dwordx4 v[12:15], v8, s[4:7], s47 offen
  s_add_u32 s47, s46, 2109440
  buffer_store_dwordx4 v[12:15], v8, s[4:7], s47 offen
  s_add_u32 s47, s46, 2113536
  buffer_store_dwordx4 v[12:15], v8, s[4:7], s47 offen
  s_branch rf_189
rf_189_f:
  s_add_u32 s47, s46, 0
  buffer_store_dwordx4 v[12:15], v8, s[4:7], s47 offen sc1
  s_add_u32 s47, s46, 4096
  buffer_store_dwordx4 v[12:15], v8, s[4:7], s47 offen sc1
  s_add_u32 s47, s46, 8192
  buffer_store_dwordx4 v[12:15], v8, s[4:7], s47 offen sc1
  s_add_u32 s47, s46, 12288
  buffer_store_dwordx4 v[12:15], v8, s[4:7], s47 offen sc1
  s_add_u32 s47, s46, 16384
  buffer_store_dwordx4 v[12:15], v8, s[4:7], s47 offen sc1
  s_add_u32 s47, s46, 2097152
  buffer_store_dwordx4 v[12:15], v8, s[4:7], s47 offen sc1
  s_add_u32 s47, s46, 2101248
  buffer_store_dwordx4 v[12:15], v8, s[4:7], s47 offen sc1
  s_add_u32 s47, s46, 2105344
  buffer_store_dwordx4 v[12:15], v8, s[4:7], s47 offen sc1
  s_add_u32 s47, s46, 2109440
  buffer_store_dwordx4 v[12:15], v8, s[4:7], s47 offen sc1
  s_add_u32 s47, s46, 2113536
  buffer_store_dwordx4 v[12:15], v8, s[4:7], s47 offen sc1
rf_189:
  s_cmp_lt_u32 s51, 256
  s_cbranch_scc0 W_noln_b
  s_waitcnt vmcnt(10)
  v_lshlrev_b32 v72, 16, v32
  v_and_b32 v73, 0xffff0000, v32
  v_lshlrev_b32 v74, 16, v33
  v_and_b32 v75, 0xffff0000, v33
  v_lshlrev_b32 v76, 16, v34
  v_and_b32 v77, 0xffff0000, v34
  v_lshlrev_b32 v78, 16, v35
  v_and_b32 v79, 0xffff0000, v35
  v_lshlrev_b32 v80, 16, v36
  v_and_b32 v81, 0xffff0000, v36
  v_lshlrev_b32 v82, 16, v37
  v_and_b32 v83, 0xffff0000, v37
  v_lshlrev_b32 v84, 16, v38
  v_and_b32 v85, 0xffff0000, v38
  v_lshlrev_b32 v86, 16, v39
  v_and_b32 v87, 0xffff0000, v39
  v_lshlrev_b32 v88, 16, v40
  v_and_b32 v89, 0xffff0000, v40
  v_lshlrev_b32 v90, 16, v41
  v_and_b32 v91, 0xffff0000, v41
  v_lshlrev_b32 v92, 16, v42
  v_and_b32 v93, 0xffff0000, v42
  v_lshlrev_b32 v94, 16, v43
  v_and_b32 v95, 0xffff0000, v43
  v_lshlrev_b32 v96, 16, v44
  v_and_b32 v97, 0xffff0000, v44
  v_lshlrev_b32 v98, 16, v45
  v_and_b32 v99, 0xffff0000, v45
  v_lshlrev_b32 v100, 16, v46
  v_and_b32 v101, 0xffff0000, v46
  v_lshlrev_b32 v102, 16, v47
  v_and_b32 v103, 0xffff0000, v47
  v_lshlrev_b32 v104, 16, v48
  v_and_b32 v105, 0xffff0000, v48
  v_lshlrev_b32 v106, 16, v49
  v_and_b32 v107, 0xffff0000, v49
  v_lshlrev_b32 v108, 16, v50
  v_and_b32 v109, 0xffff0000, v50
  v_lshlrev_b32 v110, 16, v51
  v_and_b32 v111, 0xffff0000, v51
  v_lshlrev_b32 v112, 16, v52
  v_and_b32 v113, 0xffff0000, v52
  v_lshlrev_b32 v114, 16, v53
  v_and_b32 v115, 0xffff0000, v53
  v_lshlrev_b32 v116, 16, v54
  v_and_b32 v117, 0xffff0000, v54
  v_lshlrev_b32 v118, 16, v55
  v_and_b32 v119, 0xffff0000, v55
  v_lshlrev_b32 v120, 16, v56
  v_and_b32 v121, 0xffff0000, v56
  v_lshlrev_b32 v122, 16, v57
  v_and_b32 v123, 0xffff0000, v57
  v_lshlrev_b32 v124, 16, v58
  v_and_b32 v125, 0xffff0000, v58
  v_lshlrev_b32 v126, 16, v59
  v_and_b32 v127, 0xffff0000, v59
  v_lshlrev_b32 v128, 16, v60
  v_and_b32 v129, 0xffff0000, v60
  v_lshlrev_b32 v130, 16, v61
  v_and_b32 v131, 0xffff0000, v61
  v_lshlrev_b32 v132, 16, v62
  v_and_b32 v133, 0xffff0000, v62
  v_lshlrev_b32 v134, 16, v63
  v_and_b32 v135, 0xffff0000, v63
  v_lshlrev_b32 v136, 16, v64
  v_and_b32 v137, 0xffff0000, v64
  v_lshlrev_b32 v138, 16, v65
  v_and_b32 v139, 0xffff0000, v65
  v_lshlrev_b32 v140, 16, v66
  v_and_b32 v141, 0xffff0000, v66
  v_lshlrev_b32 v142, 16, v67
  v_and_b32 v143, 0xffff0000, v67
  v_pk_add_f32 v[20:21], v[72:73], v[74:75]
  v_pk_add_f32 v[20:21], v[20:21], v[76:77]
  v_pk_add_f32 v[20:21], v[20:21], v[78:79]
  v_pk_add_f32 v[20:21], v[20:21], v[80:81]
  v_pk_add_f32 v[20:21], v[20:21], v[82:83]
  v_pk_add_f32 v[20:21], v[20:21], v[84:85]
  v_pk_add_f32 v[20:21], v[20:21], v[86:87]
  v_pk_add_f32 v[20:21], v[20:21], v[88:89]
  v_pk_add_f32 v[20:21], v[20:21], v[90:91]
  v_pk_add_f32 v[20:21], v[20:21], v[92:93]
  v_pk_add_f32 v[20:21], v[20:21], v[94:95]
  v_pk_add_f32 v[20:21], v[20:21], v[96:97]
  v_pk_add_f32 v[20:21], v[20:21], v[98:99]
  v_pk_add_f32 v[20:21], v[20:21], v[100:101]
  v_pk_add_f32 v[20:21], v[20:21], v[102:103]
  v_pk_add_f32 v[20:21], v[20:21], v[104:105]
  v_pk_add_f32 v[20:21], v[20:21], v[106:107]
  v_pk_add_f32 v[20:21], v[20:21], v[108:109]
  v_pk_add_f32 v[20:21], v[20:21], v[110:111]
  v_pk_add_f32 v[20:21], v[20:21], v[112:113]
  v_pk_add_f32 v[20:21], v[20:21], v[114:115]
  v_pk_add_f32 v[20:21], v[20:21], v[116:117]
  v_pk_add_f32 v[20:21], v[20:21], v[118:119]
  v_pk_add_f32 v[20:21], v[20:21], v[120:121]
  v_pk_add_f32 v[20:21], v[20:21], v[122:123]
  v_pk_add_f32 v[20:21], v[20:21], v[124:125]
  v_pk_add_f32 v[20:21], v[20:21], v[126:127]
  v_pk_add_f32 v[20:21], v[20:21], v[128:129]
  v_pk_add_f32 v[20:21], v[20:21], v[130:131]
  v_pk_add_f32 v[20:21], v[20:21], v[132:133]
  v_pk_add_f32 v[20:21], v[20:21], v[134:135]
  v_pk_add_f32 v[20:21], v[20:21], v[136:137]
  v_pk_add_f32 v[20:21], v[20:21], v[138:139]
  v_pk_add_f32 v[20:21], v[20:21], v[140:141]
  v_pk_add_f32 v[20:21], v[20:21], v[142:143]
  v_add_f32 v16, v20, v21
  s_nop 1
  v_add_f32_dpp v16, v16, v16 row_ror:8 row_mask:0xf bank_mask:0xf
  v_mov_b32 v17, v16
  s_nop 1
  v_permlane16_swap_b32 v16, v17
  v_add_f32 v16, v16, v17
  v_mov_b32 v17, v16
  s_nop 1
  v_permlane32_swap_b32 v16, v17
  v_add_f32 v16, v16, v17
  v_mul_f32 v16, 0xbae38e39, v16
  v_mov_b32 v18, 0
  v_mov_b32 v19, 0
  v_pk_add_f32 v[20:21], v[72:73], v[16:17] op_sel_hi:[1,0]
  s_nop 0
  v_pk_fma_f32 v[18:19], v[20:21], v[20:21], v[18:19]
  v_pk_add_f32 v[20:21], v[74:75], v[16:17] op_sel_hi:[1,0]
  s_nop 0
  v_pk_fma_f32 v[18:19], v[20:21], v[20:21], v[18:19]
  v_pk_add_f32 v[20:21], v[76:77], v[16:17] op_sel_hi:[1,0]
  s_nop 0
  v_pk_fma_f32 v[18:19], v[20:21], v[20:21], v[18:19]
  v_pk_add_f32 v[20:21], v[78:79], v[16:17] op_sel_hi:[1,0]
  s_nop 0
  v_pk_fma_f32 v[18:19], v[20:21], v[20:21], v[18:19]
  v_pk_add_f32 v[20:21], v[80:81], v[16:17] op_sel_hi:[1,0]
  s_nop 0
  v_pk_fma_f32 v[18:19], v[20:21], v[20:21], v[18:19]
  v_pk_add_f32 v[20:21], v[82:83], v[16:17] op_sel_hi:[1,0]
  s_nop 0
  v_pk_fma_f32 v[18:19], v[20:21], v[20:21], v[18:19]
  v_pk_add_f32 v[20:21], v[84:85], v[16:17] op_sel_hi:[1,0]
  s_nop 0
  v_pk_fma_f32 v[18:19], v[20:21], v[20:21], v[18:19]
  v_pk_add_f32 v[20:21], v[86:87], v[16:17] op_sel_hi:[1,0]
  s_nop 0
  v_pk_fma_f32 v[18:19], v[20:21], v[20:21], v[18:19]
  v_pk_add_f32 v[20:21], v[88:89], v[16:17] op_sel_hi:[1,0]
  s_nop 0
  v_pk_fma_f32 v[18:19], v[20:21], v[20:21], v[18:19]
  v_pk_add_f32 v[20:21], v[90:91], v[16:17] op_sel_hi:[1,0]
  s_nop 0
  v_pk_fma_f32 v[18:19], v[20:21], v[20:21], v[18:19]
  v_pk_add_f32 v[20:21], v[92:93], v[16:17] op_sel_hi:[1,0]
  s_nop 0
  v_pk_fma_f32 v[18:19], v[20:21], v[20:21], v[18:19]
  v_pk_add_f32 v[20:21], v[94:95], v[16:17] op_sel_hi:[1,0]
  s_nop 0
  v_pk_fma_f32 v[18:19], v[20:21], v[20:21], v[18:19]
  v_pk_add_f32 v[20:21], v[96:97], v[16:17] op_sel_hi:[1,0]
  s_nop 0
  v_pk_fma_f32 v[18:19], v[20:21], v[20:21], v[18:19]
  v_pk_add_f32 v[20:21], v[98:99], v[16:17] op_sel_hi:[1,0]
  s_nop 0
  v_pk_fma_f32 v[18:19], v[20:21], v[20:21], v[18:19]
  v_pk_add_f32 v[20:21], v[100:101], v[16:17] op_sel_hi:[1,0]
  s_nop 0
  v_pk_fma_f32 v[18:19], v[20:21], v[20:21], v[18:19]
  v_pk_add_f32 v[20:21], v[102:103], v[16:17] op_sel_hi:[1,0]
  s_nop 0
  v_pk_fma_f32 v[18:19], v[20:21], v[20:21], v[18:19]
  v_pk_add_f32 v[20:21], v[104:105], v[16:17] op_sel_hi:[1,0]
  s_nop 0
  v_pk_fma_f32 v[18:19], v[20:21], v[20:21], v[18:19]
  v_pk_add_f32 v[20:21], v[106:107], v[16:17] op_sel_hi:[1,0]
  s_nop 0
  v_pk_fma_f32 v[18:19], v[20:21], v[20:21], v[18:19]
  v_pk_add_f32 v[20:21], v[108:109], v[16:17] op_sel_hi:[1,0]
  s_nop 0
  v_pk_fma_f32 v[18:19], v[20:21], v[20:21], v[18:19]
  v_pk_add_f32 v[20:21], v[110:111], v[16:17] op_sel_hi:[1,0]
  s_nop 0
  v_pk_fma_f32 v[18:19], v[20:21], v[20:21], v[18:19]
  v_pk_add_f32 v[20:21], v[112:113], v[16:17] op_sel_hi:[1,0]
  s_nop 0
  v_pk_fma_f32 v[18:19], v[20:21], v[20:21], v[18:19]
  v_pk_add_f32 v[20:21], v[114:115], v[16:17] op_sel_hi:[1,0]
  s_nop 0
  v_pk_fma_f32 v[18:19], v[20:21], v[20:21], v[18:19]
  v_pk_add_f32 v[20:21], v[116:117], v[16:17] op_sel_hi:[1,0]
  s_nop 0
  v_pk_fma_f32 v[18:19], v[20:21], v[20:21], v[18:19]
  v_pk_add_f32 v[20:21], v[118:119], v[16:17] op_sel_hi:[1,0]
  s_nop 0
  v_pk_fma_f32 v[18:19], v[20:21], v[20:21], v[18:19]
  v_pk_add_f32 v[20:21], v[120:121], v[16:17] op_sel_hi:[1,0]
  s_nop 0
  v_pk_fma_f32 v[18:19], v[20:21], v[20:21], v[18:19]
  v_pk_add_f32 v[20:21], v[122:123], v[16:17] op_sel_hi:[1,0]
  s_nop 0
  v_pk_fma_f32 v[18:19], v[20:21], v[20:21], v[18:19]
  v_pk_add_f32 v[20:21], v[124:125], v[16:17] op_sel_hi:[1,0]
  s_nop 0
  v_pk_fma_f32 v[18:19], v[20:21], v[20:21], v[18:19]
  v_pk_add_f32 v[20:21], v[126:127], v[16:17] op_sel_hi:[1,0]
  s_nop 0
  v_pk_fma_f32 v[18:19], v[20:21], v[20:21], v[18:19]
  v_pk_add_f32 v[20:21], v[128:129], v[16:17] op_sel_hi:[1,0]
  s_nop 0
  v_pk_fma_f32 v[18:19], v[20:21], v[20:21], v[18:19]
  v_pk_add_f32 v[20:21], v[130:131], v[16:17] op_sel_hi:[1,0]
  s_nop 0
  v_pk_fma_f32 v[18:19], v[20:21], v[20:21], v[18:19]
  v_pk_add_f32 v[20:21], v[132:133], v[16:17] op_sel_hi:[1,0]
  s_nop 0
  v_pk_fma_f32 v[18:19], v[20:21], v[20:21], v[18:19]
  v_pk_add_f32 v[20:21], v[134:135], v[16:17] op_sel_hi:[1,0]
  s_nop 0
  v_pk_fma_f32 v[18:19], v[20:21], v[20:21], v[18:19]
  v_pk_add_f32 v[20:21], v[136:137], v[16:17] op_sel_hi:[1,0]
  s_nop 0
  v_pk_fma_f32 v[18:19], v[20:21], v[20:21], v[18:19]
  v_pk_add_f32 v[20:21], v[138:139], v[16:17] op_sel_hi:[1,0]
  s_nop 0
  v_pk_fma_f32 v[18:19], v[20:21], v[20:21], v[18:19]
  v_pk_add_f32 v[20:21], v[140:141], v[16:17] op_sel_hi:[1,0]
  s_nop 0
  v_pk_fma_f32 v[18:19], v[20:21], v[20:21], v[18:19]
  v_pk_add_f32 v[20:21], v[142:143], v[16:17] op_sel_hi:[1,0]
  s_nop 0
  v_pk_fma_f32 v[18:19], v[20:21], v[20:21], v[18:19]
  v_add_f32 v18, v18, v19
  s_nop 1
  v_add_f32_dpp v18, v18, v18 row_ror:8 row_mask:0xf bank_mask:0xf
  v_mov_b32 v17, v18
  s_nop 1
  v_permlane16_swap_b32 v18, v17
  v_add_f32 v18, v18, v17
  v_mov_b32 v17, v18
  s_nop 1
  v_permlane32_swap_b32 v18, v17
  v_add_f32 v18, v18, v17
  v_mul_f32 v18, 0x3ae38e39, v18
  v_cvt_pk_bf16_f32 v18, v18, v18
  v_lshlrev_b32 v18, 16, v18
  v_add_f32 v18, 0x3727c5ac, v18
  v_cvt_pk_bf16_f32 v18, v18, v18
  v_lshlrev_b32 v18, 16, v18
  v_sqrt_f32 v18, v18
  s_nop 0
  v_cvt_pk_bf16_f32 v18, v18, v18
  v_lshlrev_b32 v18, 16, v18
  v_rcp_f32 v18, v18
  v_cvt_pk_bf16_f32 v16, v16, v16
  v_lshlrev_b32 v16, 16, v16
  v_pk_add_f32 v[20:21], v[72:73], v[16:17] op_sel_hi:[1,0]
  s_nop 0
  v_cvt_pk_bf16_f32 v32, v20, v21
  v_pk_add_f32 v[20:21], v[74:75], v[16:17] op_sel_hi:[1,0]
  s_nop 0
  v_cvt_pk_bf16_f32 v33, v20, v21
  v_pk_add_f32 v[20:21], v[76:77], v[16:17] op_sel_hi:[1,0]
  s_nop 0
  v_cvt_pk_bf16_f32 v34, v20, v21
  v_pk_add_f32 v[20:21], v[78:79], v[16:17] op_sel_hi:[1,0]
  s_nop 0
  v_cvt_pk_bf16_f32 v35, v20, v21
  v_pk_add_f32 v[20:21], v[80:81], v[16:17] op_sel_hi:[1,0]
  s_nop 0
  v_cvt_pk_bf16_f32 v36, v20, v21
  v_pk_add_f32 v[20:21], v[82:83], v[16:17] op_sel_hi:[1,0]
  s_nop 0
  v_cvt_pk_bf16_f32 v37, v20, v21
  v_pk_add_f32 v[20:21], v[84:85], v[16:17] op_sel_hi:[1,0]
  s_nop 0
  v_cvt_pk_bf16_f32 v38, v20, v21
  v_pk_add_f32 v[20:21], v[86:87], v[16:17] op_sel_hi:[1,0]
  s_nop 0
  v_cvt_pk_bf16_f32 v39, v20, v21
  v_pk_add_f32 v[20:21], v[88:89], v[16:17] op_sel_hi:[1,0]
  s_nop 0
  v_cvt_pk_bf16_f32 v40, v20, v21
  v_pk_add_f32 v[20:21], v[90:91], v[16:17] op_sel_hi:[1,0]
  s_nop 0
  v_cvt_pk_bf16_f32 v41, v20, v21
  v_pk_add_f32 v[20:21], v[92:93], v[16:17] op_sel_hi:[1,0]
  s_nop 0
  v_cvt_pk_bf16_f32 v42, v20, v21
  v_pk_add_f32 v[20:21], v[94:95], v[16:17] op_sel_hi:[1,0]
  s_nop 0
  v_cvt_pk_bf16_f32 v43, v20, v21
  v_pk_add_f32 v[20:21], v[96:97], v[16:17] op_sel_hi:[1,0]
  s_nop 0
  v_cvt_pk_bf16_f32 v44, v20, v21
  v_pk_add_f32 v[20:21], v[98:99], v[16:17] op_sel_hi:[1,0]
  s_nop 0
  v_cvt_pk_bf16_f32 v45, v20, v21
  v_pk_add_f32 v[20:21], v[100:101], v[16:17] op_sel_hi:[1,0]
  s_nop 0
  v_cvt_pk_bf16_f32 v46, v20, v21
  v_pk_add_f32 v[20:21], v[102:103], v[16:17] op_sel_hi:[1,0]
  s_nop 0
  v_cvt_pk_bf16_f32 v47, v20, v21
  v_pk_add_f32 v[20:21], v[104:105], v[16:17] op_sel_hi:[1,0]
  s_nop 0
  v_cvt_pk_bf16_f32 v48, v20, v21
  v_pk_add_f32 v[20:21], v[106:107], v[16:17] op_sel_hi:[1,0]
  s_nop 0
  v_cvt_pk_bf16_f32 v49, v20, v21
  v_pk_add_f32 v[20:21], v[108:109], v[16:17] op_sel_hi:[1,0]
  s_nop 0
  v_cvt_pk_bf16_f32 v50, v20, v21
  v_pk_add_f32 v[20:21], v[110:111], v[16:17] op_sel_hi:[1,0]
  s_nop 0
  v_cvt_pk_bf16_f32 v51, v20, v21
  v_pk_add_f32 v[20:21], v[112:113], v[16:17] op_sel_hi:[1,0]
  s_nop 0
  v_cvt_pk_bf16_f32 v52, v20, v21
  v_pk_add_f32 v[20:21], v[114:115], v[16:17] op_sel_hi:[1,0]
  s_nop 0
  v_cvt_pk_bf16_f32 v53, v20, v21
  v_pk_add_f32 v[20:21], v[116:117], v[16:17] op_sel_hi:[1,0]
  s_nop 0
  v_cvt_pk_bf16_f32 v54, v20, v21
  v_pk_add_f32 v[20:21], v[118:119], v[16:17] op_sel_hi:[1,0]
  s_nop 0
  v_cvt_pk_bf16_f32 v55, v20, v21
  v_pk_add_f32 v[20:21], v[120:121], v[16:17] op_sel_hi:[1,0]
  s_nop 0
  v_cvt_pk_bf16_f32 v56, v20, v21
  v_pk_add_f32 v[20:21], v[122:123], v[16:17] op_sel_hi:[1,0]
  s_nop 0
  v_cvt_pk_bf16_f32 v57, v20, v21
  v_pk_add_f32 v[20:21], v[124:125], v[16:17] op_sel_hi:[1,0]
  s_nop 0
  v_cvt_pk_bf16_f32 v58, v20, v21
  v_pk_add_f32 v[20:21], v[126:127], v[16:17] op_sel_hi:[1,0]
  s_nop 0
  v_cvt_pk_bf16_f32 v59, v20, v21
  v_pk_add_f32 v[20:21], v[128:129], v[16:17] op_sel_hi:[1,0]
  s_nop 0
  v_cvt_pk_bf16_f32 v60, v20, v21
  v_pk_add_f32 v[20:21], v[130:131], v[16:17] op_sel_hi:[1,0]
  s_nop 0
  v_cvt_pk_bf16_f32 v61, v20, v21
  v_pk_add_f32 v[20:21], v[132:133], v[16:17] op_sel_hi:[1,0]
  s_nop 0
  v_cvt_pk_bf16_f32 v62, v20, v21
  v_pk_add_f32 v[20:21], v[134:135], v[16:17] op_sel_hi:[1,0]
  s_nop 0
  v_cvt_pk_bf16_f32 v63, v20, v21
  v_pk_add_f32 v[20:21], v[136:137], v[16:17] op_sel_hi:[1,0]
  s_nop 0
  v_cvt_pk_bf16_f32 v64, v20, v21
  v_pk_add_f32 v[20:21], v[138:139], v[16:17] op_sel_hi:[1,0]
  s_nop 0
  v_cvt_pk_bf16_f32 v65, v20, v21
  v_pk_add_f32 v[20:21], v[140:141], v[16:17] op_sel_hi:[1,0]
  s_nop 0
  v_cvt_pk_bf16_f32 v66, v20, v21
  v_pk_add_f32 v[20:21], v[142:143], v[16:17] op_sel_hi:[1,0]
  s_nop 0
  v_cvt_pk_bf16_f32 v67, v20, v21
  v_lshlrev_b32 v72, 16, v32
  v_and_b32 v73, 0xffff0000, v32
  v_lshlrev_b32 v74, 16, v33
  v_and_b32 v75, 0xffff0000, v33
  v_lshlrev_b32 v76, 16, v34
  v_and_b32 v77, 0xffff0000, v34
  v_lshlrev_b32 v78, 16, v35
  v_and_b32 v79, 0xffff0000, v35
  v_lshlrev_b32 v80, 16, v36
  v_and_b32 v81, 0xffff0000, v36
  v_lshlrev_b32 v82, 16, v37
  v_and_b32 v83, 0xffff0000, v37
  v_lshlrev_b32 v84, 16, v38
  v_and_b32 v85, 0xffff0000, v38
  v_lshlrev_b32 v86, 16, v39
  v_and_b32 v87, 0xffff0000, v39
  v_lshlrev_b32 v88, 16, v40
  v_and_b32 v89, 0xffff0000, v40
  v_lshlrev_b32 v90, 16, v41
  v_and_b32 v91, 0xffff0000, v41
  v_lshlrev_b32 v92, 16, v42
  v_and_b32 v93, 0xffff0000, v42
  v_lshlrev_b32 v94, 16, v43
  v_and_b32 v95, 0xffff0000, v43
  v_lshlrev_b32 v96, 16, v44
  v_and_b32 v97, 0xffff0000, v44
  v_lshlrev_b32 v98, 16, v45
  v_and_b32 v99, 0xffff0000, v45
  v_lshlrev_b32 v100, 16, v46
  v_and_b32 v101, 0xffff0000, v46
  v_lshlrev_b32 v102, 16, v47
  v_and_b32 v103, 0xffff0000, v47
  v_lshlrev_b32 v104, 16, v48
  v_and_b32 v105, 0xffff0000, v48
  v_lshlrev_b32 v106, 16, v49
  v_and_b32 v107, 0xffff0000, v49
  v_lshlrev_b32 v108, 16, v50
  v_and_b32 v109, 0xffff0000, v50
  v_lshlrev_b32 v110, 16, v51
  v_and_b32 v111, 0xffff0000, v51
  v_lshlrev_b32 v112, 16, v52
  v_and_b32 v113, 0xffff0000, v52
  v_lshlrev_b32 v114, 16, v53
  v_and_b32 v115, 0xffff0000, v53
  v_lshlrev_b32 v116, 16, v54
  v_and_b32 v117, 0xffff0000, v54
  v_lshlrev_b32 v118, 16, v55
  v_and_b32 v119, 0xffff0000, v55
  v_lshlrev_b32 v120, 16, v56
  v_and_b32 v121, 0xffff0000, v56
  v_lshlrev_b32 v122, 16, v57
  v_and_b32 v123, 0xffff0000, v57
  v_lshlrev_b32 v124, 16, v58
  v_and_b32 v125, 0xffff0000, v58
  v_lshlrev_b32 v126, 16, v59
  v_and_b32 v127, 0xffff0000, v59
  v_lshlrev_b32 v128, 16, v60
  v_and_b32 v129, 0xffff0000, v60
  v_lshlrev_b32 v130, 16, v61
  v_and_b32 v131, 0xffff0000, v61
  v_lshlrev_b32 v132, 16, v62
  v_and_b32 v133, 0xffff0000, v62
  v_lshlrev_b32 v134, 16, v63
  v_and_b32 v135, 0xffff0000, v63
  v_lshlrev_b32 v136, 16, v64
  v_and_b32 v137, 0xffff0000, v64
  v_lshlrev_b32 v138, 16, v65
  v_and_b32 v139, 0xffff0000, v65
  v_lshlrev_b32 v140, 16, v66
  v_and_b32 v141, 0xffff0000, v66
  v_lshlrev_b32 v142, 16, v67
  v_and_b32 v143, 0xffff0000, v67
  v_pk_mul_f32 v[20:21], v[72:73], v[18:19] op_sel_hi:[1,0]
  s_nop 0
  v_cvt_pk_bf16_f32 v32, v20, v21
  v_pk_mul_f32 v[20:21], v[74:75], v[18:19] op_sel_hi:[1,0]
  s_nop 0
  v_cvt_pk_bf16_f32 v33, v20, v21
  v_pk_mul_f32 v[20:21], v[76:77], v[18:19] op_sel_hi:[1,0]
  s_nop 0
  v_cvt_pk_bf16_f32 v34, v20, v21
  v_pk_mul_f32 v[20:21], v[78:79], v[18:19] op_sel_hi:[1,0]
  s_nop 0
  v_cvt_pk_bf16_f32 v35, v20, v21
  v_pk_mul_f32 v[20:21], v[80:81], v[18:19] op_sel_hi:[1,0]
  s_nop 0
  v_cvt_pk_bf16_f32 v36, v20, v21
  v_pk_mul_f32 v[20:21], v[82:83], v[18:19] op_sel_hi:[1,0]
  s_nop 0
  v_cvt_pk_bf16_f32 v37, v20, v21
  v_pk_mul_f32 v[20:21], v[84:85], v[18:19] op_sel_hi:[1,0]
  s_nop 0
  v_cvt_pk_bf16_f32 v38, v20, v21
  v_pk_mul_f32 v[20:21], v[86:87], v[18:19] op_sel_hi:[1,0]
  s_nop 0
  v_cvt_pk_bf16_f32 v39, v20, v21
  v_pk_mul_f32 v[20:21], v[88:89], v[18:19] op_sel_hi:[1,0]
  s_nop 0
  v_cvt_pk_bf16_f32 v40, v20, v21
  v_pk_mul_f32 v[20:21], v[90:91], v[18:19] op_sel_hi:[1,0]
  s_nop 0
  v_cvt_pk_bf16_f32 v41, v20, v21
  v_pk_mul_f32 v[20:21], v[92:93], v[18:19] op_sel_hi:[1,0]
  s_nop 0
  v_cvt_pk_bf16_f32 v42, v20, v21
  v_pk_mul_f32 v[20:21], v[94:95], v[18:19] op_sel_hi:[1,0]
  s_nop 0
  v_cvt_pk_bf16_f32 v43, v20, v21
  v_pk_mul_f32 v[20:21], v[96:97], v[18:19] op_sel_hi:[1,0]
  s_nop 0
  v_cvt_pk_bf16_f32 v44, v20, v21
  v_pk_mul_f32 v[20:21], v[98:99], v[18:19] op_sel_hi:[1,0]
  s_nop 0
  v_cvt_pk_bf16_f32 v45, v20, v21
  v_pk_mul_f32 v[20:21], v[100:101], v[18:19] op_sel_hi:[1,0]
  s_nop 0
  v_cvt_pk_bf16_f32 v46, v20, v21
  v_pk_mul_f32 v[20:21], v[102:103], v[18:19] op_sel_hi:[1,0]
  s_nop 0
  v_cvt_pk_bf16_f32 v47, v20, v21
  v_pk_mul_f32 v[20:21], v[104:105], v[18:19] op_sel_hi:[1,0]
  s_nop 0
  v_cvt_pk_bf16_f32 v48, v20, v21
  v_pk_mul_f32 v[20:21], v[106:107], v[18:19] op_sel_hi:[1,0]
  s_nop 0
  v_cvt_pk_bf16_f32 v49, v20, v21
  v_pk_mul_f32 v[20:21], v[108:109], v[18:19] op_sel_hi:[1,0]
  s_nop 0
  v_cvt_pk_bf16_f32 v50, v20, v21
  v_pk_mul_f32 v[20:21], v[110:111], v[18:19] op_sel_hi:[1,0]
  s_nop 0
  v_cvt_pk_bf16_f32 v51, v20, v21
  v_pk_mul_f32 v[20:21], v[112:113], v[18:19] op_sel_hi:[1,0]
  s_nop 0
  v_cvt_pk_bf16_f32 v52, v20, v21
  v_pk_mul_f32 v[20:21], v[114:115], v[18:19] op_sel_hi:[1,0]
  s_nop 0
  v_cvt_pk_bf16_f32 v53, v20, v21
  v_pk_mul_f32 v[20:21], v[116:117], v[18:19] op_sel_hi:[1,0]
  s_nop 0
  v_cvt_pk_bf16_f32 v54, v20, v21
  v_pk_mul_f32 v[20:21], v[118:119], v[18:19] op_sel_hi:[1,0]
  s_nop 0
  v_cvt_pk_bf16_f32 v55, v20, v21
  v_pk_mul_f32 v[20:21], v[120:121], v[18:19] op_sel_hi:[1,0]
  s_nop 0
  v_cvt_pk_bf16_f32 v56, v20, v21
  v_pk_mul_f32 v[20:21], v[122:123], v[18:19] op_sel_hi:[1,0]
  s_nop 0
  v_cvt_pk_bf16_f32 v57, v20, v21
  v_pk_mul_f32 v[20:21], v[124:125], v[18:19] op_sel_hi:[1,0]
  s_nop 0
  v_cvt_pk_bf16_f32 v58, v20, v21
  v_pk_mul_f32 v[20:21], v[126:127], v[18:19] op_sel_hi:[1,0]
  s_nop 0
  v_cvt_pk_bf16_f32 v59, v20, v21
  v_pk_mul_f32 v[20:21], v[128:129], v[18:19] op_sel_hi:[1,0]
  s_nop 0
  v_cvt_pk_bf16_f32 v60, v20, v21
  v_pk_mul_f32 v[20:21], v[130:131], v[18:19] op_sel_hi:[1,0]
  s_nop 0
  v_cvt_pk_bf16_f32 v61, v20, v21
  v_pk_mul_f32 v[20:21], v[132:133], v[18:19] op_sel_hi:[1,0]
  s_nop 0
  v_cvt_pk_bf16_f32 v62, v20, v21
  v_pk_mul_f32 v[20:21], v[134:135], v[18:19] op_sel_hi:[1,0]
  s_nop 0
  v_cvt_pk_bf16_f32 v63, v20, v21
  v_pk_mul_f32 v[20:21], v[136:137], v[18:19] op_sel_hi:[1,0]
  s_nop 0
  v_cvt_pk_bf16_f32 v64, v20, v21
  v_pk_mul_f32 v[20:21], v[138:139], v[18:19] op_sel_hi:[1,0]
  s_nop 0
  v_cvt_pk_bf16_f32 v65, v20, v21
  v_pk_mul_f32 v[20:21], v[140:141], v[18:19] op_sel_hi:[1,0]
  s_nop 0
  v_cvt_pk_bf16_f32 v66, v20, v21
  v_pk_mul_f32 v[20:21], v[142:143], v[18:19] op_sel_hi:[1,0]
  s_nop 0
  v_cvt_pk_bf16_f32 v67, v20, v21
  v_lshlrev_b32 v7, 4, v5
  v_lshl_add_u32 v7, v6, 9, v7
  s_lshr_b32 s46, s51, 2
  s_mul_i32 s46, s46, 36864
  s_and_b32 s47, s51, 1
  s_lshl_b32 s47, s47, 8
  s_add_u32 s46, s46, s47
  s_and_b32 s47, s51, 2
  s_lshl_b32 s47, s47, 6
  s_add_u32 s46, s46, s47
  s_add_u32 s46, s46, 1048576
  buffer_store_dwordx4 v[32:35], v7, s[4:7], s46 offen sc1
  s_add_u32 s46, s46, 4096
  buffer_store_dwordx4 v[36:39], v7, s[4:7], s46 offen sc1
  s_add_u32 s46, s46, 4096
  buffer_store_dwordx4 v[40:43], v7, s[4:7], s46 offen sc1
  s_add_u32 s46, s46, 4096
  buffer_store_dwordx4 v[44:47], v7, s[4:7], s46 offen sc1
  s_add_u32 s46, s46, 4096
  buffer_store_dwordx4 v[48:51], v7, s[4:7], s46 offen sc1
  s_add_u32 s46, s46, 4096
  buffer_store_dwordx4 v[52:55], v7, s[4:7], s46 offen sc1
  s_add_u32 s46, s46, 4096
  buffer_store_dwordx4 v[56:59], v7, s[4:7], s46 offen sc1
  s_add_u32 s46, s46, 4096
  buffer_store_dwordx4 v[60:63], v7, s[4:7], s46 offen sc1
  s_add_u32 s46, s46, 4096
  buffer_store_dwordx4 v[64:67], v7, s[4:7], s46 offen sc1
  s_add_u32 s46, s46, 4096
W_noln_b:
  s_waitcnt vmcnt(0)
  s_barrier
  s_cmp_eq_u32 s44, 0
  s_cbranch_scc0 arr_190
  s_getreg_b32 s28, hwreg(HW_REG_XCC_ID, 0, 3)
  s_cmp_eq_u32 s75, 0
  s_cselect_b32 s28, s28, s2
  s_lshl_b32 s28, s28, 2
  s_lshl_b32 s28, 1, s28
  s_lshr_b32 s29, s2, 3
  s_lshl_b32 s29, s29, 2
  v_mov_b32 v5, s28
  s_lshl_b32 s28, s75, 7
  s_add_u32 s29, s29, s28
  v_mov_b32 v6, s29
  s_mov_b64 exec, 1
  global_atomic_add v6, v5, s[40:41] sc1
  s_mov_b64 exec, -1
arr_190:
  s_mov_b32 s50, 0x40000
  s_mov_b32 s46, 0x11111111
  s_cmp_eq_u32 s44, 0
  s_cbranch_scc0 gb_191_w
  s_branch gb_191_l
gb_191:
  s_sleep 16
gb_191_l:
  v_mbcnt_lo_u32_b32 v32, -1, 0
  v_and_b32 v32, 31, v32
  v_lshlrev_b32 v32, 2, v32
  v_lshl_add_u32 v32, s75, 7, v32
  global_load_dword v33, v32, s[40:41] sc1
  s_sub_u32 s50, s50, 1
  s_cbranch_scc1 K_end
  s_waitcnt vmcnt(0)
gb_191_c:
  v_mul_lo_u32 v34, v33, s46
  v_cmp_le_i32 vcc, 0, v34
  s_cbranch_vccnz gb_191
  v_cmp_ne_u32 vcc, s46, v33
  s_cmp_lg_u64 vcc, 0
  s_cselect_b32 s46, 1, 0
  v_mov_b32 v32, 163836
  v_mov_b32 v33, s46
  ds_write_b32 v32, v33
  s_waitcnt lgkmcnt(0)
gb_191_w:
  s_barrier
  v_mov_b32 v32, 163836
  ds_read_b32 v33, v32
  s_waitcnt lgkmcnt(0)
  v_readfirstlane_b32 s46, v33
  s_cmp_gt_u32 s46, s75
  s_cbranch_scc1 K_again
F_ld:
  v_mov_b32 v5, 0x3f80
  v_mov_b32 v6, 0x3f800000
  v_and_b32 v7, 1, v3
  v_cmp_eq_u32 vcc, 0, v7
  s_nop 1
  v_cndmask_b32 v5, v6, v5, vcc
  v_lshrrev_b32 v7, 1, v3
  v_cmp_eq_u32 vcc, 0, v7
  s_nop 1
  v_cndmask_b32 v24, 0, v5, vcc
  v_cmp_eq_u32 vcc, 1, v7
  s_nop 1
  v_cndmask_b32 v25, 0, v5, vcc
  v_cmp_eq_u32 vcc, 2, v7
  s_nop 1
  v_cndmask_b32 v26, 0, v5, vcc
  v_cmp_eq_u32 vcc, 3, v7
  s_nop 1
  v_cndmask_b32 v27, 0, v5, vcc
  v_lshrrev_b32 v5, 1, v4
  v_lshlrev_b32 v11, 4, v3
  v_lshl_add_u32 v11, v5, 8, v11
  v_and_b32 v5, 1, v4
  v_lshl_add_u32 v11, v5, 3, v11
  v_add_u32 v11, 4096, v11
  v_mul_u32_u24 v12, 18688, v4
  v_lshl_add_u32 v12, v3, 4, v12
  s_mul_i32 s47, s45, 18688
  s_add_u32 s61, s74, s47
  s_mul_i32 s47, s44, 4608
  s_add_u32 s61, s61, s47
  s_lshl_b32 s63, s44, 5
  s_add_u32 s63, s63, s45
  s_lshl_b32 s47, s63, 8
  s_add_u32 s62, s74, s47
  s_mov_b32 s64, 0
  s_mov_b32 s66, 0
  s_mov_b32 s8, s36
  s_mov_b32 s9, s37
  s_mov_b32 s10, 5308416
  s_mov_b32 s11, 0x20000
  v_lshrrev_b32 v5, 2, v3
  v_lshl_add_u32 v5, v4, 2, v5
  v_mul_u32_u24 v5, 1152, v5
  s_mul_i32 s46, s44, 288
  v_add_u32 v5, s46, v5
  v_and_b32 v6, 3, v3
  v_lshl_add_u32 v16, v6, 4, v5
  v_lshl_add_u32 v8, v6, 3, v5
  v_add_u32 v8, 256, v8
  s_mul_i32 s52, s45, 165888
  s_mul_i32 s47, s44, 27648
  s_add_u32 s46, s52, s47
  s_add_u32 s46, s46, 0
  s_add_u32 m0, s47, 0
  s_add_u32 s48, s46, 0
  buffer_load_dwordx4 v1, s[8:11], s48 offen offset:0 lds
  buffer_load_dwordx4 v1, s[8:11], s48 offen offset:1024 lds
  buffer_load_dwordx4 v1, s[8:11], s48 offen offset:2048 lds
  buffer_load_dwordx4 v1, s[8:11], s48 offen offset:3072 lds
  s_add_u32 m0, s47, 4096
  s_add_u32 s48, s46, 4096
  buffer_load_dwordx4 v1, s[8:11], s48 offen offset:0 lds
  buffer_load_dwordx4 v1, s[8:11], s48 offen offset:1024 lds
  buffer_load_dwordx4 v1, s[8:11], s48 offen offset:2048 lds
  buffer_load_dwordx4 v1, s[8:11], s48 offen offset:3072 lds
  s_add_u32 m0, s47, 8192
  s_add_u32 s48, s46, 8192
  buffer_load_dwordx4 v1, s[8:11], s48 offen offset:0 lds
  buffer_load_dwordx4 v1, s[8:11], s48 offen offset:1024 lds
  buffer_load_dwordx4 v1, s[8:11], s48 offen offset:2048 lds
  buffer_load_dwordx4 v1, s[8:11], s48 offen offset:3072 lds
  s_add_u32 m0, s47, 12288
  s_add_u32 s48, s46, 12288
  buffer_load_dwordx4 v1, s[8:11], s48 offen offset:0 lds
  buffer_load_dwordx4 v1, s[8:11], s48 offen offset:1024 lds
  buffer_load_dwordx4 v1, s[8:11], s48 offen offset:2048 lds
  buffer_load_dwordx4 v1, s[8:11], s48 offen offset:3072 lds
  s_add_u32 m0, s47, 16384
  s_add_u32 s48, s46, 16384
  buffer_load_dwordx4 v1, s[8:11], s48 offen offset:0 lds
  buffer_load_dwordx4 v1, s[8:11], s48 offen offset:1024 lds
  buffer_load_dwordx4 v1, s[8:11], s48 offen offset:2048 lds
  buffer_load_dwordx4 v1, s[8:11], s48 offen offset:3072 lds
  s_add_u32 m0, s47, 20480
  s_add_u32 s48, s46, 20480
  buffer_load_dwordx4 v1, s[8:11], s48 offen offset:0 lds
  buffer_load_dwordx4 v1, s[8:11], s48 offen offset:1024 lds
  buffer_load_dwordx4 v1, s[8:11], s48 offen offset:2048 lds
  buffer_load_dwordx4 v1, s[8:11], s48 offen offset:3072 lds
  s_add_u32 m0, s47, 24576
  s_add_u32 s48, s46, 24576
  buffer_load_dwordx4 v1, s[8:11], s48 offen offset:0 lds
  buffer_load_dwordx4 v1, s[8:11], s48 offen offset:1024 lds
  buffer_load_dwordx4 v1, s[8:11], s48 offen offset:2048 lds
  s_waitcnt vmcnt(0)
  s_barrier
  ds_read_b64_tr_b16 v[122:123], v16 offset:0
  ds_read_b64_tr_b16 v[124:125], v16 offset:18432
  ds_read_b64_tr_b16 a[0:1], v16 offset:8
  ds_read_b64_tr_b16 a[2:3], v16 offset:18440
  ds_read_b64_tr_b16 a[16:17], v16 offset:64
  ds_read_b64_tr_b16 a[18:19], v16 offset:18496
  ds_read_b64_tr_b16 v[138:139], v16 offset:72
  ds_read_b64_tr_b16 v[140:141], v16 offset:18504
  ds_read_b64_tr_b16 a[32:33], v16 offset:128
  ds_read_b64_tr_b16 a[34:35], v16 offset:18560
  ds_read_b64_tr_b16 a[48:49], v16 offset:136
  ds_read_b64_tr_b16 a[50:51], v16 offset:18568
  ds_read_b64_tr_b16 v[154:155], v16 offset:192
  ds_read_b64_tr_b16 v[156:157], v16 offset:18624
  ds_read_b64_tr_b16 a[64:65], v16 offset:200
  ds_read_b64_tr_b16 a[66:67], v16 offset:18632
  ds_read_b64_tr_b16 a[80:81], v8 offset:0
  ds_read_b64_tr_b16 a[82:83], v8 offset:18432
  v_add_u32 v16, 36864, v16
  v_add_u32 v8, 36864, v8
  ds_read_b64_tr_b16 v[126:127], v16 offset:0
  ds_read_b64_tr_b16 v[128:129], v16 offset:18432
  ds_read_b64_tr_b16 a[4:5], v16 offset:8
  ds_read_b64_tr_b16 a[6:7], v16 offset:18440
  ds_read_b64_tr_b16 a[20:21], v16 offset:64
  ds_read_b64_tr_b16 a[22:23], v16 offset:18496
  ds_read_b64_tr_b16 v[142:143], v16 offset:72
  ds_read_b64_tr_b16 v[144:145], v16 offset:18504
  ds_read_b64_tr_b16 a[36:37], v16 offset:128
  ds_read_b64_tr_b16 a[38:39], v16 offset:18560
  ds_read_b64_tr_b16 a[52:53], v16 offset:136
  ds_read_b64_tr_b16 a[54:55], v16 offset:18568
  ds_read_b64_tr_b16 v[158:159], v16 offset:192
  ds_read_b64_tr_b16 v[160:161], v16 offset:18624
  ds_read_b64_tr_b16 a[68:69], v16 offset:200
  ds_read_b64_tr_b16 a[70:71], v16 offset:18632
  ds_read_b64_tr_b16 a[84:85], v8 offset:0
  ds_read_b64_tr_b16 a[86:87], v8 offset:18432
  v_add_u32 v16, 36864, v16
  v_add_u32 v8, 36864, v8
  ds_read_b64_tr_b16 v[130:131], v16 offset:0
  ds_read_b64_tr_b16 v[132:133], v16 offset:18432
  ds_read_b64_tr_b16 a[8:9], v16 offset:8
  ds_read_b64_tr_b16 a[10:11], v16 offset:18440
  ds_read_b64_tr_b16 a[24:25], v16 offset:64
  ds_read_b64_tr_b16 a[26:27], v16 offset:18496
  ds_read_b64_tr_b16 v[146:147], v16 offset:72
  ds_read_b64_tr_b16 v[148:149], v16 offset:18504
  ds_read_b64_tr_b16 a[40:41], v16 offset:128
  ds_read_b64_tr_b16 a[42:43], v16 offset:18560
  ds_read_b64_tr_b16 a[56:57], v16 offset:136
  ds_read_b64_tr_b16 a[58:59], v16 offset:18568
  ds_read_b64_tr_b16 v[162:163], v16 offset:192
  ds_read_b64_tr_b16 v[164:165], v16 offset:18624
  ds_read_b64_tr_b16 a[72:73], v16 offset:200
  ds_read_b64_tr_b16 a[74:75], v16 offset:18632
  ds_read_b64_tr_b16 a[88:89], v8 offset:0
  ds_read_b64_tr_b16 a[90:91], v8 offset:18432
  v_add_u32 v16, -73728, v16
  v_add_u32 v8, -73728, v8
  s_waitcnt lgkmcnt(0)
  s_barrier
  s_mul_i32 s47, s44, 14336
  s_add_u32 s46, s52, s47
  s_add_u32 s46, s46, 110592
  s_add_u32 m0, s47, 0
  s_add_u32 s48, s46, 0
  buffer_load_dwordx4 v1, s[8:11], s48 offen offset:0 lds
  buffer_load_dwordx4 v1, s[8:11], s48 offen offset:1024 lds
  buffer_load_dwordx4 v1, s[8:11], s48 offen offset:2048 lds
  buffer_load_dwordx4 v1, s[8:11], s48 offen offset:3072 lds
  s_add_u32 m0, s47, 4096
  s_add_u32 s48, s46, 4096
  buffer_load_dwordx4 v1, s[8:11], s48 offen offset:0 lds
  buffer_load_dwordx4 v1, s[8:11], s48 offen offset:1024 lds
  buffer_load_dwordx4 v1, s[8:11], s48 offen offset:2048 lds
  buffer_load_dwordx4 v1, s[8:11], s48 offen offset:3072 lds
  s_add_u32 m0, s47, 8192
  s_add_u32 s48, s46, 8192
  buffer_load_dwordx4 v1, s[8:11], s48 offen offset:0 lds
  buffer_load_dwordx4 v1, s[8:11], s48 offen offset:1024 lds
  buffer_load_dwordx4 v1, s[8:11], s48 offen offset:2048 lds
  buffer_load_dwordx4 v1, s[8:11], s48 offen offset:3072 lds
  s_add_u32 m0, s47, 12288
  s_add_u32 s48, s46, 12288
  buffer_load_dwordx4 v1, s[8:11], s48 offen offset:0 lds
  buffer_load_dwordx4 v1, s[8:11], s48 offen offset:1024 lds
  s_waitcnt vmcnt(0)
  s_barrier
  ds_read_b64_tr_b16 v[134:135], v16 offset:0
  ds_read_b64_tr_b16 v[136:137], v16 offset:18432
  ds_read_b64_tr_b16 a[12:13], v16 offset:8
  ds_read_b64_tr_b16 a[14:15], v16 offset:18440
  ds_read_b64_tr_b16 a[28:29], v16 offset:64
  ds_read_b64_tr_b16 a[30:31], v16 offset:18496
  ds_read_b64_tr_b16 v[150:151], v16 offset:72
  ds_read_b64_tr_b16 v[152:153], v16 offset:18504
  ds_read_b64_tr_b16 a[44:45], v16 offset:128
  ds_read_b64_tr_b16 a[46:47], v16 offset:18560
  ds_read_b64_tr_b16 a[60:61], v16 offset:136
  ds_read_b64_tr_b16 a[62:63], v16 offset:18568
  ds_read_b64_tr_b16 v[166:167], v16 offset:192
  ds_read_b64_tr_b16 v[168:169], v16 offset:18624
  ds_read_b64_tr_b16 a[76:77], v16 offset:200
  ds_read_b64_tr_b16 a[78:79], v16 offset:18632
  ds_read_b64_tr_b16 a[92:93], v8 offset:0
  ds_read_b64_tr_b16 a[94:95], v8 offset:18432
  v_add_u32 v16, 36864, v16
  v_add_u32 v8, 36864, v8
  ds_read_b64_tr_b16 v[170:171], v16 offset:0
  ds_read_b64_tr_b16 v[172:173], v16 offset:8
  ds_read_b64_tr_b16 v[174:175], v16 offset:64
  ds_read_b64_tr_b16 v[176:177], v16 offset:72
  ds_read_b64_tr_b16 v[178:179], v16 offset:128
  ds_read_b64_tr_b16 v[180:181], v16 offset:136
  ds_read_b64_tr_b16 v[182:183], v16 offset:192
  ds_read_b64_tr_b16 v[184:185], v16 offset:200
  ds_read_b64_tr_b16 v[186:187], v8 offset:0
  v_add_u32 v16, 36864, v16
  v_add_u32 v8, 36864, v8
  s_waitcnt lgkmcnt(0)
  s_barrier
  s_mul_i32 s46, s44, 24576
  s_add_u32 s46, s46, 26624
  v_add_u32 v14, s46, v1
  ds_write_b128 v14, a[0:3] offset:0
  ds_write_b128 v14, a[4:7] offset:1024
  ds_write_b128 v14, a[8:11] offset:2048
  ds_write_b128 v14, a[12:15] offset:3072
  ds_write_b128 v14, a[16:19] offset:4096
  ds_write_b128 v14, a[20:23] offset:5120
  ds_write_b128 v14, a[24:27] offset:6144
  ds_write_b128 v14, a[28:31] offset:7168
  ds_write_b128 v14, a[32:35] offset:8192
  ds_write_b128 v14, a[36:39] offset:9216
  ds_write_b128 v14, a[40:43] offset:10240
  ds_write_b128 v14, a[44:47] offset:11264
  ds_write_b128 v14, a[48:51] offset:12288
  ds_write_b128 v14, a[52:55] offset:13312
  ds_write_b128 v14, a[56:59] offset:14336
  ds_write_b128 v14, a[60:63] offset:15360
  ds_write_b128 v14, a[64:67] offset:16384
  ds_write_b128 v14, a[68:71] offset:17408
  ds_write_b128 v14, a[72:75] offset:18432
  ds_write_b128 v14, a[76:79] offset:19456
  ds_write_b128 v14, a[80:83] offset:20480
  ds_write_b128 v14, a[84:87] offset:21504
  ds_write_b128 v14, a[88:91] offset:22528
  ds_write_b128 v14, a[92:95] offset:23552
  s_waitcnt lgkmcnt(0)
  s_mov_b32 s8, s32
  s_mov_b32 s9, s33
  s_mov_b32 s10, 5308416
  s_mov_b32 s11, 0x20000
  s_mov_b32 s12, s34
  s_mov_b32 s13, s35
  s_mov_b32 s14, 5308416
  s_mov_b32 s15, 0x20000
  s_mul_i32 s53, s44, 6144
  s_lshl_b32 s54, s44, 13
  s_add_u32 s54, s54, 124928
  v_lshrrev_b32 v5, 2, v2
  v_mul_u32_u24 v5, 9216, v5
  v_and_b32 v6, 3, v2
  v_lshl_add_u32 v5, v6, 4, v5
  v_lshrrev_b32 v7, 1, v2
  v_mul_u32_u24 v7, 9216, v7
  v_and_b32 v8, 1, v2
  v_lshl_add_u32 v7, v8, 4, v7
  s_mul_i32 s55, s45, 288
  s_lshl_b32 s46, s44, 6
  s_add_u32 s52, s55, s46
  s_and_b32 s46, s44, 1
  s_mul_i32 s46, s46, 2654208
  s_add_u32 s55, s55, s46
  s_add_u32 s55, s55, 256
  v_lshrrev_b32 v8, 2, v3
  v_lshl_add_u32 v8, v4, 3, v8
  v_lshlrev_b32 v6, 3, v6
  v_lshl_add_u32 v32, v8, 6, v6
  v_lshl_add_u32 v33, v8, 5, v6
  v_add_u32 v34, s54, v32
  v_add_u32 v35, s54, v33
  v_add_u32 v32, s53, v32
  v_add_u32 v33, s53, v33
  s_add_u32 m0, s53, 0
  s_add_u32 s46, s52, 0
  buffer_load_dwordx4 v5, s[8:11], s46 offen lds
  s_add_u32 m0, s53, 1024
  s_add_u32 s46, s52, 147456
  buffer_load_dwordx4 v5, s[8:11], s46 offen lds
  s_add_u32 m0, s53, 2048
  s_add_u32 s46, s52, 0
  buffer_load_dwordx4 v5, s[12:15], s46 offen lds
  s_add_u32 m0, s53, 3072
  s_add_u32 s46, s52, 147456
  buffer_load_dwordx4 v5, s[12:15], s46 offen lds
  s_add_u32 m0, s53, 4096
  s_add_u32 s46, s52, 294912
  buffer_load_dwordx4 v5, s[8:11], s46 offen lds
  s_add_u32 m0, s53, 5120
  s_add_u32 s46, s52, 442368
  buffer_load_dwordx4 v5, s[8:11], s46 offen lds
  s_add_u32 m0, s54, 0
  s_add_u32 s46, s52, 294912
  buffer_load_dwordx4 v5, s[12:15], s46 offen lds
  s_add_u32 m0, s54, 1024
  s_add_u32 s46, s52, 442368
  buffer_load_dwordx4 v5, s[12:15], s46 offen lds
  s_add_u32 m0, s54, 2048
  s_add_u32 s46, s52, 589824
  buffer_load_dwordx4 v5, s[8:11], s46 offen lds
  s_add_u32 m0, s54, 3072
  s_add_u32 s46, s52, 737280
  buffer_load_dwordx4 v5, s[8:11], s46 offen lds
  s_add_u32 m0, s54, 4096
  s_add_u32 s46, s52, 589824
  buffer_load_dwordx4 v5, s[12:15], s46 offen lds
  s_add_u32 m0, s54, 5120
  s_add_u32 s46, s52, 737280
  buffer_load_dwordx4 v5, s[12:15], s46 offen lds
  s_add_u32 m0, s54, 6144
  s_add_u32 s46, s52, 884736
  buffer_load_dwordx4 v5, s[8:11], s46 offen lds
  s_add_u32 m0, s54, 7168
  s_add_u32 s46, s52, 1032192
  buffer_load_dwordx4 v5, s[8:11], s46 offen lds
  s_waitcnt vmcnt(12)
  ds_read_b64_tr_b16 a[0:1], v32 offset:0
  ds_read_b64_tr_b16 a[2:3], v32 offset:256
  ds_read_b64_tr_b16 a[4:5], v32 offset:32
  ds_read_b64_tr_b16 a[6:7], v32 offset:288
  s_waitcnt lgkmcnt(0)
  s_add_u32 m0, s53, 0
  s_add_u32 s46, s52, 884736
  buffer_load_dwordx4 v5, s[12:15], s46 offen lds
  s_add_u32 m0, s53, 1024
  s_add_u32 s46, s52, 1032192
  buffer_load_dwordx4 v5, s[12:15], s46 offen lds
  s_waitcnt vmcnt(12)
  ds_read_b64_tr_b16 a[8:9], v32 offset:2048
  ds_read_b64_tr_b16 a[10:11], v32 offset:2304
  ds_read_b64_tr_b16 a[12:13], v32 offset:2080
  ds_read_b64_tr_b16 a[14:15], v32 offset:2336
  s_waitcnt lgkmcnt(0)
  s_add_u32 m0, s53, 2048
  s_add_u32 s46, s52, 1179648
  buffer_load_dwordx4 v5, s[8:11], s46 offen lds
  s_add_u32 m0, s53, 3072
  s_add_u32 s46, s52, 1327104
  buffer_load_dwordx4 v5, s[8:11], s46 offen lds
  s_waitcnt vmcnt(12)
  ds_read_b64_tr_b16 a[16:17], v32 offset:4096
  ds_read_b64_tr_b16 a[18:19], v32 offset:4352
  ds_read_b64_tr_b16 a[20:21], v32 offset:4128
  ds_read_b64_tr_b16 a[22:23], v32 offset:4384
  s_waitcnt lgkmcnt(0)
  s_add_u32 m0, s53, 4096
  s_add_u32 s46, s52, 1179648
  buffer_load_dwordx4 v5, s[12:15], s46 offen lds
  s_add_u32 m0, s53, 5120
  s_add_u32 s46, s52, 1327104
  buffer_load_dwordx4 v5, s[12:15], s46 offen lds
  s_waitcnt vmcnt(12)
  ds_read_b64_tr_b16 a[24:25], v34 offset:0
  ds_read_b64_tr_b16 a[26:27], v34 offset:256
  ds_read_b64_tr_b16 a[28:29], v34 offset:32
  ds_read_b64_tr_b16 a[30:31], v34 offset:288
  s_waitcnt lgkmcnt(0)
  s_add_u32 m0, s54, 0
  s_add_u32 s46, s52, 1474560
  buffer_load_dwordx4 v5, s[8:11], s46 offen lds
  s_add_u32 m0, s54, 1024
  s_add_u32 s46, s52, 1622016
  buffer_load_dwordx4 v5, s[8:11], s46 offen lds
  s_waitcnt vmcnt(12)
  ds_read_b64_tr_b16 a[32:33], v34 offset:2048
  ds_read_b64_tr_b16 a[34:35], v34 offset:2304
  ds_read_b64_tr_b16 a[36:37], v34 offset:2080
  ds_read_b64_tr_b16 a[38:39], v34 offset:2336
  s_waitcnt lgkmcnt(0)
  s_add_u32 m0, s54, 2048
  s_add_u32 s46, s52, 1474560
  buffer_load_dwordx4 v5, s[12:15], s46 offen lds
  s_add_u32 m0, s54, 3072
  s_add_u32 s46, s52, 1622016
  buffer_load_dwordx4 v5, s[12:15], s46 offen lds
  s_waitcnt vmcnt(12)
  ds_read_b64_tr_b16 a[40:41], v34 offset:4096
  ds_read_b64_tr_b16 a[42:43], v34 offset:4352
  ds_read_b64_tr_b16 a[44:45], v34 offset:4128
  ds_read_b64_tr_b16 a[46:47], v34 offset:4384
  s_waitcnt lgkmcnt(0)
  s_add_u32 m0, s54, 4096
  s_add_u32 s46, s52, 1769472
  buffer_load_dwordx4 v5, s[8:11], s46 offen lds
  s_add_u32 m0, s54, 5120
  s_add_u32 s46, s52, 1916928
  buffer_load_dwordx4 v5, s[8:11], s46 offen lds
  s_waitcnt vmcnt(12)
  ds_read_b64_tr_b16 a[48:49], v34 offset:6144
  ds_read_b64_tr_b16 a[50:51], v34 offset:6400
  ds_read_b64_tr_b16 a[52:53], v34 offset:6176
  ds_read_b64_tr_b16 a[54:55], v34 offset:6432
  s_waitcnt lgkmcnt(0)
  s_add_u32 m0, s54, 6144
  s_add_u32 s46, s52, 1769472
  buffer_load_dwordx4 v5, s[12:15], s46 offen lds
  s_add_u32 m0, s54, 7168
  s_add_u32 s46, s52, 1916928
  buffer_load_dwordx4 v5, s[12:15], s46 offen lds
  s_waitcnt vmcnt(12)
  ds_read_b64_tr_b16 a[56:57], v32 offset:0
  ds_read_b64_tr_b16 a[58:59], v32 offset:256
  ds_read_b64_tr_b16 a[60:61], v32 offset:32
  ds_read_b64_tr_b16 a[62:63], v32 offset:288
  s_waitcnt lgkmcnt(0)
  s_add_u32 m0, s53, 0
  s_add_u32 s46, s52, 2064384
  buffer_load_dwordx4 v5, s[8:11], s46 offen lds
  s_add_u32 m0, s53, 1024
  s_add_u32 s46, s52, 2211840
  buffer_load_dwordx4 v5, s[8:11], s46 offen lds
  s_waitcnt vmcnt(12)
  ds_read_b64_tr_b16 a[64:65], v32 offset:2048
  ds_read_b64_tr_b16 a[66:67], v32 offset:2304
  ds_read_b64_tr_b16 a[68:69], v32 offset:2080
  ds_read_b64_tr_b16 a[70:71], v32 offset:2336
  s_waitcnt lgkmcnt(0)
  s_add_u32 m0, s53, 2048
  s_add_u32 s46, s52, 2064384
  buffer_load_dwordx4 v5, s[12:15], s46 offen lds
  s_add_u32 m0, s53, 3072
  s_add_u32 s46, s52, 2211840
  buffer_load_dwordx4 v5, s[12:15], s46 offen lds
  s_waitcnt vmcnt(12)
  ds_read_b64_tr_b16 a[72:73], v32 offset:4096
  ds_read_b64_tr_b16 a[74:75], v32 offset:4352
  ds_read_b64_tr_b16 a[76:77], v32 offset:4128
  ds_read_b64_tr_b16 a[78:79], v32 offset:4384
  s_waitcnt lgkmcnt(0)
  s_add_u32 m0, s53, 4096
  s_add_u32 s46, s52, 2359296
  buffer_load_dwordx4 v5, s[8:11], s46 offen lds
  s_add_u32 m0, s53, 5120
  s_add_u32 s46, s52, 2506752
  buffer_load_dwordx4 v5, s[8:11], s46 offen lds
  s_waitcnt vmcnt(12)
  ds_read_b64_tr_b16 a[80:81], v34 offset:0
  ds_read_b64_tr_b16 a[82:83], v34 offset:256
  ds_read_b64_tr_b16 a[84:85], v34 offset:32
  ds_read_b64_tr_b16 a[86:87], v34 offset:288
  s_waitcnt lgkmcnt(0)
  s_add_u32 m0, s54, 0
  s_add_u32 s46, s52, 2359296
  buffer_load_dwordx4 v5, s[12:15], s46 offen lds
  s_add_u32 m0, s54, 1024
  s_add_u32 s46, s52, 2506752
  buffer_load_dwordx4 v5, s[12:15], s46 offen lds
  s_waitcnt vmcnt(12)
  ds_read_b64_tr_b16 a[88:89], v34 offset:2048
  ds_read_b64_tr_b16 a[90:91], v34 offset:2304
  ds_read_b64_tr_b16 a[92:93], v34 offset:2080
  ds_read_b64_tr_b16 a[94:95], v34 offset:2336
  s_waitcnt lgkmcnt(0)
  s_add_u32 m0, s54, 2048
  s_add_u32 s46, s52, 2654208
  buffer_load_dwordx4 v5, s[8:11], s46 offen lds
  s_add_u32 m0, s54, 3072
  s_add_u32 s46, s52, 2801664
  buffer_load_dwordx4 v5, s[8:11], s46 offen lds
  s_waitcnt vmcnt(12)
  ds_read_b64_tr_b16 a[96:97], v34 offset:4096
  ds_read_b64_tr_b16 a[98:99], v34 offset:4352
  ds_read_b64_tr_b16 a[100:101], v34 offset:4128
  ds_read_b64_tr_b16 a[102:103], v34 offset:4384
  s_waitcnt lgkmcnt(0)
  s_add_u32 m0, s54, 4096
  s_add_u32 s46, s52, 2654208
  buffer_load_dwordx4 v5, s[12:15], s46 offen lds
  s_add_u32 m0, s54, 5120
  s_add_u32 s46, s52, 2801664
  buffer_load_dwordx4 v5, s[12:15], s46 offen lds
  s_waitcnt vmcnt(12)
  ds_read_b64_tr_b16 a[104:105], v34 offset:6144
  ds_read_b64_tr_b16 a[106:107], v34 offset:6400
  ds_read_b64_tr_b16 a[108:109], v34 offset:6176
  ds_read_b64_tr_b16 a[110:111], v34 offset:6432
  s_waitcnt lgkmcnt(0)
  s_add_u32 m0, s54, 6144
  s_add_u32 s46, s52, 2949120
  buffer_load_dwordx4 v5, s[8:11], s46 offen lds
  s_add_u32 m0, s54, 7168
  s_add_u32 s46, s52, 3096576
  buffer_load_dwordx4 v5, s[8:11], s46 offen lds
  s_waitcnt vmcnt(12)
  ds_read_b64_tr_b16 a[112:113], v32 offset:0
  ds_read_b64_tr_b16 a[114:115], v32 offset:256
  ds_read_b64_tr_b16 a[116:117], v32 offset:32
  ds_read_b64_tr_b16 a[118:119], v32 offset:288
  s_waitcnt lgkmcnt(0)
  s_add_u32 m0, s53, 0
  s_add_u32 s46, s52, 2949120
  buffer_load_dwordx4 v5, s[12:15], s46 offen lds
  s_add_u32 m0, s53, 1024
  s_add_u32 s46, s52, 3096576
  buffer_load_dwordx4 v5, s[12:15], s46 offen lds
  s_waitcnt vmcnt(12)
  ds_read_b64_tr_b16 a[120:121], v32 offset:2048
  ds_read_b64_tr_b16 a[122:123], v32 offset:2304
  ds_read_b64_tr_b16 a[124:125], v32 offset:2080
  ds_read_b64_tr_b16 a[126:127], v32 offset:2336
  s_waitcnt lgkmcnt(0)
  s_add_u32 m0, s53, 2048
  s_add_u32 s46, s52, 3244032
  buffer_load_dwordx4 v5, s[8:11], s46 offen lds
  s_add_u32 m0, s53, 3072
  s_add_u32 s46, s52, 3391488
  buffer_load_dwordx4 v5, s[8:11], s46 offen lds
  s_waitcnt vmcnt(12)
  ds_read_b64_tr_b16 a[128:129], v32 offset:4096
  ds_read_b64_tr_b16 a[130:131], v32 offset:4352
  ds_read_b64_tr_b16 a[132:133], v32 offset:4128
  ds_read_b64_tr_b16 a[134:135], v32 offset:4384
  s_waitcnt lgkmcnt(0)
  s_add_u32 m0, s53, 4096
  s_add_u32 s46, s52, 3244032
  buffer_load_dwordx4 v5, s[12:15], s46 offen lds
  s_add_u32 m0, s53, 5120
  s_add_u32 s46, s52, 3391488
  buffer_load_dwordx4 v5, s[12:15], s46 offen lds
  s_waitcnt vmcnt(12)
  ds_read_b64_tr_b16 a[136:137], v34 offset:0
  ds_read_b64_tr_b16 a[138:139], v34 offset:256
  ds_read_b64_tr_b16 a[140:141], v34 offset:32
  ds_read_b64_tr_b16 a[142:143], v34 offset:288
  s_waitcnt lgkmcnt(0)
  s_add_u32 m0, s54, 0
  s_add_u32 s46, s52, 3538944
  buffer_load_dwordx4 v5, s[8:11], s46 offen lds
  s_add_u32 m0, s54, 1024
  s_add_u32 s46, s52, 3686400
  buffer_load_dwordx4 v5, s[8:11], s46 offen lds
  s_waitcnt vmcnt(12)
  ds_read_b64_tr_b16 a[144:145], v34 offset:2048
  ds_read_b64_tr_b16 a[146:147], v34 offset:2304
  ds_read_b64_tr_b16 a[148:149], v34 offset:2080
  ds_read_b64_tr_b16 a[150:151], v34 offset:2336
  s_waitcnt lgkmcnt(0)
  s_add_u32 m0, s54, 2048
  s_add_u32 s46, s52, 3538944
  buffer_load_dwordx4 v5, s[12:15], s46 offen lds
  s_add_u32 m0, s54, 3072
  s_add_u32 s46, s52, 3686400
  buffer_load_dwordx4 v5, s[12:15], s46 offen lds
  s_waitcnt vmcnt(12)
  ds_read_b64_tr_b16 a[152:153], v34 offset:4096
  ds_read_b64_tr_b16 a[154:155], v34 offset:4352
  ds_read_b64_tr_b16 a[156:157], v34 offset:4128
  ds_read_b64_tr_b16 a[158:159], v34 offset:4384
  s_waitcnt lgkmcnt(0)
  s_add_u32 m0, s54, 4096
  s_add_u32 s46, s52, 3833856
  buffer_load_dwordx4 v5, s[8:11], s46 offen lds
  s_add_u32 m0, s54, 5120
  s_add_u32 s46, s52, 3981312
  buffer_load_dwordx4 v5, s[8:11], s46 offen lds
  s_waitcnt vmcnt(12)
  ds_read_b64_tr_b16 a[160:161], v34 offset:6144
  ds_read_b64_tr_b16 a[162:163], v34 offset:6400
  ds_read_b64_tr_b16 a[164:165], v34 offset:6176
  ds_read_b64_tr_b16 a[166:167], v34 offset:6432
  s_waitcnt lgkmcnt(0)
  s_add_u32 m0, s54, 6144
  s_add_u32 s46, s52, 3833856
  buffer_load_dwordx4 v5, s[12:15], s46 offen lds
  s_add_u32 m0, s54, 7168
  s_add_u32 s46, s52, 3981312
  buffer_load_dwordx4 v5, s[12:15], s46 offen lds
  s_waitcnt vmcnt(12)
  ds_read_b64_tr_b16 a[168:169], v32 offset:0
  ds_read_b64_tr_b16 a[170:171], v32 offset:256
  ds_read_b64_tr_b16 a[172:173], v32 offset:32
  ds_read_b64_tr_b16 a[174:175], v32 offset:288
  s_waitcnt lgkmcnt(0)
  s_add_u32 m0, s53, 0
  s_add_u32 s46, s52, 4128768
  buffer_load_dwordx4 v5, s[8:11], s46 offen lds
  s_add_u32 m0, s53, 1024
  s_add_u32 s46, s52, 4276224
  buffer_load_dwordx4 v5, s[8:11], s46 offen lds
  s_waitcnt vmcnt(12)
  ds_read_b64_tr_b16 a[176:177], v32 offset:2048
  ds_read_b64_tr_b16 a[178:179], v32 offset:2304
  ds_read_b64_tr_b16 a[180:181], v32 offset:2080
  ds_read_b64_tr_b16 a[182:183], v32 offset:2336
  s_waitcnt lgkmcnt(0)
  s_add_u32 m0, s53, 2048
  s_add_u32 s46, s52, 4128768
  buffer_load_dwordx4 v5, s[12:15], s46 offen lds
  s_add_u32 m0, s53, 3072
  s_add_u32 s46, s52, 4276224
  buffer_load_dwordx4 v5, s[12:15], s46 offen lds
  s_waitcnt vmcnt(12)
  ds_read_b64_tr_b16 a[184:185], v32 offset:4096
  ds_read_b64_tr_b16 a[186:187], v32 offset:4352
  ds_read_b64_tr_b16 a[188:189], v32 offset:4128
  ds_read_b64_tr_b16 a[190:191], v32 offset:4384
  s_waitcnt lgkmcnt(0)
  s_add_u32 m0, s53, 4096
  s_add_u32 s46, s52, 4423680
  buffer_load_dwordx4 v5, s[8:11], s46 offen lds
  s_add_u32 m0, s53, 5120
  s_add_u32 s46, s52, 4571136
  buffer_load_dwordx4 v5, s[8:11], s46 offen lds
  s_waitcnt vmcnt(12)
  ds_read_b64_tr_b16 a[192:193], v34 offset:0
  ds_read_b64_tr_b16 a[194:195], v34 offset:256
  ds_read_b64_tr_b16 a[196:197], v34 offset:32
  ds_read_b64_tr_b16 a[198:199], v34 offset:288
  s_waitcnt lgkmcnt(0)
  s_add_u32 m0, s54, 0
  s_add_u32 s46, s52, 4423680
  buffer_load_dwordx4 v5, s[12:15], s46 offen lds
  s_add_u32 m0, s54, 1024
  s_add_u32 s46, s52, 4571136
  buffer_load_dwordx4 v5, s[12:15], s46 offen lds
  s_waitcnt vmcnt(12)
  ds_read_b64_tr_b16 a[200:201], v34 offset:2048
  ds_read_b64_tr_b16 a[202:203], v34 offset:2304
  ds_read_b64_tr_b16 a[204:205], v34 offset:2080
  ds_read_b64_tr_b16 a[206:207], v34 offset:2336
  s_waitcnt lgkmcnt(0)
  s_add_u32 m0, s54, 2048
  s_add_u32 s46, s52, 4718592
  buffer_load_dwordx4 v5, s[8:11], s46 offen lds
  s_add_u32 m0, s54, 3072
  s_add_u32 s46, s52, 4866048
  buffer_load_dwordx4 v5, s[8:11], s46 offen lds
  s_waitcnt vmcnt(12)
  ds_read_b64_tr_b16 a[208:209], v34 offset:4096
  ds_read_b64_tr_b16 a[210:211], v34 offset:4352
  ds_read_b64_tr_b16 a[212:213], v34 offset:4128
  ds_read_b64_tr_b16 a[214:215], v34 offset:4384
  s_waitcnt lgkmcnt(0)
  s_add_u32 m0, s54, 4096
  s_add_u32 s46, s52, 4718592
  buffer_load_dwordx4 v5, s[12:15], s46 offen lds
  s_add_u32 m0, s54, 5120
  s_add_u32 s46, s52, 4866048
  buffer_load_dwordx4 v5, s[12:15], s46 offen lds
  s_waitcnt vmcnt(12)
  ds_read_b64_tr_b16 a[216:217], v34 offset:6144
  ds_read_b64_tr_b16 a[218:219], v34 offset:6400
  ds_read_b64_tr_b16 a[220:221], v34 offset:6176
  ds_read_b64_tr_b16 a[222:223], v34 offset:6432
  s_waitcnt lgkmcnt(0)
  s_add_u32 m0, s54, 6144
  s_add_u32 s46, s52, 5013504
  buffer_load_dwordx4 v5, s[8:11], s46 offen lds
  s_add_u32 m0, s54, 7168
  s_add_u32 s46, s52, 5160960
  buffer_load_dwordx4 v5, s[8:11], s46 offen lds
  s_waitcnt vmcnt(12)
  ds_read_b64_tr_b16 a[224:225], v32 offset:0
  ds_read_b64_tr_b16 a[226:227], v32 offset:256
  ds_read_b64_tr_b16 a[228:229], v32 offset:32
  ds_read_b64_tr_b16 a[230:231], v32 offset:288
  s_waitcnt lgkmcnt(0)
  s_add_u32 m0, s53, 0
  s_add_u32 s46, s52, 5013504
  buffer_load_dwordx4 v5, s[12:15], s46 offen lds
  s_add_u32 m0, s53, 1024
  s_add_u32 s46, s52, 5160960
  buffer_load_dwordx4 v5, s[12:15], s46 offen lds
  s_waitcnt vmcnt(12)
  ds_read_b64_tr_b16 a[232:233], v32 offset:2048
  ds_read_b64_tr_b16 a[234:235], v32 offset:2304
  ds_read_b64_tr_b16 a[236:237], v32 offset:2080
  ds_read_b64_tr_b16 a[238:239], v32 offset:2336
  s_waitcnt lgkmcnt(0)
  s_cmp_ge_u32 s44, 2
  s_cselect_b32 s8, s34, s32
  s_cselect_b32 s9, s35, s33
  s_add_u32 m0, s53, 2048
  s_add_u32 s46, s55, 0
  buffer_load_dwordx4 v7, s[8:11], s46 offen lds
  s_add_u32 m0, s53, 3072
  s_add_u32 s46, s55, 294912
  buffer_load_dwordx4 v7, s[8:11], s46 offen lds
  s_waitcnt vmcnt(12)
  ds_read_b64_tr_b16 a[240:241], v32 offset:4096
  ds_read_b64_tr_b16 a[242:243], v32 offset:4352
  ds_read_b64_tr_b16 a[244:245], v32 offset:4128
  ds_read_b64_tr_b16 a[246:247], v32 offset:4384
  s_waitcnt lgkmcnt(0)
  s_add_u32 m0, s53, 4096
  s_add_u32 s46, s55, 589824
  buffer_load_dwordx4 v7, s[8:11], s46 offen lds
  s_add_u32 m0, s53, 5120
  s_add_u32 s46, s55, 884736
  buffer_load_dwordx4 v7, s[8:11], s46 offen lds
  s_waitcnt vmcnt(12)
  ds_read_b64_tr_b16 a[248:249], v34 offset:0
  ds_read_b64_tr_b16 a[250:251], v34 offset:256
  ds_read_b64_tr_b16 a[252:253], v34 offset:32
  ds_read_b64_tr_b16 a[254:255], v34 offset:288
  s_waitcnt lgkmcnt(0)
  s_add_u32 m0, s54, 0
  s_add_u32 s46, s55, 1179648
  buffer_load_dwordx4 v7, s[8:11], s46 offen lds
  s_add_u32 m0, s54, 1024
  s_add_u32 s46, s55, 1474560
  buffer_load_dwordx4 v7, s[8:11], s46 offen lds
  s_waitcnt vmcnt(12)
  ds_read_b64_tr_b16 v[188:189], v34 offset:2048
  ds_read_b64_tr_b16 v[190:191], v34 offset:2304
  ds_read_b64_tr_b16 v[192:193], v34 offset:2080
  ds_read_b64_tr_b16 v[194:195], v34 offset:2336
  s_waitcnt lgkmcnt(0)
  s_add_u32 m0, s54, 2048
  s_add_u32 s46, s55, 1769472
  buffer_load_dwordx4 v7, s[8:11], s46 offen lds
  s_add_u32 m0, s54, 3072
  s_add_u32 s46, s55, 2064384
  buffer_load_dwordx4 v7, s[8:11], s46 offen lds
  s_waitcnt vmcnt(12)
  ds_read_b64_tr_b16 v[196:197], v34 offset:4096
  ds_read_b64_tr_b16 v[198:199], v34 offset:4352
  ds_read_b64_tr_b16 v[200:201], v34 offset:4128
  ds_read_b64_tr_b16 v[202:203], v34 offset:4384
  s_waitcnt lgkmcnt(0)
  s_add_u32 m0, s54, 4096
  s_add_u32 s46, s55, 2359296
  buffer_load_dwordx4 v7, s[8:11], s46 offen lds
  s_waitcnt vmcnt(11)
  ds_read_b64_tr_b16 v[204:205], v34 offset:6144
  ds_read_b64_tr_b16 v[206:207], v34 offset:6400
  ds_read_b64_tr_b16 v[208:209], v34 offset:6176
  ds_read_b64_tr_b16 v[210:211], v34 offset:6432
  s_waitcnt lgkmcnt(0)
  s_waitcnt vmcnt(9)
  ds_read_b64_tr_b16 v[212:213], v32 offset:0
  ds_read_b64_tr_b16 v[214:215], v32 offset:256
  ds_read_b64_tr_b16 v[216:217], v32 offset:32
  ds_read_b64_tr_b16 v[218:219], v32 offset:288
  s_waitcnt lgkmcnt(0)
  s_waitcnt vmcnt(7)
  ds_read_b64_tr_b16 v[220:221], v33 offset:2048
  ds_read_b64_tr_b16 v[222:223], v33 offset:2176
  ds_read_b64_tr_b16 v[224:225], v33 offset:3072
  ds_read_b64_tr_b16 v[226:227], v33 offset:3200
  s_waitcnt lgkmcnt(0)
  s_waitcnt vmcnt(5)
  ds_read_b64_tr_b16 v[228:229], v33 offset:4096
  ds_read_b64_tr_b16 v[230:231], v33 offset:4224
  ds_read_b64_tr_b16 v[232:233], v33 offset:5120
  ds_read_b64_tr_b16 v[234:235], v33 offset:5248
  s_waitcnt lgkmcnt(0)
  s_waitcnt vmcnt(3)
  ds_read_b64_tr_b16 v[236:237], v35 offset:0
  ds_read_b64_tr_b16 v[238:239], v35 offset:128
  ds_read_b64_tr_b16 v[240:241], v35 offset:1024
  ds_read_b64_tr_b16 v[242:243], v35 offset:1152
  s_waitcnt lgkmcnt(0)
  s_waitcnt vmcnt(1)
  ds_read_b64_tr_b16 v[244:245], v35 offset:2048
  ds_read_b64_tr_b16 v[246:247], v35 offset:2176
  ds_read_b64_tr_b16 v[248:249], v35 offset:3072
  ds_read_b64_tr_b16 v[250:251], v35 offset:3200
  s_waitcnt lgkmcnt(0)
  s_waitcnt vmcnt(0)
  ds_read_b64_tr_b16 v[252:253], v35 offset:4096
  ds_read_b64_tr_b16 v[254:255], v35 offset:4224
  s_waitcnt lgkmcnt(0)
  v_mov_b32 v32, 0x3f803f80
  v_mov_b32 v33, 0x3f803f80
  v_mov_b32 v34, 0x3f803f80
  v_mov_b32 v35, 0x3f803f80
  s_nop 1
  v_mfma_f32_16x16x32_bf16 v[102:105], a[0:3], v[32:35], 0
  v_mfma_f32_16x16x32_bf16 v[106:109], a[4:7], v[32:35], 0
  v_mfma_f32_16x16x32_bf16 v[110:113], a[8:11], v[32:35], 0
  v_mfma_f32_16x16x32_bf16 v[114:117], a[12:15], v[32:35], 0
  v_mfma_f32_16x16x32_bf16 v[118:121], v[220:223], v[32:35], 0
  v_mfma_f32_16x16x32_bf16 v[102:105], a[16:19], v[32:35], v[102:105]
  v_mfma_f32_16x16x32_bf16 v[106:109], a[20:23], v[32:35], v[106:109]
  v_mfma_f32_16x16x32_bf16 v[110:113], a[24:27], v[32:35], v[110:113]
  v_mfma_f32_16x16x32_bf16 v[114:117], a[28:31], v[32:35], v[114:117]
  v_mfma_f32_16x16x32_bf16 v[118:121], v[224:227], v[32:35], v[118:121]
  v_mfma_f32_16x16x32_bf16 v[102:105], a[32:35], v[32:35], v[102:105]
  v_mfma_f32_16x16x32_bf16 v[106:109], a[36:39], v[32:35], v[106:109]
  v_mfma_f32_16x16x32_bf16 v[110:113], a[40:43], v[32:35], v[110:113]
  v_mfma_f32_16x16x32_bf16 v[114:117], a[44:47], v[32:35], v[114:117]
  v_mfma_f32_16x16x32_bf16 v[118:121], v[228:231], v[32:35], v[118:121]
  v_mfma_f32_16x16x32_bf16 v[102:105], a[48:51], v[32:35], v[102:105]
  v_mfma_f32_16x16x32_bf16 v[106:109], a[52:55], v[32:35], v[106:109]
  v_mfma_f32_16x16x32_bf16 v[110:113], a[56:59], v[32:35], v[110:113]
  v_mfma_f32_16x16x32_bf16 v[114:117], a[60:63], v[32:35], v[114:117]
  v_mfma_f32_16x16x32_bf16 v[118:121], v[232:235], v[32:35], v[118:121]
  v_mfma_f32_16x16x32_bf16 v[102:105], a[64:67], v[32:35], v[102:105]
  v_mfma_f32_16x16x32_bf16 v[106:109], a[68:71], v[32:35], v[106:109]
  v_mfma_f32_16x16x32_bf16 v[110:113], a[72:75], v[32:35], v[110:113]
  v_mfma_f32_16x16x32_bf16 v[114:117], a[76:79], v[32:35], v[114:117]
  v_mfma_f32_16x16x32_bf16 v[118:121], v[236:239], v[32:35], v[118:121]
  v_mfma_f32_16x16x32_bf16 v[102:105], a[80:83], v[32:35], v[102:105]
  v_mfma_f32_16x16x32_bf16 v[106:109], a[84:87], v[32:35], v[106:109]
  v_mfma_f32_16x16x32_bf16 v[110:113], a[88:91], v[32:35], v[110:113]
  v_mfma_f32_16x16x32_bf16 v[114:117], a[92:95], v[32:35], v[114:117]
  v_mfma_f32_16x16x32_bf16 v[118:121], v[240:243], v[32:35], v[118:121]
  v_mfma_f32_16x16x32_bf16 v[102:105], a[96:99], v[32:35], v[102:105]
  v_mfma_f32_16x16x32_bf16 v[106:109], a[100:103], v[32:35], v[106:109]
  v_mfma_f32_16x16x32_bf16 v[110:113], a[104:107], v[32:35], v[110:113]
  v_mfma_f32_16x16x32_bf16 v[114:117], a[108:111], v[32:35], v[114:117]
  v_mfma_f32_16x16x32_bf16 v[118:121], v[244:247], v[32:35], v[118:121]
  v_mfma_f32_16x16x32_bf16 v[102:105], a[112:115], v[32:35], v[102:105]
  v_mfma_f32_16x16x32_bf16 v[106:109], a[116:119], v[32:35], v[106:109]
  v_mfma_f32_16x16x32_bf16 v[110:113], a[120:123], v[32:35], v[110:113]
  v_mfma_f32_16x16x32_bf16 v[114:117], a[124:127], v[32:35], v[114:117]
  v_mfma_f32_16x16x32_bf16 v[118:121], v[248:251], v[32:35], v[118:121]
  v_mfma_f32_16x16x32_bf16 v[102:105], a[128:131], v[32:35], v[102:105]
  v_mfma_f32_16x16x32_bf16 v[106:109], a[132:135], v[32:35], v[106:109]
  v_mfma_f32_16x16x32_bf16 v[110:113], a[136:139], v[32:35], v[110:113]
  v_mfma_f32_16x16x32_bf16 v[114:117], a[140:143], v[32:35], v[114:117]
  v_mfma_f32_16x16x32_bf16 v[118:121], v[252:255], v[32:35], v[118:121]
  v_mfma_f32_16x16x32_bf16 v[102:105], a[144:147], v[32:35], v[102:105]
  v_mfma_f32_16x16x32_bf16 v[106:109], a[148:151], v[32:35], v[106:109]
  v_mfma_f32_16x16x32_bf16 v[110:113], a[152:155], v[32:35], v[110:113]
  v_mfma_f32_16x16x32_bf16 v[114:117], a[156:159], v[32:35], v[114:117]
  v_mfma_f32_16x16x32_bf16 v[102:105], a[160:163], v[32:35], v[102:105]
  v_mfma_f32_16x16x32_bf16 v[106:109], a[164:167], v[32:35], v[106:109]
  v_mfma_f32_16x16x32_bf16 v[110:113], a[168:171], v[32:35], v[110:113]
  v_mfma_f32_16x16x32_bf16 v[114:117], a[172:175], v[32:35], v[114:117]
  v_mfma_f32_16x16x32_bf16 v[102:105], a[176:179], v[32:35], v[102:105]
  v_mfma_f32_16x16x32_bf16 v[106:109], a[180:183], v[32:35], v[106:109]
  v_mfma_f32_16x16x32_bf16 v[110:113], a[184:187], v[32:35], v[110:113]
  v_mfma_f32_16x16x32_bf16 v[114:117], a[188:191], v[32:35], v[114:117]
  v_mfma_f32_16x16x32_bf16 v[102:105], a[192:195], v[32:35], v[102:105]
  v_mfma_f32_16x16x32_bf16 v[106:109], a[196:199], v[32:35], v[106:109]
  v_mfma_f32_16x16x32_bf16 v[110:113], a[200:203], v[32:35], v[110:113]
  v_mfma_f32_16x16x32_bf16 v[114:117], a[204:207], v[32:35], v[114:117]
  v_mfma_f32_16x16x32_bf16 v[102:105], a[208:211], v[32:35], v[102:105]
  v_mfma_f32_16x16x32_bf16 v[106:109], a[212:215], v[32:35], v[106:109]
  v_mfma_f32_16x16x32_bf16 v[110:113], a[216:219], v[32:35], v[110:113]
  v_mfma_f32_16x16x32_bf16 v[114:117], a[220:223], v[32:35], v[114:117]
  v_mfma_f32_16x16x32_bf16 v[102:105], a[224:227], v[32:35], v[102:105]
  v_mfma_f32_16x16x32_bf16 v[106:109], a[228:231], v[32:35], v[106:109]
  v_mfma_f32_16x16x32_bf16 v[110:113], a[232:235], v[32:35], v[110:113]
  v_mfma_f32_16x16x32_bf16 v[114:117], a[236:239], v[32:35], v[114:117]
  v_mfma_f32_16x16x32_bf16 v[102:105], a[240:243], v[32:35], v[102:105]
  v_mfma_f32_16x16x32_bf16 v[106:109], a[244:247], v[32:35], v[106:109]
  v_mfma_f32_16x16x32_bf16 v[110:113], a[248:251], v[32:35], v[110:113]
  v_mfma_f32_16x16x32_bf16 v[114:117], a[252:255], v[32:35], v[114:117]
  v_mfma_f32_16x16x32_bf16 v[102:105], v[188:191], v[32:35], v[102:105]
  v_mfma_f32_16x16x32_bf16 v[106:109], v[192:195], v[32:35], v[106:109]
  v_mfma_f32_16x16x32_bf16 v[110:113], v[196:199], v[32:35], v[110:113]
  v_mfma_f32_16x16x32_bf16 v[114:117], v[200:203], v[32:35], v[114:117]
  v_mfma_f32_16x16x32_bf16 v[102:105], v[204:207], v[32:35], v[102:105]
  v_mfma_f32_16x16x32_bf16 v[106:109], v[208:211], v[32:35], v[106:109]
  v_mfma_f32_16x16x32_bf16 v[110:113], v[212:215], v[32:35], v[110:113]
  v_mfma_f32_16x16x32_bf16 v[114:117], v[216:219], v[32:35], v[114:117]
  s_cmp_eq_u32 s3, 1
  s_cbranch_scc0 U_no
  s_mov_b32 s50, 0x1000
  s_cmp_eq_u32 s44, 0
  s_cbranch_scc0 U_go
  s_branch U_l
U_w:
  s_sleep 32
U_l:
  buffer_load_dword v32, off, s[4:7], 0 offset:2048 sc1
  s_sub_u32 s50, s50, 1
  s_cbranch_scc1 K_end
  s_waitcnt vmcnt(0)
  v_readfirstlane_b32 s46, v32
  s_cmp_lt_u32 s46, 100
  s_cbranch_scc1 U_w
U_go:
  s_barrier
U_no:
  s_mov_b32 s8, s38
  s_mov_b32 s9, s39
  s_mov_b32 s10, 2359296
  s_mov_b32 s11, 0x20000
  s_sub_u32 s51, s3, 5
  s_cselect_b32 s51, 199, s51
  s_mul_i32 s56, s51, 18432
  s_lshl_b32 s69, s44, 10
  s_add_u32 s52, s56, s69
  s_add_u32 s52, s52, 12582912
  s_lshl_b32 s47, s63, 4
  s_add_u32 s56, s56, s47
  v_mul_u32_u24 v10, 1152, v3
  v_mov_b32 v5, 1073741824
  v_cmp_eq_u32 vcc, 0, v4
  s_nop 1
  v_cndmask_b32 v10, v5, v10, vcc
  v_lshlrev_b32 v13, 4, v3
  v_and_b32 v5, 1, v4
  v_lshl_add_u32 v13, v5, 3, v13
  s_min_u32 s47, s63, 71
  s_lshl_b32 s47, s47, 8
  v_add_u32 v13, s47, v13
  v_mov_b32 v16, v1
  v_add_u32 v19, s69, v1
  v_mov_b32 v18, v19
  v_add_u32 v9, 16384, v19
  v_mov_b32 v5, 125440
  s_cmp_lt_u32 s44, 2
  s_cselect_b32 s68, 131072, 0
  s_cselect_b64 vcc, -1, 0
  v_cndmask_b32 v9, v5, v9, vcc
  s_and_b32 s46, s44, 1
  s_mul_i32 s46, s46, 9216
  v_add_u32 v20, s46, v1
  v_lshlrev_b32 v21, 4, v3
  v_lshrrev_b32 v6, 2, v3
  v_lshl_add_u32 v6, v6, 8, v21
  v_and_b32 v7, 3, v3
  v_lshl_add_u32 v6, v7, 2, v6
  v_add_u32 v21, 124928, v21
  s_lshl_b32 s46, s44, 2
  v_add_u32 v15, s46, v21
  v_mov_b64 v[28:29], 0
  v_mov_b64 v[30:31], 0
  s_mov_b32 s53, 0x3f803f80
  s_mov_b32 s54, 0xbfb8aa3b
  s_mov_b32 s50, 0x100000
  s_mov_b32 s67, 0
  s_cmp_eq_u32 s63, 127
  s_cselect_b32 s70, 0, -1
  s_barrier
  ds_write_b128 v5, v[28:31]
  v_add_u32 v5, 18432, v6
  s_cmp_lt_u32 s44, 2
  s_cbranch_scc0 fd_233
  s_add_u32 m0, s69, 16384
  s_add_u32 s46, s52, 16384
  buffer_load_dwordx4 v1, s[4:7], s46 offen sc1 lds
fd_233:
  s_add_u32 m0, s69, 0
  s_add_u32 s46, s52, 0
  buffer_load_dwordx4 v1, s[4:7], s46 offen sc1 lds
  s_add_u32 m0, s69, 4096
  s_add_u32 s46, s52, 4096
  buffer_load_dwordx4 v1, s[4:7], s46 offen sc1 lds
  s_add_u32 m0, s69, 8192
  s_add_u32 s46, s52, 8192
  buffer_load_dwordx4 v1, s[4:7], s46 offen sc1 lds
  s_add_u32 m0, s69, 12288
  s_add_u32 s46, s52, 12288
  buffer_load_dwordx4 v1, s[4:7], s46 offen sc1 lds
  s_waitcnt vmcnt(0) lgkmcnt(0)
  s_cmp_eq_u32 s75, 0
  s_cbranch_scc0 FF_loop
F_loop:
  ds_read_b128 v[86:89], v18 offset:0
  ds_read_b128 v[90:93], v18 offset:4096
  ds_read_b128 v[94:97], v18 offset:8192
  ds_read_b128 v[98:101], v18 offset:12288
  ds_read_b128 v[28:31], v9
  v_mov_b32 v32, s53
  v_mov_b32 v33, s53
  v_mov_b32 v34, s53
  v_mov_b32 v35, s53
  s_waitcnt lgkmcnt(4)
  v_max_u32 v17, v86, v87
  v_max3_u32 v17, v17, v88, v89
  s_waitcnt lgkmcnt(3)
  v_max3_u32 v17, v17, v90, v91
  v_max3_u32 v17, v17, v92, v93
  s_waitcnt lgkmcnt(2)
  v_max3_u32 v17, v17, v94, v95
  v_max3_u32 v17, v17, v96, v97
  s_waitcnt lgkmcnt(1)
  v_max3_u32 v17, v17, v98, v99
  v_max3_u32 v17, v17, v100, v101
  s_waitcnt lgkmcnt(0)
  v_max3_u32 v17, v17, v28, v29
  v_max3_u32 v17, v17, v30, v31
  v_cmp_eq_u32 vcc, -1, v17
  s_cbranch_vccnz F_wait
  s_barrier
  ds_read_b128 v[68:71], v20 offset:0
  ds_read_b128 v[52:55], v16 offset:0
  v_mfma_f32_16x16x32_bf16 v[64:67], v[32:35], v[86:89], 0
  ds_read_b128 v[72:75], v20 offset:1024
  v_mfma_f32_16x16x32_bf16 v[86:89], v[86:89], v[86:89], 0
  ds_read_b128 v[76:79], v20 offset:2048
  v_mfma_f32_16x16x32_bf16 v[64:67], v[32:35], v[90:93], v[64:67]
  ds_read_b128 v[56:59], v16 offset:1024
  v_mfma_f32_16x16x32_bf16 v[86:89], v[90:93], v[90:93], v[86:89]
  ds_read_b128 v[80:83], v20 offset:3072
  v_mfma_f32_16x16x32_bf16 v[64:67], v[32:35], v[94:97], v[64:67]
  ds_read_b128 v[60:63], v16 offset:2048
  v_mfma_f32_16x16x32_bf16 v[86:89], v[94:97], v[94:97], v[86:89]
  v_xor_b32 v18, 131072, v18
  v_mfma_f32_16x16x32_bf16 v[64:67], v[32:35], v[98:101], v[64:67]
  v_xor_b32 v9, s68, v9
  v_mfma_f32_16x16x32_bf16 v[86:89], v[98:101], v[98:101], v[86:89]
  v_mfma_f32_16x16x32_bf16 v[64:67], v[32:35], v[28:31], v[64:67]
  v_mfma_f32_16x16x32_bf16 v[86:89], v[28:31], v[28:31], v[86:89]
  s_waitcnt lgkmcnt(6)
  v_mfma_f32_16x16x32_bf16 v[48:51], v[220:223], v[68:71], 0
  s_cmp_lt_u32 s51, 196
  s_cselect_b32 s71, 3, 4
  s_add_u32 s51, s51, s71
  s_mul_i32 s71, s71, 18432
  s_waitcnt lgkmcnt(5)
  v_mfma_f32_16x16x32_bf16 v[32:35], a[0:3], v[52:55], 0
  s_add_u32 s52, s52, s71
  s_cmp_lt_u32 s51, 128
  s_cselect_b32 s52, s52, 1073741824
  s_xor_b32 s69, s69, 131072
  v_mfma_f32_16x16x32_bf16 v[36:39], a[4:7], v[52:55], 0
  ds_read_b128 v[68:71], v20 offset:4096
  ds_write_b32 v15, v64
  s_waitcnt lgkmcnt(6)
  v_mfma_f32_16x16x32_bf16 v[48:51], v[224:227], v[72:75], v[48:51]
  ds_write_b128 v19, v[86:89] offset:18432
  v_mfma_f32_16x16x32_bf16 v[40:43], a[8:11], v[52:55], 0
  v_mfma_f32_16x16x32_bf16 v[44:47], a[12:15], v[52:55], 0
  ds_read_b128 v[72:75], v20 offset:5120
  ds_read_b128 v[64:67], v16 offset:3072
  s_waitcnt lgkmcnt(8)
  v_mfma_f32_16x16x32_bf16 v[48:51], v[228:231], v[76:79], v[48:51]
  s_waitcnt lgkmcnt(7)
  v_mfma_f32_16x16x32_bf16 v[32:35], a[16:19], v[56:59], v[32:35]
  ds_read_b128 v[52:55], v16 offset:4096
  v_mfma_f32_16x16x32_bf16 v[36:39], a[20:23], v[56:59], v[36:39]
  ds_read_b128 v[76:79], v20 offset:6144
  s_waitcnt lgkmcnt(4)
  s_barrier
  v_mfma_f32_16x16x32_bf16 v[48:51], v[232:235], v[80:83], v[48:51]
  ds_read_b128 v[86:89], v21
  v_mfma_f32_16x16x32_bf16 v[40:43], a[24:27], v[56:59], v[40:43]
  ds_read2st64_b32 v[90:91], v5 offset0:0 offset1:4
  v_mfma_f32_16x16x32_bf16 v[44:47], a[28:31], v[56:59], v[44:47]
  ds_read_b128 v[80:83], v20 offset:7168
  ds_read2st64_b32 v[92:93], v5 offset0:8 offset1:12
  v_mfma_f32_16x16x32_bf16 v[48:51], v[236:239], v[68:71], v[48:51]
  v_mfma_f32_16x16x32_bf16 v[32:35], a[32:35], v[60:63], v[32:35]
  ds_read_b128 v[56:59], v16 offset:5120
  v_mfma_f32_16x16x32_bf16 v[36:39], a[36:39], v[60:63], v[36:39]
  ds_read_b128 v[68:71], v20 offset:8192
  s_waitcnt lgkmcnt(9)
  v_mfma_f32_16x16x32_bf16 v[48:51], v[240:243], v[72:75], v[48:51]
  s_waitcnt lgkmcnt(5)
  v_add_f32 v86, v86, v87
  v_add_f32 v88, v88, v89
  v_mfma_f32_16x16x32_bf16 v[40:43], a[40:43], v[60:63], v[40:43]
  s_waitcnt lgkmcnt(4)
  v_add_f32 v90, v90, v91
  s_waitcnt lgkmcnt(2)
  v_add_f32 v92, v92, v93
  v_mfma_f32_16x16x32_bf16 v[44:47], a[44:47], v[60:63], v[44:47]
  v_add_f32 v2, v86, v88
  v_add_f32 v3, v90, v92
  v_mfma_f32_16x16x32_bf16 v[48:51], v[244:247], v[76:79], v[48:51]
  v_mul_f32 v2, 0xbae38e39, v2
  v_mul_f32 v3, 0x3ae38e39, v3
  v_mfma_f32_16x16x32_bf16 v[32:35], a[48:51], v[64:67], v[32:35]
  ds_read_b128 v[60:63], v16 offset:6144
  v_fma_f32 v3, -v2, v2, v3
  v_mfma_f32_16x16x32_bf16 v[36:39], a[52:55], v[64:67], v[36:39]
  v_cvt_pk_bf16_f32 v2, v2, v2
  v_mfma_f32_16x16x32_bf16 v[48:51], v[248:251], v[80:83], v[48:51]
  v_lshlrev_b32 v2, 16, v2
  v_mfma_f32_16x16x32_bf16 v[40:43], a[56:59], v[64:67], v[40:43]
  v_max_f32 v3, 0, v3
  v_mfma_f32_16x16x32_bf16 v[44:47], a[60:63], v[64:67], v[44:47]
  v_cvt_pk_bf16_f32 v3, v3, v3
  s_waitcnt lgkmcnt(1)
  v_mfma_f32_16x16x32_bf16 v[48:51], v[252:255], v[68:71], v[48:51]
  v_lshlrev_b32 v3, 16, v3
  v_mfma_f32_16x16x32_bf16 v[32:35], a[64:67], v[52:55], v[32:35]
  ds_read_b128 v[64:67], v16 offset:7168
  v_mfma_f32_16x16x32_bf16 v[36:39], a[68:71], v[52:55], v[36:39]
  v_mfma_f32_16x16x32_bf16 v[40:43], a[72:75], v[52:55], v[40:43]
  v_fma_f32 v48, v2, v118, v48
  v_fma_f32 v49, v2, v119, v49
  v_mfma_f32_16x16x32_bf16 v[44:47], a[76:79], v[52:55], v[44:47]
  v_fma_f32 v50, v2, v120, v50
  v_fma_f32 v51, v2, v121, v51
  v_mfma_f32_16x16x32_bf16 v[32:35], a[80:83], v[56:59], v[32:35]
  ds_read_b128 v[52:55], v16 offset:8192
  v_mfma_f32_16x16x32_bf16 v[36:39], a[84:87], v[56:59], v[36:39]
  ds_write_b128 v19, v[48:51] offset:22528
  v_mfma_f32_16x16x32_bf16 v[40:43], a[88:91], v[56:59], v[40:43]
  v_add_f32 v3, 0x3727c5ac, v3
  v_mfma_f32_16x16x32_bf16 v[44:47], a[92:95], v[56:59], v[44:47]
  v_cvt_pk_bf16_f32 v3, v3, v3
  s_waitcnt lgkmcnt(3)
  v_mfma_f32_16x16x32_bf16 v[32:35], a[96:99], v[60:63], v[32:35]
  ds_read_b128 v[56:59], v16 offset:9216
  v_lshlrev_b32 v3, 16, v3
  v_mfma_f32_16x16x32_bf16 v[36:39], a[100:103], v[60:63], v[36:39]
  v_sqrt_f32 v3, v3
  v_mfma_f32_16x16x32_bf16 v[40:43], a[104:107], v[60:63], v[40:43]
  s_waitcnt lgkmcnt(1)
  s_barrier
  v_mfma_f32_16x16x32_bf16 v[44:47], a[108:111], v[60:63], v[44:47]
  ds_read_b128 v[68:71], v1 offset:22528
  v_cvt_pk_bf16_f32 v3, v3, v3
  v_mfma_f32_16x16x32_bf16 v[32:35], a[112:115], v[64:67], v[32:35]
  ds_read_b128 v[60:63], v16 offset:10240
  ds_read_b128 v[72:75], v1 offset:23552
  v_lshlrev_b32 v3, 16, v3
  v_mfma_f32_16x16x32_bf16 v[36:39], a[116:119], v[64:67], v[36:39]
  ds_read_b128 v[76:79], v1 offset:24576
  v_rcp_f32 v3, v3
  v_mfma_f32_16x16x32_bf16 v[40:43], a[120:123], v[64:67], v[40:43]
  ds_read_b128 v[80:83], v1 offset:25600
  v_mfma_f32_16x16x32_bf16 v[44:47], a[124:127], v[64:67], v[44:47]
  v_mul_f32 v4, v3, v3
  v_mfma_f32_16x16x32_bf16 v[32:35], a[128:131], v[52:55], v[32:35]
  ds_read_b128 v[64:67], v16 offset:11264
  v_mul_f32 v3, s54, v3
  v_mfma_f32_16x16x32_bf16 v[36:39], a[132:135], v[52:55], v[36:39]
  v_mfma_f32_16x16x32_bf16 v[40:43], a[136:139], v[52:55], v[40:43]
  s_waitcnt lgkmcnt(3)
  v_add_f32 v68, v68, v72
  v_add_f32 v69, v69, v73
  v_mfma_f32_16x16x32_bf16 v[44:47], a[140:143], v[52:55], v[44:47]
  v_add_f32 v70, v70, v74
  v_add_f32 v71, v71, v75
  v_mfma_f32_16x16x32_bf16 v[32:35], a[144:147], v[56:59], v[32:35]
  ds_read_b128 v[52:55], v16 offset:12288
  v_mul_f32 v72, v68, v3
  v_mfma_f32_16x16x32_bf16 v[36:39], a[148:151], v[56:59], v[36:39]
  v_mul_f32 v73, v69, v3
  v_mul_f32 v74, v70, v3
  v_mfma_f32_16x16x32_bf16 v[40:43], a[152:155], v[56:59], v[40:43]
  v_mul_f32 v75, v71, v3
  v_mfma_f32_16x16x32_bf16 v[44:47], a[156:159], v[56:59], v[44:47]
  v_exp_f32 v72, v72
  v_mfma_f32_16x16x32_bf16 v[32:35], a[160:163], v[60:63], v[32:35]
  ds_read_b128 v[56:59], v16 offset:13312
  v_mfma_f32_16x16x32_bf16 v[36:39], a[164:167], v[60:63], v[36:39]
  v_exp_f32 v73, v73
  v_mfma_f32_16x16x32_bf16 v[40:43], a[168:171], v[60:63], v[40:43]
  v_exp_f32 v74, v74
  v_mfma_f32_16x16x32_bf16 v[44:47], a[172:175], v[60:63], v[44:47]
  v_exp_f32 v75, v75
  s_waitcnt lgkmcnt(2)
  v_mfma_f32_16x16x32_bf16 v[32:35], a[176:179], v[64:67], v[32:35]
  ds_read_b128 v[60:63], v16 offset:14336
  v_add_f32 v76, v76, v80
  v_mfma_f32_16x16x32_bf16 v[36:39], a[180:183], v[64:67], v[36:39]
  v_add_f32 v77, v77, v81
  v_add_f32 v78, v78, v82
  v_mfma_f32_16x16x32_bf16 v[40:43], a[184:187], v[64:67], v[40:43]
  v_add_f32 v79, v79, v83
  v_add_f32 v72, 1.0, v72
  v_mfma_f32_16x16x32_bf16 v[44:47], a[188:191], v[64:67], v[44:47]
  v_add_f32 v73, 1.0, v73
  v_add_f32 v74, 1.0, v74
  s_waitcnt lgkmcnt(2)
  v_mfma_f32_16x16x32_bf16 v[32:35], a[192:195], v[52:55], v[32:35]
  ds_read_b128 v[64:67], v16 offset:15360
  v_add_f32 v75, 1.0, v75
  v_mfma_f32_16x16x32_bf16 v[36:39], a[196:199], v[52:55], v[36:39]
  v_mul_f32 v68, v68, v76
  v_mul_f32 v69, v69, v77
  v_mfma_f32_16x16x32_bf16 v[40:43], a[200:203], v[52:55], v[40:43]
  v_mul_f32 v70, v70, v78
  v_mul_f32 v71, v71, v79
  v_mfma_f32_16x16x32_bf16 v[44:47], a[204:207], v[52:55], v[44:47]
  v_rcp_f32 v72, v72
  s_waitcnt lgkmcnt(2)
  v_mfma_f32_16x16x32_bf16 v[32:35], a[208:211], v[56:59], v[32:35]
  ds_read_b128 v[52:55], v16 offset:16384
  v_mfma_f32_16x16x32_bf16 v[36:39], a[212:215], v[56:59], v[36:39]
  v_rcp_f32 v73, v73
  v_mfma_f32_16x16x32_bf16 v[40:43], a[216:219], v[56:59], v[40:43]
  v_rcp_f32 v74, v74
  v_mfma_f32_16x16x32_bf16 v[44:47], a[220:223], v[56:59], v[44:47]
  v_rcp_f32 v75, v75
  s_waitcnt lgkmcnt(2)
  v_mfma_f32_16x16x32_bf16 v[32:35], a[224:227], v[60:63], v[32:35]
  ds_read_b128 v[56:59], v16 offset:17408
  v_mul_f32 v68, v68, v4
  v_mfma_f32_16x16x32_bf16 v[36:39], a[228:231], v[60:63], v[36:39]
  v_mul_f32 v69, v69, v4
  v_mul_f32 v70, v70, v4
  v_mfma_f32_16x16x32_bf16 v[40:43], a[232:235], v[60:63], v[40:43]
  v_mul_f32 v71, v71, v4
  v_mul_f32 v68, v68, v72
  v_mfma_f32_16x16x32_bf16 v[44:47], a[236:239], v[60:63], v[44:47]
  v_mul_f32 v69, v69, v73
  v_mul_f32 v70, v70, v74
  s_waitcnt lgkmcnt(2)
  v_mfma_f32_16x16x32_bf16 v[32:35], a[240:243], v[64:67], v[32:35]
  v_mul_f32 v71, v71, v75
  v_mfma_f32_16x16x32_bf16 v[36:39], a[244:247], v[64:67], v[36:39]
  v_cvt_pk_bf16_f32 v84, v68, v69
  v_cvt_pk_bf16_f32 v85, v70, v71
  v_mfma_f32_16x16x32_bf16 v[40:43], a[248:251], v[64:67], v[40:43]
  v_mfma_f32_16x16x32_bf16 v[44:47], a[252:255], v[64:67], v[44:47]
  s_waitcnt lgkmcnt(1)
  v_mfma_f32_16x16x32_bf16 v[32:35], v[188:191], v[52:55], v[32:35]
  v_mfma_f32_16x16x32_bf16 v[36:39], v[192:195], v[52:55], v[36:39]
  v_mfma_f32_16x16x32_bf16 v[40:43], v[196:199], v[52:55], v[40:43]
  v_mfma_f32_16x16x32_bf16 v[44:47], v[200:203], v[52:55], v[44:47]
  s_waitcnt lgkmcnt(0)
  v_mfma_f32_16x16x32_bf16 v[32:35], v[204:207], v[56:59], v[32:35]
  v_mfma_f32_16x16x32_bf16 v[36:39], v[208:211], v[56:59], v[36:39]
  v_mfma_f32_16x16x32_bf16 v[40:43], v[212:215], v[56:59], v[40:43]
  v_mfma_f32_16x16x32_bf16 v[44:47], v[216:219], v[56:59], v[44:47]
  s_cmp_eq_u32 s67, 0
  s_cbranch_scc1 F_nl
  s_add_u32 s46, s62, 0
  buffer_load_dwordx4 v[52:55], v12, s[4:7], s46 offen sc1
  s_add_u32 s46, s62, 74752
  buffer_load_dwordx4 v[56:59], v12, s[4:7], s46 offen sc1
  s_add_u32 s46, s62, 149504
  buffer_load_dwordx4 v[60:63], v12, s[4:7], s46 offen sc1
  s_add_u32 s46, s62, 224256
  buffer_load_dwordx4 v[64:67], v12, s[4:7], s46 offen sc1
  s_add_u32 s46, s62, 299008
  buffer_load_dwordx4 v[68:71], v12, s[4:7], s46 offen sc1
  s_add_u32 s46, s62, 373760
  buffer_load_dwordx4 v[72:75], v12, s[4:7], s46 offen sc1
  s_add_u32 s46, s62, 448512
  buffer_load_dwordx4 v[76:79], v12, s[4:7], s46 offen sc1
  s_add_u32 s46, s62, 523264
  buffer_load_dwordx4 v[80:83], v12, s[4:7], s46 offen sc1
F_nl:
  v_pk_fma_f32 v[32:33], v[2:3], v[102:103], v[32:33] op_sel_hi:[0,1,1]
  v_pk_fma_f32 v[34:35], v[2:3], v[104:105], v[34:35] op_sel_hi:[0,1,1]
  v_pk_fma_f32 v[36:37], v[2:3], v[106:107], v[36:37] op_sel_hi:[0,1,1]
  v_pk_fma_f32 v[38:39], v[2:3], v[108:109], v[38:39] op_sel_hi:[0,1,1]
  v_pk_fma_f32 v[40:41], v[2:3], v[110:111], v[40:41] op_sel_hi:[0,1,1]
  v_pk_fma_f32 v[42:43], v[2:3], v[112:113], v[42:43] op_sel_hi:[0,1,1]
  v_pk_fma_f32 v[44:45], v[2:3], v[114:115], v[44:45] op_sel_hi:[0,1,1]
  v_pk_fma_f32 v[46:47], v[2:3], v[116:117], v[46:47] op_sel_hi:[0,1,1]
  v_pk_mul_f32 v[86:87], v[32:33], v[2:3] op_sel:[0,1] op_sel_hi:[1,1]
  v_pk_mul_f32 v[88:89], v[34:35], v[2:3] op_sel:[0,1] op_sel_hi:[1,1]
  v_pk_mul_f32 v[90:91], v[36:37], v[2:3] op_sel:[0,1] op_sel_hi:[1,1]
  v_pk_mul_f32 v[92:93], v[38:39], v[2:3] op_sel:[0,1] op_sel_hi:[1,1]
  v_exp_f32 v86, v86
  v_exp_f32 v87, v87
  v_pk_mul_f32 v[32:33], v[32:33], v[40:41]
  v_exp_f32 v88, v88
  v_exp_f32 v89, v89
  v_pk_mul_f32 v[34:35], v[34:35], v[42:43]
  v_exp_f32 v90, v90
  v_exp_f32 v91, v91
  v_pk_mul_f32 v[36:37], v[36:37], v[44:45]
  v_exp_f32 v92, v92
  v_exp_f32 v93, v93
  v_pk_mul_f32 v[38:39], v[38:39], v[46:47]
  v_pk_add_f32 v[86:87], v[86:87], 1.0 op_sel_hi:[1,0]
  v_pk_add_f32 v[88:89], v[88:89], 1.0 op_sel_hi:[1,0]
  v_pk_add_f32 v[90:91], v[90:91], 1.0 op_sel_hi:[1,0]
  v_pk_add_f32 v[92:93], v[92:93], 1.0 op_sel_hi:[1,0]
  v_rcp_f32 v86, v86
  v_rcp_f32 v87, v87
  v_pk_mul_f32 v[32:33], v[32:33], v[4:5] op_sel_hi:[1,0]
  v_rcp_f32 v88, v88
  v_rcp_f32 v89, v89
  v_pk_mul_f32 v[34:35], v[34:35], v[4:5] op_sel_hi:[1,0]
  v_rcp_f32 v90, v90
  v_rcp_f32 v91, v91
  v_pk_mul_f32 v[36:37], v[36:37], v[4:5] op_sel_hi:[1,0]
  v_rcp_f32 v92, v92
  v_rcp_f32 v93, v93
  v_pk_mul_f32 v[38:39], v[38:39], v[4:5] op_sel_hi:[1,0]
  v_pk_mul_f32 v[32:33], v[32:33], v[86:87]
  v_pk_mul_f32 v[34:35], v[34:35], v[88:89]
  v_pk_mul_f32 v[36:37], v[36:37], v[90:91]
  v_pk_mul_f32 v[38:39], v[38:39], v[92:93]
  v_cvt_pk_bf16_f32 v32, v32, v33
  v_cvt_pk_bf16_f32 v33, v34, v35
  v_cvt_pk_bf16_f32 v34, v36, v37
  v_cvt_pk_bf16_f32 v35, v38, v39
  ds_write_b128 v19, v[32:35] offset:18432
  ds_read_b128 v[86:89], v14 offset:0
  ds_read_b128 v[90:93], v14 offset:4096
  ds_read_b128 v[94:97], v14 offset:1024
  ds_read_b128 v[98:101], v14 offset:5120
  s_cmp_eq_u32 s67, 0
  s_cbranch_scc1 F_nr
F_rs:
  s_waitcnt vmcnt(7)
  v_mfma_f32_16x16x32_bf16 v[28:31], v[24:27], v[52:55], 0
  v_bitop3_b32 v7, v52, v53, s65 bitop3:0x7e
  v_bitop3_b32 v8, v54, v55, s65 bitop3:0x7e
  v_or_b32 v17, v7, v8
  s_waitcnt vmcnt(6)
  v_mfma_f32_16x16x32_bf16 v[28:31], v[24:27], v[56:59], v[28:31]
  v_bitop3_b32 v7, v56, v57, s65 bitop3:0x7e
  v_bitop3_b32 v8, v58, v59, s65 bitop3:0x7e
  v_or3_b32 v17, v17, v7, v8
  s_waitcnt vmcnt(5)
  v_mfma_f32_16x16x32_bf16 v[28:31], v[24:27], v[60:63], v[28:31]
  v_bitop3_b32 v7, v60, v61, s65 bitop3:0x7e
  v_bitop3_b32 v8, v62, v63, s65 bitop3:0x7e
  v_or3_b32 v17, v17, v7, v8
  s_waitcnt vmcnt(4)
  v_mfma_f32_16x16x32_bf16 v[28:31], v[24:27], v[64:67], v[28:31]
  v_bitop3_b32 v7, v64, v65, s65 bitop3:0x7e
  v_bitop3_b32 v8, v66, v67, s65 bitop3:0x7e
  v_or3_b32 v17, v17, v7, v8
  s_waitcnt vmcnt(3)
  v_mfma_f32_16x16x32_bf16 v[28:31], v[24:27], v[68:71], v[28:31]
  v_bitop3_b32 v7, v68, v69, s65 bitop3:0x7e
  v_bitop3_b32 v8, v70, v71, s65 bitop3:0x7e
  v_or3_b32 v17, v17, v7, v8
  s_waitcnt vmcnt(2)
  v_mfma_f32_16x16x32_bf16 v[28:31], v[24:27], v[72:75], v[28:31]
  v_bitop3_b32 v7, v72, v73, s65 bitop3:0x7e
  v_bitop3_b32 v8, v74, v75, s65 bitop3:0x7e
  v_or3_b32 v17, v17, v7, v8
  s_waitcnt vmcnt(1)
  v_mfma_f32_16x16x32_bf16 v[28:31], v[24:27], v[76:79], v[28:31]
  v_bitop3_b32 v7, v76, v77, s65 bitop3:0x7e
  v_bitop3_b32 v8, v78, v79, s65 bitop3:0x7e
  v_or3_b32 v17, v17, v7, v8
  s_waitcnt vmcnt(0)
  v_mfma_f32_16x16x32_bf16 v[28:31], v[24:27], v[80:83], v[28:31]
  v_bitop3_b32 v7, v80, v81, s65 bitop3:0x7e
  v_bitop3_b32 v8, v82, v83, s65 bitop3:0x7e
  v_or3_b32 v17, v17, v7, v8
  v_and_b32 v17, 1, v17
  v_cmp_ne_u32 vcc, 0, v17
  s_cbranch_vccnz F_ra
  s_nop 1
  v_cvt_pk_bf16_f32 v28, v28, v29
  v_cvt_pk_bf16_f32 v29, v30, v31
  v_lshlrev_b32 v52, 16, v28
  v_and_b32 v53, 0xffff0000, v28
  v_lshlrev_b32 v54, 16, v22
  v_and_b32 v55, 0xffff0000, v22
  v_pk_add_f32 v[52:53], v[52:53], v[54:55]
  v_cvt_pk_bf16_f32 v28, v52, v53
  v_lshlrev_b32 v52, 16, v29
  v_and_b32 v53, 0xffff0000, v29
  v_lshlrev_b32 v54, 16, v23
  v_and_b32 v55, 0xffff0000, v23
  v_pk_add_f32 v[52:53], v[52:53], v[54:55]
  v_cvt_pk_bf16_f32 v29, v52, v53
  v_permlane16_swap_b32 v28, v30
  s_nop 0
  v_permlane16_swap_b32 v29, v31
  buffer_store_dwordx4 v[28:31], v10, s[8:11], s56 offen
  s_add_u32 s56, s56, s72
  s_xor_b32 s62, s62, 2097152
  s_mov_b32 s67, 0
F_nr:
  s_waitcnt lgkmcnt(4)
  s_barrier
  ds_read_b128 v[68:71], v1 offset:18432
  ds_read_b128 v[72:75], v1 offset:19456
  ds_read_b128 v[76:79], v1 offset:20480
  ds_read_b128 v[80:83], v1 offset:21504
  ds_read_b64 v[22:23], v13
  v_mfma_f32_16x16x16_bf16 v[32:35], v[170:171], v[84:85], 0
  v_mfma_f32_16x16x16_bf16 v[36:39], v[172:173], v[84:85], 0
  s_cmp_lt_u32 s44, 2
  s_cbranch_scc0 Fd_237
  s_add_u32 m0, s69, 16384
  s_add_u32 s46, s52, 16384
  buffer_load_dwordx4 v1, s[4:7], s46 offen sc1 lds
Fd_237:
  v_mfma_f32_16x16x16_bf16 v[40:43], v[174:175], v[84:85], 0
  v_mfma_f32_16x16x16_bf16 v[44:47], v[176:177], v[84:85], 0
  v_mfma_f32_16x16x16_bf16 v[48:51], v[178:179], v[84:85], 0
  v_mfma_f32_16x16x16_bf16 v[52:55], v[180:181], v[84:85], 0
  v_mfma_f32_16x16x16_bf16 v[56:59], v[182:183], v[84:85], 0
  s_add_u32 m0, s69, 0
  s_add_u32 s46, s52, 0
  buffer_load_dwordx4 v1, s[4:7], s46 offen sc1 lds
  v_mfma_f32_16x16x16_bf16 v[60:63], v[184:185], v[84:85], 0
  v_mfma_f32_16x16x16_bf16 v[64:67], v[186:187], v[84:85], 0
  s_waitcnt lgkmcnt(4)
  v_mfma_f32_16x16x32_bf16 v[32:35], v[122:125], v[68:71], v[32:35]
  s_add_u32 m0, s69, 4096
  s_add_u32 s46, s52, 4096
  buffer_load_dwordx4 v1, s[4:7], s46 offen sc1 lds
  v_mfma_f32_16x16x32_bf16 v[36:39], v[86:89], v[68:71], v[36:39]
  ds_read_b128 v[86:89], v14 offset:2048
  v_mfma_f32_16x16x32_bf16 v[40:43], v[90:93], v[68:71], v[40:43]
  ds_read_b128 v[90:93], v14 offset:6144
  s_waitcnt lgkmcnt(5)
  v_mfma_f32_16x16x32_bf16 v[32:35], v[126:129], v[72:75], v[32:35]
  s_add_u32 m0, s69, 8192
  s_add_u32 s46, s52, 8192
  buffer_load_dwordx4 v1, s[4:7], s46 offen sc1 lds
  v_xor_b32 v16, 131072, v16
  v_xor_b32 v20, 131072, v20
  v_xor_b32 v13, 131072, v13
  v_mfma_f32_16x16x32_bf16 v[36:39], v[94:97], v[72:75], v[36:39]
  ds_read_b128 v[94:97], v14 offset:3072
  v_mfma_f32_16x16x32_bf16 v[40:43], v[98:101], v[72:75], v[40:43]
  ds_read_b128 v[98:101], v14 offset:7168
  s_waitcnt lgkmcnt(6)
  v_mfma_f32_16x16x32_bf16 v[32:35], v[130:133], v[76:79], v[32:35]
  s_add_u32 m0, s69, 12288
  s_add_u32 s46, s52, 12288
  buffer_load_dwordx4 v1, s[4:7], s46 offen sc1 lds
  s_waitcnt lgkmcnt(3)
  v_mfma_f32_16x16x32_bf16 v[36:39], v[86:89], v[76:79], v[36:39]
  ds_read_b128 v[86:89], v14 offset:8192
  s_waitcnt lgkmcnt(3)
  v_mfma_f32_16x16x32_bf16 v[40:43], v[90:93], v[76:79], v[40:43]
  ds_read_b128 v[90:93], v14 offset:12288
  v_mfma_f32_16x16x32_bf16 v[32:35], v[134:137], v[80:83], v[32:35]
  s_waitcnt lgkmcnt(3)
  v_mfma_f32_16x16x32_bf16 v[36:39], v[94:97], v[80:83], v[36:39]
  ds_read_b128 v[94:97], v14 offset:9216
  s_waitcnt lgkmcnt(3)
  v_mfma_f32_16x16x32_bf16 v[40:43], v[98:101], v[80:83], v[40:43]
  ds_read_b128 v[98:101], v14 offset:13312
  v_mfma_f32_16x16x32_bf16 v[44:47], v[138:141], v[68:71], v[44:47]
  s_waitcnt lgkmcnt(3)
  v_mfma_f32_16x16x32_bf16 v[48:51], v[86:89], v[68:71], v[48:51]
  ds_read_b128 v[86:89], v14 offset:10240
  s_waitcnt lgkmcnt(3)
  v_mfma_f32_16x16x32_bf16 v[52:55], v[90:93], v[68:71], v[52:55]
  ds_read_b128 v[90:93], v14 offset:14336
  v_mfma_f32_16x16x32_bf16 v[44:47], v[142:145], v[72:75], v[44:47]
  v_cvt_pk_bf16_f32 v32, v32, v33
  v_cvt_pk_bf16_f32 v33, v34, v35
  v_cvt_pk_bf16_f32 v34, v36, v37
  s_waitcnt lgkmcnt(3)
  v_mfma_f32_16x16x32_bf16 v[48:51], v[94:97], v[72:75], v[48:51]
  ds_read_b128 v[94:97], v14 offset:11264
  v_cvt_pk_bf16_f32 v35, v38, v39
  v_bfi_b32 v32, 1, s64, v32
  s_waitcnt lgkmcnt(3)
  v_mfma_f32_16x16x32_bf16 v[52:55], v[98:101], v[72:75], v[52:55]
  ds_read_b128 v[98:101], v14 offset:15360
  v_bfi_b32 v33, 1, s64, v33
  v_bfi_b32 v34, 1, s64, v34
  v_mfma_f32_16x16x32_bf16 v[44:47], v[146:149], v[76:79], v[44:47]
  v_bfi_b32 v35, 1, s64, v35
  buffer_store_dwordx4 v[32:35], v1, s[4:7], s61 offen offset:0
  s_waitcnt lgkmcnt(3)
  v_mfma_f32_16x16x32_bf16 v[48:51], v[86:89], v[76:79], v[48:51]
  ds_read_b128 v[86:89], v14 offset:16384
  s_waitcnt lgkmcnt(3)
  v_mfma_f32_16x16x32_bf16 v[52:55], v[90:93], v[76:79], v[52:55]
  ds_read_b128 v[90:93], v14 offset:20480
  v_mfma_f32_16x16x32_bf16 v[44:47], v[150:153], v[80:83], v[44:47]
  s_waitcnt lgkmcnt(3)
  v_mfma_f32_16x16x32_bf16 v[48:51], v[94:97], v[80:83], v[48:51]
  ds_read_b128 v[94:97], v14 offset:17408
  s_waitcnt lgkmcnt(3)
  v_mfma_f32_16x16x32_bf16 v[52:55], v[98:101], v[80:83], v[52:55]
  ds_read_b128 v[98:101], v14 offset:21504
  v_mfma_f32_16x16x32_bf16 v[56:59], v[154:157], v[68:71], v[56:59]
  s_waitcnt lgkmcnt(3)
  v_mfma_f32_16x16x32_bf16 v[60:63], v[86:89], v[68:71], v[60:63]
  ds_read_b128 v[86:89], v14 offset:18432
  s_waitcnt lgkmcnt(3)
  v_mfma_f32_16x16x32_bf16 v[64:67], v[90:93], v[68:71], v[64:67]
  ds_read_b128 v[90:93], v14 offset:22528
  v_mfma_f32_16x16x32_bf16 v[56:59], v[158:161], v[72:75], v[56:59]
  v_cvt_pk_bf16_f32 v40, v40, v41
  v_cvt_pk_bf16_f32 v41, v42, v43
  v_cvt_pk_bf16_f32 v42, v44, v45
  s_waitcnt lgkmcnt(3)
  v_mfma_f32_16x16x32_bf16 v[60:63], v[94:97], v[72:75], v[60:63]
  ds_read_b128 v[94:97], v14 offset:19456
  v_cvt_pk_bf16_f32 v43, v46, v47
  v_bfi_b32 v40, 1, s64, v40
  s_waitcnt lgkmcnt(3)
  v_mfma_f32_16x16x32_bf16 v[64:67], v[98:101], v[72:75], v[64:67]
  ds_read_b128 v[98:101], v14 offset:23552
  v_bfi_b32 v41, 1, s64, v41
  v_bfi_b32 v42, 1, s64, v42
  v_mfma_f32_16x16x32_bf16 v[56:59], v[162:165], v[76:79], v[56:59]
  v_bfi_b32 v43, 1, s64, v43
  buffer_store_dwordx4 v[40:43], v1, s[4:7], s61 offen offset:1024
  v_cvt_pk_bf16_f32 v48, v48, v49
  s_waitcnt lgkmcnt(3)
  v_mfma_f32_16x16x32_bf16 v[60:63], v[86:89], v[76:79], v[60:63]
  v_cvt_pk_bf16_f32 v49, v50, v51
  v_cvt_pk_bf16_f32 v50, v52, v53
  s_waitcnt lgkmcnt(2)
  v_mfma_f32_16x16x32_bf16 v[64:67], v[90:93], v[76:79], v[64:67]
  v_cvt_pk_bf16_f32 v51, v54, v55
  v_bfi_b32 v48, 1, s64, v48
  v_mfma_f32_16x16x32_bf16 v[56:59], v[166:169], v[80:83], v[56:59]
  v_bfi_b32 v49, 1, s64, v49
  v_bfi_b32 v50, 1, s64, v50
  v_bfi_b32 v51, 1, s64, v51
  s_waitcnt lgkmcnt(1)
  v_mfma_f32_16x16x32_bf16 v[60:63], v[94:97], v[80:83], v[60:63]
  buffer_store_dwordx4 v[48:51], v1, s[4:7], s61 offen offset:2048
  s_waitcnt lgkmcnt(0)
  v_mfma_f32_16x16x32_bf16 v[64:67], v[98:101], v[80:83], v[64:67]
  v_cvt_pk_bf16_f32 v56, v56, v57
  v_cvt_pk_bf16_f32 v57, v58, v59
  s_nop 1
  v_cvt_pk_bf16_f32 v58, v60, v61
  v_cvt_pk_bf16_f32 v59, v62, v63
  v_bfi_b32 v56, 1, s64, v56
  v_bfi_b32 v57, 1, s64, v57
  v_bfi_b32 v58, 1, s64, v58
  v_bfi_b32 v59, 1, s64, v59
  buffer_store_dwordx4 v[56:59], v1, s[4:7], s61 offen offset:3072
  v_cvt_pk_bf16_f32 v64, v64, v65
  v_cvt_pk_bf16_f32 v65, v66, v67
  v_bfi_b32 v64, 1, s64, v64
  v_bfi_b32 v65, 1, s64, v65
  buffer_store_dwordx2 v[64:65], v11, s[4:7], s61 offen
  s_xor_b32 s61, s61, 2097152
  s_mov_b32 s65, s64
  s_add_u32 s66, s66, 1
  s_lshr_b32 s64, s66, 1
  s_cmp_lt_u32 s63, 72
  s_cselect_b32 s67, 1, 0
  s_mov_b32 s72, s71
  s_cmp_lt_u32 s51, 128
  s_cbranch_scc0 F_wait
  s_waitcnt vmcnt(5)
  s_branch F_loop
F_wait:
  s_cmp_eq_u32 s67, 0
  s_cbranch_scc1 F_w2
  s_add_u32 s46, s62, 0
  buffer_load_dwordx4 v[52:55], v12, s[4:7], s46 offen sc1
  s_add_u32 s46, s62, 74752
  buffer_load_dwordx4 v[56:59], v12, s[4:7], s46 offen sc1
  s_add_u32 s46, s62, 149504
  buffer_load_dwordx4 v[60:63], v12, s[4:7], s46 offen sc1
  s_add_u32 s46, s62, 224256
  buffer_load_dwordx4 v[64:67], v12, s[4:7], s46 offen sc1
  s_add_u32 s46, s62, 299008
  buffer_load_dwordx4 v[68:71], v12, s[4:7], s46 offen sc1
  s_add_u32 s46, s62, 373760
  buffer_load_dwordx4 v[72:75], v12, s[4:7], s46 offen sc1
  s_add_u32 s46, s62, 448512
  buffer_load_dwordx4 v[76:79], v12, s[4:7], s46 offen sc1
  s_add_u32 s46, s62, 523264
  buffer_load_dwordx4 v[80:83], v12, s[4:7], s46 offen sc1
  s_cmp_lt_u32 s44, 2
  s_cbranch_scc0 Fv_239
  s_add_u32 m0, s69, 16384
  s_add_u32 s46, s52, 16384
  buffer_load_dwordx4 v1, s[4:7], s46 offen sc1 lds
Fv_239:
  s_add_u32 m0, s69, 0
  s_add_u32 s46, s52, 0
  buffer_load_dwordx4 v1, s[4:7], s46 offen sc1 lds
  s_add_u32 m0, s69, 4096
  s_add_u32 s46, s52, 4096
  buffer_load_dwordx4 v1, s[4:7], s46 offen sc1 lds
  s_add_u32 m0, s69, 8192
  s_add_u32 s46, s52, 8192
  buffer_load_dwordx4 v1, s[4:7], s46 offen sc1 lds
  s_add_u32 m0, s69, 12288
  s_add_u32 s46, s52, 12288
  buffer_load_dwordx4 v1, s[4:7], s46 offen sc1 lds
  s_waitcnt vmcnt(4)
F_w1:
  v_mfma_f32_16x16x32_bf16 v[28:31], v[24:27], v[52:55], 0
  v_bitop3_b32 v7, v52, v53, s65 bitop3:0x7e
  v_bitop3_b32 v8, v54, v55, s65 bitop3:0x7e
  v_bitop3_b32 v7, v7, v8, 1 bitop3:0xa8
  v_cmp_ne_u32 s[16:17], 0, v7
  v_mfma_f32_16x16x32_bf16 v[28:31], v[24:27], v[56:59], v[28:31]
  v_bitop3_b32 v7, v56, v57, s65 bitop3:0x7e
  v_bitop3_b32 v8, v58, v59, s65 bitop3:0x7e
  v_bitop3_b32 v7, v7, v8, 1 bitop3:0xa8
  v_cmp_ne_u32 s[18:19], 0, v7
  v_mfma_f32_16x16x32_bf16 v[28:31], v[24:27], v[60:63], v[28:31]
  v_bitop3_b32 v7, v60, v61, s65 bitop3:0x7e
  v_bitop3_b32 v8, v62, v63, s65 bitop3:0x7e
  s_or_b64 s[36:37], s[18:19], s[16:17]
  v_bitop3_b32 v7, v7, v8, 1 bitop3:0xa8
  v_cmp_ne_u32 s[20:21], 0, v7
  v_mfma_f32_16x16x32_bf16 v[28:31], v[24:27], v[64:67], v[28:31]
  v_bitop3_b32 v7, v64, v65, s65 bitop3:0x7e
  v_bitop3_b32 v8, v66, v67, s65 bitop3:0x7e
  s_or_b64 s[36:37], s[20:21], s[36:37]
  v_bitop3_b32 v7, v7, v8, 1 bitop3:0xa8
  v_cmp_ne_u32 s[22:23], 0, v7
  v_mfma_f32_16x16x32_bf16 v[28:31], v[24:27], v[68:71], v[28:31]
  v_bitop3_b32 v7, v68, v69, s65 bitop3:0x7e
  v_bitop3_b32 v8, v70, v71, s65 bitop3:0x7e
  s_or_b64 s[36:37], s[22:23], s[36:37]
  v_bitop3_b32 v7, v7, v8, 1 bitop3:0xa8
  v_cmp_ne_u32 s[24:25], 0, v7
  v_mfma_f32_16x16x32_bf16 v[28:31], v[24:27], v[72:75], v[28:31]
  v_bitop3_b32 v7, v72, v73, s65 bitop3:0x7e
  v_bitop3_b32 v8, v74, v75, s65 bitop3:0x7e
  s_or_b64 s[36:37], s[24:25], s[36:37]
  v_bitop3_b32 v7, v7, v8, 1 bitop3:0xa8
  v_cmp_ne_u32 s[26:27], 0, v7
  v_mfma_f32_16x16x32_bf16 v[28:31], v[24:27], v[76:79], v[28:31]
  v_bitop3_b32 v7, v76, v77, s65 bitop3:0x7e
  v_bitop3_b32 v8, v78, v79, s65 bitop3:0x7e
  s_or_b64 s[36:37], s[26:27], s[36:37]
  v_bitop3_b32 v7, v7, v8, 1 bitop3:0xa8
  v_cmp_ne_u32 s[32:33], 0, v7
  v_mfma_f32_16x16x32_bf16 v[28:31], v[24:27], v[80:83], v[28:31]
  v_bitop3_b32 v7, v80, v81, s65 bitop3:0x7e
  v_bitop3_b32 v8, v82, v83, s65 bitop3:0x7e
  s_or_b64 s[36:37], s[32:33], s[36:37]
  v_bitop3_b32 v7, v7, v8, 1 bitop3:0xa8
  v_cmp_ne_u32 s[34:35], 0, v7
  s_or_b64 s[36:37], s[36:37], s[34:35]
  s_cbranch_scc1 F_wa
  s_nop 0
  v_cvt_pk_bf16_f32 v28, v28, v29
  v_cvt_pk_bf16_f32 v29, v30, v31
  v_lshlrev_b32 v52, 16, v28
  v_and_b32 v53, 0xffff0000, v28
  v_lshlrev_b32 v54, 16, v22
  v_and_b32 v55, 0xffff0000, v22
  v_pk_add_f32 v[52:53], v[52:53], v[54:55]
  v_cvt_pk_bf16_f32 v28, v52, v53
  v_lshlrev_b32 v52, 16, v29
  v_and_b32 v53, 0xffff0000, v29
  v_lshlrev_b32 v54, 16, v23
  v_and_b32 v55, 0xffff0000, v23
  v_pk_add_f32 v[52:53], v[52:53], v[54:55]
  v_cvt_pk_bf16_f32 v29, v52, v53
  v_permlane16_swap_b32 v28, v30
  s_nop 0
  v_permlane16_swap_b32 v29, v31
  buffer_store_dwordx4 v[28:31], v10, s[8:11], s56 offen
  s_add_u32 s56, s56, s72
  s_xor_b32 s62, s62, 2097152
  s_mov_b32 s67, 0
  s_cmp_lt_u32 s51, 128
  s_cbranch_scc0 K_end
  s_waitcnt vmcnt(1)
  s_branch F_loop
F_w2:
  s_cmp_lt_u32 s51, 128
  s_cbranch_scc0 K_end
  s_cmp_lt_u32 s44, 2
  s_cbranch_scc0 Fw_240
  s_add_u32 m0, s69, 16384
  s_add_u32 s46, s52, 16384
  buffer_load_dwordx4 v1, s[4:7], s46 offen sc1 lds
Fw_240:
  s_add_u32 m0, s69, 0
  s_add_u32 s46, s52, 0
  buffer_load_dwordx4 v1, s[4:7], s46 offen sc1 lds
  s_add_u32 m0, s69, 4096
  s_add_u32 s46, s52, 4096
  buffer_load_dwordx4 v1, s[4:7], s46 offen sc1 lds
  s_add_u32 m0, s69, 8192
  s_add_u32 s46, s52, 8192
  buffer_load_dwordx4 v1, s[4:7], s46 offen sc1 lds
  s_add_u32 m0, s69, 12288
  s_add_u32 s46, s52, 12288
  buffer_load_dwordx4 v1, s[4:7], s46 offen sc1 lds
  s_sub_u32 s50, s50, 1
  s_cbranch_scc1 K_end
  s_waitcnt vmcnt(0)
  s_branch F_loop
F_ra:
  s_add_u32 s46, s62, 0
  buffer_load_dwordx4 v[52:55], v12, s[4:7], s46 offen sc1
  s_add_u32 s46, s62, 74752
  buffer_load_dwordx4 v[56:59], v12, s[4:7], s46 offen sc1
  s_add_u32 s46, s62, 149504
  buffer_load_dwordx4 v[60:63], v12, s[4:7], s46 offen sc1
  s_add_u32 s46, s62, 224256
  buffer_load_dwordx4 v[64:67], v12, s[4:7], s46 offen sc1
  s_add_u32 s46, s62, 299008
  buffer_load_dwordx4 v[68:71], v12, s[4:7], s46 offen sc1
  s_add_u32 s46, s62, 373760
  buffer_load_dwordx4 v[72:75], v12, s[4:7], s46 offen sc1
  s_add_u32 s46, s62, 448512
  buffer_load_dwordx4 v[76:79], v12, s[4:7], s46 offen sc1
  s_add_u32 s46, s62, 523264
  buffer_load_dwordx4 v[80:83], v12, s[4:7], s46 offen sc1
  s_sub_u32 s50, s50, 1
  s_cbranch_scc1 K_end
  s_waitcnt vmcnt(0)
  s_branch F_rs
F_wa:
  s_cmp_lg_u64 s[16:17], 0
  s_cbranch_scc0 F_wa_0
  s_add_u32 s46, s62, 0
  buffer_load_dwordx4 v[52:55], v12, s[4:7], s46 offen sc1
F_wa_0:
  s_cmp_lg_u64 s[18:19], 0
  s_cbranch_scc0 F_wa_1
  s_add_u32 s46, s62, 74752
  buffer_load_dwordx4 v[56:59], v12, s[4:7], s46 offen sc1
F_wa_1:
  s_cmp_lg_u64 s[20:21], 0
  s_cbranch_scc0 F_wa_2
  s_add_u32 s46, s62, 149504
  buffer_load_dwordx4 v[60:63], v12, s[4:7], s46 offen sc1
F_wa_2:
  s_cmp_lg_u64 s[22:23], 0
  s_cbranch_scc0 F_wa_3
  s_add_u32 s46, s62, 224256
  buffer_load_dwordx4 v[64:67], v12, s[4:7], s46 offen sc1
F_wa_3:
  s_cmp_lg_u64 s[24:25], 0
  s_cbranch_scc0 F_wa_4
  s_add_u32 s46, s62, 299008
  buffer_load_dwordx4 v[68:71], v12, s[4:7], s46 offen sc1
F_wa_4:
  s_cmp_lg_u64 s[26:27], 0
  s_cbranch_scc0 F_wa_5
  s_add_u32 s46, s62, 373760
  buffer_load_dwordx4 v[72:75], v12, s[4:7], s46 offen sc1
F_wa_5:
  s_cmp_lg_u64 s[32:33], 0
  s_cbranch_scc0 F_wa_6
  s_add_u32 s46, s62, 448512
  buffer_load_dwordx4 v[76:79], v12, s[4:7], s46 offen sc1
F_wa_6:
  s_cmp_lg_u64 s[34:35], 0
  s_cbranch_scc0 F_wa_7
  s_add_u32 s46, s62, 523264
  buffer_load_dwordx4 v[80:83], v12, s[4:7], s46 offen sc1
F_wa_7:
  s_sub_u32 s50, s50, 1
  s_cbranch_scc1 K_end
  s_waitcnt vmcnt(0)
  s_branch F_w1
FF_loop:
  ds_read_b128 v[86:89], v18 offset:0
  ds_read_b128 v[90:93], v18 offset:4096
  ds_read_b128 v[94:97], v18 offset:8192
  ds_read_b128 v[98:101], v18 offset:12288
  ds_read_b128 v[28:31], v9
  v_mov_b32 v32, s53
  v_mov_b32 v33, s53
  v_mov_b32 v34, s53
  v_mov_b32 v35, s53
  s_waitcnt lgkmcnt(4)
  v_max_u32 v17, v86, v87
  v_max3_u32 v17, v17, v88, v89
  s_waitcnt lgkmcnt(3)
  v_max3_u32 v17, v17, v90, v91
  v_max3_u32 v17, v17, v92, v93
  s_waitcnt lgkmcnt(2)
  v_max3_u32 v17, v17, v94, v95
  v_max3_u32 v17, v17, v96, v97
  s_waitcnt lgkmcnt(1)
  v_max3_u32 v17, v17, v98, v99
  v_max3_u32 v17, v17, v100, v101
  s_waitcnt lgkmcnt(0)
  v_max3_u32 v17, v17, v28, v29
  v_max3_u32 v17, v17, v30, v31
  v_cmp_eq_u32 vcc, -1, v17
  s_cbranch_vccnz FF_wait
  s_barrier
  ds_read_b128 v[68:71], v20 offset:0
  ds_read_b128 v[52:55], v16 offset:0
  v_mfma_f32_16x16x32_bf16 v[64:67], v[32:35], v[86:89], 0
  ds_read_b128 v[72:75], v20 offset:1024
  v_mfma_f32_16x16x32_bf16 v[86:89], v[86:89], v[86:89], 0
  ds_read_b128 v[76:79], v20 offset:2048
  v_mfma_f32_16x16x32_bf16 v[64:67], v[32:35], v[90:93], v[64:67]
  ds_read_b128 v[56:59], v16 offset:1024
  v_mfma_f32_16x16x32_bf16 v[86:89], v[90:93], v[90:93], v[86:89]
  ds_read_b128 v[80:83], v20 offset:3072
  v_mfma_f32_16x16x32_bf16 v[64:67], v[32:35], v[94:97], v[64:67]
  ds_read_b128 v[60:63], v16 offset:2048
  v_mfma_f32_16x16x32_bf16 v[86:89], v[94:97], v[94:97], v[86:89]
  v_xor_b32 v18, 131072, v18
  v_mfma_f32_16x16x32_bf16 v[64:67], v[32:35], v[98:101], v[64:67]
  v_xor_b32 v9, s68, v9
  v_mfma_f32_16x16x32_bf16 v[86:89], v[98:101], v[98:101], v[86:89]
  v_mfma_f32_16x16x32_bf16 v[64:67], v[32:35], v[28:31], v[64:67]
  v_mfma_f32_16x16x32_bf16 v[86:89], v[28:31], v[28:31], v[86:89]
  s_waitcnt lgkmcnt(6)
  v_mfma_f32_16x16x32_bf16 v[48:51], v[220:223], v[68:71], 0
  s_cmp_lt_u32 s51, 196
  s_cselect_b32 s71, 3, 4
  s_add_u32 s51, s51, s71
  s_mul_i32 s71, s71, 18432
  s_waitcnt lgkmcnt(5)
  v_mfma_f32_16x16x32_bf16 v[32:35], a[0:3], v[52:55], 0
  s_add_u32 s52, s52, s71
  s_cmp_lt_u32 s51, 128
  s_cselect_b32 s52, s52, 1073741824
  s_xor_b32 s69, s69, 131072
  v_mfma_f32_16x16x32_bf16 v[36:39], a[4:7], v[52:55], 0
  ds_read_b128 v[68:71], v20 offset:4096
  ds_write_b32 v15, v64
  s_waitcnt lgkmcnt(6)
  v_mfma_f32_16x16x32_bf16 v[48:51], v[224:227], v[72:75], v[48:51]
  ds_write_b128 v19, v[86:89] offset:18432
  v_mfma_f32_16x16x32_bf16 v[40:43], a[8:11], v[52:55], 0
  v_mfma_f32_16x16x32_bf16 v[44:47], a[12:15], v[52:55], 0
  ds_read_b128 v[72:75], v20 offset:5120
  ds_read_b128 v[64:67], v16 offset:3072
  s_waitcnt lgkmcnt(8)
  v_mfma_f32_16x16x32_bf16 v[48:51], v[228:231], v[76:79], v[48:51]
  s_waitcnt lgkmcnt(7)
  v_mfma_f32_16x16x32_bf16 v[32:35], a[16:19], v[56:59], v[32:35]
  ds_read_b128 v[52:55], v16 offset:4096
  v_mfma_f32_16x16x32_bf16 v[36:39], a[20:23], v[56:59], v[36:39]
  ds_read_b128 v[76:79], v20 offset:6144
  s_waitcnt lgkmcnt(4)
  s_barrier
  v_mfma_f32_16x16x32_bf16 v[48:51], v[232:235], v[80:83], v[48:51]
  ds_read_b128 v[86:89], v21
  v_mfma_f32_16x16x32_bf16 v[40:43], a[24:27], v[56:59], v[40:43]
  ds_read2st64_b32 v[90:91], v5 offset0:0 offset1:4
  v_mfma_f32_16x16x32_bf16 v[44:47], a[28:31], v[56:59], v[44:47]
  ds_read_b128 v[80:83], v20 offset:7168
  ds_read2st64_b32 v[92:93], v5 offset0:8 offset1:12
  v_mfma_f32_16x16x32_bf16 v[48:51], v[236:239], v[68:71], v[48:51]
  v_mfma_f32_16x16x32_bf16 v[32:35], a[32:35], v[60:63], v[32:35]
  ds_read_b128 v[56:59], v16 offset:5120
  v_mfma_f32_16x16x32_bf16 v[36:39], a[36:39], v[60:63], v[36:39]
  ds_read_b128 v[68:71], v20 offset:8192
  s_waitcnt lgkmcnt(9)
  v_mfma_f32_16x16x32_bf16 v[48:51], v[240:243], v[72:75], v[48:51]
  s_waitcnt lgkmcnt(5)
  v_add_f32 v86, v86, v87
  v_add_f32 v88, v88, v89
  v_mfma_f32_16x16x32_bf16 v[40:43], a[40:43], v[60:63], v[40:43]
  s_waitcnt lgkmcnt(4)
  v_add_f32 v90, v90, v91
  s_waitcnt lgkmcnt(2)
  v_add_f32 v92, v92, v93
  v_mfma_f32_16x16x32_bf16 v[44:47], a[44:47], v[60:63], v[44:47]
  v_add_f32 v2, v86, v88
  v_add_f32 v3, v90, v92
  v_mfma_f32_16x16x32_bf16 v[48:51], v[244:247], v[76:79], v[48:51]
  v_mul_f32 v2, 0xbae38e39, v2
  v_mul_f32 v3, 0x3ae38e39, v3
  v_mfma_f32_16x16x32_bf16 v[32:35], a[48:51], v[64:67], v[32:35]
  ds_read_b128 v[60:63], v16 offset:6144
  v_fma_f32 v3, -v2, v2, v3
  v_mfma_f32_16x16x32_bf16 v[36:39], a[52:55], v[64:67], v[36:39]
  v_cvt_pk_bf16_f32 v2, v2, v2
  v_mfma_f32_16x16x32_bf16 v[48:51], v[248:251], v[80:83], v[48:51]
  v_lshlrev_b32 v2, 16, v2
  v_mfma_f32_16x16x32_bf16 v[40:43], a[56:59], v[64:67], v[40:43]
  v_max_f32 v3, 0, v3
  v_mfma_f32_16x16x32_bf16 v[44:47], a[60:63], v[64:67], v[44:47]
  v_cvt_pk_bf16_f32 v3, v3, v3
  s_waitcnt lgkmcnt(1)
  v_mfma_f32_16x16x32_bf16 v[48:51], v[252:255], v[68:71], v[48:51]
  v_lshlrev_b32 v3, 16, v3
  v_mfma_f32_16x16x32_bf16 v[32:35], a[64:67], v[52:55], v[32:35]
  ds_read_b128 v[64:67], v16 offset:7168
  v_mfma_f32_16x16x32_bf16 v[36:39], a[68:71], v[52:55], v[36:39]
  v_mfma_f32_16x16x32_bf16 v[40:43], a[72:75], v[52:55], v[40:43]
  v_fma_f32 v48, v2, v118, v48
  v_fma_f32 v49, v2, v119, v49
  v_mfma_f32_16x16x32_bf16 v[44:47], a[76:79], v[52:55], v[44:47]
  v_fma_f32 v50, v2, v120, v50
  v_fma_f32 v51, v2, v121, v51
  v_mfma_f32_16x16x32_bf16 v[32:35], a[80:83], v[56:59], v[32:35]
  ds_read_b128 v[52:55], v16 offset:8192
  v_mfma_f32_16x16x32_bf16 v[36:39], a[84:87], v[56:59], v[36:39]
  ds_write_b128 v19, v[48:51] offset:22528
  v_mfma_f32_16x16x32_bf16 v[40:43], a[88:91], v[56:59], v[40:43]
  v_add_f32 v3, 0x3727c5ac, v3
  v_mfma_f32_16x16x32_bf16 v[44:47], a[92:95], v[56:59], v[44:47]
  v_cvt_pk_bf16_f32 v3, v3, v3
  s_waitcnt lgkmcnt(3)
  v_mfma_f32_16x16x32_bf16 v[32:35], a[96:99], v[60:63], v[32:35]
  ds_read_b128 v[56:59], v16 offset:9216
  v_lshlrev_b32 v3, 16, v3
  v_mfma_f32_16x16x32_bf16 v[36:39], a[100:103], v[60:63], v[36:39]
  v_sqrt_f32 v3, v3
  v_mfma_f32_16x16x32_bf16 v[40:43], a[104:107], v[60:63], v[40:43]
  s_waitcnt lgkmcnt(1)
  s_barrier
  v_mfma_f32_16x16x32_bf16 v[44:47], a[108:111], v[60:63], v[44:47]
  ds_read_b128 v[68:71], v1 offset:22528
  v_cvt_pk_bf16_f32 v3, v3, v3
  v_mfma_f32_16x16x32_bf16 v[32:35], a[112:115], v[64:67], v[32:35]
  ds_read_b128 v[60:63], v16 offset:10240
  ds_read_b128 v[72:75], v1 offset:23552
  v_lshlrev_b32 v3, 16, v3
  v_mfma_f32_16x16x32_bf16 v[36:39], a[116:119], v[64:67], v[36:39]
  ds_read_b128 v[76:79], v1 offset:24576
  v_rcp_f32 v3, v3
  v_mfma_f32_16x16x32_bf16 v[40:43], a[120:123], v[64:67], v[40:43]
  ds_read_b128 v[80:83], v1 offset:25600
  v_mfma_f32_16x16x32_bf16 v[44:47], a[124:127], v[64:67], v[44:47]
  v_mul_f32 v4, v3, v3
  v_mfma_f32_16x16x32_bf16 v[32:35], a[128:131], v[52:55], v[32:35]
  ds_read_b128 v[64:67], v16 offset:11264
  v_mul_f32 v3, s54, v3
  v_mfma_f32_16x16x32_bf16 v[36:39], a[132:135], v[52:55], v[36:39]
  v_mfma_f32_16x16x32_bf16 v[40:43], a[136:139], v[52:55], v[40:43]
  s_waitcnt lgkmcnt(3)
  v_add_f32 v68, v68, v72
  v_add_f32 v69, v69, v73
  v_mfma_f32_16x16x32_bf16 v[44:47], a[140:143], v[52:55], v[44:47]
  v_add_f32 v70, v70, v74
  v_add_f32 v71, v71, v75
  v_mfma_f32_16x16x32_bf16 v[32:35], a[144:147], v[56:59], v[32:35]
  ds_read_b128 v[52:55], v16 offset:12288
  v_mul_f32 v72, v68, v3
  v_mfma_f32_16x16x32_bf16 v[36:39], a[148:151], v[56:59], v[36:39]
  v_mul_f32 v73, v69, v3
  v_mul_f32 v74, v70, v3
  v_mfma_f32_16x16x32_bf16 v[40:43], a[152:155], v[56:59], v[40:43]
  v_mul_f32 v75, v71, v3
  v_mfma_f32_16x16x32_bf16 v[44:47], a[156:159], v[56:59], v[44:47]
  v_exp_f32 v72, v72
  v_mfma_f32_16x16x32_bf16 v[32:35], a[160:163], v[60:63], v[32:35]
  ds_read_b128 v[56:59], v16 offset:13312
  v_mfma_f32_16x16x32_bf16 v[36:39], a[164:167], v[60:63], v[36:39]
  v_exp_f32 v73, v73
  v_mfma_f32_16x16x32_bf16 v[40:43], a[168:171], v[60:63], v[40:43]
  v_exp_f32 v74, v74
  v_mfma_f32_16x16x32_bf16 v[44:47], a[172:175], v[60:63], v[44:47]
  v_exp_f32 v75, v75
  s_waitcnt lgkmcnt(2)
  v_mfma_f32_16x16x32_bf16 v[32:35], a[176:179], v[64:67], v[32:35]
  ds_read_b128 v[60:63], v16 offset:14336
  v_add_f32 v76, v76, v80
  v_mfma_f32_16x16x32_bf16 v[36:39], a[180:183], v[64:67], v[36:39]
  v_add_f32 v77, v77, v81
  v_add_f32 v78, v78, v82
  v_mfma_f32_16x16x32_bf16 v[40:43], a[184:187], v[64:67], v[40:43]
  v_add_f32 v79, v79, v83
  v_add_f32 v72, 1.0, v72
  v_mfma_f32_16x16x32_bf16 v[44:47], a[188:191], v[64:67], v[44:47]
  v_add_f32 v73, 1.0, v73
  v_add_f32 v74, 1.0, v74
  s_waitcnt lgkmcnt(2)
  v_mfma_f32_16x16x32_bf16 v[32:35], a[192:195], v[52:55], v[32:35]
  ds_read_b128 v[64:67], v16 offset:15360
  v_add_f32 v75, 1.0, v75
  v_mfma_f32_16x16x32_bf16 v[36:39], a[196:199], v[52:55], v[36:39]
  v_mul_f32 v68, v68, v76
  v_mul_f32 v69, v69, v77
  v_mfma_f32_16x16x32_bf16 v[40:43], a[200:203], v[52:55], v[40:43]
  v_mul_f32 v70, v70, v78
  v_mul_f32 v71, v71, v79
  v_mfma_f32_16x16x32_bf16 v[44:47], a[204:207], v[52:55], v[44:47]
  v_rcp_f32 v72, v72
  s_waitcnt lgkmcnt(2)
  v_mfma_f32_16x16x32_bf16 v[32:35], a[208:211], v[56:59], v[32:35]
  ds_read_b128 v[52:55], v16 offset:16384
  v_mfma_f32_16x16x32_bf16 v[36:39], a[212:215], v[56:59], v[36:39]
  v_rcp_f32 v73, v73
  v_mfma_f32_16x16x32_bf16 v[40:43], a[216:219], v[56:59], v[40:43]
  v_rcp_f32 v74, v74
  v_mfma_f32_16x16x32_bf16 v[44:47], a[220:223], v[56:59], v[44:47]
  v_rcp_f32 v75, v75
  s_waitcnt lgkmcnt(2)
  v_mfma_f32_16x16x32_bf16 v[32:35], a[224:227], v[60:63], v[32:35]
  ds_read_b128 v[56:59], v16 offset:17408
  v_mul_f32 v68, v68, v4
  v_mfma_f32_16x16x32_bf16 v[36:39], a[228:231], v[60:63], v[36:39]
  v_mul_f32 v69, v69, v4
  v_mul_f32 v70, v70, v4
  v_mfma_f32_16x16x32_bf16 v[40:43], a[232:235], v[60:63], v[40:43]
  v_mul_f32 v71, v71, v4
  v_mul_f32 v68, v68, v72
  v_mfma_f32_16x16x32_bf16 v[44:47], a[236:239], v[60:63], v[44:47]
  v_mul_f32 v69, v69, v73
  v_mul_f32 v70, v70, v74
  s_waitcnt lgkmcnt(2)
  v_mfma_f32_16x16x32_bf16 v[32:35], a[240:243], v[64:67], v[32:35]
  v_mul_f32 v71, v71, v75
  v_mfma_f32_16x16x32_bf16 v[36:39], a[244:247], v[64:67], v[36:39]
  v_cvt_pk_bf16_f32 v84, v68, v69
  v_cvt_pk_bf16_f32 v85, v70, v71
  v_mfma_f32_16x16x32_bf16 v[40:43], a[248:251], v[64:67], v[40:43]
  v_mfma_f32_16x16x32_bf16 v[44:47], a[252:255], v[64:67], v[44:47]
  s_waitcnt lgkmcnt(1)
  v_mfma_f32_16x16x32_bf16 v[32:35], v[188:191], v[52:55], v[32:35]
  v_mfma_f32_16x16x32_bf16 v[36:39], v[192:195], v[52:55], v[36:39]
  v_mfma_f32_16x16x32_bf16 v[40:43], v[196:199], v[52:55], v[40:43]
  v_mfma_f32_16x16x32_bf16 v[44:47], v[200:203], v[52:55], v[44:47]
  s_waitcnt lgkmcnt(0)
  v_mfma_f32_16x16x32_bf16 v[32:35], v[204:207], v[56:59], v[32:35]
  v_mfma_f32_16x16x32_bf16 v[36:39], v[208:211], v[56:59], v[36:39]
  v_mfma_f32_16x16x32_bf16 v[40:43], v[212:215], v[56:59], v[40:43]
  v_mfma_f32_16x16x32_bf16 v[44:47], v[216:219], v[56:59], v[44:47]
  s_cmp_eq_u32 s67, 0
  s_cbranch_scc1 FF_nl
  s_add_u32 s46, s62, 0
  buffer_load_dwordx4 v[52:55], v12, s[4:7], s46 offen sc1
  s_add_u32 s46, s62, 74752
  buffer_load_dwordx4 v[56:59], v12, s[4:7], s46 offen sc1
  s_add_u32 s46, s62, 149504
  buffer_load_dwordx4 v[60:63], v12, s[4:7], s46 offen sc1
  s_add_u32 s46, s62, 224256
  buffer_load_dwordx4 v[64:67], v12, s[4:7], s46 offen sc1
  s_add_u32 s46, s62, 299008
  buffer_load_dwordx4 v[68:71], v12, s[4:7], s46 offen sc1
  s_add_u32 s46, s62, 373760
  buffer_load_dwordx4 v[72:75], v12, s[4:7], s46 offen sc1
  s_add_u32 s46, s62, 448512
  buffer_load_dwordx4 v[76:79], v12, s[4:7], s46 offen sc1
  s_add_u32 s46, s62, 523264
  buffer_load_dwordx4 v[80:83], v12, s[4:7], s46 offen sc1
FF_nl:
  v_pk_fma_f32 v[32:33], v[2:3], v[102:103], v[32:33] op_sel_hi:[0,1,1]
  v_pk_fma_f32 v[34:35], v[2:3], v[104:105], v[34:35] op_sel_hi:[0,1,1]
  v_pk_fma_f32 v[36:37], v[2:3], v[106:107], v[36:37] op_sel_hi:[0,1,1]
  v_pk_fma_f32 v[38:39], v[2:3], v[108:109], v[38:39] op_sel_hi:[0,1,1]
  v_pk_fma_f32 v[40:41], v[2:3], v[110:111], v[40:41] op_sel_hi:[0,1,1]
  v_pk_fma_f32 v[42:43], v[2:3], v[112:113], v[42:43] op_sel_hi:[0,1,1]
  v_pk_fma_f32 v[44:45], v[2:3], v[114:115], v[44:45] op_sel_hi:[0,1,1]
  v_pk_fma_f32 v[46:47], v[2:3], v[116:117], v[46:47] op_sel_hi:[0,1,1]
  v_pk_mul_f32 v[86:87], v[32:33], v[2:3] op_sel:[0,1] op_sel_hi:[1,1]
  v_pk_mul_f32 v[88:89], v[34:35], v[2:3] op_sel:[0,1] op_sel_hi:[1,1]
  v_pk_mul_f32 v[90:91], v[36:37], v[2:3] op_sel:[0,1] op_sel_hi:[1,1]
  v_pk_mul_f32 v[92:93], v[38:39], v[2:3] op_sel:[0,1] op_sel_hi:[1,1]
  v_exp_f32 v86, v86
  v_exp_f32 v87, v87
  v_pk_mul_f32 v[32:33], v[32:33], v[40:41]
  v_exp_f32 v88, v88
  v_exp_f32 v89, v89
  v_pk_mul_f32 v[34:35], v[34:35], v[42:43]
  v_exp_f32 v90, v90
  v_exp_f32 v91, v91
  v_pk_mul_f32 v[36:37], v[36:37], v[44:45]
  v_exp_f32 v92, v92
  v_exp_f32 v93, v93
  v_pk_mul_f32 v[38:39], v[38:39], v[46:47]
  v_pk_add_f32 v[86:87], v[86:87], 1.0 op_sel_hi:[1,0]
  v_pk_add_f32 v[88:89], v[88:89], 1.0 op_sel_hi:[1,0]
  v_pk_add_f32 v[90:91], v[90:91], 1.0 op_sel_hi:[1,0]
  v_pk_add_f32 v[92:93], v[92:93], 1.0 op_sel_hi:[1,0]
  v_rcp_f32 v86, v86
  v_rcp_f32 v87, v87
  v_pk_mul_f32 v[32:33], v[32:33], v[4:5] op_sel_hi:[1,0]
  v_rcp_f32 v88, v88
  v_rcp_f32 v89, v89
  v_pk_mul_f32 v[34:35], v[34:35], v[4:5] op_sel_hi:[1,0]
  v_rcp_f32 v90, v90
  v_rcp_f32 v91, v91
  v_pk_mul_f32 v[36:37], v[36:37], v[4:5] op_sel_hi:[1,0]
  v_rcp_f32 v92, v92
  v_rcp_f32 v93, v93
  v_pk_mul_f32 v[38:39], v[38:39], v[4:5] op_sel_hi:[1,0]
  v_pk_mul_f32 v[32:33], v[32:33], v[86:87]
  v_pk_mul_f32 v[34:35], v[34:35], v[88:89]
  v_pk_mul_f32 v[36:37], v[36:37], v[90:91]
  v_pk_mul_f32 v[38:39], v[38:39], v[92:93]
  v_cvt_pk_bf16_f32 v32, v32, v33
  v_cvt_pk_bf16_f32 v33, v34, v35
  v_cvt_pk_bf16_f32 v34, v36, v37
  v_cvt_pk_bf16_f32 v35, v38, v39
  ds_write_b128 v19, v[32:35] offset:18432
  ds_read_b128 v[86:89], v14 offset:0
  ds_read_b128 v[90:93], v14 offset:4096
  ds_read_b128 v[94:97], v14 offset:1024
  ds_read_b128 v[98:101], v14 offset:5120
  s_cmp_eq_u32 s67, 0
  s_cbranch_scc1 FF_nr
FF_rs:
  s_waitcnt vmcnt(7)
  v_mfma_f32_16x16x32_bf16 v[28:31], v[24:27], v[52:55], 0
  v_bitop3_b32 v7, v52, v53, s65 bitop3:0x7e
  v_bitop3_b32 v8, v54, v55, s65 bitop3:0x7e
  v_or_b32 v17, v7, v8
  s_waitcnt vmcnt(6)
  v_mfma_f32_16x16x32_bf16 v[28:31], v[24:27], v[56:59], v[28:31]
  v_bitop3_b32 v7, v56, v57, s65 bitop3:0x7e
  v_bitop3_b32 v8, v58, v59, s65 bitop3:0x7e
  v_or3_b32 v17, v17, v7, v8
  s_waitcnt vmcnt(5)
  v_mfma_f32_16x16x32_bf16 v[28:31], v[24:27], v[60:63], v[28:31]
  v_bitop3_b32 v7, v60, v61, s65 bitop3:0x7e
  v_bitop3_b32 v8, v62, v63, s65 bitop3:0x7e
  v_or3_b32 v17, v17, v7, v8
  s_waitcnt vmcnt(4)
  v_mfma_f32_16x16x32_bf16 v[28:31], v[24:27], v[64:67], v[28:31]
  v_bitop3_b32 v7, v64, v65, s65 bitop3:0x7e
  v_bitop3_b32 v8, v66, v67, s65 bitop3:0x7e
  v_or3_b32 v17, v17, v7, v8
  s_waitcnt vmcnt(3)
  v_mfma_f32_16x16x32_bf16 v[28:31], v[24:27], v[68:71], v[28:31]
  v_bitop3_b32 v7, v68, v69, s65 bitop3:0x7e
  v_bitop3_b32 v8, v70, v71, s65 bitop3:0x7e
  v_or3_b32 v17, v17, v7, v8
  s_waitcnt vmcnt(2)
  v_mfma_f32_16x16x32_bf16 v[28:31], v[24:27], v[72:75], v[28:31]
  v_bitop3_b32 v7, v72, v73, s65 bitop3:0x7e
  v_bitop3_b32 v8, v74, v75, s65 bitop3:0x7e
  v_or3_b32 v17, v17, v7, v8
  s_waitcnt vmcnt(1)
  v_mfma_f32_16x16x32_bf16 v[28:31], v[24:27], v[76:79], v[28:31]
  v_bitop3_b32 v7, v76, v77, s65 bitop3:0x7e
  v_bitop3_b32 v8, v78, v79, s65 bitop3:0x7e
  v_or3_b32 v17, v17, v7, v8
  s_waitcnt vmcnt(0)
  v_mfma_f32_16x16x32_bf16 v[28:31], v[24:27], v[80:83], v[28:31]
  v_bitop3_b32 v7, v80, v81, s65 bitop3:0x7e
  v_bitop3_b32 v8, v82, v83, s65 bitop3:0x7e
  v_or3_b32 v17, v17, v7, v8
  v_and_b32 v17, 1, v17
  v_cmp_ne_u32 vcc, 0, v17
  s_cbranch_vccnz FF_ra
  s_nop 1
  v_cvt_pk_bf16_f32 v28, v28, v29
  v_cvt_pk_bf16_f32 v29, v30, v31
  v_lshlrev_b32 v52, 16, v28
  v_and_b32 v53, 0xffff0000, v28
  v_lshlrev_b32 v54, 16, v22
  v_and_b32 v55, 0xffff0000, v22
  v_pk_add_f32 v[52:53], v[52:53], v[54:55]
  v_cvt_pk_bf16_f32 v28, v52, v53
  v_lshlrev_b32 v52, 16, v29
  v_and_b32 v53, 0xffff0000, v29
  v_lshlrev_b32 v54, 16, v23
  v_and_b32 v55, 0xffff0000, v23
  v_pk_add_f32 v[52:53], v[52:53], v[54:55]
  v_cvt_pk_bf16_f32 v29, v52, v53
  v_permlane16_swap_b32 v28, v30
  s_nop 0
  v_permlane16_swap_b32 v29, v31
  buffer_store_dwordx4 v[28:31], v10, s[8:11], s56 offen
  s_add_u32 s56, s56, s72
  s_xor_b32 s62, s62, 2097152
  s_mov_b32 s67, 0
FF_nr:
  s_waitcnt lgkmcnt(4)
  s_barrier
  ds_read_b128 v[68:71], v1 offset:18432
  ds_read_b128 v[72:75], v1 offset:19456
  ds_read_b128 v[76:79], v1 offset:20480
  ds_read_b128 v[80:83], v1 offset:21504
  ds_read_b64 v[22:23], v13
  v_mfma_f32_16x16x16_bf16 v[32:35], v[170:171], v[84:85], 0
  v_mfma_f32_16x16x16_bf16 v[36:39], v[172:173], v[84:85], 0
  s_cmp_lt_u32 s44, 2
  s_cbranch_scc0 FFd_244
  s_add_u32 m0, s69, 16384
  s_add_u32 s46, s52, 16384
  buffer_load_dwordx4 v1, s[4:7], s46 offen sc1 lds
FFd_244:
  v_mfma_f32_16x16x16_bf16 v[40:43], v[174:175], v[84:85], 0
  v_mfma_f32_16x16x16_bf16 v[44:47], v[176:177], v[84:85], 0
  v_mfma_f32_16x16x16_bf16 v[48:51], v[178:179], v[84:85], 0
  v_mfma_f32_16x16x16_bf16 v[52:55], v[180:181], v[84:85], 0
  v_mfma_f32_16x16x16_bf16 v[56:59], v[182:183], v[84:85], 0
  s_add_u32 m0, s69, 0
  s_add_u32 s46, s52, 0
  buffer_load_dwordx4 v1, s[4:7], s46 offen sc1 lds
  v_mfma_f32_16x16x16_bf16 v[60:63], v[184:185], v[84:85], 0
  v_mfma_f32_16x16x16_bf16 v[64:67], v[186:187], v[84:85], 0
  s_waitcnt lgkmcnt(4)
  v_mfma_f32_16x16x32_bf16 v[32:35], v[122:125], v[68:71], v[32:35]
  s_add_u32 m0, s69, 4096
  s_add_u32 s46, s52, 4096
  buffer_load_dwordx4 v1, s[4:7], s46 offen sc1 lds
  v_mfma_f32_16x16x32_bf16 v[36:39], v[86:89], v[68:71], v[36:39]
  ds_read_b128 v[86:89], v14 offset:2048
  v_mfma_f32_16x16x32_bf16 v[40:43], v[90:93], v[68:71], v[40:43]
  ds_read_b128 v[90:93], v14 offset:6144
  s_waitcnt lgkmcnt(5)
  v_mfma_f32_16x16x32_bf16 v[32:35], v[126:129], v[72:75], v[32:35]
  s_add_u32 m0, s69, 8192
  s_add_u32 s46, s52, 8192
  buffer_load_dwordx4 v1, s[4:7], s46 offen sc1 lds
  v_xor_b32 v16, 131072, v16
  v_xor_b32 v20, 131072, v20
  v_xor_b32 v13, 131072, v13
  v_mfma_f32_16x16x32_bf16 v[36:39], v[94:97], v[72:75], v[36:39]
  ds_read_b128 v[94:97], v14 offset:3072
  v_mfma_f32_16x16x32_bf16 v[40:43], v[98:101], v[72:75], v[40:43]
  ds_read_b128 v[98:101], v14 offset:7168
  s_waitcnt lgkmcnt(6)
  v_mfma_f32_16x16x32_bf16 v[32:35], v[130:133], v[76:79], v[32:35]
  s_add_u32 m0, s69, 12288
  s_add_u32 s46, s52, 12288
  buffer_load_dwordx4 v1, s[4:7], s46 offen sc1 lds
  s_waitcnt lgkmcnt(3)
  v_mfma_f32_16x16x32_bf16 v[36:39], v[86:89], v[76:79], v[36:39]
  ds_read_b128 v[86:89], v14 offset:8192
  s_waitcnt lgkmcnt(3)
  v_mfma_f32_16x16x32_bf16 v[40:43], v[90:93], v[76:79], v[40:43]
  ds_read_b128 v[90:93], v14 offset:12288
  v_mfma_f32_16x16x32_bf16 v[32:35], v[134:137], v[80:83], v[32:35]
  s_waitcnt lgkmcnt(3)
  v_mfma_f32_16x16x32_bf16 v[36:39], v[94:97], v[80:83], v[36:39]
  ds_read_b128 v[94:97], v14 offset:9216
  s_waitcnt lgkmcnt(3)
  v_mfma_f32_16x16x32_bf16 v[40:43], v[98:101], v[80:83], v[40:43]
  ds_read_b128 v[98:101], v14 offset:13312
  v_mfma_f32_16x16x32_bf16 v[44:47], v[138:141], v[68:71], v[44:47]
  s_waitcnt lgkmcnt(3)
  v_mfma_f32_16x16x32_bf16 v[48:51], v[86:89], v[68:71], v[48:51]
  ds_read_b128 v[86:89], v14 offset:10240
  s_waitcnt lgkmcnt(3)
  v_mfma_f32_16x16x32_bf16 v[52:55], v[90:93], v[68:71], v[52:55]
  ds_read_b128 v[90:93], v14 offset:14336
  v_mfma_f32_16x16x32_bf16 v[44:47], v[142:145], v[72:75], v[44:47]
  v_cvt_pk_bf16_f32 v32, v32, v33
  v_cvt_pk_bf16_f32 v33, v34, v35
  v_cvt_pk_bf16_f32 v34, v36, v37
  s_waitcnt lgkmcnt(3)
  v_mfma_f32_16x16x32_bf16 v[48:51], v[94:97], v[72:75], v[48:51]
  ds_read_b128 v[94:97], v14 offset:11264
  v_cvt_pk_bf16_f32 v35, v38, v39
  v_bfi_b32 v32, 1, s64, v32
  s_waitcnt lgkmcnt(3)
  v_mfma_f32_16x16x32_bf16 v[52:55], v[98:101], v[72:75], v[52:55]
  ds_read_b128 v[98:101], v14 offset:15360
  v_bfi_b32 v33, 1, s64, v33
  v_bfi_b32 v34, 1, s64, v34
  v_mfma_f32_16x16x32_bf16 v[44:47], v[146:149], v[76:79], v[44:47]
  v_bfi_b32 v35, 1, s64, v35
  buffer_store_dwordx4 v[32:35], v1, s[4:7], s61 offen offset:0 sc1
  s_waitcnt lgkmcnt(3)
  v_mfma_f32_16x16x32_bf16 v[48:51], v[86:89], v[76:79], v[48:51]
  ds_read_b128 v[86:89], v14 offset:16384
  s_waitcnt lgkmcnt(3)
  v_mfma_f32_16x16x32_bf16 v[52:55], v[90:93], v[76:79], v[52:55]
  ds_read_b128 v[90:93], v14 offset:20480
  v_mfma_f32_16x16x32_bf16 v[44:47], v[150:153], v[80:83], v[44:47]
  s_waitcnt lgkmcnt(3)
  v_mfma_f32_16x16x32_bf16 v[48:51], v[94:97], v[80:83], v[48:51]
  ds_read_b128 v[94:97], v14 offset:17408
  s_waitcnt lgkmcnt(3)
  v_mfma_f32_16x16x32_bf16 v[52:55], v[98:101], v[80:83], v[52:55]
  ds_read_b128 v[98:101], v14 offset:21504
  v_mfma_f32_16x16x32_bf16 v[56:59], v[154:157], v[68:71], v[56:59]
  s_waitcnt lgkmcnt(3)
  v_mfma_f32_16x16x32_bf16 v[60:63], v[86:89], v[68:71], v[60:63]
  ds_read_b128 v[86:89], v14 offset:18432
  s_waitcnt lgkmcnt(3)
  v_mfma_f32_16x16x32_bf16 v[64:67], v[90:93], v[68:71], v[64:67]
  ds_read_b128 v[90:93], v14 offset:22528
  v_mfma_f32_16x16x32_bf16 v[56:59], v[158:161], v[72:75], v[56:59]
  v_cvt_pk_bf16_f32 v40, v40, v41
  v_cvt_pk_bf16_f32 v41, v42, v43
  v_cvt_pk_bf16_f32 v42, v44, v45
  s_waitcnt lgkmcnt(3)
  v_mfma_f32_16x16x32_bf16 v[60:63], v[94:97], v[72:75], v[60:63]
  ds_read_b128 v[94:97], v14 offset:19456
  v_cvt_pk_bf16_f32 v43, v46, v47
  v_bfi_b32 v40, 1, s64, v40
  s_waitcnt lgkmcnt(3)
  v_mfma_f32_16x16x32_bf16 v[64:67], v[98:101], v[72:75], v[64:67]
  ds_read_b128 v[98:101], v14 offset:23552
  v_bfi_b32 v41, 1, s64, v41
  v_bfi_b32 v42, 1, s64, v42
  v_mfma_f32_16x16x32_bf16 v[56:59], v[162:165], v[76:79], v[56:59]
  v_bfi_b32 v43, 1, s64, v43
  buffer_store_dwordx4 v[40:43], v1, s[4:7], s61 offen offset:1024 sc1
  v_cvt_pk_bf16_f32 v48, v48, v49
  s_waitcnt lgkmcnt(3)
  v_mfma_f32_16x16x32_bf16 v[60:63], v[86:89], v[76:79], v[60:63]
  v_cvt_pk_bf16_f32 v49, v50, v51
  v_cvt_pk_bf16_f32 v50, v52, v53
  s_waitcnt lgkmcnt(2)
  v_mfma_f32_16x16x32_bf16 v[64:67], v[90:93], v[76:79], v[64:67]
  v_cvt_pk_bf16_f32 v51, v54, v55
  v_bfi_b32 v48, 1, s64, v48
  v_mfma_f32_16x16x32_bf16 v[56:59], v[166:169], v[80:83], v[56:59]
  v_bfi_b32 v49, 1, s64, v49
  v_bfi_b32 v50, 1, s64, v50
  v_bfi_b32 v51, 1, s64, v51
  s_waitcnt lgkmcnt(1)
  v_mfma_f32_16x16x32_bf16 v[60:63], v[94:97], v[80:83], v[60:63]
  buffer_store_dwordx4 v[48:51], v1, s[4:7], s61 offen offset:2048 sc1
  s_waitcnt lgkmcnt(0)
  v_mfma_f32_16x16x32_bf16 v[64:67], v[98:101], v[80:83], v[64:67]
  v_cvt_pk_bf16_f32 v56, v56, v57
  v_cvt_pk_bf16_f32 v57, v58, v59
  s_nop 1
  v_cvt_pk_bf16_f32 v58, v60, v61
  v_cvt_pk_bf16_f32 v59, v62, v63
  v_bfi_b32 v56, 1, s64, v56
  v_bfi_b32 v57, 1, s64, v57
  v_bfi_b32 v58, 1, s64, v58
  v_bfi_b32 v59, 1, s64, v59
  buffer_store_dwordx4 v[56:59], v1, s[4:7], s61 offen offset:3072 sc1
  v_cvt_pk_bf16_f32 v64, v64, v65
  v_cvt_pk_bf16_f32 v65, v66, v67
  v_bfi_b32 v64, 1, s64, v64
  v_bfi_b32 v65, 1, s64, v65
  buffer_store_dwordx2 v[64:65], v11, s[4:7], s61 offen sc1
  s_xor_b32 s61, s61, 2097152
  s_mov_b32 s65, s64
  s_add_u32 s66, s66, 1
  s_lshr_b32 s64, s66, 1
  s_cmp_lt_u32 s63, 72
  s_cselect_b32 s67, 1, 0
  s_mov_b32 s72, s71
  s_cmp_lt_u32 s51, 128
  s_cbranch_scc0 FF_wait
  s_waitcnt vmcnt(5)
  s_branch FF_loop
FF_wait:
  s_cmp_eq_u32 s67, 0
  s_cbranch_scc1 FF_w2
  s_add_u32 s46, s62, 0
  buffer_load_dwordx4 v[52:55], v12, s[4:7], s46 offen sc1
  s_add_u32 s46, s62, 74752
  buffer_load_dwordx4 v[56:59], v12, s[4:7], s46 offen sc1
  s_add_u32 s46, s62, 149504
  buffer_load_dwordx4 v[60:63], v12, s[4:7], s46 offen sc1
  s_add_u32 s46, s62, 224256
  buffer_load_dwordx4 v[64:67], v12, s[4:7], s46 offen sc1
  s_add_u32 s46, s62, 299008
  buffer_load_dwordx4 v[68:71], v12, s[4:7], s46 offen sc1
  s_add_u32 s46, s62, 373760
  buffer_load_dwordx4 v[72:75], v12, s[4:7], s46 offen sc1
  s_add_u32 s46, s62, 448512
  buffer_load_dwordx4 v[76:79], v12, s[4:7], s46 offen sc1
  s_add_u32 s46, s62, 523264
  buffer_load_dwordx4 v[80:83], v12, s[4:7], s46 offen sc1
  s_cmp_lt_u32 s44, 2
  s_cbranch_scc0 FFv_246
  s_add_u32 m0, s69, 16384
  s_add_u32 s46, s52, 16384
  buffer_load_dwordx4 v1, s[4:7], s46 offen sc1 lds
FFv_246:
  s_add_u32 m0, s69, 0
  s_add_u32 s46, s52, 0
  buffer_load_dwordx4 v1, s[4:7], s46 offen sc1 lds
  s_add_u32 m0, s69, 4096
  s_add_u32 s46, s52, 4096
  buffer_load_dwordx4 v1, s[4:7], s46 offen sc1 lds
  s_add_u32 m0, s69, 8192
  s_add_u32 s46, s52, 8192
  buffer_load_dwordx4 v1, s[4:7], s46 offen sc1 lds
  s_add_u32 m0, s69, 12288
  s_add_u32 s46, s52, 12288
  buffer_load_dwordx4 v1, s[4:7], s46 offen sc1 lds
  s_waitcnt vmcnt(4)
FF_w1:
  v_mfma_f32_16x16x32_bf16 v[28:31], v[24:27], v[52:55], 0
  v_bitop3_b32 v7, v52, v53, s65 bitop3:0x7e
  v_bitop3_b32 v8, v54, v55, s65 bitop3:0x7e
  v_bitop3_b32 v7, v7, v8, 1 bitop3:0xa8
  v_cmp_ne_u32 s[16:17], 0, v7
  v_mfma_f32_16x16x32_bf16 v[28:31], v[24:27], v[56:59], v[28:31]
  v_bitop3_b32 v7, v56, v57, s65 bitop3:0x7e
  v_bitop3_b32 v8, v58, v59, s65 bitop3:0x7e
  v_bitop3_b32 v7, v7, v8, 1 bitop3:0xa8
  v_cmp_ne_u32 s[18:19], 0, v7
  v_mfma_f32_16x16x32_bf16 v[28:31], v[24:27], v[60:63], v[28:31]
  v_bitop3_b32 v7, v60, v61, s65 bitop3:0x7e
  v_bitop3_b32 v8, v62, v63, s65 bitop3:0x7e
  s_or_b64 s[36:37], s[18:19], s[16:17]
  v_bitop3_b32 v7, v7, v8, 1 bitop3:0xa8
  v_cmp_ne_u32 s[20:21], 0, v7
  v_mfma_f32_16x16x32_bf16 v[28:31], v[24:27], v[64:67], v[28:31]
  v_bitop3_b32 v7, v64, v65, s65 bitop3:0x7e
  v_bitop3_b32 v8, v66, v67, s65 bitop3:0x7e
  s_or_b64 s[36:37], s[20:21], s[36:37]
  v_bitop3_b32 v7, v7, v8, 1 bitop3:0xa8
  v_cmp_ne_u32 s[22:23], 0, v7
  v_mfma_f32_16x16x32_bf16 v[28:31], v[24:27], v[68:71], v[28:31]
  v_bitop3_b32 v7, v68, v69, s65 bitop3:0x7e
  v_bitop3_b32 v8, v70, v71, s65 bitop3:0x7e
  s_or_b64 s[36:37], s[22:23], s[36:37]
  v_bitop3_b32 v7, v7, v8, 1 bitop3:0xa8
  v_cmp_ne_u32 s[24:25], 0, v7
  v_mfma_f32_16x16x32_bf16 v[28:31], v[24:27], v[72:75], v[28:31]
  v_bitop3_b32 v7, v72, v73, s65 bitop3:0x7e
  v_bitop3_b32 v8, v74, v75, s65 bitop3:0x7e
  s_or_b64 s[36:37], s[24:25], s[36:37]
  v_bitop3_b32 v7, v7, v8, 1 bitop3:0xa8
  v_cmp_ne_u32 s[26:27], 0, v7
  v_mfma_f32_16x16x32_bf16 v[28:31], v[24:27], v[76:79], v[28:31]
  v_bitop3_b32 v7, v76, v77, s65 bitop3:0x7e
  v_bitop3_b32 v8, v78, v79, s65 bitop3:0x7e
  s_or_b64 s[36:37], s[26:27], s[36:37]
  v_bitop3_b32 v7, v7, v8, 1 bitop3:0xa8
  v_cmp_ne_u32 s[32:33], 0, v7
  v_mfma_f32_16x16x32_bf16 v[28:31], v[24:27], v[80:83], v[28:31]
  v_bitop3_b32 v7, v80, v81, s65 bitop3:0x7e
  v_bitop3_b32 v8, v82, v83, s65 bitop3:0x7e
  s_or_b64 s[36:37], s[32:33], s[36:37]
  v_bitop3_b32 v7, v7, v8, 1 bitop3:0xa8
  v_cmp_ne_u32 s[34:35], 0, v7
  s_or_b64 s[36:37], s[36:37], s[34:35]
  s_cbranch_scc1 FF_wa
  s_nop 0
  v_cvt_pk_bf16_f32 v28, v28, v29
  v_cvt_pk_bf16_f32 v29, v30, v31
  v_lshlrev_b32 v52, 16, v28
  v_and_b32 v53, 0xffff0000, v28
  v_lshlrev_b32 v54, 16, v22
  v_and_b32 v55, 0xffff0000, v22
  v_pk_add_f32 v[52:53], v[52:53], v[54:55]
  v_cvt_pk_bf16_f32 v28, v52, v53
  v_lshlrev_b32 v52, 16, v29
  v_and_b32 v53, 0xffff0000, v29
  v_lshlrev_b32 v54, 16, v23
  v_and_b32 v55, 0xffff0000, v23
  v_pk_add_f32 v[52:53], v[52:53], v[54:55]
  v_cvt_pk_bf16_f32 v29, v52, v53
  v_permlane16_swap_b32 v28, v30
  s_nop 0
  v_permlane16_swap_b32 v29, v31
  buffer_store_dwordx4 v[28:31], v10, s[8:11], s56 offen
  s_add_u32 s56, s56, s72
  s_xor_b32 s62, s62, 2097152
  s_mov_b32 s67, 0
  s_cmp_lt_u32 s51, 128
  s_cbranch_scc0 K_end
  s_waitcnt vmcnt(1)
  s_branch FF_loop
FF_w2:
  s_cmp_lt_u32 s51, 128
  s_cbranch_scc0 K_end
  s_cmp_lt_u32 s44, 2
  s_cbranch_scc0 FFw_247
  s_add_u32 m0, s69, 16384
  s_add_u32 s46, s52, 16384
  buffer_load_dwordx4 v1, s[4:7], s46 offen sc1 lds
FFw_247:
  s_add_u32 m0, s69, 0
  s_add_u32 s46, s52, 0
  buffer_load_dwordx4 v1, s[4:7], s46 offen sc1 lds
  s_add_u32 m0, s69, 4096
  s_add_u32 s46, s52, 4096
  buffer_load_dwordx4 v1, s[4:7], s46 offen sc1 lds
  s_add_u32 m0, s69, 8192
  s_add_u32 s46, s52, 8192
  buffer_load_dwordx4 v1, s[4:7], s46 offen sc1 lds
  s_add_u32 m0, s69, 12288
  s_add_u32 s46, s52, 12288
  buffer_load_dwordx4 v1, s[4:7], s46 offen sc1 lds
  s_sub_u32 s50, s50, 1
  s_cbranch_scc1 K_end
  s_waitcnt vmcnt(0)
  s_branch FF_loop
FF_ra:
  s_add_u32 s46, s62, 0
  buffer_load_dwordx4 v[52:55], v12, s[4:7], s46 offen sc1
  s_add_u32 s46, s62, 74752
  buffer_load_dwordx4 v[56:59], v12, s[4:7], s46 offen sc1
  s_add_u32 s46, s62, 149504
  buffer_load_dwordx4 v[60:63], v12, s[4:7], s46 offen sc1
  s_add_u32 s46, s62, 224256
  buffer_load_dwordx4 v[64:67], v12, s[4:7], s46 offen sc1
  s_add_u32 s46, s62, 299008
  buffer_load_dwordx4 v[68:71], v12, s[4:7], s46 offen sc1
  s_add_u32 s46, s62, 373760
  buffer_load_dwordx4 v[72:75], v12, s[4:7], s46 offen sc1
  s_add_u32 s46, s62, 448512
  buffer_load_dwordx4 v[76:79], v12, s[4:7], s46 offen sc1
  s_add_u32 s46, s62, 523264
  buffer_load_dwordx4 v[80:83], v12, s[4:7], s46 offen sc1
  s_sub_u32 s50, s50, 1
  s_cbranch_scc1 K_end
  s_waitcnt vmcnt(0)
  s_branch FF_rs
FF_wa:
  s_cmp_lg_u64 s[16:17], 0
  s_cbranch_scc0 FF_wa_0
  s_add_u32 s46, s62, 0
  buffer_load_dwordx4 v[52:55], v12, s[4:7], s46 offen sc1
FF_wa_0:
  s_cmp_lg_u64 s[18:19], 0
  s_cbranch_scc0 FF_wa_1
  s_add_u32 s46, s62, 74752
  buffer_load_dwordx4 v[56:59], v12, s[4:7], s46 offen sc1
FF_wa_1:
  s_cmp_lg_u64 s[20:21], 0
  s_cbranch_scc0 FF_wa_2
  s_add_u32 s46, s62, 149504
  buffer_load_dwordx4 v[60:63], v12, s[4:7], s46 offen sc1
FF_wa_2:
  s_cmp_lg_u64 s[22:23], 0
  s_cbranch_scc0 FF_wa_3
  s_add_u32 s46, s62, 224256
  buffer_load_dwordx4 v[64:67], v12, s[4:7], s46 offen sc1
FF_wa_3:
  s_cmp_lg_u64 s[24:25], 0
  s_cbranch_scc0 FF_wa_4
  s_add_u32 s46, s62, 299008
  buffer_load_dwordx4 v[68:71], v12, s[4:7], s46 offen sc1
FF_wa_4:
  s_cmp_lg_u64 s[26:27], 0
  s_cbranch_scc0 FF_wa_5
  s_add_u32 s46, s62, 373760
  buffer_load_dwordx4 v[72:75], v12, s[4:7], s46 offen sc1
FF_wa_5:
  s_cmp_lg_u64 s[32:33], 0
  s_cbranch_scc0 FF_wa_6
  s_add_u32 s46, s62, 448512
  buffer_load_dwordx4 v[76:79], v12, s[4:7], s46 offen sc1
FF_wa_6:
  s_cmp_lg_u64 s[34:35], 0
  s_cbranch_scc0 FF_wa_7
  s_add_u32 s46, s62, 523264
  buffer_load_dwordx4 v[80:83], v12, s[4:7], s46 offen sc1
FF_wa_7:
  s_sub_u32 s50, s50, 1
  s_cbranch_scc1 K_end
  s_waitcnt vmcnt(0)
  s_branch FF_w1
K_end:
  s_waitcnt vmcnt(0)
K_exit:
s_endpgm
.section .rodata,"a"
.p2align 6
.amdhsa_kernel sequential_preLN__memory_aug_recurrent_mem_tr__swiglu_ffn__prompt_kernel
  .amdhsa_next_free_vgpr 512
  .amdhsa_next_free_sgpr 102
  .amdhsa_accum_offset 256
  .amdhsa_group_segment_fixed_size 0
  .amdhsa_kernarg_size 112
  .amdhsa_user_sgpr_count 2
  .amdhsa_user_sgpr_kernarg_segment_ptr 1
  .amdhsa_system_sgpr_workgroup_id_x 1
.end_amdhsa_kernel
```
